```python
import torch

def _softmax(x, axis=-1):
    return torch.softmax(x, dim=axis)
def _gelu(x):
    return torch.nn.functional.gelu(x, approximate="tanh")
def _silu(x):
    return torch.nn.functional.silu(x)
def _sigmoid(x):
    return torch.sigmoid(x)
def _layernorm(x, axis=-1, eps=1e-5):
    m = x.mean(dim=axis, keepdim=True)
    v = x.var(dim=axis, keepdim=True, unbiased=False)
    return (x - m) / torch.sqrt(v + eps)
def _scatter_add(tgt, idx, src, axis=0):
    return tgt.clone().index_add_(axis, idx, src)
def _segment_sum(src, seg, n):
    out = torch.zeros((n,) + src.shape[1:], dtype=src.dtype)
    return out.index_add_(0, seg, src)
def _pad(x, pw):
    flat = tuple(v for pair in reversed(pw) for v in pair)
    return torch.nn.functional.pad(x, flat)

kernel_name = 'concat_heads__mha_block_cached__gqa_block_cached__near_ridge'

def setup_inputs():

    _w = (lambda a: (lambda t: t.to(torch.bfloat16) if t.is_floating_point() else t)(torch.as_tensor(a)))
    def _A_setup():
        B, Sq, D = 8, 192, 448
        H, Sk, Dh = 16, 512, 256
        return {
            "x": _w((lambda *s: torch.randn(*s, dtype=torch.bfloat16) * 0.8)(B, Sq, D)),
            "k_cache": _w((lambda *s: torch.randn(*s, dtype=torch.bfloat16) * 0.8)(B, H, Sk, Dh)),
            "v_cache": _w((lambda *s: torch.randn(*s, dtype=torch.bfloat16) * 0.05)(B, H, Sk, Dh)),
            "wq": _w((lambda *s: torch.randn(*s, dtype=torch.bfloat16) * 0.8)(D, H * Dh) * (D ** -0.5)),
            "wo": _w((lambda *s: torch.randn(*s, dtype=torch.bfloat16) * 0.05)(H * Dh, D) * ((H * Dh) ** -0.5)),
        }
    _A_in = _A_setup()

    def _B_setup():
        B, Sq, D = 8, 192, 448
        Hq, Hkv, Sk, Dh = 16, 16, 512, 256
        assert Hq % Hkv == 0, (Hq, Hkv)
        return {
            "x": _w((lambda *s: torch.randn(*s, dtype=torch.bfloat16) * 0.8)(B, Sq, D)),
            "k_cache": _w((lambda *s: torch.randn(*s, dtype=torch.bfloat16) * 0.8)(B, Hkv, Sk, Dh)),
            "v_cache": _w((lambda *s: torch.randn(*s, dtype=torch.bfloat16) * 0.05)(B, Hkv, Sk, Dh)),
            "wq": _w((lambda *s: torch.randn(*s, dtype=torch.bfloat16) * 0.8)(D, Hq * Dh) * (D ** -0.5)),
            "wo": _w((lambda *s: torch.randn(*s, dtype=torch.bfloat16) * 0.05)(Hq * Dh, D) * ((Hq * Dh) ** -0.5)),
        }
    _B_in = _B_setup()

    return {
        "A_x": _A_in["x"],
        "A_k_cache": _A_in["k_cache"],
        "A_v_cache": _A_in["v_cache"],
        "A_wq": _A_in["wq"],
        "A_wo": _A_in["wo"],
        "B_x": _B_in["x"],
        "B_k_cache": _B_in["k_cache"],
        "B_v_cache": _B_in["v_cache"],
        "B_wq": _B_in["wq"],
        "B_wo": _B_in["wo"],
    }

def reference(A_x, A_k_cache, A_v_cache, A_wq, A_wo, B_x, B_k_cache, B_v_cache, B_wq, B_wo):
    def _A_ref(x, k_cache, v_cache, wq, wo):
        B, Sq, D = x.shape
        H, Dh = 16, 256
        q = (lambda x, *d: x.permute(*d))((x @ wq).reshape(B, Sq, H, Dh), 0, 2, 1, 3)
        scores = torch.einsum("bhqd,bhkd->bhqk", q, k_cache) * (Dh ** -0.5)
        p = _softmax(scores, axis=-1)
        o = torch.einsum("bhqk,bhkd->bhqd", p, v_cache)
        return (lambda x, *d: x.permute(*d))(o, 0, 2, 1, 3).reshape(B, Sq, H * Dh) @ wo

    def _B_ref(x, k_cache, v_cache, wq, wo):
        B, Sq, D = x.shape
        Hq, Dh = 16, 256
        Hkv = k_cache.shape[1]
        rep = Hq // Hkv
        q = (lambda x, *d: x.permute(*d))((x @ wq).reshape(B, Sq, Hq, Dh), 0, 2, 1, 3)
        k = (lambda x, n, axis: torch.repeat_interleave(x, n, dim=axis))(k_cache, rep, axis=1)
        v = (lambda x, n, axis: torch.repeat_interleave(x, n, dim=axis))(v_cache, rep, axis=1)
        scores = torch.einsum("bhqd,bhkd->bhqk", q, k) * (Dh ** -0.5)
        p = _softmax(scores, axis=-1)
        o = torch.einsum("bhqk,bhkd->bhqd", p, v)
        return (lambda x, *d: x.permute(*d))(o, 0, 2, 1, 3).reshape(B, Sq, Hq * Dh) @ wo

    a = _A_ref(A_x, A_k_cache, A_v_cache, A_wq, A_wo)
    b = _B_ref(B_x, B_k_cache, B_v_cache, B_wq, B_wo)
    return torch.concatenate([a, b], axis=-1)
```

```asm
; @launch grid=(256,1,1) block=(256,1,1) lds=163840
.amdgcn_target "amdgcn-amd-amdhsa--gfx950"
.text
.globl concat_heads__mha_block_cached__gqa_block_cached__near_ridge_kernel
.p2align 8
.type concat_heads__mha_block_cached__gqa_block_cached__near_ridge_kernel,@function
concat_heads__mha_block_cached__gqa_block_cached__near_ridge_kernel:
    s_cmp_ge_u32 s2, 256
    s_cbranch_scc1 L_end
    s_bfe_u32 s3, s2, 0x10002
    s_mul_i32 s50, s3, 40
    s_load_dwordx8 s[88:95], s[0:1], s50
    s_mov_b32 s7, s50
    s_getpc_b64 s[70:71]
L_pc:
    s_lshr_b32 s51, s2, 3
    s_mul_i32 s51, s51, 2304
    v_min_u32 v210, 17, v0
    v_lshlrev_b32 v210, 7, v210
    s_add_u32 s70, s70, s51
    s_addc_u32 s71, s71, 0
    global_load_dword v239, v210, s[70:71]
    v_lshrrev_b32 v210, 6, v0
    v_and_b32 v204, 63, v0
    v_readfirstlane_b32 s32, v210
    s_and_b32 s5, s2, 3
    s_lshl_b32 s5, s5, 2
    s_bfe_u32 s6, s2, 0x20003
    s_add_u32 s5, s5, s6
    s_lshr_b32 s4, s2, 5
    v_lshrrev_b32 v205, 5, v204
    v_and_b32 v206, 31, v204
    v_lshlrev_b32 v206, 4, v206
    v_lshrrev_b32 v207, 3, v204
    v_lshrrev_b32 v208, 4, v204
    v_and_b32 v209, 7, v204
    s_lshr_b32 s98, s32, 1
    s_and_b32 s99, s32, 1
    v_lshlrev_b32 v210, 1, v208
    v_xor_b32 v210, v210, v209
    v_lshlrev_b32 v210, 4, v210
    s_lshl_b32 s50, s4, 2
    s_add_u32 s50, s50, s32
    s_mul_i32 s50, s50, 43008
    v_mul_u32_u24 v211, 896, v207
    v_add3_u32 v194, v211, v210, s50
    s_lshl_b32 s50, s99, 16
    s_lshl_b32 s51, s5, 9
    s_add_u32 s86, s50, s51
    s_lshl_b32 s51, s98, 15
    s_add_u32 s50, s86, s51
    v_lshlrev_b32 v211, 17, v205
    v_add3_u32 v192, v211, v206, s50
    s_mul_i32 s33, s32, 4224
    s_mul_i32 s35, s32, 6144
    s_mov_b32 s10, 1376256
    s_mov_b32 s11, 0x00020000
    s_mov_b32 s14, 3670016
    s_mov_b32 s15, 0x00020000
    s_mul_i32 s50, s6, 2
    s_add_u32 s50, s50, s4
    s_mul_i32 s51, s50, 37
    s_lshr_b32 s51, s51, 8
    s_mul_i32 s51, s51, 7
    s_sub_u32 s50, s50, s51
    s_mov_b32 s54, 0x06543210
    s_mov_b32 s55, 0x10654321
    s_lshl_b32 s87, s50, 2
    s_lshr_b64 s[54:55], s[54:55], s87
    s_mov_b32 s87, s54
    s_bfe_u32 s50, s87, 262144
    s_lshl_b32 s43, s50, 7
    s_lshl_b32 s36, s50, 19
    s_bfe_u32 s50, s87, 262148
    s_lshl_b32 s44, s50, 7
    s_bfe_u32 s50, s87, 262152
    s_lshl_b32 s45, s50, 7
    s_bfe_u32 s50, s87, 262156
    s_lshl_b32 s46, s50, 7
    s_bfe_u32 s50, s87, 262160
    s_lshl_b32 s47, s50, 7
    s_bfe_u32 s50, s87, 262164
    s_lshl_b32 s48, s50, 7
    s_bfe_u32 s50, s87, 262168
    s_lshl_b32 s49, s50, 7
    s_lshl_b32 s50, s98, 2
    s_lshr_b32 s87, s87, s50
    s_bfe_u32 s50, s87, 262148
    s_lshl_b32 s37, s50, 19
    s_bfe_u32 s50, s87, 262156
    s_lshl_b32 s39, s50, 19
    s_bfe_u32 s50, s87, 262164
    s_lshl_b32 s41, s50, 19
    s_waitcnt lgkmcnt(0)
    s_mov_b64 s[8:9], s[88:89]
    s_mov_b64 s[12:13], s[94:95]
    s_add_u32 m0, s35, 135168
    s_add_u32 s50, s43, 0
    buffer_load_dwordx4 v194, s[8:11], s50 offen lds
    s_add_u32 m0, s35, 136192
    s_add_u32 s50, s43, 7168
    buffer_load_dwordx4 v194, s[8:11], s50 offen lds
    s_add_u32 m0, s35, 137216
    s_add_u32 s50, s43, 14336
    buffer_load_dwordx4 v194, s[8:11], s50 offen lds
    s_add_u32 m0, s35, 138240
    s_add_u32 s50, s43, 21504
    buffer_load_dwordx4 v194, s[8:11], s50 offen lds
    s_add_u32 m0, s35, 139264
    s_add_u32 s50, s43, 28672
    buffer_load_dwordx4 v194, s[8:11], s50 offen lds
    s_add_u32 m0, s35, 140288
    s_add_u32 s50, s43, 35840
    buffer_load_dwordx4 v194, s[8:11], s50 offen lds
    s_add_u32 m0, s33, 0
    s_add_u32 s50, s36, 0
    buffer_load_dwordx4 v192, s[12:15], s50 offen lds
    s_add_u32 m0, s33, 1032
    s_add_u32 s50, s36, 8192
    buffer_load_dwordx4 v192, s[12:15], s50 offen lds
    s_add_u32 m0, s33, 2112
    s_add_u32 s50, s36, 16384
    buffer_load_dwordx4 v192, s[12:15], s50 offen lds
    s_add_u32 m0, s33, 3144
    s_add_u32 s50, s36, 24576
    buffer_load_dwordx4 v192, s[12:15], s50 offen lds
    s_load_dwordx2 s[24:25], s[0:1], s7 offset:32
    s_load_dwordx2 s[76:77], s[0:1], 80
    s_load_dwordx2 s[80:81], s[0:1], 88
    s_load_dwordx2 s[28:29], s[0:1], 96
    s_mov_b64 s[16:17], s[90:91]
    s_mov_b64 s[20:21], s[92:93]
    v_lshrrev_b32 v215, 2, v204
    v_and_b32 v215, 7, v215
    v_and_b32 v214, 3, v204
    v_lshlrev_b32 v210, 10, v215
    v_and_b32 v211, 1, v215
    v_lshl_add_u32 v210, v211, 3, v210
    v_lshrrev_b32 v211, 1, v215
    v_lshl_add_u32 v210, v211, 6, v210
    v_lshl_add_u32 v210, v214, 4, v210
    v_lshl_add_u32 v195, v205, 9, v210
    v_lshl_add_u32 v197, v205, 7, v210
    v_add_u32 v196, 50688, v195
    v_add_u32 v198, 50688, v197
    v_and_b32 v213, 15, v204
    v_lshlrev_b32 v210, 7, v213
    v_and_b32 v211, 6, v204
    v_xor_b32 v211, v211, v208
    v_lshl_add_u32 v210, v211, 4, v210
    s_add_u32 s50, s35, 84480
    v_add_u32 v199, s50, v210
    v_xor_b32 v210, 64, v210
    v_add_u32 v200, s50, v210
    s_mov_b32 s18, 33554432
    s_mov_b32 s19, 0x00020000
    s_mov_b32 s22, 33554432
    s_mov_b32 s23, 0x00020000
    s_mov_b32 s30, 268435456
    s_mov_b32 s31, 0x00020000
    s_mov_b32 s82, 256
    s_mov_b32 s83, 0x00020000
    s_mov_b32 s26, 3670016
    s_mov_b32 s27, 0x00020000
    s_mov_b32 s78, 2752512
    s_mov_b32 s79, 0x00020000
    v_lshlrev_b32 v211, 4, v209
    v_lshl_add_u32 v211, v205, 18, v211
    v_and_b32 v210, 1, v207
    v_lshl_add_u32 v211, v210, 17, v211
    v_and_b32 v210, 1, v208
    v_lshl_add_u32 v211, v210, 15, v211
    v_add_u32 v193, s86, v211
    s_add_u32 m0, s33, 16896
    s_add_u32 s50, s36, 262144
    buffer_load_dwordx4 v192, s[12:15], s50 offen lds
    s_add_u32 m0, s33, 17928
    s_add_u32 s50, s36, 270336
    buffer_load_dwordx4 v192, s[12:15], s50 offen lds
    s_mov_b64 exec, 0
    s_cmp_eq_u32 s32, 0
    s_cbranch_scc1 L_pad0
    s_cmp_eq_u32 s32, 1
    s_cbranch_scc1 L_pad1
    s_cmp_eq_u32 s32, 2
    s_cbranch_scc1 L_pad2
    s_branch L_pad3
    .p2align 12
L_main:
    s_mov_b64 exec, -1
    s_add_u32 m0, s33, 19008
    s_add_u32 s50, s36, 278528
    buffer_load_dwordx4 v192, s[12:15], s50 offen lds
    s_lshl_b32 s86, s3, 3
    s_add_u32 s86, s86, s4
    s_lshl_b32 s86, s86, 2
    s_add_u32 m0, s33, 20040
    s_add_u32 s50, s36, 286720
    buffer_load_dwordx4 v192, s[12:15], s50 offen lds
    s_add_u32 s86, s86, s32
    s_lshl_b32 s88, s86, 21
    s_lshr_b32 s86, s86, 2
    s_add_u32 m0, s35, 109824
    s_add_u32 s50, s44, 0
    buffer_load_dwordx4 v194, s[8:11], s50 offen lds
    s_lshl_b32 s6, s86, 4
    s_add_u32 s97, s88, 1835008
    s_min_u32 s87, s5, 1
    s_add_u32 m0, s35, 110848
    s_add_u32 s50, s44, 7168
    buffer_load_dwordx4 v194, s[8:11], s50 offen lds
    s_lshl_b32 s86, s87, 28
    s_add_u32 s70, s97, s86
    s_or_b32 s87, s5, s32
    s_add_u32 m0, s35, 111872
    s_add_u32 s50, s44, 14336
    buffer_load_dwordx4 v194, s[8:11], s50 offen lds
    s_min_u32 s87, s87, 1
    s_lshl_b32 s86, s87, 28
    s_add_u32 s7, s6, s86
    s_add_u32 m0, s35, 112896
    s_add_u32 s50, s44, 21504
    buffer_load_dwordx4 v194, s[8:11], s50 offen lds
    s_add_u32 s67, s97, s86
    v_lshrrev_b32 v210, 1, v204
    v_mul_u32_u24 v211, 16640, v210
    s_add_u32 m0, s35, 113920
    s_add_u32 s50, s44, 28672
    buffer_load_dwordx4 v194, s[8:11], s50 offen lds
    v_min_u32 v202, 1, v210
    v_min_u32 v203, 1, v210
    v_and_b32 v210, 3, v204
    s_add_u32 m0, s35, 114944
    s_add_u32 s50, s44, 35840
    buffer_load_dwordx4 v194, s[8:11], s50 offen lds
    v_lshrrev_b32 v212, 1, v210
    v_lshl_add_u32 v211, v212, 12, v211
    v_and_b32 v210, 1, v204
    s_add_u32 m0, s35, 84480
    s_add_u32 s50, s45, 0
    buffer_load_dwordx4 v194, s[8:11], s50 offen lds
    v_lshl_add_u32 v211, v210, 13, v211
    v_cmp_gt_u32 vcc, 14, v204
    v_mov_b32 v212, 268435456
    s_add_u32 m0, s35, 85504
    s_add_u32 s50, s45, 7168
    buffer_load_dwordx4 v194, s[8:11], s50 offen lds
    v_min_u32 v210, 1, v204
    v_lshlrev_b32 v252, 28, v210
    v_cndmask_b32 v201, v212, v211, vcc
    s_waitcnt vmcnt(12)
    s_waitcnt lgkmcnt(0)
    buffer_store_dwordx2 v[202:203], v201, s[28:31], s70 offen sc1
    s_barrier
    ds_read_b128 a[0:3], v199 offset:50688
    ds_read_b128 a[4:7], v199 offset:52736
    ds_read_b128 a[8:11], v199 offset:54784
    ds_read_b128 a[12:15], v200 offset:50688
    ds_read_b128 a[16:19], v200 offset:52736
    ds_read_b128 a[20:23], v200 offset:54784
    ds_read_b64_tr_b16 a[208:209], v195 offset:0
    ds_read_b64_tr_b16 a[210:211], v195 offset:8448
    ds_read_b64_tr_b16 a[212:213], v195 offset:8
    ds_read_b64_tr_b16 a[214:215], v195 offset:8456
    ds_read_b64_tr_b16 a[216:217], v195 offset:64
    ds_read_b64_tr_b16 a[218:219], v195 offset:8512
    ds_read_b64_tr_b16 a[220:221], v195 offset:72
    ds_read_b64_tr_b16 a[222:223], v195 offset:8520
    ds_read_b64_tr_b16 a[224:225], v195 offset:128
    ds_read_b64_tr_b16 a[226:227], v195 offset:8576
    ds_read_b64_tr_b16 a[228:229], v195 offset:136
    ds_read_b64_tr_b16 a[230:231], v195 offset:8584
    s_waitcnt lgkmcnt(10)
    v_mfma_f32_16x16x32_bf16 v[0:3], a[208:211], a[0:3], 0
    s_waitcnt lgkmcnt(8)
    ds_read_b64_tr_b16 a[232:233], v195 offset:192
    ds_read_b64_tr_b16 a[234:235], v195 offset:8640
    s_lshl_b32 s86, s4, 4
    s_add_u32 s86, s86, s5
    s_lshl_b32 s86, s86, 18
    s_lshl_b32 s87, s98, 13
    s_add_u32 s86, s86, s87
    s_lshl_b32 s87, s99, 16
    s_add_u32 s86, s86, s87
    v_lshlrev_b32 v210, 15, v205
    v_mfma_f32_16x16x32_bf16 v[8:11], a[208:211], a[4:7], 0
    v_mfma_f32_16x16x32_bf16 v[16:19], a[208:211], a[8:11], 0
    s_add_u32 m0, s35, 86528
    s_add_u32 s50, s45, 14336
    buffer_load_dwordx4 v194, s[8:11], s50 offen lds
    v_mfma_f32_16x16x32_bf16 v[20:23], a[212:215], a[8:11], 0
    s_waitcnt lgkmcnt(8)
    ds_read_b64_tr_b16 a[236:237], v195 offset:200
    ds_read_b64_tr_b16 a[238:239], v195 offset:8648
    v_mfma_f32_16x16x32_bf16 v[12:15], a[212:215], a[4:7], 0
    v_mfma_f32_16x16x32_bf16 v[4:7], a[212:215], a[0:3], 0
    s_add_u32 m0, s35, 87552
    s_add_u32 s50, s45, 21504
    buffer_load_dwordx4 v194, s[8:11], s50 offen lds
    v_mfma_f32_16x16x32_bf16 v[24:27], a[216:219], a[0:3], 0
    s_waitcnt lgkmcnt(8)
    ds_read_b64_tr_b16 a[240:241], v195 offset:256
    ds_read_b64_tr_b16 a[242:243], v195 offset:8704
    v_mfma_f32_16x16x32_bf16 v[32:35], a[216:219], a[4:7], 0
    v_mfma_f32_16x16x32_bf16 v[40:43], a[216:219], a[8:11], 0
    s_add_u32 m0, s35, 88576
    s_add_u32 s50, s45, 28672
    buffer_load_dwordx4 v194, s[8:11], s50 offen lds
    v_mfma_f32_16x16x32_bf16 v[44:47], a[220:223], a[8:11], 0
    s_waitcnt lgkmcnt(8)
    ds_read_b64_tr_b16 a[244:245], v195 offset:264
    ds_read_b64_tr_b16 a[246:247], v195 offset:8712
    v_add3_u32 v240, v210, v206, s86
    v_lshlrev_b32 v251, 4, v204
    s_andn2_b32 s86, s2, 8
    s_mul_i32 s86, s86, 0x9e3779b1
    s_lshr_b32 s86, s86, 25
    s_lshl_b32 s86, s86, 11
    s_and_b32 s95, s86, 153600
    s_mov_b32 s52, 0x3db8aa3b
    v_mfma_f32_16x16x32_bf16 v[36:39], a[220:223], a[4:7], 0
    v_mfma_f32_16x16x32_bf16 v[28:31], a[220:223], a[0:3], 0
    s_add_u32 m0, s35, 89600
    s_add_u32 s50, s45, 35840
    buffer_load_dwordx4 v194, s[8:11], s50 offen lds
    v_mfma_f32_16x16x32_bf16 v[48:51], a[224:227], a[0:3], 0
    s_waitcnt lgkmcnt(8)
    ds_read_b64_tr_b16 a[248:249], v195 offset:320
    ds_read_b64_tr_b16 a[250:251], v195 offset:8768
    v_mfma_f32_16x16x32_bf16 v[56:59], a[224:227], a[4:7], 0
    v_mfma_f32_16x16x32_bf16 v[64:67], a[224:227], a[8:11], 0
    s_add_u32 m0, s33, 33792
    s_add_u32 s50, s37, 0
    buffer_load_dwordx4 v193, s[12:15], s50 offen lds
    v_mfma_f32_16x16x32_bf16 v[68:71], a[228:231], a[8:11], 0
    s_waitcnt lgkmcnt(8)
    ds_read_b64_tr_b16 a[252:253], v195 offset:328
    ds_read_b64_tr_b16 a[254:255], v195 offset:8776
    s_mov_b32 s53, 1266679808
    s_mov_b32 s34, 864026624
    v_mul_u32_u24 v210, 1056, v215
    v_lshl_add_u32 v210, v214, 3, v210
    v_lshl_add_u32 v244, v205, 9, v210
    v_lshl_add_u32 v248, v205, 7, v210
    v_mul_u32_u24 v210, 1056, v209
    v_and_b32 v211, 1, v207
    v_mfma_f32_16x16x32_bf16 v[60:63], a[228:231], a[4:7], 0
    v_mfma_f32_16x16x32_bf16 v[52:55], a[228:231], a[0:3], 0
    s_add_u32 m0, s33, 34824
    s_add_u32 s50, s37, 8192
    buffer_load_dwordx4 v193, s[12:15], s50 offen lds
    v_mfma_f32_16x16x32_bf16 v[72:75], a[232:235], a[0:3], 0
    s_waitcnt lgkmcnt(8)
    ds_read_b64_tr_b16 a[208:209], v195 offset:384
    ds_read_b64_tr_b16 a[210:211], v195 offset:8832
    v_mfma_f32_16x16x32_bf16 v[80:83], a[232:235], a[4:7], 0
    v_mfma_f32_16x16x32_bf16 v[88:91], a[232:235], a[8:11], 0
    s_add_u32 m0, s33, 35904
    s_add_u32 s50, s37, 16384
    buffer_load_dwordx4 v193, s[12:15], s50 offen lds
    v_mfma_f32_16x16x32_bf16 v[92:95], a[236:239], a[8:11], 0
    s_waitcnt lgkmcnt(8)
    ds_read_b64_tr_b16 a[212:213], v195 offset:392
    ds_read_b64_tr_b16 a[214:215], v195 offset:8840
    v_lshl_add_u32 v210, v211, 9, v210
    v_lshl_add_u32 v241, v208, 4, v210
    v_add_u32 v242, 50688, v241
    v_add_u32 v243, 101376, v241
    v_add_u32 v245, 50688, v244
    v_add_u32 v246, 101376, v244
    v_add_u32 v249, 50688, v248
    v_add_u32 v250, 101376, v248
    v_mfma_f32_16x16x32_bf16 v[84:87], a[236:239], a[4:7], 0
    v_mfma_f32_16x16x32_bf16 v[76:79], a[236:239], a[0:3], 0
    s_add_u32 m0, s33, 36936
    s_add_u32 s50, s37, 24576
    buffer_load_dwordx4 v193, s[12:15], s50 offen lds
    v_mfma_f32_16x16x32_bf16 v[96:99], a[240:243], a[0:3], 0
    s_waitcnt lgkmcnt(8)
    ds_read_b64_tr_b16 a[216:217], v195 offset:448
    ds_read_b64_tr_b16 a[218:219], v195 offset:8896
    v_mfma_f32_16x16x32_bf16 v[104:107], a[240:243], a[4:7], 0
    v_mfma_f32_16x16x32_bf16 v[112:115], a[240:243], a[8:11], 0
    s_add_u32 m0, s33, 50688
    s_add_u32 s50, s37, 128
    buffer_load_dwordx4 v193, s[12:15], s50 offen lds
    v_mfma_f32_16x16x32_bf16 v[116:119], a[244:247], a[8:11], 0
    s_waitcnt vmcnt(18)
    ds_read_b64_tr_b16 a[220:221], v195 offset:456
    ds_read_b64_tr_b16 a[222:223], v195 offset:8904
    v_mfma_f32_16x16x32_bf16 v[108:111], a[244:247], a[4:7], 0
    v_mfma_f32_16x16x32_bf16 v[100:103], a[244:247], a[0:3], 0
    s_waitcnt lgkmcnt(10)
    v_mfma_f32_16x16x32_bf16 v[120:123], a[248:251], a[0:3], 0
    s_barrier
    ds_read_b64_tr_b16 a[224:225], v195 offset:16896
    ds_read_b64_tr_b16 a[226:227], v195 offset:25344
    v_mov_b32 v211, 0x3f803f80
    v_cmp_eq_u32 vcc, 0, v214
    v_mov_b32 v216, 0
    v_mov_b32 v217, 0
    v_mov_b32 v218, 0
    v_mov_b32 v219, 0
    v_cndmask_b32 v210, 0, v211, vcc
    v_accvgpr_write_b32 a192, v210
    v_mfma_f32_16x16x32_bf16 v[128:131], a[248:251], a[4:7], 0
    s_add_u32 m0, s33, 51720
    s_add_u32 s50, s37, 8320
    buffer_load_dwordx4 v193, s[12:15], s50 offen lds
    v_mfma_f32_16x16x32_bf16 v[136:139], a[248:251], a[8:11], 0
    s_waitcnt lgkmcnt(10)
    v_mfma_f32_16x16x32_bf16 v[140:143], a[252:255], a[8:11], 0
    s_waitcnt lgkmcnt(8)
    ds_read_b64_tr_b16 a[228:229], v195 offset:16904
    ds_read_b64_tr_b16 a[230:231], v195 offset:25352
    v_mfma_f32_16x16x32_bf16 v[132:135], a[252:255], a[4:7], 0
    s_add_u32 m0, s33, 52800
    s_add_u32 s50, s37, 16512
    buffer_load_dwordx4 v193, s[12:15], s50 offen lds
    v_mfma_f32_16x16x32_bf16 v[124:127], a[252:255], a[0:3], 0
    v_mfma_f32_16x16x32_bf16 v[144:147], a[208:211], a[0:3], 0
    s_waitcnt lgkmcnt(8)
    ds_read_b64_tr_b16 a[232:233], v195 offset:16960
    ds_read_b64_tr_b16 a[234:235], v195 offset:25408
    v_accvgpr_write_b32 a193, v210
    v_accvgpr_write_b32 a194, v210
    v_accvgpr_write_b32 a195, v210
    v_cmp_eq_u32 vcc, 1, v214
    v_mov_b32 v220, 0
    v_mov_b32 v221, 0
    v_mov_b32 v222, 0
    v_mov_b32 v223, 0
    v_mfma_f32_16x16x32_bf16 v[152:155], a[208:211], a[4:7], 0
    s_add_u32 m0, s33, 53832
    s_add_u32 s50, s37, 24704
    buffer_load_dwordx4 v193, s[12:15], s50 offen lds
    v_mfma_f32_16x16x32_bf16 v[160:163], a[208:211], a[8:11], 0
    v_mfma_f32_16x16x32_bf16 v[164:167], a[212:215], a[8:11], 0
    s_waitcnt lgkmcnt(8)
    ds_read_b64_tr_b16 a[236:237], v195 offset:16968
    ds_read_b64_tr_b16 a[238:239], v195 offset:25416
    v_mfma_f32_16x16x32_bf16 v[156:159], a[212:215], a[4:7], 0
    s_add_u32 m0, s35, 135168
    s_add_u32 s50, s46, 0
    buffer_load_dwordx4 v194, s[8:11], s50 offen lds
    v_mfma_f32_16x16x32_bf16 v[148:151], a[212:215], a[0:3], 0
    v_mfma_f32_16x16x32_bf16 v[168:171], a[216:219], a[0:3], 0
    s_waitcnt lgkmcnt(8)
    ds_read_b64_tr_b16 a[240:241], v195 offset:17024
    ds_read_b64_tr_b16 a[242:243], v195 offset:25472
    v_cndmask_b32 v210, 0, v211, vcc
    v_accvgpr_write_b32 a196, v210
    v_accvgpr_write_b32 a197, v210
    v_accvgpr_write_b32 a198, v210
    v_accvgpr_write_b32 a199, v210
    v_cmp_eq_u32 vcc, 2, v214
    v_mov_b32 v224, 0
    v_mov_b32 v225, 0
    v_mfma_f32_16x16x32_bf16 v[176:179], a[216:219], a[4:7], 0
    s_add_u32 m0, s35, 136192
    s_add_u32 s50, s46, 7168
    buffer_load_dwordx4 v194, s[8:11], s50 offen lds
    v_mfma_f32_16x16x32_bf16 v[184:187], a[216:219], a[8:11], 0
    v_mfma_f32_16x16x32_bf16 v[188:191], a[220:223], a[8:11], 0
    s_waitcnt lgkmcnt(8)
    ds_read_b64_tr_b16 a[244:245], v195 offset:17032
    ds_read_b64_tr_b16 a[246:247], v195 offset:25480
    v_mfma_f32_16x16x32_bf16 v[180:183], a[220:223], a[4:7], 0
    s_add_u32 m0, s35, 137216
    s_add_u32 s50, s46, 14336
    buffer_load_dwordx4 v194, s[8:11], s50 offen lds
    v_mfma_f32_16x16x32_bf16 v[172:175], a[220:223], a[0:3], 0
    v_mfma_f32_16x16x32_bf16 v[0:3], a[224:227], a[12:15], v[0:3]
    s_waitcnt lgkmcnt(8)
    ds_read_b64_tr_b16 a[248:249], v195 offset:17088
    ds_read_b64_tr_b16 a[250:251], v195 offset:25536
    v_mfma_f32_16x16x32_bf16 v[8:11], a[224:227], a[16:19], v[8:11]
    s_add_u32 m0, s35, 138240
    s_add_u32 s50, s46, 21504
    buffer_load_dwordx4 v194, s[8:11], s50 offen lds
    v_mfma_f32_16x16x32_bf16 v[16:19], a[224:227], a[20:23], v[16:19]
    v_mfma_f32_16x16x32_bf16 v[20:23], a[228:231], a[20:23], v[20:23]
    s_waitcnt lgkmcnt(8)
    ds_read_b64_tr_b16 a[252:253], v195 offset:17096
    ds_read_b64_tr_b16 a[254:255], v195 offset:25544
    v_mov_b32 v226, 0
    v_mov_b32 v227, 0
    v_cndmask_b32 v210, 0, v211, vcc
    v_accvgpr_write_b32 a200, v210
    v_accvgpr_write_b32 a201, v210
    v_accvgpr_write_b32 a202, v210
    v_accvgpr_write_b32 a203, v210
    s_lshl_b32 s86, s5, 2
    v_mfma_f32_16x16x32_bf16 v[12:15], a[228:231], a[16:19], v[12:15]
    s_add_u32 m0, s35, 139264
    s_add_u32 s50, s46, 28672
    buffer_load_dwordx4 v194, s[8:11], s50 offen lds
    v_mfma_f32_16x16x32_bf16 v[4:7], a[228:231], a[12:15], v[4:7]
    v_mfma_f32_16x16x32_bf16 v[24:27], a[232:235], a[12:15], v[24:27]
    s_waitcnt lgkmcnt(8)
    ds_read_b64_tr_b16 a[208:209], v195 offset:17152
    ds_read_b64_tr_b16 a[210:211], v195 offset:25600
    v_mfma_f32_16x16x32_bf16 v[32:35], a[232:235], a[16:19], v[32:35]
    s_add_u32 m0, s35, 140288
    s_add_u32 s50, s46, 35840
    buffer_load_dwordx4 v194, s[8:11], s50 offen lds
    v_mfma_f32_16x16x32_bf16 v[40:43], a[232:235], a[20:23], v[40:43]
    v_mfma_f32_16x16x32_bf16 v[44:47], a[236:239], a[20:23], v[44:47]
    s_waitcnt vmcnt(21)
    ds_read_b64_tr_b16 a[212:213], v195 offset:17160
    ds_read_b64_tr_b16 a[214:215], v195 offset:25608
    s_add_u32 s86, s86, s98
    s_lshl_b32 s86, s86, 4
    s_add_u32 s86, s86, s99
    s_mul_i32 s86, s86, 3584
    v_mul_u32_u24 v210, 7168, v207
    v_lshlrev_b32 v211, 4, v209
    v_add3_u32 v247, v210, v211, s86
    v_mul_u32_u24 v210, 1792, v209
    v_mfma_f32_16x16x32_bf16 v[36:39], a[236:239], a[16:19], v[36:39]
    ds_read_b128 a[24:27], v199 offset:25344
    s_add_u32 m0, s33, 67584
    s_add_u32 s50, s37, 256
    buffer_load_dwordx4 v193, s[12:15], s50 offen lds
    v_mfma_f32_16x16x32_bf16 v[28:31], a[236:239], a[12:15], v[28:31]
    s_waitcnt lgkmcnt(11)
    ds_read_b128 a[28:31], v199 offset:27392
    v_mfma_f32_16x16x32_bf16 v[48:51], a[240:243], a[12:15], v[48:51]
    ds_read_b64_tr_b16 a[216:217], v195 offset:17216
    ds_read_b64_tr_b16 a[218:219], v195 offset:25664
    v_mfma_f32_16x16x32_bf16 v[56:59], a[240:243], a[16:19], v[56:59]
    ds_read_b128 a[32:35], v199 offset:29440
    v_mfma_f32_16x16x32_bf16 v[64:67], a[240:243], a[20:23], v[64:67]
    s_waitcnt lgkmcnt(13)
    ds_read_b128 a[36:39], v200 offset:25344
    v_mfma_f32_16x16x32_bf16 v[68:71], a[244:247], a[20:23], v[68:71]
    ds_read_b64_tr_b16 a[220:221], v195 offset:17224
    ds_read_b64_tr_b16 a[222:223], v195 offset:25672
    v_lshl_add_u32 v210, v205, 4, v210
    v_and_b32 v211, 1, v208
    v_lshl_add_u32 v210, v211, 5, v210
    v_and_b32 v212, 1, v207
    v_lshl_add_u32 v254, v212, 3, v210
    v_xor_b32 v211, v211, v212
    v_lshrrev_b32 v210, 1, v209
    v_lshl_add_u32 v210, v211, 2, v210
    v_mfma_f32_16x16x32_bf16 v[60:63], a[244:247], a[16:19], v[60:63]
    ds_read_b128 a[40:43], v200 offset:27392
    v_mfma_f32_16x16x32_bf16 v[52:55], a[244:247], a[12:15], v[52:55]
    s_waitcnt lgkmcnt(15)
    ds_read_b128 a[44:47], v200 offset:29440
    v_mfma_f32_16x16x32_bf16 v[72:75], a[248:251], a[12:15], v[72:75]
    s_waitcnt lgkmcnt(14)
    ds_read_b64_tr_b16 a[224:225], v195 offset:17280
    ds_read_b64_tr_b16 a[226:227], v195 offset:25728
    v_mfma_f32_16x16x32_bf16 v[80:83], a[248:251], a[16:19], v[80:83]
    s_add_u32 m0, s33, 68616
    s_add_u32 s50, s37, 8448
    buffer_load_dwordx4 v193, s[12:15], s50 offen lds
    v_mfma_f32_16x16x32_bf16 v[88:91], a[248:251], a[20:23], v[88:91]
    v_mfma_f32_16x16x32_bf16 v[92:95], a[252:255], a[20:23], v[92:95]
    s_waitcnt lgkmcnt(14)
    ds_read_b64_tr_b16 a[228:229], v195 offset:17288
    ds_read_b64_tr_b16 a[230:231], v195 offset:25736
    v_mfma_f32_16x16x32_bf16 v[84:87], a[252:255], a[16:19], v[84:87]
    s_add_u32 m0, s33, 69696
    s_add_u32 s50, s37, 16640
    buffer_load_dwordx4 v193, s[12:15], s50 offen lds
    v_mfma_f32_16x16x32_bf16 v[76:79], a[252:255], a[12:15], v[76:79]
    v_mfma_f32_16x16x32_bf16 v[96:99], a[208:211], a[12:15], v[96:99]
    s_waitcnt lgkmcnt(14)
    ds_read_b64_tr_b16 a[232:233], v195 offset:17344
    ds_read_b64_tr_b16 a[234:235], v195 offset:25792
    v_and_b32 v211, 1, v204
    v_lshlrev_b32 v211, 4, v211
    v_mov_b32 v212, 0x3f80
    v_lshlrev_b32 v211, v211, v212
    v_cmp_eq_u32 vcc, 0, v210
    s_nop 1
    v_cndmask_b32 v212, 0, v211, vcc
    v_accvgpr_write_b32 a204, v212
    v_mfma_f32_16x16x32_bf16 v[104:107], a[208:211], a[16:19], v[104:107]
    s_add_u32 m0, s33, 70728
    s_add_u32 s50, s37, 24832
    buffer_load_dwordx4 v193, s[12:15], s50 offen lds
    v_mfma_f32_16x16x32_bf16 v[112:115], a[208:211], a[20:23], v[112:115]
    v_mfma_f32_16x16x32_bf16 v[116:119], a[212:215], a[20:23], v[116:119]
    s_waitcnt vmcnt(14)
    ds_read_b64_tr_b16 a[236:237], v195 offset:17352
    ds_read_b64_tr_b16 a[238:239], v195 offset:25800
    s_waitcnt vmcnt(14)
    v_mfma_f32_16x16x32_bf16 v[108:111], a[212:215], a[16:19], v[108:111]
    ds_read_b128 a[48:51], v199 offset:0
    v_mfma_f32_16x16x32_bf16 v[100:103], a[212:215], a[12:15], v[100:103]
    s_waitcnt lgkmcnt(15)
    ds_read_b128 a[52:55], v199 offset:2048
    v_cmp_eq_u32 vcc, 1, v210
    s_nop 1
    v_cndmask_b32 v212, 0, v211, vcc
    v_accvgpr_write_b32 a205, v212
    v_cmp_eq_u32 vcc, 2, v210
    s_nop 1
    v_cndmask_b32 v212, 0, v211, vcc
    v_accvgpr_write_b32 a206, v212
    v_mfma_f32_16x16x32_bf16 v[120:123], a[216:219], a[12:15], v[120:123]
    s_barrier
    ds_read_b64_tr_b16 a[240:241], v197 offset:33792
    ds_read_b64_tr_b16 a[242:243], v197 offset:34048
    v_mfma_f32_16x16x32_bf16 v[128:131], a[216:219], a[16:19], v[128:131]
    ds_read_b128 a[56:59], v199 offset:4096
    v_mfma_f32_16x16x32_bf16 v[136:139], a[216:219], a[20:23], v[136:139]
    s_waitcnt lgkmcnt(15)
    ds_read_b128 a[60:63], v200 offset:0
    v_mfma_f32_16x16x32_bf16 v[140:143], a[220:223], a[20:23], v[140:143]
    ds_read_b64_tr_b16 a[244:245], v197 offset:34304
    ds_read_b64_tr_b16 a[246:247], v197 offset:34560
    v_mfma_f32_16x16x32_bf16 v[132:135], a[220:223], a[16:19], v[132:135]
    ds_read_b128 a[64:67], v200 offset:2048
    v_mfma_f32_16x16x32_bf16 v[124:127], a[220:223], a[12:15], v[124:127]
    s_waitcnt lgkmcnt(15)
    ds_read_b128 a[68:71], v200 offset:4096
    v_mfma_f32_16x16x32_bf16 v[144:147], a[224:227], a[12:15], v[144:147]
    s_waitcnt lgkmcnt(14)
    ds_read_b64_tr_b16 a[248:249], v197 offset:42240
    ds_read_b64_tr_b16 a[250:251], v197 offset:42496
    v_cmp_eq_u32 vcc, 3, v210
    s_nop 1
    v_cndmask_b32 v212, 0, v211, vcc
    v_accvgpr_write_b32 a207, v212
    s_lshl_b32 s86, s4, 2
    s_lshr_b32 s86, 1679844384, s86
    s_and_b32 s86, s86, 15
    s_mov_b32 s54, 0x06543210
    v_mfma_f32_16x16x32_bf16 v[152:155], a[224:227], a[16:19], v[152:155]
    v_mfma_f32_16x16x32_bf16 v[160:163], a[224:227], a[20:23], v[160:163]
    v_mfma_f32_16x16x32_bf16 v[164:167], a[228:231], a[20:23], v[164:167]
    s_waitcnt lgkmcnt(14)
    ds_read_b64_tr_b16 a[252:253], v197 offset:42752
    ds_read_b64_tr_b16 a[254:255], v197 offset:43008
    v_mfma_f32_16x16x32_bf16 v[156:159], a[228:231], a[16:19], v[156:159]
    v_mfma_f32_16x16x32_bf16 v[148:151], a[228:231], a[12:15], v[148:151]
    v_mfma_f32_16x16x32_bf16 v[168:171], a[232:235], a[12:15], v[168:171]
    s_waitcnt lgkmcnt(14)
    ds_read_b64_tr_b16 a[208:209], v197 offset:33800
    ds_read_b64_tr_b16 a[210:211], v197 offset:34056
    v_mfma_f32_16x16x32_bf16 v[176:179], a[232:235], a[16:19], v[176:179]
    v_mfma_f32_16x16x32_bf16 v[184:187], a[232:235], a[20:23], v[184:187]
    v_mfma_f32_16x16x32_bf16 v[188:191], a[236:239], a[20:23], v[188:191]
    ds_read_b64_tr_b16 a[212:213], v197 offset:34312
    ds_read_b64_tr_b16 a[214:215], v197 offset:34568
    s_mov_b32 s55, 0x10654321
    s_lshl_b32 s91, s86, 2
    s_lshr_b64 s[54:55], s[54:55], s91
    s_mov_b32 s91, s54
    s_bfe_u32 s86, s91, 262144
    s_lshl_b32 s56, s86, 7
    s_bfe_u32 s86, s91, 262148
    s_lshl_b32 s57, s86, 7
    v_mfma_f32_16x16x32_bf16 v[180:183], a[236:239], a[16:19], v[180:183]
    v_mfma_f32_16x16x32_bf16 v[172:175], a[236:239], a[12:15], v[172:175]
    s_waitcnt lgkmcnt(8)
    v_mfma_f32_16x16x32_bf16 v[0:3], a[240:243], a[24:27], v[0:3]
    s_waitcnt lgkmcnt(4)
    ds_read_b64_tr_b16 a[216:217], v197 offset:42248
    ds_read_b64_tr_b16 a[218:219], v197 offset:42504
    v_mfma_f32_16x16x32_bf16 v[0:3], a[244:247], a[36:39], v[0:3]
    s_add_u32 m0, s33, 0
    s_add_u32 s50, s37, 384
    buffer_load_dwordx4 v193, s[12:15], s50 offen lds
    v_mfma_f32_16x16x32_bf16 v[0:3], a[248:251], a[48:51], v[0:3]
    v_mfma_f32_16x16x32_bf16 v[0:3], a[252:255], a[60:63], v[0:3]
    ds_read_b64_tr_b16 a[220:221], v197 offset:42760
    ds_read_b64_tr_b16 a[222:223], v197 offset:43016
    s_bfe_u32 s86, s91, 262152
    s_lshl_b32 s58, s86, 7
    s_bfe_u32 s86, s91, 262156
    s_lshl_b32 s59, s86, 7
    s_bfe_u32 s86, s91, 262160
    s_lshl_b32 s60, s86, 7
    s_bfe_u32 s86, s91, 262164
    s_lshl_b32 s61, s86, 7
    v_mfma_f32_16x16x32_bf16 v[8:11], a[252:255], a[64:67], v[8:11]
    s_add_u32 m0, s33, 1032
    s_add_u32 s50, s37, 8576
    buffer_load_dwordx4 v193, s[12:15], s50 offen lds
    v_mfma_f32_16x16x32_bf16 v[8:11], a[248:251], a[52:55], v[8:11]
    v_mfma_f32_16x16x32_bf16 v[8:11], a[244:247], a[40:43], v[8:11]
    ds_read_b64_tr_b16 a[224:225], v197 offset:33856
    ds_read_b64_tr_b16 a[226:227], v197 offset:34112
    v_mfma_f32_16x16x32_bf16 v[8:11], a[240:243], a[28:31], v[8:11]
    s_add_u32 m0, s33, 2112
    s_add_u32 s50, s37, 16768
    buffer_load_dwordx4 v193, s[12:15], s50 offen lds
    v_mfma_f32_16x16x32_bf16 v[16:19], a[240:243], a[32:35], v[16:19]
    v_mfma_f32_16x16x32_bf16 v[16:19], a[244:247], a[44:47], v[16:19]
    s_waitcnt lgkmcnt(8)
    ds_read_b64_tr_b16 a[228:229], v197 offset:34368
    ds_read_b64_tr_b16 a[230:231], v197 offset:34624
    s_bfe_u32 s86, s91, 262168
    s_lshl_b32 s62, s86, 7
    s_mul_i32 s90, s4, 344064
    s_mul_i32 s86, s3, 896
    s_add_u32 s90, s90, s86
    s_mul_i32 s86, s32, 86016
    s_add_u32 s90, s90, s86
    s_lshl_b32 s63, s5, 14
    v_mfma_f32_16x16x32_bf16 v[16:19], a[248:251], a[56:59], v[16:19]
    s_add_u32 m0, s33, 3144
    s_add_u32 s50, s37, 24960
    buffer_load_dwordx4 v193, s[12:15], s50 offen lds
    v_mfma_f32_16x16x32_bf16 v[16:19], a[252:255], a[68:71], v[16:19]
    v_mfma_f32_16x16x32_bf16 v[20:23], a[208:211], a[32:35], v[20:23]
    s_waitcnt lgkmcnt(4)
    ds_read_b64_tr_b16 a[232:233], v197 offset:42304
    ds_read_b64_tr_b16 a[234:235], v197 offset:42560
    v_mfma_f32_16x16x32_bf16 v[20:23], a[212:215], a[44:47], v[20:23]
    v_mfma_f32_16x16x32_bf16 v[20:23], a[216:219], a[56:59], v[20:23]
    s_add_u32 m0, s35, 109824
    s_add_u32 s50, s47, 0
    buffer_load_dwordx4 v194, s[8:11], s50 offen lds
    v_mfma_f32_16x16x32_bf16 v[20:23], a[220:223], a[68:71], v[20:23]
    ds_read_b64_tr_b16 a[236:237], v197 offset:42816
    ds_read_b64_tr_b16 a[238:239], v197 offset:43072
    v_mfma_f32_16x16x32_bf16 v[12:15], a[220:223], a[64:67], v[12:15]
    v_mfma_f32_16x16x32_bf16 v[12:15], a[216:219], a[52:55], v[12:15]
    s_add_u32 m0, s35, 110848
    s_add_u32 s50, s47, 7168
    buffer_load_dwordx4 v194, s[8:11], s50 offen lds
    v_mfma_f32_16x16x32_bf16 v[12:15], a[212:215], a[40:43], v[12:15]
    ds_read_b64_tr_b16 a[240:241], v197 offset:33864
    ds_read_b64_tr_b16 a[242:243], v197 offset:34120
    s_and_b32 s86, s5, 2
    s_lshl_b32 s86, s86, 10
    s_add_u32 s63, s63, s86
    v_mfma_f32_16x16x32_bf16 v[12:15], a[208:211], a[28:31], v[12:15]
    v_mfma_f32_16x16x32_bf16 v[4:7], a[208:211], a[24:27], v[4:7]
    s_add_u32 m0, s35, 111872
    s_add_u32 s50, s47, 14336
    buffer_load_dwordx4 v194, s[8:11], s50 offen lds
    v_mfma_f32_16x16x32_bf16 v[4:7], a[212:215], a[36:39], v[4:7]
    s_waitcnt lgkmcnt(8)
    ds_read_b64_tr_b16 a[244:245], v197 offset:34376
    ds_read_b64_tr_b16 a[246:247], v197 offset:34632
    v_mfma_f32_16x16x32_bf16 v[4:7], a[216:219], a[48:51], v[4:7]
    v_mfma_f32_16x16x32_bf16 v[4:7], a[220:223], a[60:63], v[4:7]
    s_add_u32 m0, s35, 112896
    s_add_u32 s50, s47, 21504
    buffer_load_dwordx4 v194, s[8:11], s50 offen lds
    v_mfma_f32_16x16x32_bf16 v[24:27], a[224:227], a[24:27], v[24:27]
    s_waitcnt lgkmcnt(4)
    ds_read_b64_tr_b16 a[248:249], v197 offset:42312
    ds_read_b64_tr_b16 a[250:251], v197 offset:42568
    v_mfma_f32_16x16x32_bf16 v[24:27], a[228:231], a[36:39], v[24:27]
    v_mfma_f32_16x16x32_bf16 v[24:27], a[232:235], a[48:51], v[24:27]
    s_add_u32 m0, s35, 113920
    s_add_u32 s50, s47, 28672
    buffer_load_dwordx4 v194, s[8:11], s50 offen lds
    v_mfma_f32_16x16x32_bf16 v[24:27], a[236:239], a[60:63], v[24:27]
    s_waitcnt vmcnt(19)
    ds_read_b64_tr_b16 a[252:253], v197 offset:42824
    ds_read_b64_tr_b16 a[254:255], v197 offset:43080
    v_mfma_f32_16x16x32_bf16 v[32:35], a[236:239], a[64:67], v[32:35]
    v_mfma_f32_16x16x32_bf16 v[32:35], a[232:235], a[52:55], v[32:35]
    s_add_u32 m0, s35, 114944
    s_add_u32 s50, s47, 35840
    buffer_load_dwordx4 v194, s[8:11], s50 offen lds
    v_mfma_f32_16x16x32_bf16 v[32:35], a[228:231], a[40:43], v[32:35]
    s_barrier
    ds_read_b64_tr_b16 a[208:209], v198 offset:0
    ds_read_b64_tr_b16 a[210:211], v198 offset:256
    s_waitcnt vmcnt(20)
    v_mfma_f32_16x16x32_bf16 v[32:35], a[224:227], a[28:31], v[32:35]
    v_mfma_f32_16x16x32_bf16 v[40:43], a[224:227], a[32:35], v[40:43]
    v_mfma_f32_16x16x32_bf16 v[40:43], a[228:231], a[44:47], v[40:43]
    s_waitcnt lgkmcnt(8)
    ds_read_b64_tr_b16 a[212:213], v198 offset:512
    ds_read_b64_tr_b16 a[214:215], v198 offset:768
    s_mov_b32 s69, 0
    v_mfma_f32_16x16x32_bf16 v[40:43], a[232:235], a[56:59], v[40:43]
    v_mfma_f32_16x16x32_bf16 v[40:43], a[236:239], a[68:71], v[40:43]
L_pad0:
    s_cbranch_execz L_pad4
    v_mfma_f32_16x16x32_bf16 v[44:47], a[240:243], a[32:35], v[44:47]
    s_waitcnt lgkmcnt(4)
    ds_read_b64_tr_b16 a[216:217], v198 offset:8448
    ds_read_b64_tr_b16 a[218:219], v198 offset:8704
    s_mov_b64 s[84:85], 0
    v_mfma_f32_16x16x32_bf16 v[44:47], a[244:247], a[44:47], v[44:47]
    v_mfma_f32_16x16x32_bf16 v[44:47], a[248:251], a[56:59], v[44:47]
    v_mfma_f32_16x16x32_bf16 v[44:47], a[252:255], a[68:71], v[44:47]
    s_mov_b32 s68, 0
    ds_read_b64_tr_b16 a[220:221], v198 offset:8960
    ds_read_b64_tr_b16 a[222:223], v198 offset:9216
    v_mfma_f32_16x16x32_bf16 v[36:39], a[252:255], a[64:67], v[36:39]
    v_mfma_f32_16x16x32_bf16 v[36:39], a[248:251], a[52:55], v[36:39]
    v_mfma_f32_16x16x32_bf16 v[36:39], a[244:247], a[40:43], v[36:39]
    s_buffer_load_dword s84, s[28:31], s67 offset:20736
    ds_read_b64_tr_b16 a[224:225], v198 offset:8
    ds_read_b64_tr_b16 a[226:227], v198 offset:264
    s_buffer_load_dword s85, s[28:31], s67 offset:28928
    v_mfma_f32_16x16x32_bf16 v[36:39], a[240:243], a[28:31], v[36:39]
    v_mfma_f32_16x16x32_bf16 v[28:31], a[240:243], a[24:27], v[28:31]
    v_mfma_f32_16x16x32_bf16 v[28:31], a[244:247], a[36:39], v[28:31]
    s_waitcnt lgkmcnt(8)
    ds_read_b64_tr_b16 a[228:229], v198 offset:520
    ds_read_b64_tr_b16 a[230:231], v198 offset:776
    v_mfma_f32_16x16x32_bf16 v[28:31], a[248:251], a[48:51], v[28:31]
    v_mfma_f32_16x16x32_bf16 v[28:31], a[252:255], a[60:63], v[28:31]
    v_mfma_f32_16x16x32_bf16 v[48:51], a[208:211], a[24:27], v[48:51]
    s_waitcnt lgkmcnt(4)
    ds_read_b64_tr_b16 a[232:233], v198 offset:8456
    ds_read_b64_tr_b16 a[234:235], v198 offset:8712
    v_mfma_f32_16x16x32_bf16 v[48:51], a[212:215], a[36:39], v[48:51]
    s_add_u32 m0, s33, 16896
    s_add_u32 s50, s39, 0
    buffer_load_dwordx4 v193, s[12:15], s50 offen lds
    v_mfma_f32_16x16x32_bf16 v[48:51], a[216:219], a[48:51], v[48:51]
    v_mfma_f32_16x16x32_bf16 v[48:51], a[220:223], a[60:63], v[48:51]
    ds_read_b64_tr_b16 a[236:237], v198 offset:8968
    ds_read_b64_tr_b16 a[238:239], v198 offset:9224
    v_mfma_f32_16x16x32_bf16 v[56:59], a[220:223], a[64:67], v[56:59]
    s_add_u32 m0, s33, 17928
    s_add_u32 s50, s39, 8192
    buffer_load_dwordx4 v193, s[12:15], s50 offen lds
    v_mfma_f32_16x16x32_bf16 v[56:59], a[216:219], a[52:55], v[56:59]
    v_mfma_f32_16x16x32_bf16 v[56:59], a[212:215], a[40:43], v[56:59]
    s_add_u32 s68, s68, s84
    ds_read_b64_tr_b16 a[240:241], v198 offset:64
    ds_read_b64_tr_b16 a[242:243], v198 offset:320
    s_sub_u32 s68, s68, s85
    v_mfma_f32_16x16x32_bf16 v[56:59], a[208:211], a[28:31], v[56:59]
    s_add_u32 m0, s33, 19008
    s_add_u32 s50, s39, 16384
    buffer_load_dwordx4 v193, s[12:15], s50 offen lds
    v_mfma_f32_16x16x32_bf16 v[64:67], a[208:211], a[32:35], v[64:67]
    v_mfma_f32_16x16x32_bf16 v[64:67], a[212:215], a[44:47], v[64:67]
    s_waitcnt lgkmcnt(8)
    ds_read_b64_tr_b16 a[244:245], v198 offset:576
    ds_read_b64_tr_b16 a[246:247], v198 offset:832
    s_add_u32 s68, s68, s84
    v_mfma_f32_16x16x32_bf16 v[64:67], a[216:219], a[56:59], v[64:67]
    s_add_u32 m0, s33, 20040
    s_add_u32 s50, s39, 24576
    buffer_load_dwordx4 v193, s[12:15], s50 offen lds
    v_mfma_f32_16x16x32_bf16 v[64:67], a[220:223], a[68:71], v[64:67]
    v_mfma_f32_16x16x32_bf16 v[68:71], a[224:227], a[32:35], v[68:71]
    s_waitcnt vmcnt(18)
    ds_read_b64_tr_b16 a[248:249], v198 offset:8512
    ds_read_b64_tr_b16 a[250:251], v198 offset:8768
    s_waitcnt lgkmcnt(6)
    v_mfma_f32_16x16x32_bf16 v[68:71], a[228:231], a[44:47], v[68:71]
    s_sub_u32 s68, s68, s85
    ds_read_b128 a[72:75], v199 offset:50688
    v_mfma_f32_16x16x32_bf16 v[68:71], a[232:235], a[56:59], v[68:71]
    s_add_u32 s68, s68, s84
    ds_read_b128 a[76:79], v199 offset:52736
    s_sub_u32 s68, s68, s85
    v_mfma_f32_16x16x32_bf16 v[68:71], a[236:239], a[68:71], v[68:71]
    ds_read_b64_tr_b16 a[252:253], v198 offset:9024
    ds_read_b64_tr_b16 a[254:255], v198 offset:9280
    v_mfma_f32_16x16x32_bf16 v[60:63], a[236:239], a[64:67], v[60:63]
    s_add_u32 s68, s68, s84
    ds_read_b128 a[80:83], v199 offset:54784
    s_sub_u32 s68, s68, s85
    v_mfma_f32_16x16x32_bf16 v[60:63], a[232:235], a[52:55], v[60:63]
    ds_read_b128 a[84:87], v200 offset:50688
    v_mfma_f32_16x16x32_bf16 v[60:63], a[228:231], a[40:43], v[60:63]
    s_add_u32 s68, s68, s84
    ds_read_b64_tr_b16 a[208:209], v198 offset:72
    ds_read_b64_tr_b16 a[210:211], v198 offset:328
    s_sub_u32 s68, s68, s85
    v_mfma_f32_16x16x32_bf16 v[60:63], a[224:227], a[28:31], v[60:63]
    ds_read_b128 a[88:91], v200 offset:52736
    v_mfma_f32_16x16x32_bf16 v[52:55], a[224:227], a[24:27], v[52:55]
    s_add_u32 s68, s68, s84
    ds_read_b128 a[92:95], v200 offset:54784
    s_sub_u32 s68, s68, s85
    v_mfma_f32_16x16x32_bf16 v[52:55], a[228:231], a[36:39], v[52:55]
    s_waitcnt lgkmcnt(14)
    ds_read_b64_tr_b16 a[212:213], v198 offset:584
    ds_read_b64_tr_b16 a[214:215], v198 offset:840
    v_mfma_f32_16x16x32_bf16 v[52:55], a[232:235], a[48:51], v[52:55]
    v_mfma_f32_16x16x32_bf16 v[52:55], a[236:239], a[60:63], v[52:55]
    v_mfma_f32_16x16x32_bf16 v[72:75], a[240:243], a[24:27], v[72:75]
    s_waitcnt lgkmcnt(8)
    ds_read_b64_tr_b16 a[216:217], v198 offset:8520
    ds_read_b64_tr_b16 a[218:219], v198 offset:8776
    s_add_u32 s68, s68, s84
    v_mfma_f32_16x16x32_bf16 v[72:75], a[244:247], a[36:39], v[72:75]
    v_mfma_f32_16x16x32_bf16 v[72:75], a[248:251], a[48:51], v[72:75]
    v_mfma_f32_16x16x32_bf16 v[72:75], a[252:255], a[60:63], v[72:75]
    s_waitcnt vmcnt(14)
    ds_read_b64_tr_b16 a[220:221], v198 offset:9032
    ds_read_b64_tr_b16 a[222:223], v198 offset:9288
    s_sub_u32 s68, s68, s85
    v_mfma_f32_16x16x32_bf16 v[80:83], a[252:255], a[64:67], v[80:83]
    v_mfma_f32_16x16x32_bf16 v[80:83], a[248:251], a[52:55], v[80:83]
    s_add_u32 m0, s35, 84480
    s_add_u32 s50, s48, 0
    buffer_load_dwordx4 v194, s[8:11], s50 offen lds
    v_mfma_f32_16x16x32_bf16 v[80:83], a[244:247], a[40:43], v[80:83]
    s_barrier
    ds_read_b64_tr_b16 a[224:225], v198 offset:16896
    ds_read_b64_tr_b16 a[226:227], v198 offset:17152
    s_add_u32 s68, s68, s84
    v_mfma_f32_16x16x32_bf16 v[80:83], a[240:243], a[28:31], v[80:83]
    v_mfma_f32_16x16x32_bf16 v[88:91], a[240:243], a[32:35], v[88:91]
    s_add_u32 m0, s35, 85504
    s_add_u32 s50, s48, 7168
    buffer_load_dwordx4 v194, s[8:11], s50 offen lds
    v_mfma_f32_16x16x32_bf16 v[88:91], a[244:247], a[44:47], v[88:91]
    s_waitcnt lgkmcnt(10)
    ds_read_b64_tr_b16 a[228:229], v198 offset:17408
    ds_read_b64_tr_b16 a[230:231], v198 offset:17664
    s_sub_u32 s68, s68, s85
    v_mfma_f32_16x16x32_bf16 v[88:91], a[248:251], a[56:59], v[88:91]
    v_mfma_f32_16x16x32_bf16 v[88:91], a[252:255], a[68:71], v[88:91]
    s_add_u32 m0, s35, 86528
    s_add_u32 s50, s48, 14336
    buffer_load_dwordx4 v194, s[8:11], s50 offen lds
    v_mfma_f32_16x16x32_bf16 v[92:95], a[208:211], a[32:35], v[92:95]
    s_waitcnt lgkmcnt(4)
    ds_read_b64_tr_b16 a[232:233], v198 offset:25344
    ds_read_b64_tr_b16 a[234:235], v198 offset:25600
    s_min_i32 s68, s68, 4
    v_mfma_f32_16x16x32_bf16 v[92:95], a[212:215], a[44:47], v[92:95]
    v_mfma_f32_16x16x32_bf16 v[92:95], a[216:219], a[56:59], v[92:95]
    s_add_u32 m0, s35, 87552
    s_add_u32 s50, s48, 21504
    buffer_load_dwordx4 v194, s[8:11], s50 offen lds
    v_mfma_f32_16x16x32_bf16 v[92:95], a[220:223], a[68:71], v[92:95]
    s_max_i32 s68, s68, -4
    ds_read_b64_tr_b16 a[236:237], v198 offset:25856
    ds_read_b64_tr_b16 a[238:239], v198 offset:26112
    s_add_u32 s69, s69, s68
    v_mfma_f32_16x16x32_bf16 v[84:87], a[220:223], a[64:67], v[84:87]
    v_mfma_f32_16x16x32_bf16 v[84:87], a[216:219], a[52:55], v[84:87]
    s_add_u32 m0, s35, 88576
    s_add_u32 s50, s48, 28672
    buffer_load_dwordx4 v194, s[8:11], s50 offen lds
    v_mfma_f32_16x16x32_bf16 v[84:87], a[212:215], a[40:43], v[84:87]
    s_mov_b32 s68, 0
    ds_read_b64_tr_b16 a[240:241], v198 offset:16904
    ds_read_b64_tr_b16 a[242:243], v198 offset:17160
    s_mov_b64 s[84:85], 0
    v_mfma_f32_16x16x32_bf16 v[84:87], a[208:211], a[28:31], v[84:87]
    v_mfma_f32_16x16x32_bf16 v[76:79], a[208:211], a[24:27], v[76:79]
    s_add_u32 m0, s35, 89600
    s_add_u32 s50, s48, 35840
    buffer_load_dwordx4 v194, s[8:11], s50 offen lds
    v_mfma_f32_16x16x32_bf16 v[76:79], a[212:215], a[36:39], v[76:79]
    s_waitcnt lgkmcnt(8)
    ds_read_b64_tr_b16 a[244:245], v198 offset:17416
    ds_read_b64_tr_b16 a[246:247], v198 offset:17672
    s_buffer_load_dword s85, s[28:31], s67 offset:41472
    v_mfma_f32_16x16x32_bf16 v[76:79], a[216:219], a[48:51], v[76:79]
    v_mfma_f32_16x16x32_bf16 v[76:79], a[220:223], a[60:63], v[76:79]
    v_mfma_f32_16x16x32_bf16 v[96:99], a[224:227], a[24:27], v[96:99]
    s_waitcnt lgkmcnt(4)
    ds_read_b64_tr_b16 a[248:249], v198 offset:25352
    ds_read_b64_tr_b16 a[250:251], v198 offset:25608
    s_buffer_load_dword s84, s[28:31], s67 offset:33280
    v_mfma_f32_16x16x32_bf16 v[96:99], a[228:231], a[36:39], v[96:99]
    s_add_u32 m0, s33, 33792
    s_add_u32 s50, s39, 128
    buffer_load_dwordx4 v193, s[12:15], s50 offen lds
    v_mfma_f32_16x16x32_bf16 v[96:99], a[232:235], a[48:51], v[96:99]
    v_mfma_f32_16x16x32_bf16 v[96:99], a[236:239], a[60:63], v[96:99]
    ds_read_b64_tr_b16 a[252:253], v198 offset:25864
    ds_read_b64_tr_b16 a[254:255], v198 offset:26120
    v_mfma_f32_16x16x32_bf16 v[104:107], a[236:239], a[64:67], v[104:107]
    s_add_u32 m0, s33, 34824
    s_add_u32 s50, s39, 8320
    buffer_load_dwordx4 v193, s[12:15], s50 offen lds
    v_mfma_f32_16x16x32_bf16 v[104:107], a[232:235], a[52:55], v[104:107]
    v_mfma_f32_16x16x32_bf16 v[104:107], a[228:231], a[40:43], v[104:107]
    ds_read_b64_tr_b16 a[208:209], v198 offset:16960
    ds_read_b64_tr_b16 a[210:211], v198 offset:17216
    v_mfma_f32_16x16x32_bf16 v[104:107], a[224:227], a[28:31], v[104:107]
    s_add_u32 m0, s33, 35904
    s_add_u32 s50, s39, 16512
    buffer_load_dwordx4 v193, s[12:15], s50 offen lds
    v_mfma_f32_16x16x32_bf16 v[112:115], a[224:227], a[32:35], v[112:115]
    v_mfma_f32_16x16x32_bf16 v[112:115], a[228:231], a[44:47], v[112:115]
    s_waitcnt lgkmcnt(8)
    ds_read_b64_tr_b16 a[212:213], v198 offset:17472
    ds_read_b64_tr_b16 a[214:215], v198 offset:17728
    v_mfma_f32_16x16x32_bf16 v[112:115], a[232:235], a[56:59], v[112:115]
    s_add_u32 m0, s33, 36936
    s_add_u32 s50, s39, 24704
    buffer_load_dwordx4 v193, s[12:15], s50 offen lds
    v_mfma_f32_16x16x32_bf16 v[112:115], a[236:239], a[68:71], v[112:115]
    v_mfma_f32_16x16x32_bf16 v[116:119], a[240:243], a[32:35], v[116:119]
    s_waitcnt vmcnt(14)
    ds_read_b64_tr_b16 a[216:217], v198 offset:25408
    ds_read_b64_tr_b16 a[218:219], v198 offset:25664
    s_waitcnt lgkmcnt(6)
    v_mfma_f32_16x16x32_bf16 v[116:119], a[244:247], a[44:47], v[116:119]
    s_sub_u32 s68, s68, s85
    ds_read_b128 a[96:99], v199 offset:25344
    s_add_u32 s68, s68, s84
    v_mfma_f32_16x16x32_bf16 v[116:119], a[248:251], a[56:59], v[116:119]
    s_sub_u32 s68, s68, s85
    ds_read_b128 a[100:103], v199 offset:27392
    s_add_u32 s68, s68, s84
    v_mfma_f32_16x16x32_bf16 v[116:119], a[252:255], a[68:71], v[116:119]
    ds_read_b64_tr_b16 a[220:221], v198 offset:25920
    ds_read_b64_tr_b16 a[222:223], v198 offset:26176
    v_mfma_f32_16x16x32_bf16 v[108:111], a[252:255], a[64:67], v[108:111]
    s_sub_u32 s68, s68, s85
    ds_read_b128 a[104:107], v199 offset:29440
    s_add_u32 s68, s68, s84
    v_mfma_f32_16x16x32_bf16 v[108:111], a[248:251], a[52:55], v[108:111]
    ds_read_b128 a[108:111], v200 offset:25344
    v_mfma_f32_16x16x32_bf16 v[108:111], a[244:247], a[40:43], v[108:111]
    s_sub_u32 s68, s68, s85
    ds_read_b64_tr_b16 a[224:225], v198 offset:16968
    ds_read_b64_tr_b16 a[226:227], v198 offset:17224
    s_add_u32 s68, s68, s84
    v_mfma_f32_16x16x32_bf16 v[108:111], a[240:243], a[28:31], v[108:111]
    ds_read_b128 a[112:115], v200 offset:27392
    v_mfma_f32_16x16x32_bf16 v[100:103], a[240:243], a[24:27], v[100:103]
    s_sub_u32 s68, s68, s85
    ds_read_b128 a[116:119], v200 offset:29440
    s_add_u32 s68, s68, s84
    v_mfma_f32_16x16x32_bf16 v[100:103], a[244:247], a[36:39], v[100:103]
    s_waitcnt lgkmcnt(14)
    ds_read_b64_tr_b16 a[228:229], v198 offset:17480
    ds_read_b64_tr_b16 a[230:231], v198 offset:17736
    v_mfma_f32_16x16x32_bf16 v[100:103], a[248:251], a[48:51], v[100:103]
    v_mfma_f32_16x16x32_bf16 v[100:103], a[252:255], a[60:63], v[100:103]
    v_mfma_f32_16x16x32_bf16 v[120:123], a[208:211], a[24:27], v[120:123]
    s_waitcnt lgkmcnt(8)
    ds_read_b64_tr_b16 a[232:233], v198 offset:25416
    ds_read_b64_tr_b16 a[234:235], v198 offset:25672
    s_sub_u32 s68, s68, s85
    v_mfma_f32_16x16x32_bf16 v[120:123], a[212:215], a[36:39], v[120:123]
    v_mfma_f32_16x16x32_bf16 v[120:123], a[216:219], a[48:51], v[120:123]
    v_mfma_f32_16x16x32_bf16 v[120:123], a[220:223], a[60:63], v[120:123]
    s_waitcnt vmcnt(14)
    ds_read_b64_tr_b16 a[236:237], v198 offset:25928
    ds_read_b64_tr_b16 a[238:239], v198 offset:26184
    s_add_u32 s68, s68, s84
    v_mfma_f32_16x16x32_bf16 v[128:131], a[220:223], a[64:67], v[128:131]
    v_mfma_f32_16x16x32_bf16 v[128:131], a[216:219], a[52:55], v[128:131]
    s_add_u32 m0, s35, 135168
    s_add_u32 s50, s49, 0
    buffer_load_dwordx4 v194, s[8:11], s50 offen lds
    v_mfma_f32_16x16x32_bf16 v[128:131], a[212:215], a[40:43], v[128:131]
    s_barrier
    ds_read_b64_tr_b16 a[240:241], v197 offset:0
    ds_read_b64_tr_b16 a[242:243], v197 offset:256
    s_sub_u32 s68, s68, s85
    v_mfma_f32_16x16x32_bf16 v[128:131], a[208:211], a[28:31], v[128:131]
    v_mfma_f32_16x16x32_bf16 v[136:139], a[208:211], a[32:35], v[136:139]
    s_add_u32 m0, s35, 136192
    s_add_u32 s50, s49, 7168
    buffer_load_dwordx4 v194, s[8:11], s50 offen lds
    v_mfma_f32_16x16x32_bf16 v[136:139], a[212:215], a[44:47], v[136:139]
    s_waitcnt lgkmcnt(10)
    ds_read_b64_tr_b16 a[244:245], v197 offset:512
    ds_read_b64_tr_b16 a[246:247], v197 offset:768
    s_add_u32 s68, s68, s84
    v_mfma_f32_16x16x32_bf16 v[136:139], a[216:219], a[56:59], v[136:139]
    v_mfma_f32_16x16x32_bf16 v[136:139], a[220:223], a[68:71], v[136:139]
    s_add_u32 m0, s35, 137216
    s_add_u32 s50, s49, 14336
    buffer_load_dwordx4 v194, s[8:11], s50 offen lds
    v_mfma_f32_16x16x32_bf16 v[140:143], a[224:227], a[32:35], v[140:143]
    s_waitcnt lgkmcnt(4)
    ds_read_b64_tr_b16 a[248:249], v197 offset:8448
    ds_read_b64_tr_b16 a[250:251], v197 offset:8704
    s_sub_u32 s68, s68, s85
    v_mfma_f32_16x16x32_bf16 v[140:143], a[228:231], a[44:47], v[140:143]
    v_mfma_f32_16x16x32_bf16 v[140:143], a[232:235], a[56:59], v[140:143]
    s_add_u32 m0, s35, 138240
    s_add_u32 s50, s49, 21504
    buffer_load_dwordx4 v194, s[8:11], s50 offen lds
    v_mfma_f32_16x16x32_bf16 v[140:143], a[236:239], a[68:71], v[140:143]
    s_add_u32 s68, s68, s84
    ds_read_b64_tr_b16 a[252:253], v197 offset:8960
    ds_read_b64_tr_b16 a[254:255], v197 offset:9216
    v_mfma_f32_16x16x32_bf16 v[132:135], a[236:239], a[64:67], v[132:135]
    v_mfma_f32_16x16x32_bf16 v[132:135], a[232:235], a[52:55], v[132:135]
    s_add_u32 m0, s35, 139264
    s_add_u32 s50, s49, 28672
    buffer_load_dwordx4 v194, s[8:11], s50 offen lds
    v_mfma_f32_16x16x32_bf16 v[132:135], a[228:231], a[40:43], v[132:135]
    s_min_i32 s68, s68, 4
    ds_read_b64_tr_b16 a[208:209], v197 offset:8
    ds_read_b64_tr_b16 a[210:211], v197 offset:264
    s_max_i32 s68, s68, -4
    v_mfma_f32_16x16x32_bf16 v[132:135], a[224:227], a[28:31], v[132:135]
    v_mfma_f32_16x16x32_bf16 v[124:127], a[224:227], a[24:27], v[124:127]
    s_add_u32 m0, s35, 140288
    s_add_u32 s50, s49, 35840
    buffer_load_dwordx4 v194, s[8:11], s50 offen lds
    v_mfma_f32_16x16x32_bf16 v[124:127], a[228:231], a[36:39], v[124:127]
    s_waitcnt lgkmcnt(8)
    ds_read_b64_tr_b16 a[212:213], v197 offset:520
    ds_read_b64_tr_b16 a[214:215], v197 offset:776
    s_add_u32 m0, s33, 50688
    v_mfma_f32_16x16x32_bf16 v[124:127], a[232:235], a[48:51], v[124:127]
    s_add_u32 s50, s39, 256
    v_mfma_f32_16x16x32_bf16 v[124:127], a[236:239], a[60:63], v[124:127]
    v_mfma_f32_16x16x32_bf16 v[144:147], a[240:243], a[24:27], v[144:147]
    s_waitcnt lgkmcnt(4)
    ds_read_b64_tr_b16 a[216:217], v197 offset:8456
    s_add_u32 s69, s69, s68
    v_mfma_f32_16x16x32_bf16 v[144:147], a[244:247], a[36:39], v[144:147]
    s_mov_b32 s68, 0
    ds_read_b64_tr_b16 a[218:219], v197 offset:8712
    s_mov_b64 s[84:85], 0
    v_mfma_f32_16x16x32_bf16 v[144:147], a[248:251], a[48:51], v[144:147]
    buffer_load_dwordx4 v193, s[12:15], s50 offen lds
    v_mfma_f32_16x16x32_bf16 v[144:147], a[252:255], a[60:63], v[144:147]
    s_xor_b32 s51, s95, 149504
    ds_read_b64_tr_b16 a[220:221], v197 offset:8968
    s_buffer_load_dword s85, s[28:31], s67 offset:62208
    v_mfma_f32_16x16x32_bf16 v[152:155], a[252:255], a[64:67], v[152:155]
    s_buffer_load_dword s84, s[28:31], s67 offset:54016
    ds_read_b64_tr_b16 a[222:223], v197 offset:9224
    v_mfma_f32_16x16x32_bf16 v[152:155], a[248:251], a[52:55], v[152:155]
    buffer_load_dwordx4 a[0:3], v240, s[16:19], s51 offen nt
    v_mfma_f32_16x16x32_bf16 v[152:155], a[244:247], a[40:43], v[152:155]
    s_add_u32 m0, s33, 51720
    ds_read_b64_tr_b16 a[224:225], v197 offset:64
    s_add_u32 s50, s39, 8448
    v_mfma_f32_16x16x32_bf16 v[152:155], a[240:243], a[28:31], v[152:155]
    ds_read_b64_tr_b16 a[226:227], v197 offset:320
    v_mfma_f32_16x16x32_bf16 v[160:163], a[240:243], a[32:35], v[160:163]
    buffer_load_dwordx4 v193, s[12:15], s50 offen lds
    v_mfma_f32_16x16x32_bf16 v[160:163], a[244:247], a[44:47], v[160:163]
    s_add_u32 m0, s33, 52800
    ds_read_b64_tr_b16 a[228:229], v197 offset:576
    s_add_u32 s50, s39, 16640
    v_mfma_f32_16x16x32_bf16 v[160:163], a[248:251], a[56:59], v[160:163]
    s_waitcnt lgkmcnt(9)
    ds_read_b64_tr_b16 a[230:231], v197 offset:832
    v_mfma_f32_16x16x32_bf16 v[160:163], a[252:255], a[68:71], v[160:163]
    buffer_load_dwordx4 v193, s[12:15], s50 offen lds
    v_mfma_f32_16x16x32_bf16 v[164:167], a[208:211], a[32:35], v[164:167]
    s_waitcnt lgkmcnt(4)
    ds_read_b64_tr_b16 a[232:233], v197 offset:8512
    s_add_u32 m0, s33, 53832
    v_mfma_f32_16x16x32_bf16 v[164:167], a[212:215], a[44:47], v[164:167]
    s_waitcnt vmcnt(14)
    ds_read_b64_tr_b16 a[234:235], v197 offset:8768
    s_add_u32 s50, s39, 24832
    v_mfma_f32_16x16x32_bf16 v[164:167], a[216:219], a[56:59], v[164:167]
    s_sub_u32 s68, s68, s85
    ds_read_b128 a[120:123], v199 offset:0
    buffer_load_dwordx4 v193, s[12:15], s50 offen lds
    v_mfma_f32_16x16x32_bf16 v[164:167], a[220:223], a[68:71], v[164:167]
    s_add_u32 s68, s68, s84
    ds_read_b64_tr_b16 a[236:237], v197 offset:9024
    v_mfma_f32_16x16x32_bf16 v[156:159], a[220:223], a[64:67], v[156:159]
    s_sub_u32 s68, s68, s85
    ds_read_b64_tr_b16 a[238:239], v197 offset:9280
    s_add_u32 s68, s68, s84
    v_mfma_f32_16x16x32_bf16 v[156:159], a[216:219], a[52:55], v[156:159]
    ds_read_b128 a[124:127], v199 offset:2048
    buffer_load_dwordx4 a[4:7], v240, s[16:19], s51 offen offset:512 nt
    v_mfma_f32_16x16x32_bf16 v[156:159], a[212:215], a[40:43], v[156:159]
    s_sub_u32 s68, s68, s85
    ds_read_b64_tr_b16 a[240:241], v197 offset:72
    s_add_u32 s68, s68, s84
    v_mfma_f32_16x16x32_bf16 v[156:159], a[208:211], a[28:31], v[156:159]
    ds_read_b64_tr_b16 a[242:243], v197 offset:328
    v_mfma_f32_16x16x32_bf16 v[148:151], a[208:211], a[24:27], v[148:151]
    s_sub_u32 s68, s68, s85
    ds_read_b128 a[128:131], v199 offset:4096
    s_add_u32 s68, s68, s84
    v_mfma_f32_16x16x32_bf16 v[148:151], a[212:215], a[36:39], v[148:151]
    ds_read_b64_tr_b16 a[244:245], v197 offset:584
    v_mfma_f32_16x16x32_bf16 v[148:151], a[216:219], a[48:51], v[148:151]
    s_sub_u32 s68, s68, s85
    ds_read_b64_tr_b16 a[246:247], v197 offset:840
    s_add_u32 s68, s68, s84
    v_mfma_f32_16x16x32_bf16 v[148:151], a[220:223], a[60:63], v[148:151]
    s_waitcnt lgkmcnt(13)
    ds_read_b128 a[132:135], v200 offset:0
    v_mfma_f32_16x16x32_bf16 v[168:171], a[224:227], a[24:27], v[168:171]
    s_waitcnt lgkmcnt(7)
    ds_read_b64_tr_b16 a[248:249], v197 offset:8520
    s_sub_u32 s68, s68, s85
    v_mfma_f32_16x16x32_bf16 v[168:171], a[228:231], a[36:39], v[168:171]
    s_add_u32 s68, s68, s84
    ds_read_b64_tr_b16 a[250:251], v197 offset:8776
    v_mfma_f32_16x16x32_bf16 v[168:171], a[232:235], a[48:51], v[168:171]
    s_sub_u32 s68, s68, s85
    ds_read_b128 a[136:139], v200 offset:2048
    s_add_u32 s68, s68, s84
    v_mfma_f32_16x16x32_bf16 v[168:171], a[236:239], a[60:63], v[168:171]
    ds_read_b64_tr_b16 a[252:253], v197 offset:9032
    v_mfma_f32_16x16x32_bf16 v[176:179], a[236:239], a[64:67], v[176:179]
    s_waitcnt vmcnt(16)
    ds_read_b64_tr_b16 a[254:255], v197 offset:9288
    s_sub_u32 s68, s68, s85
    v_mfma_f32_16x16x32_bf16 v[176:179], a[232:235], a[52:55], v[176:179]
    s_add_u32 s68, s68, s84
    ds_read_b128 a[140:143], v200 offset:4096
    v_mfma_f32_16x16x32_bf16 v[176:179], a[228:231], a[40:43], v[176:179]
    s_barrier
    ds_read_b64_tr_b16 a[208:209], v197 offset:16896
    s_sub_u32 s68, s68, s85
    v_mfma_f32_16x16x32_bf16 v[176:179], a[224:227], a[28:31], v[176:179]
    s_add_u32 s68, s68, s84
    ds_read_b64_tr_b16 a[210:211], v197 offset:17152
    v_mfma_f32_16x16x32_bf16 v[184:187], a[224:227], a[32:35], v[184:187]
    buffer_load_dwordx4 a[8:11], v240, s[16:19], s51 offen offset:1024 nt
    v_mfma_f32_16x16x32_bf16 v[184:187], a[228:231], a[44:47], v[184:187]
    s_sub_u32 s68, s68, s85
    ds_read_b64_tr_b16 a[212:213], v197 offset:17408
    s_add_u32 s68, s68, s84
    v_mfma_f32_16x16x32_bf16 v[184:187], a[232:235], a[56:59], v[184:187]
    s_waitcnt lgkmcnt(13)
    ds_read_b64_tr_b16 a[214:215], v197 offset:17664
    s_sub_u32 s68, s68, s85
    v_mfma_f32_16x16x32_bf16 v[184:187], a[236:239], a[68:71], v[184:187]
    v_mfma_f32_16x16x32_bf16 v[188:191], a[240:243], a[32:35], v[188:191]
    s_waitcnt lgkmcnt(5)
    ds_read_b64_tr_b16 a[216:217], v197 offset:25344
    s_add_u32 s68, s68, s84
    v_mfma_f32_16x16x32_bf16 v[188:191], a[244:247], a[44:47], v[188:191]
    s_sub_u32 s68, s68, s85
    ds_read_b64_tr_b16 a[218:219], v197 offset:25600
    s_add_u32 s68, s68, s84
    v_mfma_f32_16x16x32_bf16 v[188:191], a[248:251], a[56:59], v[188:191]
    buffer_load_dwordx4 a[12:15], v240, s[16:19], s51 offen offset:1536 nt
    v_mfma_f32_16x16x32_bf16 v[188:191], a[252:255], a[68:71], v[188:191]
    s_sub_u32 s68, s68, s85
    ds_read_b64_tr_b16 a[220:221], v197 offset:25856
    s_add_u32 s68, s68, s84
    v_mfma_f32_16x16x32_bf16 v[180:183], a[252:255], a[64:67], v[180:183]
    ds_read_b64_tr_b16 a[222:223], v197 offset:26112
    v_mfma_f32_16x16x32_bf16 v[180:183], a[248:251], a[52:55], v[180:183]
    v_mfma_f32_16x16x32_bf16 v[180:183], a[244:247], a[40:43], v[180:183]
    s_sub_u32 s68, s68, s85
    ds_read_b64_tr_b16 a[224:225], v197 offset:16904
    s_add_u32 s68, s68, s84
    v_mfma_f32_16x16x32_bf16 v[180:183], a[240:243], a[28:31], v[180:183]
    s_sub_u32 s68, s68, s85
    ds_read_b64_tr_b16 a[226:227], v197 offset:17160
    s_add_u32 s68, s68, s84
    v_mfma_f32_16x16x32_bf16 v[172:175], a[240:243], a[24:27], v[172:175]
    s_add_u32 m0, s33, 67584
    s_add_u32 s50, s39, 384
    v_mfma_f32_16x16x32_bf16 v[172:175], a[244:247], a[36:39], v[172:175]
    s_min_i32 s68, s68, 4
    ds_read_b64_tr_b16 a[228:229], v197 offset:17416
    s_max_i32 s68, s68, -4
    v_mfma_f32_16x16x32_bf16 v[172:175], a[248:251], a[48:51], v[172:175]
    s_add_u32 s69, s69, s68
    ds_read_b64_tr_b16 a[230:231], v197 offset:17672
    s_mov_b32 s68, 0
    v_mfma_f32_16x16x32_bf16 v[172:175], a[252:255], a[60:63], v[172:175]
    s_waitcnt lgkmcnt(10)
    v_mfma_f32_16x16x32_bf16 v[0:3], a[208:211], a[72:75], v[0:3]
    s_waitcnt lgkmcnt(4)
    ds_read_b64_tr_b16 a[232:233], v197 offset:25352
    s_mov_b64 s[84:85], 0
    v_mfma_f32_16x16x32_bf16 v[0:3], a[212:215], a[84:87], v[0:3]
    s_buffer_load_dword s84, s[28:31], s67 offset:66560
    ds_read_b64_tr_b16 a[234:235], v197 offset:25608
    s_buffer_load_dword s85, s[28:31], s67 offset:74752
    v_mfma_f32_16x16x32_bf16 v[0:3], a[216:219], a[96:99], v[0:3]
    buffer_load_dwordx4 v193, s[12:15], s50 offen lds
    v_mfma_f32_16x16x32_bf16 v[0:3], a[220:223], a[108:111], v[0:3]
    s_add_u32 m0, s33, 68616
    ds_read_b64_tr_b16 a[236:237], v197 offset:25864
    s_add_u32 s50, s39, 8576
    v_mfma_f32_16x16x32_bf16 v[8:11], a[220:223], a[112:115], v[8:11]
    ds_read_b64_tr_b16 a[238:239], v197 offset:26120
    v_mfma_f32_16x16x32_bf16 v[8:11], a[216:219], a[100:103], v[8:11]
    buffer_load_dwordx4 v193, s[12:15], s50 offen lds
    v_mfma_f32_16x16x32_bf16 v[8:11], a[212:215], a[88:91], v[8:11]
    s_xor_b32 s51, s95, 0
    ds_read_b64_tr_b16 a[240:241], v197 offset:16960
    s_add_u32 m0, s33, 118272
    v_mfma_f32_16x16x32_bf16 v[8:11], a[208:211], a[76:79], v[8:11]
    ds_read_b64_tr_b16 a[242:243], v197 offset:17216
    v_mfma_f32_16x16x32_bf16 v[16:19], a[208:211], a[80:83], v[16:19]
    buffer_load_dwordx4 v240, s[16:19], s51 offen nt lds
    v_mfma_f32_16x16x32_bf16 v[16:19], a[212:215], a[92:95], v[16:19]
    s_add_u32 m0, s33, 69696
    ds_read_b64_tr_b16 a[244:245], v197 offset:17472
    s_add_u32 s50, s39, 16768
    v_mfma_f32_16x16x32_bf16 v[16:19], a[216:219], a[104:107], v[16:19]
    s_waitcnt lgkmcnt(9)
    ds_read_b64_tr_b16 a[246:247], v197 offset:17728
    v_mfma_f32_16x16x32_bf16 v[16:19], a[220:223], a[116:119], v[16:19]
    buffer_load_dwordx4 v193, s[12:15], s50 offen lds
    v_mfma_f32_16x16x32_bf16 v[20:23], a[224:227], a[80:83], v[20:23]
    s_waitcnt lgkmcnt(4)
    ds_read_b64_tr_b16 a[248:249], v197 offset:25408
    s_add_u32 m0, s33, 70728
    v_mfma_f32_16x16x32_bf16 v[20:23], a[228:231], a[92:95], v[20:23]
    s_waitcnt vmcnt(12)
    ds_read_b64_tr_b16 a[250:251], v197 offset:25664
    s_add_u32 s50, s39, 24960
    v_mfma_f32_16x16x32_bf16 v[20:23], a[232:235], a[104:107], v[20:23]
    s_add_u32 s68, s68, s84
    ds_read_b128 a[144:147], v199 offset:50688
    buffer_load_dwordx4 v193, s[12:15], s50 offen lds
    v_mfma_f32_16x16x32_bf16 v[20:23], a[236:239], a[116:119], v[20:23]
    s_add_u32 m0, s33, 118816
    ds_read_b64_tr_b16 a[252:253], v197 offset:25920
    s_sub_u32 s68, s68, s85
    v_mfma_f32_16x16x32_bf16 v[12:15], a[236:239], a[112:115], v[12:15]
    s_add_u32 s68, s68, s84
    ds_read_b64_tr_b16 a[254:255], v197 offset:26176
    s_sub_u32 s68, s68, s85
    v_mfma_f32_16x16x32_bf16 v[12:15], a[232:235], a[100:103], v[12:15]
    ds_read_b128 a[148:151], v199 offset:52736
    buffer_load_dwordx4 v240, s[16:19], s51 offen offset:512 nt lds
    v_mfma_f32_16x16x32_bf16 v[12:15], a[228:231], a[88:91], v[12:15]
    s_add_u32 s68, s68, s84
    ds_read_b64_tr_b16 a[208:209], v197 offset:16968
    s_sub_u32 s68, s68, s85
    v_mfma_f32_16x16x32_bf16 v[12:15], a[224:227], a[76:79], v[12:15]
    ds_read_b64_tr_b16 a[210:211], v197 offset:17224
    v_mfma_f32_16x16x32_bf16 v[4:7], a[224:227], a[72:75], v[4:7]
    s_add_u32 s68, s68, s84
    ds_read_b128 a[152:155], v199 offset:54784
    s_sub_u32 s68, s68, s85
    v_mfma_f32_16x16x32_bf16 v[4:7], a[228:231], a[84:87], v[4:7]
    ds_read_b64_tr_b16 a[212:213], v197 offset:17480
    v_mfma_f32_16x16x32_bf16 v[4:7], a[232:235], a[96:99], v[4:7]
    s_add_u32 s68, s68, s84
    ds_read_b64_tr_b16 a[214:215], v197 offset:17736
    s_sub_u32 s68, s68, s85
    v_mfma_f32_16x16x32_bf16 v[4:7], a[236:239], a[108:111], v[4:7]
    s_waitcnt lgkmcnt(13)
    ds_read_b128 a[156:159], v200 offset:50688
    v_mfma_f32_16x16x32_bf16 v[24:27], a[240:243], a[72:75], v[24:27]
    s_waitcnt lgkmcnt(7)
    ds_read_b64_tr_b16 a[216:217], v197 offset:25416
    s_add_u32 s68, s68, s84
    v_mfma_f32_16x16x32_bf16 v[24:27], a[244:247], a[84:87], v[24:27]
    s_sub_u32 s68, s68, s85
    ds_read_b64_tr_b16 a[218:219], v197 offset:25672
    v_mfma_f32_16x16x32_bf16 v[24:27], a[248:251], a[96:99], v[24:27]
    s_add_u32 m0, s33, 119360
    ds_read_b128 a[160:163], v200 offset:52736
    s_add_u32 s68, s68, s84
    v_mfma_f32_16x16x32_bf16 v[24:27], a[252:255], a[108:111], v[24:27]
    s_sub_u32 s68, s68, s85
    ds_read_b64_tr_b16 a[220:221], v197 offset:25928
    v_mfma_f32_16x16x32_bf16 v[32:35], a[252:255], a[112:115], v[32:35]
    s_waitcnt vmcnt(14)
    ds_read_b64_tr_b16 a[222:223], v197 offset:26184
    s_add_u32 s68, s68, s84
    v_mfma_f32_16x16x32_bf16 v[32:35], a[248:251], a[100:103], v[32:35]
    s_sub_u32 s68, s68, s85
    ds_read_b128 a[164:167], v200 offset:54784
    v_mfma_f32_16x16x32_bf16 v[32:35], a[244:247], a[88:91], v[32:35]
    s_barrier
    ds_read_b64_tr_b16 a[224:225], v197 offset:33792
    s_add_u32 s68, s68, s84
    v_mfma_f32_16x16x32_bf16 v[32:35], a[240:243], a[76:79], v[32:35]
    s_sub_u32 s68, s68, s85
    ds_read_b64_tr_b16 a[226:227], v197 offset:34048
    v_mfma_f32_16x16x32_bf16 v[40:43], a[240:243], a[80:83], v[40:43]
    buffer_load_dwordx4 v240, s[16:19], s51 offen offset:1024 nt lds
    v_mfma_f32_16x16x32_bf16 v[40:43], a[244:247], a[92:95], v[40:43]
    s_add_u32 s68, s68, s84
    ds_read_b64_tr_b16 a[228:229], v197 offset:34304
    s_sub_u32 s68, s68, s85
    v_mfma_f32_16x16x32_bf16 v[40:43], a[248:251], a[104:107], v[40:43]
    s_waitcnt lgkmcnt(13)
    ds_read_b64_tr_b16 a[230:231], v197 offset:34560
    s_add_u32 s68, s68, s84
    v_mfma_f32_16x16x32_bf16 v[40:43], a[252:255], a[116:119], v[40:43]
L_pad1:
    s_cbranch_execz L_pad5
    s_add_u32 m0, s33, 119904
    v_mfma_f32_16x16x32_bf16 v[44:47], a[208:211], a[80:83], v[44:47]
    s_waitcnt lgkmcnt(5)
    ds_read_b64_tr_b16 a[232:233], v197 offset:42240
    s_sub_u32 s68, s68, s85
    v_mfma_f32_16x16x32_bf16 v[44:47], a[212:215], a[92:95], v[44:47]
    s_add_u32 s68, s68, s84
    ds_read_b64_tr_b16 a[234:235], v197 offset:42496
    s_sub_u32 s68, s68, s85
    v_mfma_f32_16x16x32_bf16 v[44:47], a[216:219], a[104:107], v[44:47]
    v_mfma_f32_16x16x32_bf16 v[44:47], a[220:223], a[116:119], v[44:47]
    s_add_u32 s68, s68, s84
    ds_read_b64_tr_b16 a[236:237], v197 offset:42752
    s_sub_u32 s68, s68, s85
    v_mfma_f32_16x16x32_bf16 v[36:39], a[220:223], a[112:115], v[36:39]
    ds_read_b64_tr_b16 a[238:239], v197 offset:43008
    v_mfma_f32_16x16x32_bf16 v[36:39], a[216:219], a[100:103], v[36:39]
    buffer_load_dwordx4 v240, s[16:19], s51 offen offset:1536 nt lds
    v_mfma_f32_16x16x32_bf16 v[36:39], a[212:215], a[88:91], v[36:39]
    s_min_i32 s68, s68, 4
    ds_read_b64_tr_b16 a[240:241], v197 offset:33800
    s_max_i32 s68, s68, -4
    v_mfma_f32_16x16x32_bf16 v[36:39], a[208:211], a[76:79], v[36:39]
    s_add_u32 s69, s69, s68
    ds_read_b64_tr_b16 a[242:243], v197 offset:34056
    s_mov_b32 s68, 0
    v_mfma_f32_16x16x32_bf16 v[28:31], a[208:211], a[72:75], v[28:31]
    s_add_u32 m0, s33, 0
    s_add_u32 s50, s41, 0
    v_mfma_f32_16x16x32_bf16 v[28:31], a[212:215], a[84:87], v[28:31]
    s_mov_b64 s[84:85], 0
    ds_read_b64_tr_b16 a[244:245], v197 offset:34312
    v_mfma_f32_16x16x32_bf16 v[28:31], a[216:219], a[96:99], v[28:31]
    s_waitcnt lgkmcnt(9)
    ds_read_b64_tr_b16 a[246:247], v197 offset:34568
    s_buffer_load_dword s84, s[28:31], s67 offset:87296
    v_mfma_f32_16x16x32_bf16 v[28:31], a[220:223], a[108:111], v[28:31]
    v_mfma_f32_16x16x32_bf16 v[48:51], a[224:227], a[72:75], v[48:51]
    s_waitcnt lgkmcnt(4)
    ds_read_b64_tr_b16 a[248:249], v197 offset:42248
    s_buffer_load_dword s85, s[28:31], s67 offset:95488
    v_mfma_f32_16x16x32_bf16 v[48:51], a[228:231], a[84:87], v[48:51]
    ds_read_b64_tr_b16 a[250:251], v197 offset:42504
    v_mfma_f32_16x16x32_bf16 v[48:51], a[232:235], a[96:99], v[48:51]
    buffer_load_dwordx4 v193, s[12:15], s50 offen lds
    v_mfma_f32_16x16x32_bf16 v[48:51], a[236:239], a[108:111], v[48:51]
    s_add_u32 m0, s33, 1032
    ds_read_b64_tr_b16 a[252:253], v197 offset:42760
    s_add_u32 s50, s41, 8192
    v_mfma_f32_16x16x32_bf16 v[56:59], a[236:239], a[112:115], v[56:59]
    ds_read_b64_tr_b16 a[254:255], v197 offset:43016
    v_mfma_f32_16x16x32_bf16 v[56:59], a[232:235], a[100:103], v[56:59]
    buffer_load_dwordx4 v193, s[12:15], s50 offen lds
    v_mfma_f32_16x16x32_bf16 v[56:59], a[228:231], a[88:91], v[56:59]
    s_add_u32 m0, s33, 2112
    ds_read_b64_tr_b16 a[208:209], v197 offset:33856
    s_add_u32 s50, s41, 16384
    v_mfma_f32_16x16x32_bf16 v[56:59], a[224:227], a[76:79], v[56:59]
    ds_read_b64_tr_b16 a[210:211], v197 offset:34112
    v_mfma_f32_16x16x32_bf16 v[64:67], a[224:227], a[80:83], v[64:67]
    buffer_load_dwordx4 v193, s[12:15], s50 offen lds
    v_mfma_f32_16x16x32_bf16 v[64:67], a[228:231], a[92:95], v[64:67]
    s_add_u32 m0, s33, 3144
    ds_read_b64_tr_b16 a[212:213], v197 offset:34368
    s_add_u32 s50, s41, 24576
    v_mfma_f32_16x16x32_bf16 v[64:67], a[232:235], a[104:107], v[64:67]
    s_waitcnt lgkmcnt(9)
    ds_read_b64_tr_b16 a[214:215], v197 offset:34624
    s_add_u32 s68, s68, s84
    v_mfma_f32_16x16x32_bf16 v[64:67], a[236:239], a[116:119], v[64:67]
    buffer_load_dwordx4 v193, s[12:15], s50 offen lds
    v_mfma_f32_16x16x32_bf16 v[68:71], a[240:243], a[80:83], v[68:71]
    s_waitcnt lgkmcnt(4)
    ds_read_b64_tr_b16 a[216:217], v197 offset:42304
    s_xor_b32 s51, s95, 2048
    v_mfma_f32_16x16x32_bf16 v[68:71], a[244:247], a[92:95], v[68:71]
    s_add_u32 m0, s33, 84480
    ds_read_b64_tr_b16 a[218:219], v197 offset:42560
    s_sub_u32 s68, s68, s85
    v_mfma_f32_16x16x32_bf16 v[68:71], a[248:251], a[104:107], v[68:71]
    buffer_load_dwordx4 v240, s[16:19], s51 offen nt lds
    v_mfma_f32_16x16x32_bf16 v[68:71], a[252:255], a[116:119], v[68:71]
    s_add_u32 s68, s68, s84
    ds_read_b64_tr_b16 a[220:221], v197 offset:42816
    s_sub_u32 s68, s68, s85
    v_mfma_f32_16x16x32_bf16 v[60:63], a[252:255], a[112:115], v[60:63]
    s_add_u32 s68, s68, s84
    ds_read_b64_tr_b16 a[222:223], v197 offset:43072
    s_sub_u32 s68, s68, s85
    v_mfma_f32_16x16x32_bf16 v[60:63], a[248:251], a[100:103], v[60:63]
    s_add_u32 m0, s33, 85024
    v_mfma_f32_16x16x32_bf16 v[60:63], a[244:247], a[88:91], v[60:63]
    s_add_u32 s68, s68, s84
    ds_read_b64_tr_b16 a[224:225], v197 offset:33864
    s_sub_u32 s68, s68, s85
    v_mfma_f32_16x16x32_bf16 v[60:63], a[240:243], a[76:79], v[60:63]
    ds_read_b64_tr_b16 a[226:227], v197 offset:34120
    v_mfma_f32_16x16x32_bf16 v[52:55], a[240:243], a[72:75], v[52:55]
    v_mfma_f32_16x16x32_bf16 v[52:55], a[244:247], a[84:87], v[52:55]
    s_add_u32 s68, s68, s84
    ds_read_b64_tr_b16 a[228:229], v197 offset:34376
    s_sub_u32 s68, s68, s85
    v_mfma_f32_16x16x32_bf16 v[52:55], a[248:251], a[96:99], v[52:55]
    s_waitcnt lgkmcnt(9)
    ds_read_b64_tr_b16 a[230:231], v197 offset:34632
    s_add_u32 s68, s68, s84
    v_mfma_f32_16x16x32_bf16 v[52:55], a[252:255], a[108:111], v[52:55]
    buffer_load_dwordx4 v240, s[16:19], s51 offen offset:512 nt lds
    v_mfma_f32_16x16x32_bf16 v[72:75], a[208:211], a[72:75], v[72:75]
    s_waitcnt lgkmcnt(4)
    ds_read_b64_tr_b16 a[232:233], v197 offset:42312
    s_sub_u32 s68, s68, s85
    v_mfma_f32_16x16x32_bf16 v[72:75], a[212:215], a[84:87], v[72:75]
    s_add_u32 s68, s68, s84
    ds_read_b64_tr_b16 a[234:235], v197 offset:42568
    s_sub_u32 s68, s68, s85
    v_mfma_f32_16x16x32_bf16 v[72:75], a[216:219], a[96:99], v[72:75]
    v_mfma_f32_16x16x32_bf16 v[72:75], a[220:223], a[108:111], v[72:75]
    s_add_u32 s68, s68, s84
    ds_read_b64_tr_b16 a[236:237], v197 offset:42824
    s_sub_u32 s68, s68, s85
    v_mfma_f32_16x16x32_bf16 v[80:83], a[220:223], a[112:115], v[80:83]
    s_waitcnt vmcnt(17)
    ds_read_b64_tr_b16 a[238:239], v197 offset:43080
    v_mfma_f32_16x16x32_bf16 v[80:83], a[216:219], a[100:103], v[80:83]
    s_add_u32 m0, s33, 85568
    v_mfma_f32_16x16x32_bf16 v[80:83], a[212:215], a[88:91], v[80:83]
    s_barrier
    ds_read_b64_tr_b16 a[240:241], v198 offset:0
    s_add_u32 s68, s68, s84
    v_mfma_f32_16x16x32_bf16 v[80:83], a[208:211], a[76:79], v[80:83]
    s_sub_u32 s68, s68, s85
    ds_read_b64_tr_b16 a[242:243], v198 offset:256
    v_mfma_f32_16x16x32_bf16 v[88:91], a[208:211], a[80:83], v[88:91]
    v_mfma_f32_16x16x32_bf16 v[88:91], a[212:215], a[92:95], v[88:91]
    s_add_u32 s68, s68, s84
    ds_read_b64_tr_b16 a[244:245], v198 offset:512
    s_sub_u32 s68, s68, s85
    v_mfma_f32_16x16x32_bf16 v[88:91], a[216:219], a[104:107], v[88:91]
    s_waitcnt lgkmcnt(9)
    ds_read_b64_tr_b16 a[246:247], v198 offset:768
    s_add_u32 s68, s68, s84
    v_mfma_f32_16x16x32_bf16 v[88:91], a[220:223], a[116:119], v[88:91]
    buffer_load_dwordx4 v240, s[16:19], s51 offen offset:1024 nt lds
    v_mfma_f32_16x16x32_bf16 v[92:95], a[224:227], a[80:83], v[92:95]
    s_waitcnt lgkmcnt(4)
    ds_read_b64_tr_b16 a[248:249], v198 offset:8448
    s_sub_u32 s68, s68, s85
    v_mfma_f32_16x16x32_bf16 v[92:95], a[228:231], a[92:95], v[92:95]
    s_add_u32 s68, s68, s84
    ds_read_b64_tr_b16 a[250:251], v198 offset:8704
    s_sub_u32 s68, s68, s85
    v_mfma_f32_16x16x32_bf16 v[92:95], a[232:235], a[104:107], v[92:95]
    v_mfma_f32_16x16x32_bf16 v[92:95], a[236:239], a[116:119], v[92:95]
    s_add_u32 s68, s68, s84
    ds_read_b64_tr_b16 a[252:253], v198 offset:8960
    s_sub_u32 s68, s68, s85
    v_mfma_f32_16x16x32_bf16 v[84:87], a[236:239], a[112:115], v[84:87]
    ds_read_b64_tr_b16 a[254:255], v198 offset:9216
    v_mfma_f32_16x16x32_bf16 v[84:87], a[232:235], a[100:103], v[84:87]
    s_add_u32 m0, s33, 86112
    v_mfma_f32_16x16x32_bf16 v[84:87], a[228:231], a[88:91], v[84:87]
    s_min_i32 s68, s68, 4
    ds_read_b64_tr_b16 a[208:209], v198 offset:8
    s_max_i32 s68, s68, -4
    v_mfma_f32_16x16x32_bf16 v[84:87], a[224:227], a[76:79], v[84:87]
    s_add_u32 s69, s69, s68
    ds_read_b64_tr_b16 a[210:211], v198 offset:264
    s_mov_b32 s68, 0
    v_mfma_f32_16x16x32_bf16 v[76:79], a[224:227], a[72:75], v[76:79]
    v_mfma_f32_16x16x32_bf16 v[76:79], a[228:231], a[84:87], v[76:79]
    s_mov_b64 s[84:85], 0
    ds_read_b64_tr_b16 a[212:213], v198 offset:520
    v_mfma_f32_16x16x32_bf16 v[76:79], a[232:235], a[96:99], v[76:79]
    s_waitcnt lgkmcnt(9)
    ds_read_b64_tr_b16 a[214:215], v198 offset:776
    s_buffer_load_dword s85, s[28:31], s67 offset:108032
    v_mfma_f32_16x16x32_bf16 v[76:79], a[236:239], a[108:111], v[76:79]
    buffer_load_dwordx4 v240, s[16:19], s51 offen offset:1536 nt lds
    v_mfma_f32_16x16x32_bf16 v[96:99], a[240:243], a[72:75], v[96:99]
    s_waitcnt lgkmcnt(4)
    ds_read_b64_tr_b16 a[216:217], v198 offset:8456
    s_add_u32 m0, s33, 16896
    v_mfma_f32_16x16x32_bf16 v[96:99], a[244:247], a[84:87], v[96:99]
    s_add_u32 s50, s41, 128
    ds_read_b64_tr_b16 a[218:219], v198 offset:8712
    s_buffer_load_dword s84, s[28:31], s67 offset:99840
    v_mfma_f32_16x16x32_bf16 v[96:99], a[248:251], a[96:99], v[96:99]
    buffer_load_dwordx4 v193, s[12:15], s50 offen lds
    v_mfma_f32_16x16x32_bf16 v[96:99], a[252:255], a[108:111], v[96:99]
    s_add_u32 m0, s33, 17928
    ds_read_b64_tr_b16 a[220:221], v198 offset:8968
    s_add_u32 s50, s41, 8320
    v_mfma_f32_16x16x32_bf16 v[104:107], a[252:255], a[112:115], v[104:107]
    ds_read_b64_tr_b16 a[222:223], v198 offset:9224
    v_mfma_f32_16x16x32_bf16 v[104:107], a[248:251], a[100:103], v[104:107]
    buffer_load_dwordx4 v193, s[12:15], s50 offen lds
    v_mfma_f32_16x16x32_bf16 v[104:107], a[244:247], a[88:91], v[104:107]
    s_add_u32 m0, s33, 19008
    ds_read_b64_tr_b16 a[224:225], v198 offset:64
    s_add_u32 s50, s41, 16512
    v_mfma_f32_16x16x32_bf16 v[104:107], a[240:243], a[76:79], v[104:107]
    ds_read_b64_tr_b16 a[226:227], v198 offset:320
    v_mfma_f32_16x16x32_bf16 v[112:115], a[240:243], a[80:83], v[112:115]
    buffer_load_dwordx4 v193, s[12:15], s50 offen lds
    v_mfma_f32_16x16x32_bf16 v[112:115], a[244:247], a[92:95], v[112:115]
    s_add_u32 m0, s33, 20040
    ds_read_b64_tr_b16 a[228:229], v198 offset:576
    s_add_u32 s50, s41, 24704
    v_mfma_f32_16x16x32_bf16 v[112:115], a[248:251], a[104:107], v[112:115]
    s_waitcnt lgkmcnt(9)
    ds_read_b64_tr_b16 a[230:231], v198 offset:832
    v_mfma_f32_16x16x32_bf16 v[112:115], a[252:255], a[116:119], v[112:115]
    buffer_load_dwordx4 v193, s[12:15], s50 offen lds
    v_mfma_f32_16x16x32_bf16 v[116:119], a[208:211], a[80:83], v[116:119]
    s_waitcnt lgkmcnt(4)
    ds_read_b64_tr_b16 a[232:233], v198 offset:8512
    s_xor_b32 s51, s95, 0
    v_mfma_f32_16x16x32_bf16 v[116:119], a[212:215], a[92:95], v[116:119]
    s_add_u32 m0, s33, 101376
    ds_read_b64_tr_b16 a[234:235], v198 offset:8768
    s_sub_u32 s68, s68, s85
    v_mfma_f32_16x16x32_bf16 v[116:119], a[216:219], a[104:107], v[116:119]
    buffer_load_dwordx4 v240, s[20:23], s51 offen nt lds
    v_mfma_f32_16x16x32_bf16 v[116:119], a[220:223], a[116:119], v[116:119]
    s_add_u32 s68, s68, s84
    ds_read_b64_tr_b16 a[236:237], v198 offset:9024
    v_mfma_f32_16x16x32_bf16 v[108:111], a[220:223], a[112:115], v[108:111]
    s_sub_u32 s68, s68, s85
    ds_read_b64_tr_b16 a[238:239], v198 offset:9280
    s_add_u32 s68, s68, s84
    v_mfma_f32_16x16x32_bf16 v[108:111], a[216:219], a[100:103], v[108:111]
    v_mfma_f32_16x16x32_bf16 v[108:111], a[212:215], a[88:91], v[108:111]
    s_sub_u32 s68, s68, s85
    ds_read_b64_tr_b16 a[240:241], v198 offset:72
    s_add_u32 s68, s68, s84
    v_mfma_f32_16x16x32_bf16 v[108:111], a[208:211], a[76:79], v[108:111]
    ds_read_b64_tr_b16 a[242:243], v198 offset:328
    v_mfma_f32_16x16x32_bf16 v[100:103], a[208:211], a[72:75], v[100:103]
    s_add_u32 m0, s33, 101920
    v_mfma_f32_16x16x32_bf16 v[100:103], a[212:215], a[84:87], v[100:103]
    s_sub_u32 s68, s68, s85
    ds_read_b64_tr_b16 a[244:245], v198 offset:584
    s_add_u32 s68, s68, s84
    v_mfma_f32_16x16x32_bf16 v[100:103], a[216:219], a[96:99], v[100:103]
    s_waitcnt lgkmcnt(9)
    ds_read_b64_tr_b16 a[246:247], v198 offset:840
    s_sub_u32 s68, s68, s85
    v_mfma_f32_16x16x32_bf16 v[100:103], a[220:223], a[108:111], v[100:103]
    v_mfma_f32_16x16x32_bf16 v[120:123], a[224:227], a[72:75], v[120:123]
    s_waitcnt lgkmcnt(4)
    ds_read_b64_tr_b16 a[248:249], v198 offset:8520
    s_add_u32 s68, s68, s84
    v_mfma_f32_16x16x32_bf16 v[120:123], a[228:231], a[84:87], v[120:123]
    s_sub_u32 s68, s68, s85
    ds_read_b64_tr_b16 a[250:251], v198 offset:8776
    s_add_u32 s68, s68, s84
    v_mfma_f32_16x16x32_bf16 v[120:123], a[232:235], a[96:99], v[120:123]
    buffer_load_dwordx4 v240, s[20:23], s51 offen offset:512 nt lds
    v_mfma_f32_16x16x32_bf16 v[120:123], a[236:239], a[108:111], v[120:123]
    s_sub_u32 s68, s68, s85
    ds_read_b64_tr_b16 a[252:253], v198 offset:9032
    s_add_u32 s68, s68, s84
    v_mfma_f32_16x16x32_bf16 v[128:131], a[236:239], a[112:115], v[128:131]
    s_waitcnt vmcnt(17)
    ds_read_b64_tr_b16 a[254:255], v198 offset:9288
    v_mfma_f32_16x16x32_bf16 v[128:131], a[232:235], a[100:103], v[128:131]
    v_mfma_f32_16x16x32_bf16 v[128:131], a[228:231], a[88:91], v[128:131]
    s_barrier
    ds_read_b64_tr_b16 a[208:209], v198 offset:16896
    s_sub_u32 s68, s68, s85
    v_mfma_f32_16x16x32_bf16 v[128:131], a[224:227], a[76:79], v[128:131]
    s_add_u32 s68, s68, s84
    ds_read_b64_tr_b16 a[210:211], v198 offset:17152
    v_mfma_f32_16x16x32_bf16 v[136:139], a[224:227], a[80:83], v[136:139]
    s_add_u32 m0, s33, 102464
    v_mfma_f32_16x16x32_bf16 v[136:139], a[228:231], a[92:95], v[136:139]
    s_sub_u32 s68, s68, s85
    ds_read_b64_tr_b16 a[212:213], v198 offset:17408
    s_add_u32 s68, s68, s84
    v_mfma_f32_16x16x32_bf16 v[136:139], a[232:235], a[104:107], v[136:139]
    s_waitcnt lgkmcnt(9)
    ds_read_b64_tr_b16 a[214:215], v198 offset:17664
    s_sub_u32 s68, s68, s85
    v_mfma_f32_16x16x32_bf16 v[136:139], a[236:239], a[116:119], v[136:139]
    v_mfma_f32_16x16x32_bf16 v[140:143], a[240:243], a[80:83], v[140:143]
    s_waitcnt lgkmcnt(4)
    ds_read_b64_tr_b16 a[216:217], v198 offset:25344
    s_add_u32 s68, s68, s84
    v_mfma_f32_16x16x32_bf16 v[140:143], a[244:247], a[92:95], v[140:143]
    s_sub_u32 s68, s68, s85
    ds_read_b64_tr_b16 a[218:219], v198 offset:25600
    s_add_u32 s68, s68, s84
    v_mfma_f32_16x16x32_bf16 v[140:143], a[248:251], a[104:107], v[140:143]
    buffer_load_dwordx4 v240, s[20:23], s51 offen offset:1024 nt lds
    v_mfma_f32_16x16x32_bf16 v[140:143], a[252:255], a[116:119], v[140:143]
    s_sub_u32 s68, s68, s85
    ds_read_b64_tr_b16 a[220:221], v198 offset:25856
    s_add_u32 s68, s68, s84
    v_mfma_f32_16x16x32_bf16 v[132:135], a[252:255], a[112:115], v[132:135]
    ds_read_b64_tr_b16 a[222:223], v198 offset:26112
    v_mfma_f32_16x16x32_bf16 v[132:135], a[248:251], a[100:103], v[132:135]
    v_mfma_f32_16x16x32_bf16 v[132:135], a[244:247], a[88:91], v[132:135]
    s_min_i32 s68, s68, 4
    ds_read_b64_tr_b16 a[224:225], v198 offset:16904
    s_max_i32 s68, s68, -4
    v_mfma_f32_16x16x32_bf16 v[132:135], a[240:243], a[76:79], v[132:135]
    s_add_u32 s69, s69, s68
    ds_read_b64_tr_b16 a[226:227], v198 offset:17160
    s_mov_b32 s68, 0
    v_mfma_f32_16x16x32_bf16 v[124:127], a[240:243], a[72:75], v[124:127]
    s_add_u32 m0, s33, 33792
    s_add_u32 s50, s41, 256
    v_mfma_f32_16x16x32_bf16 v[124:127], a[244:247], a[84:87], v[124:127]
    s_mov_b64 s[84:85], 0
    ds_read_b64_tr_b16 a[228:229], v198 offset:17416
    v_mfma_f32_16x16x32_bf16 v[124:127], a[248:251], a[96:99], v[124:127]
    s_waitcnt lgkmcnt(9)
    ds_read_b64_tr_b16 a[230:231], v198 offset:17672
    s_lshr_b32 s68, s69, 31
    v_mfma_f32_16x16x32_bf16 v[124:127], a[252:255], a[108:111], v[124:127]
    v_mfma_f32_16x16x32_bf16 v[144:147], a[208:211], a[72:75], v[144:147]
    s_waitcnt lgkmcnt(4)
    ds_read_b64_tr_b16 a[232:233], v198 offset:25352
    s_mul_i32 s68, s68, 3
    v_mfma_f32_16x16x32_bf16 v[144:147], a[212:215], a[84:87], v[144:147]
    s_add_u32 s68, s68, 4
    ds_read_b64_tr_b16 a[234:235], v198 offset:25608
    v_mfma_f32_16x16x32_bf16 v[144:147], a[216:219], a[96:99], v[144:147]
    buffer_load_dwordx4 v193, s[12:15], s50 offen lds
    v_mfma_f32_16x16x32_bf16 v[144:147], a[220:223], a[108:111], v[144:147]
    s_add_u32 m0, s33, 103008
    ds_read_b64_tr_b16 a[236:237], v198 offset:25864
    v_mov_b32 v253, s68
    v_mfma_f32_16x16x32_bf16 v[152:155], a[220:223], a[112:115], v[152:155]
    ds_read_b64_tr_b16 a[238:239], v198 offset:26120
    v_mfma_f32_16x16x32_bf16 v[152:155], a[216:219], a[100:103], v[152:155]
    buffer_load_dwordx4 v240, s[20:23], s51 offen offset:1536 nt lds
    v_mfma_f32_16x16x32_bf16 v[152:155], a[212:215], a[88:91], v[152:155]
    s_add_u32 m0, s33, 34824
    ds_read_b64_tr_b16 a[240:241], v198 offset:16960
    s_add_u32 s50, s41, 8448
    v_mfma_f32_16x16x32_bf16 v[152:155], a[208:211], a[76:79], v[152:155]
    ds_read_b64_tr_b16 a[242:243], v198 offset:17216
    v_mfma_f32_16x16x32_bf16 v[160:163], a[208:211], a[80:83], v[160:163]
    buffer_load_dwordx4 v193, s[12:15], s50 offen lds
    v_mfma_f32_16x16x32_bf16 v[160:163], a[212:215], a[92:95], v[160:163]
    s_add_u32 m0, s33, 35904
    ds_read_b64_tr_b16 a[244:245], v198 offset:17472
    s_add_u32 s50, s41, 16640
    v_mfma_f32_16x16x32_bf16 v[160:163], a[216:219], a[104:107], v[160:163]
    s_waitcnt lgkmcnt(9)
    ds_read_b64_tr_b16 a[246:247], v198 offset:17728
    v_mfma_f32_16x16x32_bf16 v[160:163], a[220:223], a[116:119], v[160:163]
    buffer_load_dwordx4 v193, s[12:15], s50 offen lds
    v_mfma_f32_16x16x32_bf16 v[164:167], a[224:227], a[80:83], v[164:167]
    s_waitcnt lgkmcnt(4)
    ds_read_b64_tr_b16 a[248:249], v198 offset:25408
    s_add_u32 m0, s33, 36936
    v_mfma_f32_16x16x32_bf16 v[164:167], a[228:231], a[92:95], v[164:167]
    s_add_u32 s50, s41, 24832
    ds_read_b64_tr_b16 a[250:251], v198 offset:25664
    v_mfma_f32_16x16x32_bf16 v[164:167], a[232:235], a[104:107], v[164:167]
    buffer_load_dwordx4 v193, s[12:15], s50 offen lds
    v_mfma_f32_16x16x32_bf16 v[164:167], a[236:239], a[116:119], v[164:167]
    s_xor_b32 s51, s95, 4096
    ds_read_b64_tr_b16 a[252:253], v198 offset:25920
    s_add_u32 m0, s33, 135168
    v_mfma_f32_16x16x32_bf16 v[156:159], a[236:239], a[112:115], v[156:159]
    ds_read_b64_tr_b16 a[254:255], v198 offset:26176
    v_mfma_f32_16x16x32_bf16 v[156:159], a[232:235], a[100:103], v[156:159]
    buffer_store_dword v253, v252, s[80:83], s7 offen sc1
    v_mfma_f32_16x16x32_bf16 v[156:159], a[228:231], a[88:91], v[156:159]
    ds_read_b64_tr_b16 a[208:209], v198 offset:16968
    v_mfma_f32_16x16x32_bf16 v[156:159], a[224:227], a[76:79], v[156:159]
    ds_read_b64_tr_b16 a[210:211], v198 offset:17224
    v_mfma_f32_16x16x32_bf16 v[148:151], a[224:227], a[72:75], v[148:151]
    buffer_load_dwordx4 v240, s[16:19], s51 offen nt lds
    v_mfma_f32_16x16x32_bf16 v[148:151], a[228:231], a[84:87], v[148:151]
    ds_read_b64_tr_b16 a[212:213], v198 offset:17480
    v_mfma_f32_16x16x32_bf16 v[148:151], a[232:235], a[96:99], v[148:151]
    s_waitcnt lgkmcnt(9)
    ds_read_b64_tr_b16 a[214:215], v198 offset:17736
    v_mfma_f32_16x16x32_bf16 v[148:151], a[236:239], a[108:111], v[148:151]
    v_mfma_f32_16x16x32_bf16 v[168:171], a[240:243], a[72:75], v[168:171]
    s_waitcnt lgkmcnt(4)
    ds_read_b64_tr_b16 a[216:217], v198 offset:25416
    v_mfma_f32_16x16x32_bf16 v[168:171], a[244:247], a[84:87], v[168:171]
    ds_read_b64_tr_b16 a[218:219], v198 offset:25672
    v_mfma_f32_16x16x32_bf16 v[168:171], a[248:251], a[96:99], v[168:171]
    s_add_u32 m0, s33, 135712
    v_mfma_f32_16x16x32_bf16 v[168:171], a[252:255], a[108:111], v[168:171]
    ds_read_b64_tr_b16 a[220:221], v198 offset:25928
    v_mfma_f32_16x16x32_bf16 v[176:179], a[252:255], a[112:115], v[176:179]
    s_waitcnt vmcnt(18)
    ds_read_b64_tr_b16 a[222:223], v198 offset:26184
    v_mfma_f32_16x16x32_bf16 v[176:179], a[248:251], a[100:103], v[176:179]
    v_mfma_f32_16x16x32_bf16 v[176:179], a[244:247], a[88:91], v[176:179]
    s_barrier
    ds_read_b64_tr_b16 a[224:225], v197 offset:0
    v_mfma_f32_16x16x32_bf16 v[176:179], a[240:243], a[76:79], v[176:179]
    ds_read_b64_tr_b16 a[226:227], v197 offset:256
    v_mfma_f32_16x16x32_bf16 v[184:187], a[240:243], a[80:83], v[184:187]
    buffer_load_dwordx4 v240, s[16:19], s51 offen offset:512 nt lds
    v_mfma_f32_16x16x32_bf16 v[184:187], a[244:247], a[92:95], v[184:187]
    ds_read_b64_tr_b16 a[228:229], v197 offset:512
    v_mfma_f32_16x16x32_bf16 v[184:187], a[248:251], a[104:107], v[184:187]
    s_waitcnt lgkmcnt(9)
    ds_read_b64_tr_b16 a[230:231], v197 offset:768
    v_mfma_f32_16x16x32_bf16 v[184:187], a[252:255], a[116:119], v[184:187]
    v_mfma_f32_16x16x32_bf16 v[188:191], a[208:211], a[80:83], v[188:191]
    s_waitcnt lgkmcnt(4)
    ds_read_b64_tr_b16 a[232:233], v197 offset:8448
    v_mfma_f32_16x16x32_bf16 v[188:191], a[212:215], a[92:95], v[188:191]
    ds_read_b64_tr_b16 a[234:235], v197 offset:8704
    v_mfma_f32_16x16x32_bf16 v[188:191], a[216:219], a[104:107], v[188:191]
    s_add_u32 m0, s33, 136256
    v_mfma_f32_16x16x32_bf16 v[188:191], a[220:223], a[116:119], v[188:191]
    ds_read_b64_tr_b16 a[236:237], v197 offset:8960
    v_mfma_f32_16x16x32_bf16 v[180:183], a[220:223], a[112:115], v[180:183]
    ds_read_b64_tr_b16 a[238:239], v197 offset:9216
    v_mfma_f32_16x16x32_bf16 v[180:183], a[216:219], a[100:103], v[180:183]
    v_mfma_f32_16x16x32_bf16 v[180:183], a[212:215], a[88:91], v[180:183]
    ds_read_b64_tr_b16 a[240:241], v197 offset:8
    v_mfma_f32_16x16x32_bf16 v[180:183], a[208:211], a[76:79], v[180:183]
    ds_read_b64_tr_b16 a[242:243], v197 offset:264
    v_mfma_f32_16x16x32_bf16 v[172:175], a[208:211], a[72:75], v[172:175]
    buffer_load_dwordx4 v240, s[16:19], s51 offen offset:1024 nt lds
    v_mfma_f32_16x16x32_bf16 v[172:175], a[212:215], a[84:87], v[172:175]
    s_add_u32 m0, s33, 50688
    ds_read_b64_tr_b16 a[244:245], v197 offset:520
    s_add_u32 s50, s41, 384
    v_mfma_f32_16x16x32_bf16 v[172:175], a[216:219], a[96:99], v[172:175]
    ds_read_b64_tr_b16 a[246:247], v197 offset:776
    v_mfma_f32_16x16x32_bf16 v[172:175], a[220:223], a[108:111], v[172:175]
    s_waitcnt lgkmcnt(10)
    v_mfma_f32_16x16x32_bf16 v[0:3], a[224:227], a[120:123], v[0:3]
    s_waitcnt lgkmcnt(4)
    ds_read_b64_tr_b16 a[248:249], v197 offset:8456
    v_mfma_f32_16x16x32_bf16 v[0:3], a[228:231], a[132:135], v[0:3]
    ds_read_b64_tr_b16 a[250:251], v197 offset:8712
    v_mfma_f32_16x16x32_bf16 v[0:3], a[232:235], a[144:147], v[0:3]
    buffer_load_dwordx4 v193, s[12:15], s50 offen lds
    v_mfma_f32_16x16x32_bf16 v[0:3], a[236:239], a[156:159], v[0:3]
    s_add_u32 m0, s33, 51720
    ds_read_b64_tr_b16 a[252:253], v197 offset:8968
    s_add_u32 s50, s41, 8576
    v_mfma_f32_16x16x32_bf16 v[8:11], a[236:239], a[160:163], v[8:11]
    ds_read_b64_tr_b16 a[254:255], v197 offset:9224
    v_mfma_f32_16x16x32_bf16 v[8:11], a[232:235], a[148:151], v[8:11]
    buffer_load_dwordx4 v193, s[12:15], s50 offen lds
    v_mfma_f32_16x16x32_bf16 v[8:11], a[228:231], a[136:139], v[8:11]
    s_add_u32 m0, s33, 52800
    ds_read_b64_tr_b16 a[208:209], v197 offset:64
    s_add_u32 s50, s41, 16768
    v_mfma_f32_16x16x32_bf16 v[8:11], a[224:227], a[124:127], v[8:11]
    ds_read_b64_tr_b16 a[210:211], v197 offset:320
    v_mfma_f32_16x16x32_bf16 v[16:19], a[224:227], a[128:131], v[16:19]
    buffer_load_dwordx4 v193, s[12:15], s50 offen lds
    v_mfma_f32_16x16x32_bf16 v[16:19], a[228:231], a[140:143], v[16:19]
    s_add_u32 m0, s33, 136800
    ds_read_b64_tr_b16 a[212:213], v197 offset:576
    v_mfma_f32_16x16x32_bf16 v[16:19], a[232:235], a[152:155], v[16:19]
    s_waitcnt lgkmcnt(9)
    ds_read_b64_tr_b16 a[214:215], v197 offset:832
    v_mfma_f32_16x16x32_bf16 v[16:19], a[236:239], a[164:167], v[16:19]
    buffer_load_dwordx4 v240, s[16:19], s51 offen offset:1536 nt lds
    v_mfma_f32_16x16x32_bf16 v[20:23], a[240:243], a[128:131], v[20:23]
    s_waitcnt lgkmcnt(4)
    ds_read_b64_tr_b16 a[216:217], v197 offset:8512
    s_add_u32 m0, s33, 53832
    v_mfma_f32_16x16x32_bf16 v[20:23], a[244:247], a[140:143], v[20:23]
    s_add_u32 s50, s41, 24960
    ds_read_b64_tr_b16 a[218:219], v197 offset:8768
    v_mfma_f32_16x16x32_bf16 v[20:23], a[248:251], a[152:155], v[20:23]
    buffer_load_dwordx4 v193, s[12:15], s50 offen lds
    v_mfma_f32_16x16x32_bf16 v[20:23], a[252:255], a[164:167], v[20:23]
    ds_read_b64_tr_b16 a[220:221], v197 offset:9024
    v_mul_f32 v16, s52, v16
    v_mul_f32 v17, s52, v17
    v_mfma_f32_16x16x32_bf16 v[12:15], a[252:255], a[160:163], v[12:15]
    ds_read_b64_tr_b16 a[222:223], v197 offset:9280
    v_mul_f32 v18, s52, v18
    v_mul_f32 v19, s52, v19
    v_mfma_f32_16x16x32_bf16 v[12:15], a[248:251], a[148:151], v[12:15]
    v_mfma_f32_16x16x32_bf16 v[12:15], a[244:247], a[136:139], v[12:15]
    ds_read_b64_tr_b16 a[224:225], v197 offset:72
    v_mfma_f32_16x16x32_bf16 v[12:15], a[240:243], a[124:127], v[12:15]
    ds_read_b64_tr_b16 a[226:227], v197 offset:328
    v_mul_f32 v20, s52, v20
    v_mul_f32 v21, s52, v21
    v_mfma_f32_16x16x32_bf16 v[4:7], a[240:243], a[120:123], v[4:7]
    v_mul_f32 v22, s52, v22
    v_mul_f32 v23, s52, v23
    v_mul_f32 v8, s52, v8
    v_mfma_f32_16x16x32_bf16 v[4:7], a[244:247], a[132:135], v[4:7]
    ds_read_b64_tr_b16 a[228:229], v197 offset:584
    v_mul_f32 v9, s52, v9
    v_mul_f32 v10, s52, v10
    v_mfma_f32_16x16x32_bf16 v[4:7], a[248:251], a[144:147], v[4:7]
    s_waitcnt lgkmcnt(9)
    ds_read_b64_tr_b16 a[230:231], v197 offset:840
    v_mul_f32 v11, s52, v11
    v_mfma_f32_16x16x32_bf16 v[4:7], a[252:255], a[156:159], v[4:7]
    v_mul_f32 v12, s52, v12
    v_mul_f32 v13, s52, v13
    v_mul_f32 v14, s52, v14
    v_mfma_f32_16x16x32_bf16 v[24:27], a[208:211], a[120:123], v[24:27]
    s_waitcnt lgkmcnt(4)
    ds_read_b64_tr_b16 a[232:233], v197 offset:8520
    v_mul_f32 v15, s52, v15
    v_mul_f32 v0, s52, v0
    v_mfma_f32_16x16x32_bf16 v[24:27], a[212:215], a[132:135], v[24:27]
    ds_read_b64_tr_b16 a[234:235], v197 offset:8776
    v_mul_f32 v1, s52, v1
    v_mul_f32 v2, s52, v2
    v_mfma_f32_16x16x32_bf16 v[24:27], a[216:219], a[144:147], v[24:27]
    v_mul_f32 v3, s52, v3
    v_mfma_f32_16x16x32_bf16 v[24:27], a[220:223], a[156:159], v[24:27]
    ds_read_b64_tr_b16 a[236:237], v197 offset:9032
    v_mul_f32 v4, s52, v4
    v_mul_f32 v5, s52, v5
    v_mfma_f32_16x16x32_bf16 v[32:35], a[220:223], a[160:163], v[32:35]
    s_waitcnt vmcnt(17)
    ds_read_b64_tr_b16 a[238:239], v197 offset:9288
    v_mul_f32 v6, s52, v6
    v_mul_f32 v7, s52, v7
    v_mfma_f32_16x16x32_bf16 v[32:35], a[216:219], a[148:151], v[32:35]
    s_xor_b32 s51, s95, 2048
    s_add_u32 m0, s33, 67584
    v_cvt_pk_bf16_f32 v0, v0, v1
    v_cvt_pk_bf16_f32 v1, v2, v3
    v_mfma_f32_16x16x32_bf16 v[32:35], a[212:215], a[136:139], v[32:35]
    s_barrier
    ds_read_b64_tr_b16 a[240:241], v197 offset:16896
    v_cvt_pk_bf16_f32 v2, v4, v5
    v_cvt_pk_bf16_f32 v3, v6, v7
    v_mfma_f32_16x16x32_bf16 v[32:35], a[208:211], a[124:127], v[32:35]
    ds_read_b64_tr_b16 a[242:243], v197 offset:17152
    v_cvt_pk_bf16_f32 v4, v8, v9
    v_cvt_pk_bf16_f32 v5, v10, v11
    v_mfma_f32_16x16x32_bf16 v[40:43], a[208:211], a[128:131], v[40:43]
    v_cvt_pk_bf16_f32 v6, v12, v13
    v_cvt_pk_bf16_f32 v7, v14, v15
    v_cvt_pk_bf16_f32 v8, v16, v17
    v_mfma_f32_16x16x32_bf16 v[40:43], a[212:215], a[140:143], v[40:43]
    ds_read_b64_tr_b16 a[244:245], v197 offset:17408
    v_cvt_pk_bf16_f32 v9, v18, v19
    v_cvt_pk_bf16_f32 v10, v20, v21
    v_mfma_f32_16x16x32_bf16 v[40:43], a[216:219], a[152:155], v[40:43]
    s_waitcnt lgkmcnt(9)
    ds_read_b64_tr_b16 a[246:247], v197 offset:17664
    v_cvt_pk_bf16_f32 v11, v22, v23
    v_mfma_f32_16x16x32_bf16 v[40:43], a[220:223], a[164:167], v[40:43]
    buffer_load_dwordx4 v240, s[20:23], s51 offen nt lds
    v_mfma_f32_16x16x32_bf16 v[44:47], a[224:227], a[128:131], v[44:47]
    s_waitcnt lgkmcnt(4)
    ds_read_b64_tr_b16 a[248:249], v197 offset:25344
    v_mfma_f32_16x16x32_bf16 v[44:47], a[228:231], a[140:143], v[44:47]
    ds_read_b64_tr_b16 a[250:251], v197 offset:25600
    v_mfma_f32_16x16x32_bf16 v[44:47], a[232:235], a[152:155], v[44:47]
    v_mfma_f32_16x16x32_bf16 v[44:47], a[236:239], a[164:167], v[44:47]
    ds_read_b64_tr_b16 a[252:253], v197 offset:25856
    v_mul_f32 v40, s52, v40
    v_mul_f32 v41, s52, v41
    v_mfma_f32_16x16x32_bf16 v[36:39], a[236:239], a[160:163], v[36:39]
    ds_read_b64_tr_b16 a[254:255], v197 offset:26112
    v_mul_f32 v42, s52, v42
    v_mul_f32 v43, s52, v43
    v_mfma_f32_16x16x32_bf16 v[36:39], a[232:235], a[148:151], v[36:39]
    s_add_u32 m0, s33, 68128
    v_mfma_f32_16x16x32_bf16 v[36:39], a[228:231], a[136:139], v[36:39]
    ds_read_b64_tr_b16 a[208:209], v197 offset:16904
    v_mfma_f32_16x16x32_bf16 v[36:39], a[224:227], a[124:127], v[36:39]
    ds_read_b64_tr_b16 a[210:211], v197 offset:17160
    v_mul_f32 v44, s52, v44
    v_mul_f32 v45, s52, v45
    v_mfma_f32_16x16x32_bf16 v[28:31], a[224:227], a[120:123], v[28:31]
    v_mul_f32 v46, s52, v46
    v_mul_f32 v47, s52, v47
    v_cvt_pk_bf16_f32 v20, v40, v41
    v_mfma_f32_16x16x32_bf16 v[28:31], a[228:231], a[132:135], v[28:31]
L_pad2:
    s_cbranch_execz L_pad6
    ds_read_b64_tr_b16 a[212:213], v197 offset:17416
    v_cvt_pk_bf16_f32 v21, v42, v43
    v_cvt_pk_bf16_f32 v22, v44, v45
    v_mfma_f32_16x16x32_bf16 v[28:31], a[232:235], a[144:147], v[28:31]
    s_waitcnt lgkmcnt(9)
    ds_read_b64_tr_b16 a[214:215], v197 offset:17672
    v_cvt_pk_bf16_f32 v23, v46, v47
    v_mul_f32 v32, s52, v32
    v_mfma_f32_16x16x32_bf16 v[28:31], a[236:239], a[156:159], v[28:31]
    buffer_load_dwordx4 v240, s[20:23], s51 offen offset:512 nt lds
    v_mfma_f32_16x16x32_bf16 v[48:51], a[240:243], a[120:123], v[48:51]
    s_waitcnt lgkmcnt(4)
    ds_read_b64_tr_b16 a[216:217], v197 offset:25352
    v_mul_f32 v33, s52, v33
    v_mul_f32 v34, s52, v34
    v_mfma_f32_16x16x32_bf16 v[48:51], a[244:247], a[132:135], v[48:51]
    ds_read_b64_tr_b16 a[218:219], v197 offset:25608
    v_mul_f32 v35, s52, v35
    v_mul_f32 v36, s52, v36
    v_mfma_f32_16x16x32_bf16 v[48:51], a[248:251], a[144:147], v[48:51]
    v_mul_f32 v37, s52, v37
    v_mul_f32 v38, s52, v38
    v_mul_f32 v39, s52, v39
    v_mfma_f32_16x16x32_bf16 v[48:51], a[252:255], a[156:159], v[48:51]
    ds_read_b64_tr_b16 a[220:221], v197 offset:25864
    v_cvt_pk_bf16_f32 v16, v32, v33
    v_cvt_pk_bf16_f32 v17, v34, v35
    v_mfma_f32_16x16x32_bf16 v[56:59], a[252:255], a[160:163], v[56:59]
    ds_read_b64_tr_b16 a[222:223], v197 offset:26120
    v_cvt_pk_bf16_f32 v18, v36, v37
    v_cvt_pk_bf16_f32 v19, v38, v39
    v_mfma_f32_16x16x32_bf16 v[56:59], a[248:251], a[148:151], v[56:59]
    s_add_u32 m0, s33, 68672
    v_mul_f32 v24, s52, v24
    v_mul_f32 v25, s52, v25
    v_mul_f32 v26, s52, v26
    v_mfma_f32_16x16x32_bf16 v[56:59], a[244:247], a[136:139], v[56:59]
    ds_read_b64_tr_b16 a[224:225], v197 offset:16960
    v_mul_f32 v27, s52, v27
    v_mul_f32 v28, s52, v28
    v_mfma_f32_16x16x32_bf16 v[56:59], a[240:243], a[124:127], v[56:59]
    ds_read_b64_tr_b16 a[226:227], v197 offset:17216
    v_mul_f32 v29, s52, v29
    v_mul_f32 v30, s52, v30
    v_mfma_f32_16x16x32_bf16 v[64:67], a[240:243], a[128:131], v[64:67]
    v_mul_f32 v31, s52, v31
    v_cvt_pk_bf16_f32 v12, v24, v25
    v_cvt_pk_bf16_f32 v13, v26, v27
    v_mfma_f32_16x16x32_bf16 v[64:67], a[244:247], a[140:143], v[64:67]
    ds_read_b64_tr_b16 a[228:229], v197 offset:17472
    v_cvt_pk_bf16_f32 v14, v28, v29
    v_cvt_pk_bf16_f32 v15, v30, v31
    v_mfma_f32_16x16x32_bf16 v[64:67], a[248:251], a[152:155], v[64:67]
    s_waitcnt lgkmcnt(9)
    ds_read_b64_tr_b16 a[230:231], v197 offset:17728
    v_mfma_f32_16x16x32_bf16 v[64:67], a[252:255], a[164:167], v[64:67]
    buffer_load_dwordx4 v240, s[20:23], s51 offen offset:1024 nt lds
    v_mfma_f32_16x16x32_bf16 v[68:71], a[208:211], a[128:131], v[68:71]
    s_waitcnt lgkmcnt(4)
    ds_read_b64_tr_b16 a[232:233], v197 offset:25408
    v_mfma_f32_16x16x32_bf16 v[68:71], a[212:215], a[140:143], v[68:71]
    ds_read_b64_tr_b16 a[234:235], v197 offset:25664
    v_mfma_f32_16x16x32_bf16 v[68:71], a[216:219], a[152:155], v[68:71]
    v_mfma_f32_16x16x32_bf16 v[68:71], a[220:223], a[164:167], v[68:71]
    ds_read_b64_tr_b16 a[236:237], v197 offset:25920
    v_mul_f32 v64, s52, v64
    v_mul_f32 v65, s52, v65
    v_mfma_f32_16x16x32_bf16 v[60:63], a[220:223], a[160:163], v[60:63]
    ds_read_b64_tr_b16 a[238:239], v197 offset:26176
    v_mul_f32 v66, s52, v66
    v_mul_f32 v67, s52, v67
    v_mfma_f32_16x16x32_bf16 v[60:63], a[216:219], a[148:151], v[60:63]
    s_add_u32 m0, s33, 69216
    v_mfma_f32_16x16x32_bf16 v[60:63], a[212:215], a[136:139], v[60:63]
    ds_read_b64_tr_b16 a[240:241], v197 offset:16968
    v_mfma_f32_16x16x32_bf16 v[60:63], a[208:211], a[124:127], v[60:63]
    ds_read_b64_tr_b16 a[242:243], v197 offset:17224
    v_mul_f32 v68, s52, v68
    v_mul_f32 v69, s52, v69
    v_mfma_f32_16x16x32_bf16 v[52:55], a[208:211], a[120:123], v[52:55]
    v_mul_f32 v70, s52, v70
    v_mul_f32 v71, s52, v71
    v_cvt_pk_bf16_f32 v32, v64, v65
    v_mfma_f32_16x16x32_bf16 v[52:55], a[212:215], a[132:135], v[52:55]
    ds_read_b64_tr_b16 a[244:245], v197 offset:17480
    v_cvt_pk_bf16_f32 v33, v66, v67
    v_cvt_pk_bf16_f32 v34, v68, v69
    v_mfma_f32_16x16x32_bf16 v[52:55], a[216:219], a[144:147], v[52:55]
    s_waitcnt lgkmcnt(9)
    ds_read_b64_tr_b16 a[246:247], v197 offset:17736
    v_cvt_pk_bf16_f32 v35, v70, v71
    v_mul_f32 v56, s52, v56
    v_mfma_f32_16x16x32_bf16 v[52:55], a[220:223], a[156:159], v[52:55]
    buffer_load_dwordx4 v240, s[20:23], s51 offen offset:1536 nt lds
    v_mfma_f32_16x16x32_bf16 v[72:75], a[224:227], a[120:123], v[72:75]
    s_waitcnt lgkmcnt(4)
    ds_read_b64_tr_b16 a[248:249], v197 offset:25416
    v_mul_f32 v57, s52, v57
    v_mul_f32 v58, s52, v58
    v_mfma_f32_16x16x32_bf16 v[72:75], a[228:231], a[132:135], v[72:75]
    ds_read_b64_tr_b16 a[250:251], v197 offset:25672
    v_mul_f32 v59, s52, v59
    v_mul_f32 v60, s52, v60
    v_mfma_f32_16x16x32_bf16 v[72:75], a[232:235], a[144:147], v[72:75]
    v_mul_f32 v61, s52, v61
    v_mul_f32 v62, s52, v62
    v_mul_f32 v63, s52, v63
    v_mfma_f32_16x16x32_bf16 v[72:75], a[236:239], a[156:159], v[72:75]
    ds_read_b64_tr_b16 a[252:253], v197 offset:25928
    v_cvt_pk_bf16_f32 v28, v56, v57
    v_cvt_pk_bf16_f32 v29, v58, v59
    v_mfma_f32_16x16x32_bf16 v[80:83], a[236:239], a[160:163], v[80:83]
    s_waitcnt vmcnt(13)
    ds_read_b64_tr_b16 a[254:255], v197 offset:26184
    v_cvt_pk_bf16_f32 v30, v60, v61
    v_cvt_pk_bf16_f32 v31, v62, v63
    v_mfma_f32_16x16x32_bf16 v[80:83], a[232:235], a[148:151], v[80:83]
    v_mul_f32 v48, s52, v48
    v_mul_f32 v49, s52, v49
    v_mul_f32 v50, s52, v50
    v_mfma_f32_16x16x32_bf16 v[80:83], a[228:231], a[136:139], v[80:83]
    s_barrier
    ds_read_b64_tr_b16 a[208:209], v197 offset:33792
    v_mul_f32 v51, s52, v51
    v_mul_f32 v52, s52, v52
    v_mfma_f32_16x16x32_bf16 v[80:83], a[224:227], a[124:127], v[80:83]
    ds_read_b64_tr_b16 a[210:211], v197 offset:34048
    v_mul_f32 v53, s52, v53
    v_mul_f32 v54, s52, v54
    v_mfma_f32_16x16x32_bf16 v[88:91], a[224:227], a[128:131], v[88:91]
    s_xor_b32 s51, s95, 6144
    s_add_u32 m0, s33, 0
    v_mul_f32 v55, s52, v55
    v_cvt_pk_bf16_f32 v24, v48, v49
    v_mfma_f32_16x16x32_bf16 v[88:91], a[228:231], a[140:143], v[88:91]
    ds_read_b64_tr_b16 a[212:213], v197 offset:34304
    v_cvt_pk_bf16_f32 v25, v50, v51
    v_cvt_pk_bf16_f32 v26, v52, v53
    v_mfma_f32_16x16x32_bf16 v[88:91], a[232:235], a[152:155], v[88:91]
    s_waitcnt lgkmcnt(9)
    ds_read_b64_tr_b16 a[214:215], v197 offset:34560
    v_cvt_pk_bf16_f32 v27, v54, v55
    v_mfma_f32_16x16x32_bf16 v[88:91], a[236:239], a[164:167], v[88:91]
    v_mfma_f32_16x16x32_bf16 v[92:95], a[240:243], a[128:131], v[92:95]
    s_waitcnt lgkmcnt(4)
    ds_read_b64_tr_b16 a[216:217], v197 offset:42240
    v_mfma_f32_16x16x32_bf16 v[92:95], a[244:247], a[140:143], v[92:95]
    ds_read_b64_tr_b16 a[218:219], v197 offset:42496
    v_mfma_f32_16x16x32_bf16 v[92:95], a[248:251], a[152:155], v[92:95]
    buffer_load_dwordx4 v240, s[16:19], s51 offen nt lds
    v_mfma_f32_16x16x32_bf16 v[92:95], a[252:255], a[164:167], v[92:95]
    ds_read_b64_tr_b16 a[220:221], v197 offset:42752
    v_mul_f32 v88, s52, v88
    v_mul_f32 v89, s52, v89
    v_mfma_f32_16x16x32_bf16 v[84:87], a[252:255], a[160:163], v[84:87]
    ds_read_b64_tr_b16 a[222:223], v197 offset:43008
    v_mul_f32 v90, s52, v90
    v_mul_f32 v91, s52, v91
    v_mfma_f32_16x16x32_bf16 v[84:87], a[248:251], a[148:151], v[84:87]
    v_mfma_f32_16x16x32_bf16 v[84:87], a[244:247], a[136:139], v[84:87]
    ds_read_b64_tr_b16 a[224:225], v197 offset:33800
    v_mfma_f32_16x16x32_bf16 v[84:87], a[240:243], a[124:127], v[84:87]
    ds_read_b64_tr_b16 a[226:227], v197 offset:34056
    v_mul_f32 v92, s52, v92
    v_mul_f32 v93, s52, v93
    v_mfma_f32_16x16x32_bf16 v[76:79], a[240:243], a[120:123], v[76:79]
    s_add_u32 m0, s33, 544
    v_mul_f32 v94, s52, v94
    v_mul_f32 v95, s52, v95
    v_cvt_pk_bf16_f32 v44, v88, v89
    v_mfma_f32_16x16x32_bf16 v[76:79], a[244:247], a[132:135], v[76:79]
    ds_read_b64_tr_b16 a[228:229], v197 offset:34312
    v_cvt_pk_bf16_f32 v45, v90, v91
    v_cvt_pk_bf16_f32 v46, v92, v93
    v_mfma_f32_16x16x32_bf16 v[76:79], a[248:251], a[144:147], v[76:79]
    s_waitcnt lgkmcnt(9)
    ds_read_b64_tr_b16 a[230:231], v197 offset:34568
    v_cvt_pk_bf16_f32 v47, v94, v95
    v_mul_f32 v80, s52, v80
    v_mfma_f32_16x16x32_bf16 v[76:79], a[252:255], a[156:159], v[76:79]
    v_mul_f32 v81, s52, v81
    v_mul_f32 v82, s52, v82
    v_mul_f32 v83, s52, v83
    v_mfma_f32_16x16x32_bf16 v[96:99], a[208:211], a[120:123], v[96:99]
    s_waitcnt lgkmcnt(4)
    ds_read_b64_tr_b16 a[232:233], v197 offset:42248
    v_mul_f32 v84, s52, v84
    v_mul_f32 v85, s52, v85
    v_mfma_f32_16x16x32_bf16 v[96:99], a[212:215], a[132:135], v[96:99]
    ds_read_b64_tr_b16 a[234:235], v197 offset:42504
    v_mul_f32 v86, s52, v86
    v_mul_f32 v87, s52, v87
    v_mfma_f32_16x16x32_bf16 v[96:99], a[216:219], a[144:147], v[96:99]
    buffer_load_dwordx4 v240, s[16:19], s51 offen offset:512 nt lds
    v_mfma_f32_16x16x32_bf16 v[96:99], a[220:223], a[156:159], v[96:99]
    ds_read_b64_tr_b16 a[236:237], v197 offset:42760
    v_cvt_pk_bf16_f32 v40, v80, v81
    v_cvt_pk_bf16_f32 v41, v82, v83
    v_mfma_f32_16x16x32_bf16 v[104:107], a[220:223], a[160:163], v[104:107]
    ds_read_b64_tr_b16 a[238:239], v197 offset:43016
    v_cvt_pk_bf16_f32 v42, v84, v85
    v_cvt_pk_bf16_f32 v43, v86, v87
    v_mfma_f32_16x16x32_bf16 v[104:107], a[216:219], a[148:151], v[104:107]
    v_mul_f32 v72, s52, v72
    v_mul_f32 v73, s52, v73
    v_mul_f32 v74, s52, v74
    v_mfma_f32_16x16x32_bf16 v[104:107], a[212:215], a[136:139], v[104:107]
    ds_read_b64_tr_b16 a[240:241], v197 offset:33856
    v_mul_f32 v75, s52, v75
    v_mul_f32 v76, s52, v76
    v_mfma_f32_16x16x32_bf16 v[104:107], a[208:211], a[124:127], v[104:107]
    ds_read_b64_tr_b16 a[242:243], v197 offset:34112
    v_mul_f32 v77, s52, v77
    v_mul_f32 v78, s52, v78
    v_mfma_f32_16x16x32_bf16 v[112:115], a[208:211], a[128:131], v[112:115]
    s_add_u32 m0, s33, 1088
    v_mul_f32 v79, s52, v79
    v_cvt_pk_bf16_f32 v36, v72, v73
    v_cvt_pk_bf16_f32 v37, v74, v75
    v_mfma_f32_16x16x32_bf16 v[112:115], a[212:215], a[140:143], v[112:115]
    ds_read_b64_tr_b16 a[244:245], v197 offset:34368
    v_cvt_pk_bf16_f32 v38, v76, v77
    v_cvt_pk_bf16_f32 v39, v78, v79
    v_mfma_f32_16x16x32_bf16 v[112:115], a[216:219], a[152:155], v[112:115]
    s_waitcnt lgkmcnt(9)
    ds_read_b64_tr_b16 a[246:247], v197 offset:34624
    v_mfma_f32_16x16x32_bf16 v[112:115], a[220:223], a[164:167], v[112:115]
    v_mfma_f32_16x16x32_bf16 v[116:119], a[224:227], a[128:131], v[116:119]
    s_waitcnt lgkmcnt(4)
    ds_read_b64_tr_b16 a[248:249], v197 offset:42304
    v_mfma_f32_16x16x32_bf16 v[116:119], a[228:231], a[140:143], v[116:119]
    ds_read_b64_tr_b16 a[250:251], v197 offset:42560
    v_mfma_f32_16x16x32_bf16 v[116:119], a[232:235], a[152:155], v[116:119]
    buffer_load_dwordx4 v240, s[16:19], s51 offen offset:1024 nt lds
    v_mfma_f32_16x16x32_bf16 v[116:119], a[236:239], a[164:167], v[116:119]
    ds_read_b64_tr_b16 a[252:253], v197 offset:42816
    v_mul_f32 v112, s52, v112
    v_mul_f32 v113, s52, v113
    v_mfma_f32_16x16x32_bf16 v[108:111], a[236:239], a[160:163], v[108:111]
    ds_read_b64_tr_b16 a[254:255], v197 offset:43072
    v_mul_f32 v114, s52, v114
    v_mul_f32 v115, s52, v115
    v_mfma_f32_16x16x32_bf16 v[108:111], a[232:235], a[148:151], v[108:111]
    v_mfma_f32_16x16x32_bf16 v[108:111], a[228:231], a[136:139], v[108:111]
    ds_read_b64_tr_b16 a[208:209], v197 offset:33864
    v_mfma_f32_16x16x32_bf16 v[108:111], a[224:227], a[124:127], v[108:111]
    ds_read_b64_tr_b16 a[210:211], v197 offset:34120
    v_mul_f32 v116, s52, v116
    v_mul_f32 v117, s52, v117
    v_mfma_f32_16x16x32_bf16 v[100:103], a[224:227], a[120:123], v[100:103]
    s_add_u32 m0, s33, 1632
    v_mul_f32 v118, s52, v118
    v_mul_f32 v119, s52, v119
    v_cvt_pk_bf16_f32 v56, v112, v113
    v_mfma_f32_16x16x32_bf16 v[100:103], a[228:231], a[132:135], v[100:103]
    ds_read_b64_tr_b16 a[212:213], v197 offset:34376
    v_cvt_pk_bf16_f32 v57, v114, v115
    v_cvt_pk_bf16_f32 v58, v116, v117
    v_mfma_f32_16x16x32_bf16 v[100:103], a[232:235], a[144:147], v[100:103]
    s_waitcnt lgkmcnt(9)
    ds_read_b64_tr_b16 a[214:215], v197 offset:34632
    v_cvt_pk_bf16_f32 v59, v118, v119
    v_mul_f32 v104, s52, v104
    v_mfma_f32_16x16x32_bf16 v[100:103], a[236:239], a[156:159], v[100:103]
    v_mul_f32 v105, s52, v105
    v_mul_f32 v106, s52, v106
    v_mul_f32 v107, s52, v107
    v_mfma_f32_16x16x32_bf16 v[120:123], a[240:243], a[120:123], v[120:123]
    s_waitcnt lgkmcnt(4)
    ds_read_b64_tr_b16 a[216:217], v197 offset:42312
    v_mul_f32 v108, s52, v108
    v_mul_f32 v109, s52, v109
    v_mfma_f32_16x16x32_bf16 v[120:123], a[244:247], a[132:135], v[120:123]
    ds_read_b64_tr_b16 a[218:219], v197 offset:42568
    v_mul_f32 v110, s52, v110
    v_mul_f32 v111, s52, v111
    v_mfma_f32_16x16x32_bf16 v[120:123], a[248:251], a[144:147], v[120:123]
    buffer_load_dwordx4 v240, s[16:19], s51 offen offset:1536 nt lds
    v_mfma_f32_16x16x32_bf16 v[120:123], a[252:255], a[156:159], v[120:123]
    ds_read_b64_tr_b16 a[220:221], v197 offset:42824
    v_cvt_pk_bf16_f32 v52, v104, v105
    v_cvt_pk_bf16_f32 v53, v106, v107
    v_mfma_f32_16x16x32_bf16 v[128:131], a[252:255], a[160:163], v[128:131]
    s_waitcnt vmcnt(8)
    ds_read_b64_tr_b16 a[222:223], v197 offset:43080
    v_cvt_pk_bf16_f32 v54, v108, v109
    v_cvt_pk_bf16_f32 v55, v110, v111
    v_mfma_f32_16x16x32_bf16 v[128:131], a[248:251], a[148:151], v[128:131]
    v_mul_f32 v96, s52, v96
    v_mul_f32 v97, s52, v97
    v_mul_f32 v98, s52, v98
    v_mfma_f32_16x16x32_bf16 v[128:131], a[244:247], a[136:139], v[128:131]
    s_barrier
    ds_read_b64_tr_b16 a[224:225], v198 offset:0
    v_mul_f32 v99, s52, v99
    v_mul_f32 v100, s52, v100
    v_mfma_f32_16x16x32_bf16 v[128:131], a[240:243], a[124:127], v[128:131]
    ds_read_b64_tr_b16 a[226:227], v198 offset:256
    v_mul_f32 v101, s52, v101
    v_mul_f32 v102, s52, v102
    v_mfma_f32_16x16x32_bf16 v[136:139], a[240:243], a[128:131], v[136:139]
    v_mul_f32 v103, s52, v103
    v_cvt_pk_bf16_f32 v48, v96, v97
    v_cvt_pk_bf16_f32 v49, v98, v99
    v_mfma_f32_16x16x32_bf16 v[136:139], a[244:247], a[140:143], v[136:139]
    ds_read_b64_tr_b16 a[228:229], v198 offset:512
    v_cvt_pk_bf16_f32 v50, v100, v101
    v_cvt_pk_bf16_f32 v51, v102, v103
    v_mfma_f32_16x16x32_bf16 v[136:139], a[248:251], a[152:155], v[136:139]
    s_waitcnt lgkmcnt(9)
    ds_read_b64_tr_b16 a[230:231], v198 offset:768
    v_mfma_f32_16x16x32_bf16 v[136:139], a[252:255], a[164:167], v[136:139]
    v_mfma_f32_16x16x32_bf16 v[140:143], a[208:211], a[128:131], v[140:143]
    s_waitcnt lgkmcnt(4)
    ds_read_b64_tr_b16 a[232:233], v198 offset:8448
    v_mfma_f32_16x16x32_bf16 v[140:143], a[212:215], a[140:143], v[140:143]
    ds_read_b64_tr_b16 a[234:235], v198 offset:8704
    v_mfma_f32_16x16x32_bf16 v[140:143], a[216:219], a[152:155], v[140:143]
    s_xor_b32 s51, s95, 4096
    s_add_u32 m0, s33, 16896
    v_mfma_f32_16x16x32_bf16 v[140:143], a[220:223], a[164:167], v[140:143]
    ds_read_b64_tr_b16 a[236:237], v198 offset:8960
    v_mul_f32 v136, s52, v136
    v_mul_f32 v137, s52, v137
    v_mfma_f32_16x16x32_bf16 v[132:135], a[220:223], a[160:163], v[132:135]
    ds_read_b64_tr_b16 a[238:239], v198 offset:9216
    v_mul_f32 v138, s52, v138
    v_mul_f32 v139, s52, v139
    v_mfma_f32_16x16x32_bf16 v[132:135], a[216:219], a[148:151], v[132:135]
    v_mfma_f32_16x16x32_bf16 v[132:135], a[212:215], a[136:139], v[132:135]
    ds_read_b64_tr_b16 a[240:241], v198 offset:8
    v_mfma_f32_16x16x32_bf16 v[132:135], a[208:211], a[124:127], v[132:135]
    ds_read_b64_tr_b16 a[242:243], v198 offset:264
    v_mul_f32 v140, s52, v140
    v_mul_f32 v141, s52, v141
    v_mfma_f32_16x16x32_bf16 v[124:127], a[208:211], a[120:123], v[124:127]
    buffer_load_dwordx4 v240, s[20:23], s51 offen nt lds
    v_mfma_f32_16x16x32_bf16 v[124:127], a[212:215], a[132:135], v[124:127]
    ds_read_b64_tr_b16 a[244:245], v198 offset:520
    v_mul_f32 v142, s52, v142
    v_mul_f32 v143, s52, v143
    v_mfma_f32_16x16x32_bf16 v[124:127], a[216:219], a[144:147], v[124:127]
    s_waitcnt lgkmcnt(9)
    ds_read_b64_tr_b16 a[246:247], v198 offset:776
    v_cvt_pk_bf16_f32 v68, v136, v137
    v_cvt_pk_bf16_f32 v69, v138, v139
    v_mfma_f32_16x16x32_bf16 v[124:127], a[220:223], a[156:159], v[124:127]
    v_cvt_pk_bf16_f32 v70, v140, v141
    v_cvt_pk_bf16_f32 v71, v142, v143
    v_mul_f32 v128, s52, v128
    v_mfma_f32_16x16x32_bf16 v[144:147], a[224:227], a[120:123], v[144:147]
    s_waitcnt lgkmcnt(4)
    ds_read_b64_tr_b16 a[248:249], v198 offset:8456
    v_mul_f32 v129, s52, v129
    v_mul_f32 v130, s52, v130
    v_mfma_f32_16x16x32_bf16 v[144:147], a[228:231], a[132:135], v[144:147]
    ds_read_b64_tr_b16 a[250:251], v198 offset:8712
    v_mul_f32 v131, s52, v131
    v_mul_f32 v132, s52, v132
    v_mfma_f32_16x16x32_bf16 v[144:147], a[232:235], a[144:147], v[144:147]
    s_add_u32 m0, s33, 17440
    v_mul_f32 v133, s52, v133
    v_mul_f32 v134, s52, v134
    v_mul_f32 v135, s52, v135
    v_mfma_f32_16x16x32_bf16 v[144:147], a[236:239], a[156:159], v[144:147]
    ds_read_b64_tr_b16 a[252:253], v198 offset:8968
    v_cvt_pk_bf16_f32 v64, v128, v129
    v_cvt_pk_bf16_f32 v65, v130, v131
    v_mfma_f32_16x16x32_bf16 v[152:155], a[236:239], a[160:163], v[152:155]
    ds_read_b64_tr_b16 a[254:255], v198 offset:9224
    v_cvt_pk_bf16_f32 v66, v132, v133
    v_cvt_pk_bf16_f32 v67, v134, v135
    v_mfma_f32_16x16x32_bf16 v[152:155], a[232:235], a[148:151], v[152:155]
    v_mul_f32 v120, s52, v120
    v_mul_f32 v121, s52, v121
    v_mul_f32 v122, s52, v122
    v_mfma_f32_16x16x32_bf16 v[152:155], a[228:231], a[136:139], v[152:155]
    ds_read_b64_tr_b16 a[208:209], v198 offset:64
    v_mul_f32 v123, s52, v123
    v_mul_f32 v124, s52, v124
    v_mfma_f32_16x16x32_bf16 v[152:155], a[224:227], a[124:127], v[152:155]
    ds_read_b64_tr_b16 a[210:211], v198 offset:320
    v_mul_f32 v125, s52, v125
    v_mul_f32 v126, s52, v126
    v_mfma_f32_16x16x32_bf16 v[160:163], a[224:227], a[128:131], v[160:163]
    buffer_load_dwordx4 v240, s[20:23], s51 offen offset:512 nt lds
    v_mfma_f32_16x16x32_bf16 v[160:163], a[228:231], a[140:143], v[160:163]
    ds_read_b64_tr_b16 a[212:213], v198 offset:576
    v_mul_f32 v127, s52, v127
    v_cvt_pk_bf16_f32 v60, v120, v121
    v_mfma_f32_16x16x32_bf16 v[160:163], a[232:235], a[152:155], v[160:163]
    s_waitcnt lgkmcnt(9)
    ds_read_b64_tr_b16 a[214:215], v198 offset:832
    v_cvt_pk_bf16_f32 v61, v122, v123
    v_cvt_pk_bf16_f32 v62, v124, v125
    v_mfma_f32_16x16x32_bf16 v[160:163], a[236:239], a[164:167], v[160:163]
    v_cvt_pk_bf16_f32 v63, v126, v127
    v_mfma_f32_16x16x32_bf16 v[164:167], a[240:243], a[128:131], v[164:167]
    s_waitcnt lgkmcnt(4)
    ds_read_b64_tr_b16 a[216:217], v198 offset:8512
    v_mfma_f32_16x16x32_bf16 v[164:167], a[244:247], a[140:143], v[164:167]
    ds_read_b64_tr_b16 a[218:219], v198 offset:8768
    v_mfma_f32_16x16x32_bf16 v[164:167], a[248:251], a[152:155], v[164:167]
    s_add_u32 m0, s33, 17984
    v_mfma_f32_16x16x32_bf16 v[164:167], a[252:255], a[164:167], v[164:167]
    ds_read_b64_tr_b16 a[220:221], v198 offset:9024
    v_mul_f32 v160, s52, v160
    v_mul_f32 v161, s52, v161
    v_mfma_f32_16x16x32_bf16 v[156:159], a[252:255], a[160:163], v[156:159]
    ds_read_b64_tr_b16 a[222:223], v198 offset:9280
    v_mul_f32 v162, s52, v162
    v_mul_f32 v163, s52, v163
    v_mfma_f32_16x16x32_bf16 v[156:159], a[248:251], a[148:151], v[156:159]
    v_mfma_f32_16x16x32_bf16 v[156:159], a[244:247], a[136:139], v[156:159]
    ds_read_b64_tr_b16 a[224:225], v198 offset:72
    v_mfma_f32_16x16x32_bf16 v[156:159], a[240:243], a[124:127], v[156:159]
    ds_read_b64_tr_b16 a[226:227], v198 offset:328
    v_mul_f32 v164, s52, v164
    v_mul_f32 v165, s52, v165
    v_mfma_f32_16x16x32_bf16 v[148:151], a[240:243], a[120:123], v[148:151]
    buffer_load_dwordx4 v240, s[20:23], s51 offen offset:1024 nt lds
    v_mfma_f32_16x16x32_bf16 v[148:151], a[244:247], a[132:135], v[148:151]
    ds_read_b64_tr_b16 a[228:229], v198 offset:584
    v_mul_f32 v166, s52, v166
    v_mul_f32 v167, s52, v167
    v_mfma_f32_16x16x32_bf16 v[148:151], a[248:251], a[144:147], v[148:151]
    s_waitcnt lgkmcnt(9)
    ds_read_b64_tr_b16 a[230:231], v198 offset:840
    v_cvt_pk_bf16_f32 v80, v160, v161
    v_cvt_pk_bf16_f32 v81, v162, v163
    v_mfma_f32_16x16x32_bf16 v[148:151], a[252:255], a[156:159], v[148:151]
    v_cvt_pk_bf16_f32 v82, v164, v165
    v_cvt_pk_bf16_f32 v83, v166, v167
    v_mul_f32 v152, s52, v152
    v_mfma_f32_16x16x32_bf16 v[168:171], a[208:211], a[120:123], v[168:171]
    s_waitcnt lgkmcnt(4)
    ds_read_b64_tr_b16 a[232:233], v198 offset:8520
    v_mul_f32 v153, s52, v153
    v_mul_f32 v154, s52, v154
    v_mfma_f32_16x16x32_bf16 v[168:171], a[212:215], a[132:135], v[168:171]
    s_add_u32 m0, s33, 18528
    ds_read_b64_tr_b16 a[234:235], v198 offset:8776
    v_mul_f32 v155, s52, v155
    v_mul_f32 v156, s52, v156
    v_mfma_f32_16x16x32_bf16 v[168:171], a[216:219], a[144:147], v[168:171]
    v_mul_f32 v157, s52, v157
    v_mul_f32 v158, s52, v158
    v_mul_f32 v159, s52, v159
    v_mfma_f32_16x16x32_bf16 v[168:171], a[220:223], a[156:159], v[168:171]
    ds_read_b64_tr_b16 a[236:237], v198 offset:9032
    v_cvt_pk_bf16_f32 v76, v152, v153
    v_cvt_pk_bf16_f32 v77, v154, v155
    v_mfma_f32_16x16x32_bf16 v[176:179], a[220:223], a[160:163], v[176:179]
    s_waitcnt vmcnt(11)
    ds_read_b64_tr_b16 a[238:239], v198 offset:9288
    v_cvt_pk_bf16_f32 v78, v156, v157
    v_cvt_pk_bf16_f32 v79, v158, v159
    v_mfma_f32_16x16x32_bf16 v[176:179], a[216:219], a[148:151], v[176:179]
    v_mul_f32 v144, s52, v144
    v_mul_f32 v145, s52, v145
    v_mul_f32 v146, s52, v146
    v_mfma_f32_16x16x32_bf16 v[176:179], a[212:215], a[136:139], v[176:179]
    s_barrier
    ds_read_b128 a[240:243], v243 offset:16896
    v_mul_f32 v147, s52, v147
    v_mul_f32 v148, s52, v148
    v_mfma_f32_16x16x32_bf16 v[176:179], a[208:211], a[124:127], v[176:179]
    buffer_load_dwordx4 v240, s[20:23], s51 offen offset:1536 nt lds
    v_mfma_f32_16x16x32_bf16 v[184:187], a[208:211], a[128:131], v[184:187]
    s_xor_b32 s51, s95, 16384
    v_mul_f32 v149, s52, v149
    v_mul_f32 v150, s52, v150
    v_mul_f32 v151, s52, v151
    v_mfma_f32_16x16x32_bf16 v[184:187], a[212:215], a[140:143], v[184:187]
    s_waitcnt lgkmcnt(7)
    ds_read_b128 a[244:247], v243 offset:16960
    v_cvt_pk_bf16_f32 v72, v144, v145
    v_cvt_pk_bf16_f32 v73, v146, v147
    v_mfma_f32_16x16x32_bf16 v[184:187], a[216:219], a[152:155], v[184:187]
    s_add_u32 m0, s33, 33792
    v_cvt_pk_bf16_f32 v74, v148, v149
    v_cvt_pk_bf16_f32 v75, v150, v151
    v_mfma_f32_16x16x32_bf16 v[184:187], a[220:223], a[164:167], v[184:187]
    buffer_load_dwordx4 v240, s[16:19], s51 offen nt lds
    v_mfma_f32_16x16x32_bf16 v[188:191], a[224:227], a[128:131], v[188:191]
    s_waitcnt lgkmcnt(2)
    ds_read_b128 a[248:251], v243 offset:17024
    v_mfma_f32_16x16x32_bf16 v[188:191], a[228:231], a[140:143], v[188:191]
    v_mfma_f32_16x16x32_bf16 v[188:191], a[232:235], a[152:155], v[188:191]
    v_mfma_f32_16x16x32_bf16 v[188:191], a[236:239], a[164:167], v[188:191]
    ds_read_b128 a[252:255], v243 offset:17088
    v_mul_f32 v184, s52, v184
    v_mul_f32 v185, s52, v185
    v_mfma_f32_16x16x32_bf16 v[180:183], a[236:239], a[160:163], v[180:183]
    v_mul_f32 v186, s52, v186
    v_mul_f32 v187, s52, v187
    v_mfma_f32_16x16x32_bf16 v[180:183], a[232:235], a[148:151], v[180:183]
    v_mfma_f32_16x16x32_bf16 v[180:183], a[228:231], a[136:139], v[180:183]
    ds_read_b128 a[208:211], v243 offset:17152
    v_mfma_f32_16x16x32_bf16 v[180:183], a[224:227], a[124:127], v[180:183]
    v_mul_f32 v188, s52, v188
    v_mul_f32 v189, s52, v189
    v_mul_f32 v190, s52, v190
    v_mfma_f32_16x16x32_bf16 v[172:175], a[224:227], a[120:123], v[172:175]
    v_mul_f32 v191, s52, v191
    v_cvt_pk_bf16_f32 v92, v184, v185
    v_cvt_pk_bf16_f32 v93, v186, v187
    v_mfma_f32_16x16x32_bf16 v[172:175], a[228:231], a[132:135], v[172:175]
    s_waitcnt lgkmcnt(4)
    ds_read_b128 a[212:215], v243 offset:17216
    v_cvt_pk_bf16_f32 v94, v188, v189
    v_cvt_pk_bf16_f32 v95, v190, v191
    v_mfma_f32_16x16x32_bf16 v[172:175], a[232:235], a[144:147], v[172:175]
    v_mul_f32 v176, s52, v176
    v_mul_f32 v177, s52, v177
    v_mul_f32 v178, s52, v178
    v_mfma_f32_16x16x32_bf16 v[172:175], a[236:239], a[156:159], v[172:175]
    v_mul_f32 v179, s52, v179
    v_mul_f32 v180, s52, v180
    v_mul_f32 v181, s52, v181
    v_mfma_f32_16x16x32_bf16 v[228:231], a[240:243], v[0:3], v[216:219]
    s_waitcnt lgkmcnt(2)
    ds_read_b128 a[216:219], v243 offset:17280
    v_mul_f32 v182, s52, v182
    v_mul_f32 v183, s52, v183
    v_mfma_f32_16x16x32_bf16 v[228:231], a[244:247], v[12:15], v[228:231]
    s_add_u32 m0, s33, 34336
    v_cvt_pk_bf16_f32 v88, v176, v177
    v_cvt_pk_bf16_f32 v89, v178, v179
    v_cvt_pk_bf16_f32 v90, v180, v181
    v_mfma_f32_16x16x32_bf16 v[228:231], a[248:251], v[24:27], v[228:231]
    v_cvt_pk_bf16_f32 v91, v182, v183
    v_mul_f32 v168, s52, v168
    v_mul_f32 v169, s52, v169
    v_mfma_f32_16x16x32_bf16 v[228:231], a[252:255], v[36:39], v[228:231]
    ds_read_b128 a[220:223], v243 offset:17344
    v_mul_f32 v170, s52, v170
    v_mul_f32 v171, s52, v171
    v_mfma_f32_16x16x32_bf16 v[232:235], a[252:255], v[40:43], v[220:223]
    v_mul_f32 v172, s52, v172
    v_mul_f32 v173, s52, v173
    v_mul_f32 v174, s52, v174
    v_mfma_f32_16x16x32_bf16 v[232:235], a[248:251], v[28:31], v[232:235]
    v_mul_f32 v175, s52, v175
    v_cvt_pk_bf16_f32 v84, v168, v169
    v_cvt_pk_bf16_f32 v85, v170, v171
    v_mfma_f32_16x16x32_bf16 v[232:235], a[244:247], v[16:19], v[232:235]
    ds_read_b128 a[224:227], v243 offset:25344
    v_cvt_pk_bf16_f32 v86, v172, v173
    v_cvt_pk_bf16_f32 v87, v174, v175
    v_mfma_f32_16x16x32_bf16 v[232:235], a[240:243], v[4:7], v[232:235]
    buffer_load_dwordx4 v240, s[16:19], s51 offen offset:512 nt lds
    v_mfma_f32_16x16x32_bf16 v[236:239], a[240:243], v[8:11], v[224:227]
    s_add_u32 m0, s33, 34880
    v_mfma_f32_16x16x32_bf16 v[236:239], a[244:247], v[20:23], v[236:239]
    s_waitcnt lgkmcnt(4)
    ds_read_b128 a[228:231], v243 offset:25408
    v_mfma_f32_16x16x32_bf16 v[236:239], a[248:251], v[32:35], v[236:239]
    buffer_load_dwordx4 v240, s[16:19], s51 offen offset:1024 nt lds
    v_mfma_f32_16x16x32_bf16 v[236:239], a[252:255], v[44:47], v[236:239]
    v_mfma_f32_16x16x32_bf16 v[236:239], a[208:211], v[56:59], v[236:239]
    s_waitcnt lgkmcnt(2)
    ds_read_b128 a[232:235], v243 offset:25472
    v_mfma_f32_16x16x32_bf16 v[236:239], a[212:215], v[68:71], v[236:239]
    v_mfma_f32_16x16x32_bf16 v[236:239], a[216:219], v[80:83], v[236:239]
    v_mfma_f32_16x16x32_bf16 v[236:239], a[220:223], v[92:95], v[236:239]
    ds_read_b128 a[236:239], v243 offset:25536
    v_mfma_f32_16x16x32_bf16 v[232:235], a[220:223], v[88:91], v[232:235]
    v_mfma_f32_16x16x32_bf16 v[232:235], a[216:219], v[76:79], v[232:235]
    v_mfma_f32_16x16x32_bf16 v[232:235], a[212:215], v[64:67], v[232:235]
    ds_read_b128 a[240:243], v243 offset:25600
    v_mfma_f32_16x16x32_bf16 v[232:235], a[208:211], v[52:55], v[232:235]
    v_mfma_f32_16x16x32_bf16 v[228:231], a[208:211], v[48:51], v[228:231]
    s_nop 0
    v_exp_f32 v120, v236
    v_mfma_f32_16x16x32_bf16 v[228:231], a[212:215], v[60:63], v[228:231]
    s_waitcnt lgkmcnt(4)
    ds_read_b128 a[244:247], v243 offset:25664
    v_exp_f32 v121, v237
    v_mfma_f32_16x16x32_bf16 v[228:231], a[216:219], v[72:75], v[228:231]
    v_exp_f32 v122, v238
    v_cvt_pk_bf16_f32 v104, v120, v121
    v_mfma_f32_16x16x32_bf16 v[228:231], a[220:223], v[84:87], v[228:231]
    v_exp_f32 v123, v239
    v_mfma_f32_16x16x32_bf16 v[204:207], a[224:227], v[0:3], v[216:219]
    s_waitcnt lgkmcnt(2)
    ds_read_b128 a[248:251], v243 offset:25728
    v_exp_f32 v124, v232
    v_mfma_f32_16x16x32_bf16 v[204:207], a[228:231], v[12:15], v[204:207]
    v_cvt_pk_bf16_f32 v105, v122, v123
    v_mfma_f32_16x16x32_bf16 v[204:207], a[232:235], v[24:27], v[204:207]
    v_exp_f32 v125, v233
    v_mfma_f32_16x16x32_bf16 v[204:207], a[236:239], v[36:39], v[204:207]
    s_waitcnt vmcnt(15)
    ds_read_b128 a[252:255], v243 offset:25792
    v_exp_f32 v126, v234
    v_mfma_f32_16x16x32_bf16 v[208:211], a[236:239], v[40:43], v[220:223]
    s_add_u32 m0, s33, 35424
    v_cvt_pk_bf16_f32 v100, v124, v125
    v_exp_f32 v127, v235
    v_mfma_f32_16x16x32_bf16 v[208:211], a[232:235], v[28:31], v[208:211]
    v_exp_f32 v120, v228
    v_cvt_pk_bf16_f32 v101, v126, v127
    v_mfma_f32_16x16x32_bf16 v[208:211], a[228:231], v[16:19], v[208:211]
    s_barrier
    ds_read_b128 a[208:211], v242 offset:33792
    v_exp_f32 v121, v229
    v_mfma_f32_16x16x32_bf16 v[208:211], a[224:227], v[4:7], v[208:211]
    v_exp_f32 v122, v230
    v_mfma_f32_16x16x32_bf16 v[212:215], a[224:227], v[8:11], v[224:227]
    v_cvt_pk_bf16_f32 v96, v120, v121
    v_exp_f32 v123, v231
    v_mfma_f32_16x16x32_bf16 v[212:215], a[228:231], v[20:23], v[212:215]
    s_waitcnt lgkmcnt(4)
    ds_read_b128 a[212:215], v242 offset:33856
    v_mfma_f32_16x16x32_bf16 v[212:215], a[232:235], v[32:35], v[212:215]
    buffer_load_dwordx4 v240, s[16:19], s51 offen offset:1536 nt lds
    v_mfma_f32_16x16x32_bf16 v[212:215], a[236:239], v[44:47], v[212:215]
    s_xor_b32 s51, s95, 6144
    s_add_u32 m0, s33, 50688
    v_mfma_f32_16x16x32_bf16 v[212:215], a[240:243], v[56:59], v[212:215]
    s_waitcnt lgkmcnt(2)
    ds_read_b128 a[216:219], v242 offset:33920
L_pad3:
    s_cbranch_execz L_pad7
    v_mfma_f32_16x16x32_bf16 v[212:215], a[244:247], v[68:71], v[212:215]
    buffer_load_dwordx4 v240, s[20:23], s51 offen nt lds
    v_mfma_f32_16x16x32_bf16 v[212:215], a[248:251], v[80:83], v[212:215]
    v_mfma_f32_16x16x32_bf16 v[212:215], a[252:255], v[92:95], v[212:215]
    ds_read_b128 a[220:223], v242 offset:33984
    v_mfma_f32_16x16x32_bf16 v[208:211], a[252:255], v[88:91], v[208:211]
    v_mfma_f32_16x16x32_bf16 v[208:211], a[248:251], v[76:79], v[208:211]
    v_mfma_f32_16x16x32_bf16 v[208:211], a[244:247], v[64:67], v[208:211]
    ds_read_b128 a[224:227], v242 offset:34048
    v_mfma_f32_16x16x32_bf16 v[208:211], a[240:243], v[52:55], v[208:211]
    v_mfma_f32_16x16x32_bf16 v[204:207], a[240:243], v[48:51], v[204:207]
    s_nop 0
    v_exp_f32 v124, v212
    v_mfma_f32_16x16x32_bf16 v[204:207], a[244:247], v[60:63], v[204:207]
    s_waitcnt lgkmcnt(4)
    ds_read_b128 a[228:231], v242 offset:34112
    v_cvt_pk_bf16_f32 v97, v122, v123
    v_mfma_f32_16x16x32_bf16 v[204:207], a[248:251], v[72:75], v[204:207]
    v_exp_f32 v125, v213
    v_mfma_f32_16x16x32_bf16 v[204:207], a[252:255], v[84:87], v[204:207]
    v_exp_f32 v126, v214
    v_cvt_pk_bf16_f32 v106, v124, v125
    v_mfma_f32_16x16x32_bf16 v[192:195], a[208:211], v[0:3], v[216:219]
    s_waitcnt lgkmcnt(2)
    ds_read_b128 a[232:235], v242 offset:34176
    v_exp_f32 v127, v215
    v_mfma_f32_16x16x32_bf16 v[192:195], a[212:215], v[12:15], v[192:195]
    v_exp_f32 v120, v208
    v_cvt_pk_bf16_f32 v107, v126, v127
    v_mfma_f32_16x16x32_bf16 v[192:195], a[216:219], v[24:27], v[192:195]
    v_exp_f32 v121, v209
    v_mfma_f32_16x16x32_bf16 v[192:195], a[220:223], v[36:39], v[192:195]
    ds_read_b128 a[236:239], v242 offset:34240
    v_exp_f32 v122, v210
    v_mfma_f32_16x16x32_bf16 v[196:199], a[220:223], v[40:43], v[220:223]
    s_add_u32 m0, s33, 51232
    v_cvt_pk_bf16_f32 v102, v120, v121
    v_exp_f32 v123, v211
    v_mfma_f32_16x16x32_bf16 v[196:199], a[216:219], v[28:31], v[196:199]
    v_exp_f32 v124, v204
    v_cvt_pk_bf16_f32 v103, v122, v123
    v_mfma_f32_16x16x32_bf16 v[196:199], a[212:215], v[16:19], v[196:199]
    ds_read_b128 a[240:243], v242 offset:42240
    v_exp_f32 v125, v205
    v_mfma_f32_16x16x32_bf16 v[196:199], a[208:211], v[4:7], v[196:199]
    v_exp_f32 v126, v206
    v_cvt_pk_bf16_f32 v98, v124, v125
    v_mfma_f32_16x16x32_bf16 v[200:203], a[208:211], v[8:11], v[224:227]
    v_exp_f32 v127, v207
    v_mfma_f32_16x16x32_bf16 v[200:203], a[212:215], v[20:23], v[200:203]
    ds_read_b128 a[244:247], v242 offset:42304
    v_cvt_pk_bf16_f32 v99, v126, v127
    v_mfma_f32_16x16x32_bf16 v[200:203], a[216:219], v[32:35], v[200:203]
    buffer_load_dwordx4 v240, s[20:23], s51 offen offset:512 nt lds
    v_mfma_f32_16x16x32_bf16 v[200:203], a[220:223], v[44:47], v[200:203]
    s_add_u32 m0, s33, 51776
    v_mfma_f32_16x16x32_bf16 v[128:131], a[192:195], v[96:99], 0
    v_mfma_f32_16x16x32_bf16 v[128:131], a[196:199], v[100:103], v[128:131]
    v_mfma_f32_16x16x32_bf16 v[128:131], a[200:203], v[104:107], v[128:131]
    s_waitcnt lgkmcnt(5)
    v_mfma_f32_16x16x32_bf16 v[200:203], a[224:227], v[56:59], v[200:203]
    s_waitcnt lgkmcnt(2)
    ds_read_b128 a[248:251], v242 offset:42368
    v_mfma_f32_16x16x32_bf16 v[200:203], a[228:231], v[68:71], v[200:203]
    buffer_load_dwordx4 v240, s[20:23], s51 offen offset:1024 nt lds
    v_mfma_f32_16x16x32_bf16 v[200:203], a[232:235], v[80:83], v[200:203]
    v_mfma_f32_16x16x32_bf16 v[200:203], a[236:239], v[92:95], v[200:203]
    ds_read_b128 a[252:255], v242 offset:42432
    v_mfma_f32_16x16x32_bf16 v[196:199], a[236:239], v[88:91], v[196:199]
    v_min3_f32 v137, v128, v129, v130
    v_cmp_nle_f32 s[54:55], s34, v137
    v_mfma_f32_16x16x32_bf16 v[196:199], a[232:235], v[76:79], v[196:199]
    v_max3_f32 v136, v128, v129, v130
    v_cmp_nge_f32 vcc, s53, v136
    v_mfma_f32_16x16x32_bf16 v[196:199], a[228:231], v[64:67], v[196:199]
    s_or_b64 vcc, vcc, s[54:55]
    ds_read_b128 a[208:211], v242 offset:42496
    v_mfma_f32_16x16x32_bf16 v[196:199], a[224:227], v[52:55], v[196:199]
    v_mfma_f32_16x16x32_bf16 v[192:195], a[224:227], v[48:51], v[192:195]
    v_mfma_f32_16x16x32_bf16 v[192:195], a[228:231], v[60:63], v[192:195]
    s_waitcnt lgkmcnt(4)
    ds_read_b128 a[212:215], v242 offset:42560
    v_mfma_f32_16x16x32_bf16 v[192:195], a[232:235], v[72:75], v[192:195]
    s_add_u32 m0, s33, 52320
    v_mfma_f32_16x16x32_bf16 v[192:195], a[236:239], v[84:87], v[192:195]
    s_cbranch_vccnz L_stub0
L_back0:
    v_mfma_f32_16x16x32_bf16 v[204:207], a[240:243], v[0:3], v[216:219]
    s_waitcnt lgkmcnt(2)
    ds_read_b128 a[216:219], v242 offset:42624
    v_mfma_f32_16x16x32_bf16 v[204:207], a[244:247], v[12:15], v[204:207]
    v_exp_f32 v120, v200
    v_mfma_f32_16x16x32_bf16 v[204:207], a[248:251], v[24:27], v[204:207]
    v_exp_f32 v121, v201
    v_mfma_f32_16x16x32_bf16 v[204:207], a[252:255], v[36:39], v[204:207]
    ds_read_b128 a[220:223], v242 offset:42688
    v_exp_f32 v122, v202
    v_mfma_f32_16x16x32_bf16 v[208:211], a[252:255], v[40:43], v[220:223]
    buffer_load_dwordx4 v240, s[20:23], s51 offen offset:1536 nt lds
    v_cvt_pk_bf16_f32 v116, v120, v121
    v_mfma_f32_16x16x32_bf16 v[208:211], a[248:251], v[28:31], v[208:211]
    v_exp_f32 v123, v203
    v_mfma_f32_16x16x32_bf16 v[208:211], a[244:247], v[16:19], v[208:211]
    ds_read_b64_tr_b16 a[224:225], v246 offset:0
    v_mfma_f32_16x16x32_bf16 v[208:211], a[240:243], v[4:7], v[208:211]
    ds_read_b64_tr_b16 a[226:227], v246 offset:8448
    v_mfma_f32_16x16x32_bf16 v[212:215], a[240:243], v[8:11], v[224:227]
    v_exp_f32 v124, v196
    v_mfma_f32_16x16x32_bf16 v[212:215], a[244:247], v[20:23], v[212:215]
    ds_read_b64_tr_b16 a[228:229], v246 offset:32
    v_cvt_pk_bf16_f32 v117, v122, v123
    v_mfma_f32_16x16x32_bf16 v[212:215], a[248:251], v[32:35], v[212:215]
    s_waitcnt lgkmcnt(6)
    ds_read_b64_tr_b16 a[230:231], v246 offset:8480
    v_exp_f32 v125, v197
    v_mfma_f32_16x16x32_bf16 v[212:215], a[252:255], v[44:47], v[212:215]
    v_exp_f32 v126, v198
    v_mfma_f32_16x16x32_bf16 v[212:215], a[208:211], v[56:59], v[212:215]
    s_waitcnt lgkmcnt(4)
    ds_read_b64_tr_b16 a[232:233], v246 offset:64
    v_cvt_pk_bf16_f32 v112, v124, v125
    v_mfma_f32_16x16x32_bf16 v[212:215], a[212:215], v[68:71], v[212:215]
    ds_read_b64_tr_b16 a[234:235], v246 offset:8512
    v_mfma_f32_16x16x32_bf16 v[212:215], a[216:219], v[80:83], v[212:215]
    v_exp_f32 v127, v199
    v_mfma_f32_16x16x32_bf16 v[212:215], a[220:223], v[92:95], v[212:215]
    ds_read_b64_tr_b16 a[236:237], v246 offset:96
    v_mfma_f32_16x16x32_bf16 v[208:211], a[220:223], v[88:91], v[208:211]
    ds_read_b64_tr_b16 a[238:239], v246 offset:8544
    v_exp_f32 v120, v192
    v_mfma_f32_16x16x32_bf16 v[208:211], a[216:219], v[76:79], v[208:211]
    v_cvt_pk_bf16_f32 v113, v126, v127
    v_mfma_f32_16x16x32_bf16 v[208:211], a[212:215], v[64:67], v[208:211]
    ds_read_b64_tr_b16 a[240:241], v246 offset:128
    v_mfma_f32_16x16x32_bf16 v[208:211], a[208:211], v[52:55], v[208:211]
    ds_read_b64_tr_b16 a[242:243], v246 offset:8576
    v_mfma_f32_16x16x32_bf16 v[204:207], a[208:211], v[48:51], v[204:207]
    v_exp_f32 v121, v193
    v_mfma_f32_16x16x32_bf16 v[204:207], a[212:215], v[60:63], v[204:207]
    ds_read_b64_tr_b16 a[244:245], v246 offset:160
    v_mfma_f32_16x16x32_bf16 v[204:207], a[216:219], v[72:75], v[204:207]
    s_waitcnt lgkmcnt(9)
    ds_read_b64_tr_b16 a[246:247], v246 offset:8608
    v_exp_f32 v122, v194
    v_mfma_f32_16x16x32_bf16 v[204:207], a[220:223], v[84:87], v[204:207]
    v_cvt_pk_bf16_f32 v108, v120, v121
    v_mfma_f32_16x16x32_bf16 v[144:147], a[224:227], v[96:99], 0
    ds_read_b64_tr_b16 a[248:249], v246 offset:192
    v_mfma_f32_16x16x32_bf16 v[148:151], a[224:227], v[100:103], 0
    s_waitcnt lgkmcnt(9)
    ds_read_b64_tr_b16 a[250:251], v246 offset:8640
    v_mfma_f32_16x16x32_bf16 v[152:155], a[224:227], v[104:107], 0
    v_exp_f32 v123, v195
    v_mfma_f32_16x16x32_bf16 v[164:167], a[228:231], v[104:107], 0
    ds_read_b64_tr_b16 a[252:253], v246 offset:224
    v_mfma_f32_16x16x32_bf16 v[160:163], a[228:231], v[100:103], 0
    s_waitcnt lgkmcnt(9)
    ds_read_b64_tr_b16 a[254:255], v246 offset:8672
    v_exp_f32 v124, v212
    v_mfma_f32_16x16x32_bf16 v[156:159], a[228:231], v[96:99], 0
    v_cvt_pk_bf16_f32 v109, v122, v123
    v_mfma_f32_16x16x32_bf16 v[168:171], a[232:235], v[96:99], 0
    ds_read_b64_tr_b16 a[208:209], v246 offset:256
    v_mfma_f32_16x16x32_bf16 v[172:175], a[232:235], v[100:103], 0
    s_waitcnt lgkmcnt(9)
    ds_read_b64_tr_b16 a[210:211], v246 offset:8704
    v_mfma_f32_16x16x32_bf16 v[176:179], a[232:235], v[104:107], 0
    v_exp_f32 v125, v213
    v_mfma_f32_16x16x32_bf16 v[188:191], a[236:239], v[104:107], 0
    ds_read_b64_tr_b16 a[212:213], v246 offset:288
    v_mfma_f32_16x16x32_bf16 v[184:187], a[236:239], v[100:103], 0
    s_waitcnt lgkmcnt(9)
    ds_read_b64_tr_b16 a[214:215], v246 offset:8736
    v_mfma_f32_16x16x32_bf16 v[180:183], a[236:239], v[96:99], 0
    v_exp_f32 v126, v214
    v_cvt_pk_bf16_f32 v118, v124, v125
    v_mfma_f32_16x16x32_bf16 a[48:51], a[240:243], v[96:99], 0
    ds_read_b64_tr_b16 a[216:217], v246 offset:320
    v_mfma_f32_16x16x32_bf16 a[52:55], a[240:243], v[100:103], 0
    s_waitcnt lgkmcnt(9)
    ds_read_b64_tr_b16 a[218:219], v246 offset:8768
    v_mfma_f32_16x16x32_bf16 a[56:59], a[240:243], v[104:107], 0
    v_exp_f32 v127, v215
    v_mfma_f32_16x16x32_bf16 a[68:71], a[244:247], v[104:107], 0
    ds_read_b64_tr_b16 a[220:221], v246 offset:352
    v_mfma_f32_16x16x32_bf16 a[64:67], a[244:247], v[100:103], 0
    s_waitcnt lgkmcnt(9)
    ds_read_b64_tr_b16 a[222:223], v246 offset:8800
    v_mfma_f32_16x16x32_bf16 a[60:63], a[244:247], v[96:99], 0
    v_exp_f32 v120, v208
    v_cvt_pk_bf16_f32 v119, v126, v127
    v_mfma_f32_16x16x32_bf16 a[72:75], a[248:251], v[96:99], 0
    ds_read_b64_tr_b16 a[224:225], v246 offset:384
    v_mfma_f32_16x16x32_bf16 a[76:79], a[248:251], v[100:103], 0
    s_waitcnt lgkmcnt(9)
    ds_read_b64_tr_b16 a[226:227], v246 offset:8832
    v_mfma_f32_16x16x32_bf16 a[80:83], a[248:251], v[104:107], 0
    v_exp_f32 v121, v209
    v_mfma_f32_16x16x32_bf16 a[92:95], a[252:255], v[104:107], 0
    ds_read_b64_tr_b16 a[228:229], v246 offset:416
    v_mfma_f32_16x16x32_bf16 a[88:91], a[252:255], v[100:103], 0
    s_waitcnt lgkmcnt(9)
    ds_read_b64_tr_b16 a[230:231], v246 offset:8864
    v_mfma_f32_16x16x32_bf16 a[84:87], a[252:255], v[96:99], 0
    v_exp_f32 v122, v210
    v_cvt_pk_bf16_f32 v114, v120, v121
    v_mfma_f32_16x16x32_bf16 a[96:99], a[208:211], v[96:99], 0
    ds_read_b64_tr_b16 a[232:233], v246 offset:448
    v_mfma_f32_16x16x32_bf16 a[100:103], a[208:211], v[100:103], 0
    s_waitcnt lgkmcnt(9)
    ds_read_b64_tr_b16 a[234:235], v246 offset:8896
    v_mfma_f32_16x16x32_bf16 a[104:107], a[208:211], v[104:107], 0
    v_exp_f32 v123, v211
    v_mfma_f32_16x16x32_bf16 a[116:119], a[212:215], v[104:107], 0
    s_waitcnt lgkmcnt(8)
    ds_read_b64_tr_b16 a[236:237], v246 offset:480
    v_mfma_f32_16x16x32_bf16 a[112:115], a[212:215], v[100:103], 0
    s_waitcnt vmcnt(16)
    ds_read_b64_tr_b16 a[238:239], v246 offset:8928
    v_mfma_f32_16x16x32_bf16 a[108:111], a[212:215], v[96:99], 0
    v_exp_f32 v124, v204
    v_cvt_pk_bf16_f32 v115, v122, v123
    v_mfma_f32_16x16x32_bf16 a[120:123], a[216:219], v[96:99], 0
    s_barrier
    ds_read_b128 a[240:243], v243 offset:33792
    v_mfma_f32_16x16x32_bf16 a[124:127], a[216:219], v[100:103], 0
    s_xor_b32 s51, s95, 18432
    v_exp_f32 v125, v205
    v_mfma_f32_16x16x32_bf16 a[128:131], a[216:219], v[104:107], 0
    s_waitcnt lgkmcnt(9)
    v_exp_f32 v126, v206
    v_mfma_f32_16x16x32_bf16 a[140:143], a[220:223], v[104:107], 0
    s_waitcnt lgkmcnt(7)
    ds_read_b128 a[244:247], v243 offset:33856
    v_cvt_pk_bf16_f32 v110, v124, v125
    v_mfma_f32_16x16x32_bf16 a[136:139], a[220:223], v[100:103], 0
    s_add_u32 m0, s33, 84480
    v_exp_f32 v127, v207
    v_mfma_f32_16x16x32_bf16 a[132:135], a[220:223], v[96:99], 0
    v_cvt_pk_bf16_f32 v111, v126, v127
    v_mfma_f32_16x16x32_bf16 a[144:147], a[224:227], v[96:99], 0
    ds_read_b128 a[248:251], v243 offset:33920
    v_mfma_f32_16x16x32_bf16 a[148:151], a[224:227], v[100:103], 0
    buffer_load_dwordx4 v240, s[16:19], s51 offen nt lds
    v_mfma_f32_16x16x32_bf16 a[152:155], a[224:227], v[104:107], 0
    s_add_u32 m0, s33, 85024
    v_mfma_f32_16x16x32_bf16 v[132:135], a[192:195], v[108:111], v[128:131]
    v_mfma_f32_16x16x32_bf16 v[132:135], a[196:199], v[112:115], v[132:135]
    buffer_load_dwordx4 v240, s[16:19], s51 offen offset:512 nt lds
    v_mfma_f32_16x16x32_bf16 v[132:135], a[200:203], v[116:119], v[132:135]
    s_waitcnt lgkmcnt(7)
    s_add_u32 m0, s33, 85568
    v_mfma_f32_16x16x32_bf16 a[164:167], a[228:231], v[104:107], 0
    s_waitcnt lgkmcnt(5)
    ds_read_b128 a[252:255], v243 offset:33984
    v_mfma_f32_16x16x32_bf16 a[160:163], a[228:231], v[100:103], 0
    buffer_load_dwordx4 v240, s[16:19], s51 offen offset:1024 nt lds
    v_mfma_f32_16x16x32_bf16 a[156:159], a[228:231], v[96:99], 0
    v_mfma_f32_16x16x32_bf16 a[168:171], a[232:235], v[96:99], 0
    s_waitcnt lgkmcnt(4)
    ds_read_b128 a[208:211], v243 offset:34048
    v_mfma_f32_16x16x32_bf16 a[172:175], a[232:235], v[100:103], 0
    v_max3_f32 v136, v132, v133, v134
    v_cmp_nge_f32 vcc, s53, v136
    v_mfma_f32_16x16x32_bf16 a[176:179], a[232:235], v[104:107], 0
    s_add_u32 m0, s33, 86112
    v_mfma_f32_16x16x32_bf16 a[188:191], a[236:239], v[104:107], 0
    s_waitcnt lgkmcnt(4)
    ds_read_b128 a[212:215], v243 offset:34112
    v_mfma_f32_16x16x32_bf16 a[184:187], a[236:239], v[100:103], 0
    v_mfma_f32_16x16x32_bf16 a[180:183], a[236:239], v[96:99], 0
    s_cbranch_vccnz L_stub1
L_back1:
    v_mfma_f32_16x16x32_bf16 v[192:195], a[240:243], v[0:3], v[216:219]
    s_waitcnt lgkmcnt(2)
    ds_read_b128 a[216:219], v243 offset:34176
    v_mfma_f32_16x16x32_bf16 v[192:195], a[244:247], v[12:15], v[192:195]
    v_mfma_f32_16x16x32_bf16 v[192:195], a[248:251], v[24:27], v[192:195]
    buffer_load_dwordx4 v240, s[16:19], s51 offen offset:1536 nt lds
    v_mfma_f32_16x16x32_bf16 v[192:195], a[252:255], v[36:39], v[192:195]
    s_xor_b32 s51, s95, 16384
    ds_read_b128 a[220:223], v243 offset:34240
    s_add_u32 m0, s33, 118272
    v_mfma_f32_16x16x32_bf16 v[196:199], a[252:255], v[40:43], v[220:223]
    v_mfma_f32_16x16x32_bf16 v[196:199], a[248:251], v[28:31], v[196:199]
    buffer_load_dwordx4 v240, s[20:23], s51 offen nt lds
    v_mfma_f32_16x16x32_bf16 v[196:199], a[244:247], v[16:19], v[196:199]
    ds_read_b128 a[224:227], v243 offset:42240
    v_mfma_f32_16x16x32_bf16 v[196:199], a[240:243], v[4:7], v[196:199]
    v_mfma_f32_16x16x32_bf16 v[200:203], a[240:243], v[8:11], v[224:227]
    v_mfma_f32_16x16x32_bf16 v[200:203], a[244:247], v[20:23], v[200:203]
    s_waitcnt lgkmcnt(4)
    ds_read_b128 a[228:231], v243 offset:42304
    v_mfma_f32_16x16x32_bf16 v[200:203], a[248:251], v[32:35], v[200:203]
    v_mfma_f32_16x16x32_bf16 v[200:203], a[252:255], v[44:47], v[200:203]
    v_mfma_f32_16x16x32_bf16 v[200:203], a[208:211], v[56:59], v[200:203]
    s_waitcnt lgkmcnt(2)
    ds_read_b128 a[232:235], v243 offset:42368
    v_mfma_f32_16x16x32_bf16 v[200:203], a[212:215], v[68:71], v[200:203]
    s_add_u32 m0, s33, 118816
    v_mfma_f32_16x16x32_bf16 v[200:203], a[216:219], v[80:83], v[200:203]
    v_mfma_f32_16x16x32_bf16 v[200:203], a[220:223], v[92:95], v[200:203]
    ds_read_b128 a[236:239], v243 offset:42432
    v_mfma_f32_16x16x32_bf16 v[196:199], a[220:223], v[88:91], v[196:199]
    v_mfma_f32_16x16x32_bf16 v[196:199], a[216:219], v[76:79], v[196:199]
    v_mfma_f32_16x16x32_bf16 v[196:199], a[212:215], v[64:67], v[196:199]
    ds_read_b128 a[240:243], v243 offset:42496
    v_mfma_f32_16x16x32_bf16 v[196:199], a[208:211], v[52:55], v[196:199]
    buffer_load_dwordx4 v240, s[20:23], s51 offen offset:512 nt lds
    v_mfma_f32_16x16x32_bf16 v[192:195], a[208:211], v[48:51], v[192:195]
    v_exp_f32 v120, v200
    v_mfma_f32_16x16x32_bf16 v[192:195], a[212:215], v[60:63], v[192:195]
    s_waitcnt lgkmcnt(4)
    ds_read_b128 a[244:247], v243 offset:42560
    v_mfma_f32_16x16x32_bf16 v[192:195], a[216:219], v[72:75], v[192:195]
    v_exp_f32 v121, v201
    v_mfma_f32_16x16x32_bf16 v[192:195], a[220:223], v[84:87], v[192:195]
    v_exp_f32 v122, v202
    v_mfma_f32_16x16x32_bf16 v[204:207], a[224:227], v[0:3], v[216:219]
    s_waitcnt lgkmcnt(2)
    ds_read_b128 a[248:251], v243 offset:42624
    v_cvt_pk_bf16_f32 v104, v120, v121
    v_mfma_f32_16x16x32_bf16 v[204:207], a[228:231], v[12:15], v[204:207]
    v_exp_f32 v123, v203
    v_mfma_f32_16x16x32_bf16 v[204:207], a[232:235], v[24:27], v[204:207]
    s_add_u32 m0, s33, 119360
    v_exp_f32 v124, v196
    v_mfma_f32_16x16x32_bf16 v[204:207], a[236:239], v[36:39], v[204:207]
    ds_read_b128 a[252:255], v243 offset:42688
    v_cvt_pk_bf16_f32 v105, v122, v123
    v_mfma_f32_16x16x32_bf16 v[208:211], a[236:239], v[40:43], v[220:223]
    v_exp_f32 v125, v197
    v_mfma_f32_16x16x32_bf16 v[208:211], a[232:235], v[28:31], v[208:211]
    v_exp_f32 v126, v198
    v_mfma_f32_16x16x32_bf16 v[208:211], a[228:231], v[16:19], v[208:211]
    ds_read_b64_tr_b16 a[208:209], v245 offset:16896
    v_cvt_pk_bf16_f32 v100, v124, v125
    v_mfma_f32_16x16x32_bf16 v[208:211], a[224:227], v[4:7], v[208:211]
    ds_read_b64_tr_b16 a[210:211], v245 offset:25344
    v_mfma_f32_16x16x32_bf16 v[212:215], a[224:227], v[8:11], v[224:227]
    buffer_load_dwordx4 v240, s[20:23], s51 offen offset:1024 nt lds
    v_exp_f32 v127, v199
    v_mfma_f32_16x16x32_bf16 v[212:215], a[228:231], v[20:23], v[212:215]
    ds_read_b64_tr_b16 a[212:213], v245 offset:16928
    v_mfma_f32_16x16x32_bf16 v[212:215], a[232:235], v[32:35], v[212:215]
    s_waitcnt lgkmcnt(6)
    ds_read_b64_tr_b16 a[214:215], v245 offset:25376
    v_mfma_f32_16x16x32_bf16 v[212:215], a[236:239], v[44:47], v[212:215]
    v_exp_f32 v120, v192
    v_mfma_f32_16x16x32_bf16 v[212:215], a[240:243], v[56:59], v[212:215]
    s_waitcnt lgkmcnt(4)
    ds_read_b64_tr_b16 a[216:217], v245 offset:16960
    v_cvt_pk_bf16_f32 v101, v126, v127
    v_mfma_f32_16x16x32_bf16 v[212:215], a[244:247], v[68:71], v[212:215]
    ds_read_b64_tr_b16 a[218:219], v245 offset:25408
    v_mfma_f32_16x16x32_bf16 v[212:215], a[248:251], v[80:83], v[212:215]
    v_exp_f32 v121, v193
    v_mfma_f32_16x16x32_bf16 v[212:215], a[252:255], v[92:95], v[212:215]
    ds_read_b64_tr_b16 a[220:221], v245 offset:16992
    v_mfma_f32_16x16x32_bf16 v[208:211], a[252:255], v[88:91], v[208:211]
    ds_read_b64_tr_b16 a[222:223], v245 offset:25440
    v_mfma_f32_16x16x32_bf16 v[208:211], a[248:251], v[76:79], v[208:211]
    v_exp_f32 v122, v194
    v_mfma_f32_16x16x32_bf16 v[208:211], a[244:247], v[64:67], v[208:211]
    ds_read_b64_tr_b16 a[224:225], v245 offset:17024
    v_cvt_pk_bf16_f32 v96, v120, v121
    v_mfma_f32_16x16x32_bf16 v[208:211], a[240:243], v[52:55], v[208:211]
    ds_read_b64_tr_b16 a[226:227], v245 offset:25472
    v_mfma_f32_16x16x32_bf16 v[204:207], a[240:243], v[48:51], v[204:207]
    v_exp_f32 v123, v195
    v_mfma_f32_16x16x32_bf16 v[204:207], a[244:247], v[60:63], v[204:207]
    ds_read_b64_tr_b16 a[228:229], v245 offset:17056
    v_mfma_f32_16x16x32_bf16 v[204:207], a[248:251], v[72:75], v[204:207]
    s_waitcnt lgkmcnt(9)
    ds_read_b64_tr_b16 a[230:231], v245 offset:25504
    v_mfma_f32_16x16x32_bf16 v[204:207], a[252:255], v[84:87], v[204:207]
    v_exp_f32 v124, v212
    v_mfma_f32_16x16x32_bf16 v[144:147], a[208:211], v[108:111], v[144:147]
    ds_read_b64_tr_b16 a[232:233], v245 offset:17088
    v_cvt_pk_bf16_f32 v97, v122, v123
    v_mfma_f32_16x16x32_bf16 v[148:151], a[208:211], v[112:115], v[148:151]
    s_waitcnt lgkmcnt(9)
    ds_read_b64_tr_b16 a[234:235], v245 offset:25536
    v_mfma_f32_16x16x32_bf16 v[152:155], a[208:211], v[116:119], v[152:155]
    v_exp_f32 v125, v213
    v_mfma_f32_16x16x32_bf16 v[164:167], a[212:215], v[116:119], v[164:167]
    ds_read_b64_tr_b16 a[236:237], v245 offset:17120
    v_mfma_f32_16x16x32_bf16 v[160:163], a[212:215], v[112:115], v[160:163]
    s_waitcnt lgkmcnt(9)
    ds_read_b64_tr_b16 a[238:239], v245 offset:25568
    v_mfma_f32_16x16x32_bf16 v[156:159], a[212:215], v[108:111], v[156:159]
    v_exp_f32 v126, v214
    v_mfma_f32_16x16x32_bf16 v[168:171], a[216:219], v[108:111], v[168:171]
    ds_read_b64_tr_b16 a[240:241], v245 offset:17152
    v_cvt_pk_bf16_f32 v106, v124, v125
    v_mfma_f32_16x16x32_bf16 v[172:175], a[216:219], v[112:115], v[172:175]
    s_waitcnt lgkmcnt(9)
    ds_read_b64_tr_b16 a[242:243], v245 offset:25600
    v_mfma_f32_16x16x32_bf16 v[176:179], a[216:219], v[116:119], v[176:179]
    v_exp_f32 v127, v215
    v_mfma_f32_16x16x32_bf16 v[188:191], a[220:223], v[116:119], v[188:191]
    ds_read_b64_tr_b16 a[244:245], v245 offset:17184
    v_mfma_f32_16x16x32_bf16 v[184:187], a[220:223], v[112:115], v[184:187]
    s_waitcnt lgkmcnt(9)
    ds_read_b64_tr_b16 a[246:247], v245 offset:25632
    v_mfma_f32_16x16x32_bf16 v[180:183], a[220:223], v[108:111], v[180:183]
    v_exp_f32 v120, v208
    v_mfma_f32_16x16x32_bf16 a[48:51], a[224:227], v[108:111], a[48:51]
    ds_read_b64_tr_b16 a[248:249], v245 offset:17216
    v_cvt_pk_bf16_f32 v107, v126, v127
    v_mfma_f32_16x16x32_bf16 a[52:55], a[224:227], v[112:115], a[52:55]
    s_waitcnt lgkmcnt(9)
    ds_read_b64_tr_b16 a[250:251], v245 offset:25664
    v_mfma_f32_16x16x32_bf16 a[56:59], a[224:227], v[116:119], a[56:59]
    v_exp_f32 v121, v209
    v_mfma_f32_16x16x32_bf16 a[68:71], a[228:231], v[116:119], a[68:71]
    ds_read_b64_tr_b16 a[252:253], v245 offset:17248
    v_mfma_f32_16x16x32_bf16 a[64:67], a[228:231], v[112:115], a[64:67]
    s_waitcnt lgkmcnt(9)
    ds_read_b64_tr_b16 a[254:255], v245 offset:25696
    v_mfma_f32_16x16x32_bf16 a[60:63], a[228:231], v[108:111], a[60:63]
    v_exp_f32 v122, v210
    v_mfma_f32_16x16x32_bf16 a[72:75], a[232:235], v[108:111], a[72:75]
    ds_read_b64_tr_b16 a[208:209], v245 offset:17280
    v_cvt_pk_bf16_f32 v102, v120, v121
    v_mfma_f32_16x16x32_bf16 a[76:79], a[232:235], v[112:115], a[76:79]
    s_waitcnt lgkmcnt(9)
    ds_read_b64_tr_b16 a[210:211], v245 offset:25728
    v_mfma_f32_16x16x32_bf16 a[80:83], a[232:235], v[116:119], a[80:83]
    v_exp_f32 v123, v211
    v_mfma_f32_16x16x32_bf16 a[92:95], a[236:239], v[116:119], a[92:95]
    ds_read_b64_tr_b16 a[212:213], v245 offset:17312
    v_mfma_f32_16x16x32_bf16 a[88:91], a[236:239], v[112:115], a[88:91]
    s_waitcnt lgkmcnt(9)
    ds_read_b64_tr_b16 a[214:215], v245 offset:25760
    v_mfma_f32_16x16x32_bf16 a[84:87], a[236:239], v[108:111], a[84:87]
    v_exp_f32 v124, v204
    v_mfma_f32_16x16x32_bf16 a[96:99], a[240:243], v[108:111], a[96:99]
    ds_read_b64_tr_b16 a[216:217], v245 offset:17344
    v_cvt_pk_bf16_f32 v103, v122, v123
    v_mfma_f32_16x16x32_bf16 a[100:103], a[240:243], v[112:115], a[100:103]
    s_waitcnt lgkmcnt(9)
    ds_read_b64_tr_b16 a[218:219], v245 offset:25792
    v_mfma_f32_16x16x32_bf16 a[104:107], a[240:243], v[116:119], a[104:107]
    v_exp_f32 v125, v205
    v_mfma_f32_16x16x32_bf16 a[116:119], a[244:247], v[116:119], a[116:119]
    s_waitcnt lgkmcnt(8)
    ds_read_b64_tr_b16 a[220:221], v245 offset:17376
    v_mfma_f32_16x16x32_bf16 a[112:115], a[244:247], v[112:115], a[112:115]
    s_waitcnt vmcnt(15)
    ds_read_b64_tr_b16 a[222:223], v245 offset:25824
    s_add_u32 m0, s33, 119904
    v_mfma_f32_16x16x32_bf16 a[108:111], a[244:247], v[108:111], a[108:111]
    v_exp_f32 v126, v206
    v_mfma_f32_16x16x32_bf16 a[120:123], a[248:251], v[108:111], a[120:123]
    s_barrier
    ds_read_b128 a[224:227], v241 offset:0
    v_cvt_pk_bf16_f32 v98, v124, v125
    v_mfma_f32_16x16x32_bf16 a[124:127], a[248:251], v[112:115], a[124:127]
    v_exp_f32 v127, v207
    v_mfma_f32_16x16x32_bf16 a[128:131], a[248:251], v[116:119], a[128:131]
    s_waitcnt lgkmcnt(9)
    v_cvt_pk_bf16_f32 v99, v126, v127
    v_mfma_f32_16x16x32_bf16 a[140:143], a[252:255], v[116:119], a[140:143]
    s_waitcnt lgkmcnt(7)
    ds_read_b128 a[228:231], v241 offset:64
    v_mfma_f32_16x16x32_bf16 a[136:139], a[252:255], v[112:115], a[136:139]
    buffer_load_dwordx4 v240, s[20:23], s51 offen offset:1536 nt lds
    v_mfma_f32_16x16x32_bf16 a[132:135], a[252:255], v[108:111], a[132:135]
    s_xor_b32 s51, s95, 20480
    s_add_u32 m0, s33, 101376
    v_mfma_f32_16x16x32_bf16 a[144:147], a[208:211], v[108:111], a[144:147]
    ds_read_b128 a[232:235], v241 offset:128
    v_mfma_f32_16x16x32_bf16 a[148:151], a[208:211], v[112:115], a[148:151]
    buffer_load_dwordx4 v240, s[16:19], s51 offen nt lds
    v_mfma_f32_16x16x32_bf16 a[152:155], a[208:211], v[116:119], a[152:155]
    s_add_u32 m0, s33, 101920
    v_mfma_f32_16x16x32_bf16 v[128:131], a[192:195], v[96:99], v[132:135]
    v_mfma_f32_16x16x32_bf16 v[128:131], a[196:199], v[100:103], v[128:131]
    buffer_load_dwordx4 v240, s[16:19], s51 offen offset:512 nt lds
    v_mfma_f32_16x16x32_bf16 v[128:131], a[200:203], v[104:107], v[128:131]
    s_waitcnt lgkmcnt(7)
    s_add_u32 m0, s33, 102464
    v_mfma_f32_16x16x32_bf16 a[164:167], a[212:215], v[116:119], a[164:167]
    s_waitcnt lgkmcnt(5)
    ds_read_b128 a[236:239], v241 offset:192
    v_mfma_f32_16x16x32_bf16 a[160:163], a[212:215], v[112:115], a[160:163]
    buffer_load_dwordx4 v240, s[16:19], s51 offen offset:1024 nt lds
    v_mfma_f32_16x16x32_bf16 a[156:159], a[212:215], v[108:111], a[156:159]
    v_mfma_f32_16x16x32_bf16 a[168:171], a[216:219], v[108:111], a[168:171]
    s_waitcnt lgkmcnt(4)
    ds_read_b128 a[240:243], v241 offset:256
    v_mfma_f32_16x16x32_bf16 a[172:175], a[216:219], v[112:115], a[172:175]
    v_max3_f32 v136, v128, v129, v130
    v_cmp_nge_f32 vcc, s53, v136
    v_mfma_f32_16x16x32_bf16 a[176:179], a[216:219], v[116:119], a[176:179]
    v_mfma_f32_16x16x32_bf16 a[188:191], a[220:223], v[116:119], a[188:191]
    s_waitcnt lgkmcnt(4)
    ds_read_b128 a[244:247], v241 offset:320
    v_mfma_f32_16x16x32_bf16 a[184:187], a[220:223], v[112:115], a[184:187]
    v_mfma_f32_16x16x32_bf16 a[180:183], a[220:223], v[108:111], a[180:183]
    s_cbranch_vccnz L_stub2
L_back2:
    s_add_u32 m0, s33, 103008
    v_mfma_f32_16x16x32_bf16 v[192:195], a[224:227], v[0:3], v[216:219]
    s_waitcnt lgkmcnt(2)
    ds_read_b128 a[248:251], v241 offset:384
    v_mfma_f32_16x16x32_bf16 v[192:195], a[228:231], v[12:15], v[192:195]
    v_mfma_f32_16x16x32_bf16 v[192:195], a[232:235], v[24:27], v[192:195]
    v_mfma_f32_16x16x32_bf16 v[192:195], a[236:239], v[36:39], v[192:195]
    ds_read_b128 a[252:255], v241 offset:448
    v_mfma_f32_16x16x32_bf16 v[196:199], a[236:239], v[40:43], v[220:223]
    v_mfma_f32_16x16x32_bf16 v[196:199], a[232:235], v[28:31], v[196:199]
    buffer_load_dwordx4 v240, s[16:19], s51 offen offset:1536 nt lds
    v_mfma_f32_16x16x32_bf16 v[196:199], a[228:231], v[16:19], v[196:199]
    ds_read_b128 a[208:211], v241 offset:8448
    v_mfma_f32_16x16x32_bf16 v[196:199], a[224:227], v[4:7], v[196:199]
    v_mfma_f32_16x16x32_bf16 v[200:203], a[224:227], v[8:11], v[224:227]
    v_mfma_f32_16x16x32_bf16 v[200:203], a[228:231], v[20:23], v[200:203]
    s_waitcnt lgkmcnt(4)
    ds_read_b128 a[212:215], v241 offset:8512
    v_mfma_f32_16x16x32_bf16 v[200:203], a[232:235], v[32:35], v[200:203]
    v_mfma_f32_16x16x32_bf16 v[200:203], a[236:239], v[44:47], v[200:203]
    v_mfma_f32_16x16x32_bf16 v[200:203], a[240:243], v[56:59], v[200:203]
    s_waitcnt lgkmcnt(2)
    ds_read_b128 a[216:219], v241 offset:8576
    v_mfma_f32_16x16x32_bf16 v[200:203], a[244:247], v[68:71], v[200:203]
    v_mfma_f32_16x16x32_bf16 v[200:203], a[248:251], v[80:83], v[200:203]
    v_mfma_f32_16x16x32_bf16 v[200:203], a[252:255], v[92:95], v[200:203]
    s_xor_b32 s51, s95, 18432
    ds_read_b128 a[220:223], v241 offset:8640
    s_add_u32 m0, s33, 135168
    v_mfma_f32_16x16x32_bf16 v[196:199], a[252:255], v[88:91], v[196:199]
    v_mfma_f32_16x16x32_bf16 v[196:199], a[248:251], v[76:79], v[196:199]
    v_mfma_f32_16x16x32_bf16 v[196:199], a[244:247], v[64:67], v[196:199]
    ds_read_b128 a[224:227], v241 offset:8704
    v_mfma_f32_16x16x32_bf16 v[196:199], a[240:243], v[52:55], v[196:199]
    v_mfma_f32_16x16x32_bf16 v[192:195], a[240:243], v[48:51], v[192:195]
    v_exp_f32 v120, v200
    v_mfma_f32_16x16x32_bf16 v[192:195], a[244:247], v[60:63], v[192:195]
    s_waitcnt lgkmcnt(4)
    ds_read_b128 a[228:231], v241 offset:8768
    buffer_load_dwordx4 v240, s[20:23], s51 offen nt lds
    v_mfma_f32_16x16x32_bf16 v[192:195], a[248:251], v[72:75], v[192:195]
    v_exp_f32 v121, v201
    v_mfma_f32_16x16x32_bf16 v[192:195], a[252:255], v[84:87], v[192:195]
    v_exp_f32 v122, v202
    v_mfma_f32_16x16x32_bf16 v[204:207], a[208:211], v[0:3], v[216:219]
    s_waitcnt lgkmcnt(2)
    ds_read_b128 a[232:235], v241 offset:8832
    v_cvt_pk_bf16_f32 v116, v120, v121
    v_mfma_f32_16x16x32_bf16 v[204:207], a[212:215], v[12:15], v[204:207]
    v_exp_f32 v123, v203
    v_mfma_f32_16x16x32_bf16 v[204:207], a[216:219], v[24:27], v[204:207]
    v_exp_f32 v124, v196
    v_mfma_f32_16x16x32_bf16 v[204:207], a[220:223], v[36:39], v[204:207]
    ds_read_b128 a[236:239], v241 offset:8896
    v_cvt_pk_bf16_f32 v117, v122, v123
    v_mfma_f32_16x16x32_bf16 v[208:211], a[220:223], v[40:43], v[220:223]
    v_exp_f32 v125, v197
    v_mfma_f32_16x16x32_bf16 v[208:211], a[216:219], v[28:31], v[208:211]
    s_add_u32 m0, s33, 135712
    v_exp_f32 v126, v198
    v_mfma_f32_16x16x32_bf16 v[208:211], a[212:215], v[16:19], v[208:211]
    ds_read_b64_tr_b16 a[240:241], v244 offset:16896
    v_cvt_pk_bf16_f32 v112, v124, v125
    v_mfma_f32_16x16x32_bf16 v[208:211], a[208:211], v[4:7], v[208:211]
    ds_read_b64_tr_b16 a[242:243], v244 offset:25344
    v_mfma_f32_16x16x32_bf16 v[212:215], a[208:211], v[8:11], v[224:227]
    v_exp_f32 v127, v199
    v_mfma_f32_16x16x32_bf16 v[212:215], a[212:215], v[20:23], v[212:215]
    ds_read_b64_tr_b16 a[244:245], v244 offset:16928
    v_mfma_f32_16x16x32_bf16 v[212:215], a[216:219], v[32:35], v[212:215]
    s_waitcnt lgkmcnt(6)
    ds_read_b64_tr_b16 a[246:247], v244 offset:25376
    v_mfma_f32_16x16x32_bf16 v[212:215], a[220:223], v[44:47], v[212:215]
    buffer_load_dwordx4 v240, s[20:23], s51 offen offset:512 nt lds
    v_exp_f32 v120, v192
    v_mfma_f32_16x16x32_bf16 v[212:215], a[224:227], v[56:59], v[212:215]
    s_waitcnt lgkmcnt(4)
    ds_read_b64_tr_b16 a[248:249], v244 offset:16960
    v_cvt_pk_bf16_f32 v113, v126, v127
    v_mfma_f32_16x16x32_bf16 v[212:215], a[228:231], v[68:71], v[212:215]
L_pad4:
    s_cbranch_execz L_pad8
    ds_read_b64_tr_b16 a[250:251], v244 offset:25408
    v_mfma_f32_16x16x32_bf16 v[212:215], a[232:235], v[80:83], v[212:215]
    v_exp_f32 v121, v193
    v_mfma_f32_16x16x32_bf16 v[212:215], a[236:239], v[92:95], v[212:215]
    ds_read_b64_tr_b16 a[252:253], v244 offset:16992
    v_mfma_f32_16x16x32_bf16 v[208:211], a[236:239], v[88:91], v[208:211]
    ds_read_b64_tr_b16 a[254:255], v244 offset:25440
    v_mfma_f32_16x16x32_bf16 v[208:211], a[232:235], v[76:79], v[208:211]
    v_exp_f32 v122, v194
    v_mfma_f32_16x16x32_bf16 v[208:211], a[228:231], v[64:67], v[208:211]
    ds_read_b64_tr_b16 a[208:209], v244 offset:17024
    v_cvt_pk_bf16_f32 v108, v120, v121
    v_mfma_f32_16x16x32_bf16 v[208:211], a[224:227], v[52:55], v[208:211]
    ds_read_b64_tr_b16 a[210:211], v244 offset:25472
    v_mfma_f32_16x16x32_bf16 v[204:207], a[224:227], v[48:51], v[204:207]
    v_exp_f32 v123, v195
    v_mfma_f32_16x16x32_bf16 v[204:207], a[228:231], v[60:63], v[204:207]
    ds_read_b64_tr_b16 a[212:213], v244 offset:17056
    v_mfma_f32_16x16x32_bf16 v[204:207], a[232:235], v[72:75], v[204:207]
    s_waitcnt lgkmcnt(9)
    ds_read_b64_tr_b16 a[214:215], v244 offset:25504
    v_mfma_f32_16x16x32_bf16 v[204:207], a[236:239], v[84:87], v[204:207]
    v_exp_f32 v124, v212
    v_mfma_f32_16x16x32_bf16 v[144:147], a[240:243], v[96:99], v[144:147]
    ds_read_b64_tr_b16 a[216:217], v244 offset:17088
    v_cvt_pk_bf16_f32 v109, v122, v123
    v_mfma_f32_16x16x32_bf16 v[148:151], a[240:243], v[100:103], v[148:151]
    s_waitcnt lgkmcnt(9)
    ds_read_b64_tr_b16 a[218:219], v244 offset:25536
    v_mfma_f32_16x16x32_bf16 v[152:155], a[240:243], v[104:107], v[152:155]
    v_exp_f32 v125, v213
    v_mfma_f32_16x16x32_bf16 v[164:167], a[244:247], v[104:107], v[164:167]
    ds_read_b64_tr_b16 a[220:221], v244 offset:17120
    v_mfma_f32_16x16x32_bf16 v[160:163], a[244:247], v[100:103], v[160:163]
    s_waitcnt lgkmcnt(9)
    ds_read_b64_tr_b16 a[222:223], v244 offset:25568
    v_mfma_f32_16x16x32_bf16 v[156:159], a[244:247], v[96:99], v[156:159]
    v_exp_f32 v126, v214
    v_mfma_f32_16x16x32_bf16 v[168:171], a[248:251], v[96:99], v[168:171]
    ds_read_b64_tr_b16 a[224:225], v244 offset:17152
    v_cvt_pk_bf16_f32 v118, v124, v125
    v_mfma_f32_16x16x32_bf16 v[172:175], a[248:251], v[100:103], v[172:175]
    s_waitcnt lgkmcnt(9)
    ds_read_b64_tr_b16 a[226:227], v244 offset:25600
    v_mfma_f32_16x16x32_bf16 v[176:179], a[248:251], v[104:107], v[176:179]
    v_exp_f32 v127, v215
    v_mfma_f32_16x16x32_bf16 v[188:191], a[252:255], v[104:107], v[188:191]
    ds_read_b64_tr_b16 a[228:229], v244 offset:17184
    v_mfma_f32_16x16x32_bf16 v[184:187], a[252:255], v[100:103], v[184:187]
    s_waitcnt lgkmcnt(9)
    ds_read_b64_tr_b16 a[230:231], v244 offset:25632
    v_mfma_f32_16x16x32_bf16 v[180:183], a[252:255], v[96:99], v[180:183]
    v_exp_f32 v120, v208
    v_mfma_f32_16x16x32_bf16 a[48:51], a[208:211], v[96:99], a[48:51]
    ds_read_b64_tr_b16 a[232:233], v244 offset:17216
    v_cvt_pk_bf16_f32 v119, v126, v127
    v_mfma_f32_16x16x32_bf16 a[52:55], a[208:211], v[100:103], a[52:55]
    s_waitcnt lgkmcnt(9)
    ds_read_b64_tr_b16 a[234:235], v244 offset:25664
    v_mfma_f32_16x16x32_bf16 a[56:59], a[208:211], v[104:107], a[56:59]
    v_exp_f32 v121, v209
    v_mfma_f32_16x16x32_bf16 a[68:71], a[212:215], v[104:107], a[68:71]
    ds_read_b64_tr_b16 a[236:237], v244 offset:17248
    v_mfma_f32_16x16x32_bf16 a[64:67], a[212:215], v[100:103], a[64:67]
    s_waitcnt lgkmcnt(9)
    ds_read_b64_tr_b16 a[238:239], v244 offset:25696
    v_mfma_f32_16x16x32_bf16 a[60:63], a[212:215], v[96:99], a[60:63]
    v_exp_f32 v122, v210
    v_mfma_f32_16x16x32_bf16 a[72:75], a[216:219], v[96:99], a[72:75]
    ds_read_b64_tr_b16 a[240:241], v244 offset:17280
    v_cvt_pk_bf16_f32 v114, v120, v121
    v_mfma_f32_16x16x32_bf16 a[76:79], a[216:219], v[100:103], a[76:79]
    s_waitcnt lgkmcnt(9)
    ds_read_b64_tr_b16 a[242:243], v244 offset:25728
    v_mfma_f32_16x16x32_bf16 a[80:83], a[216:219], v[104:107], a[80:83]
    v_exp_f32 v123, v211
    v_mfma_f32_16x16x32_bf16 a[92:95], a[220:223], v[104:107], a[92:95]
    ds_read_b64_tr_b16 a[244:245], v244 offset:17312
    v_mfma_f32_16x16x32_bf16 a[88:91], a[220:223], v[100:103], a[88:91]
    s_waitcnt lgkmcnt(9)
    ds_read_b64_tr_b16 a[246:247], v244 offset:25760
    v_mfma_f32_16x16x32_bf16 a[84:87], a[220:223], v[96:99], a[84:87]
    v_exp_f32 v124, v204
    v_mfma_f32_16x16x32_bf16 a[96:99], a[224:227], v[96:99], a[96:99]
    ds_read_b64_tr_b16 a[248:249], v244 offset:17344
    v_cvt_pk_bf16_f32 v115, v122, v123
    v_mfma_f32_16x16x32_bf16 a[100:103], a[224:227], v[100:103], a[100:103]
    s_waitcnt lgkmcnt(9)
    ds_read_b64_tr_b16 a[250:251], v244 offset:25792
    v_mfma_f32_16x16x32_bf16 a[104:107], a[224:227], v[104:107], a[104:107]
    v_exp_f32 v125, v205
    v_mfma_f32_16x16x32_bf16 a[116:119], a[228:231], v[104:107], a[116:119]
    s_waitcnt lgkmcnt(8)
    ds_read_b64_tr_b16 a[252:253], v244 offset:17376
    v_mfma_f32_16x16x32_bf16 a[112:115], a[228:231], v[100:103], a[112:115]
    s_waitcnt vmcnt(14)
    ds_read_b64_tr_b16 a[254:255], v244 offset:25824
    s_add_u32 m0, s33, 136256
    v_mfma_f32_16x16x32_bf16 a[108:111], a[228:231], v[96:99], a[108:111]
    v_exp_f32 v126, v206
    v_mfma_f32_16x16x32_bf16 a[120:123], a[232:235], v[96:99], a[120:123]
    s_barrier
    ds_read_b128 a[208:211], v241 offset:33792
    v_cvt_pk_bf16_f32 v110, v124, v125
    v_mfma_f32_16x16x32_bf16 a[124:127], a[232:235], v[100:103], a[124:127]
    v_exp_f32 v127, v207
    v_mfma_f32_16x16x32_bf16 a[128:131], a[232:235], v[104:107], a[128:131]
    s_waitcnt lgkmcnt(9)
    v_cvt_pk_bf16_f32 v111, v126, v127
    v_mfma_f32_16x16x32_bf16 a[140:143], a[236:239], v[104:107], a[140:143]
    s_waitcnt lgkmcnt(7)
    ds_read_b128 a[212:215], v241 offset:33856
    v_mfma_f32_16x16x32_bf16 a[136:139], a[236:239], v[100:103], a[136:139]
    buffer_load_dwordx4 v240, s[20:23], s51 offen offset:1024 nt lds
    v_mfma_f32_16x16x32_bf16 a[132:135], a[236:239], v[96:99], a[132:135]
    s_add_u32 m0, s33, 136800
    v_mfma_f32_16x16x32_bf16 a[144:147], a[240:243], v[96:99], a[144:147]
    ds_read_b128 a[216:219], v241 offset:33920
    v_mfma_f32_16x16x32_bf16 a[148:151], a[240:243], v[100:103], a[148:151]
    buffer_load_dwordx4 v240, s[20:23], s51 offen offset:1536 nt lds
    v_mfma_f32_16x16x32_bf16 a[152:155], a[240:243], v[104:107], a[152:155]
    s_xor_b32 s51, s95, 22528
    s_add_u32 m0, s33, 0
    v_mfma_f32_16x16x32_bf16 v[132:135], a[192:195], v[108:111], v[128:131]
    v_mfma_f32_16x16x32_bf16 v[132:135], a[196:199], v[112:115], v[132:135]
    buffer_load_dwordx4 v240, s[16:19], s51 offen nt lds
    v_mfma_f32_16x16x32_bf16 v[132:135], a[200:203], v[116:119], v[132:135]
    s_waitcnt lgkmcnt(7)
    s_add_u32 m0, s33, 544
    v_mfma_f32_16x16x32_bf16 a[164:167], a[244:247], v[104:107], a[164:167]
    s_waitcnt lgkmcnt(5)
    ds_read_b128 a[220:223], v241 offset:33984
    v_mfma_f32_16x16x32_bf16 a[160:163], a[244:247], v[100:103], a[160:163]
    v_mfma_f32_16x16x32_bf16 a[156:159], a[244:247], v[96:99], a[156:159]
    v_mfma_f32_16x16x32_bf16 a[168:171], a[248:251], v[96:99], a[168:171]
    s_waitcnt lgkmcnt(4)
    ds_read_b128 a[224:227], v241 offset:34048
    v_mfma_f32_16x16x32_bf16 a[172:175], a[248:251], v[100:103], a[172:175]
    v_max3_f32 v136, v132, v133, v134
    v_cmp_nge_f32 vcc, s53, v136
    v_mfma_f32_16x16x32_bf16 a[176:179], a[248:251], v[104:107], a[176:179]
    buffer_load_dwordx4 v240, s[16:19], s51 offen offset:512 nt lds
    v_mfma_f32_16x16x32_bf16 a[188:191], a[252:255], v[104:107], a[188:191]
    s_waitcnt lgkmcnt(4)
    ds_read_b128 a[228:231], v241 offset:34112
    v_mfma_f32_16x16x32_bf16 a[184:187], a[252:255], v[100:103], a[184:187]
    v_mfma_f32_16x16x32_bf16 a[180:183], a[252:255], v[96:99], a[180:183]
    s_cbranch_vccnz L_stub3
L_back3:
    v_mfma_f32_16x16x32_bf16 v[192:195], a[208:211], v[0:3], v[216:219]
    s_waitcnt lgkmcnt(2)
    ds_read_b128 a[232:235], v241 offset:34176
    v_mfma_f32_16x16x32_bf16 v[192:195], a[212:215], v[12:15], v[192:195]
    v_mfma_f32_16x16x32_bf16 v[192:195], a[216:219], v[24:27], v[192:195]
    v_mfma_f32_16x16x32_bf16 v[192:195], a[220:223], v[36:39], v[192:195]
    ds_read_b128 a[236:239], v241 offset:34240
    v_mfma_f32_16x16x32_bf16 v[196:199], a[220:223], v[40:43], v[220:223]
    s_add_u32 m0, s33, 1088
    v_mfma_f32_16x16x32_bf16 v[196:199], a[216:219], v[28:31], v[196:199]
    v_mfma_f32_16x16x32_bf16 v[196:199], a[212:215], v[16:19], v[196:199]
    ds_read_b128 a[240:243], v241 offset:42240
    v_mfma_f32_16x16x32_bf16 v[196:199], a[208:211], v[4:7], v[196:199]
    v_mfma_f32_16x16x32_bf16 v[200:203], a[208:211], v[8:11], v[224:227]
    v_mfma_f32_16x16x32_bf16 v[200:203], a[212:215], v[20:23], v[200:203]
    s_waitcnt lgkmcnt(4)
    ds_read_b128 a[244:247], v241 offset:42304
    v_mfma_f32_16x16x32_bf16 v[200:203], a[216:219], v[32:35], v[200:203]
    buffer_load_dwordx4 v240, s[16:19], s51 offen offset:1024 nt lds
    v_mfma_f32_16x16x32_bf16 v[200:203], a[220:223], v[44:47], v[200:203]
    v_mfma_f32_16x16x32_bf16 v[200:203], a[224:227], v[56:59], v[200:203]
    s_waitcnt lgkmcnt(2)
    ds_read_b128 a[248:251], v241 offset:42368
    v_mfma_f32_16x16x32_bf16 v[200:203], a[228:231], v[68:71], v[200:203]
    v_mfma_f32_16x16x32_bf16 v[200:203], a[232:235], v[80:83], v[200:203]
    v_mfma_f32_16x16x32_bf16 v[200:203], a[236:239], v[92:95], v[200:203]
    ds_read_b128 a[252:255], v241 offset:42432
    v_mfma_f32_16x16x32_bf16 v[196:199], a[236:239], v[88:91], v[196:199]
    v_mfma_f32_16x16x32_bf16 v[196:199], a[232:235], v[76:79], v[196:199]
    s_add_u32 m0, s33, 1632
    v_mfma_f32_16x16x32_bf16 v[196:199], a[228:231], v[64:67], v[196:199]
    ds_read_b128 a[208:211], v241 offset:42496
    v_mfma_f32_16x16x32_bf16 v[196:199], a[224:227], v[52:55], v[196:199]
    v_mfma_f32_16x16x32_bf16 v[192:195], a[224:227], v[48:51], v[192:195]
    v_exp_f32 v120, v200
    v_mfma_f32_16x16x32_bf16 v[192:195], a[228:231], v[60:63], v[192:195]
    s_waitcnt lgkmcnt(4)
    ds_read_b128 a[212:215], v241 offset:42560
    v_mfma_f32_16x16x32_bf16 v[192:195], a[232:235], v[72:75], v[192:195]
    v_exp_f32 v121, v201
    v_mfma_f32_16x16x32_bf16 v[192:195], a[236:239], v[84:87], v[192:195]
    buffer_load_dwordx4 v240, s[16:19], s51 offen offset:1536 nt lds
    v_exp_f32 v122, v202
    v_mfma_f32_16x16x32_bf16 v[204:207], a[240:243], v[0:3], v[216:219]
    s_waitcnt lgkmcnt(2)
    ds_read_b128 a[216:219], v241 offset:42624
    v_cvt_pk_bf16_f32 v104, v120, v121
    v_mfma_f32_16x16x32_bf16 v[204:207], a[244:247], v[12:15], v[204:207]
    v_exp_f32 v123, v203
    v_mfma_f32_16x16x32_bf16 v[204:207], a[248:251], v[24:27], v[204:207]
    v_exp_f32 v124, v196
    v_mfma_f32_16x16x32_bf16 v[204:207], a[252:255], v[36:39], v[204:207]
    ds_read_b128 a[220:223], v241 offset:42688
    v_cvt_pk_bf16_f32 v105, v122, v123
    v_mfma_f32_16x16x32_bf16 v[208:211], a[252:255], v[40:43], v[220:223]
    v_exp_f32 v125, v197
    v_mfma_f32_16x16x32_bf16 v[208:211], a[248:251], v[28:31], v[208:211]
    v_exp_f32 v126, v198
    v_mfma_f32_16x16x32_bf16 v[208:211], a[244:247], v[16:19], v[208:211]
    ds_read_b64_tr_b16 a[224:225], v245 offset:0
    v_cvt_pk_bf16_f32 v100, v124, v125
    v_mfma_f32_16x16x32_bf16 v[208:211], a[240:243], v[4:7], v[208:211]
    ds_read_b64_tr_b16 a[226:227], v245 offset:8448
    v_mfma_f32_16x16x32_bf16 v[212:215], a[240:243], v[8:11], v[224:227]
    s_xor_b32 s51, s95, 20480
    v_exp_f32 v127, v199
    v_mfma_f32_16x16x32_bf16 v[212:215], a[244:247], v[20:23], v[212:215]
    s_add_u32 m0, s33, 67584
    ds_read_b64_tr_b16 a[228:229], v245 offset:32
    v_mfma_f32_16x16x32_bf16 v[212:215], a[248:251], v[32:35], v[212:215]
    s_waitcnt lgkmcnt(6)
    ds_read_b64_tr_b16 a[230:231], v245 offset:8480
    v_mfma_f32_16x16x32_bf16 v[212:215], a[252:255], v[44:47], v[212:215]
    v_exp_f32 v120, v192
    v_mfma_f32_16x16x32_bf16 v[212:215], a[208:211], v[56:59], v[212:215]
    s_waitcnt lgkmcnt(4)
    ds_read_b64_tr_b16 a[232:233], v245 offset:64
    v_cvt_pk_bf16_f32 v101, v126, v127
    v_mfma_f32_16x16x32_bf16 v[212:215], a[212:215], v[68:71], v[212:215]
    ds_read_b64_tr_b16 a[234:235], v245 offset:8512
    v_mfma_f32_16x16x32_bf16 v[212:215], a[216:219], v[80:83], v[212:215]
    buffer_load_dwordx4 v240, s[20:23], s51 offen nt lds
    v_exp_f32 v121, v193
    v_mfma_f32_16x16x32_bf16 v[212:215], a[220:223], v[92:95], v[212:215]
    ds_read_b64_tr_b16 a[236:237], v245 offset:96
    v_mfma_f32_16x16x32_bf16 v[208:211], a[220:223], v[88:91], v[208:211]
    ds_read_b64_tr_b16 a[238:239], v245 offset:8544
    v_mfma_f32_16x16x32_bf16 v[208:211], a[216:219], v[76:79], v[208:211]
    v_exp_f32 v122, v194
    v_mfma_f32_16x16x32_bf16 v[208:211], a[212:215], v[64:67], v[208:211]
    ds_read_b64_tr_b16 a[240:241], v245 offset:128
    v_cvt_pk_bf16_f32 v96, v120, v121
    v_mfma_f32_16x16x32_bf16 v[208:211], a[208:211], v[52:55], v[208:211]
    ds_read_b64_tr_b16 a[242:243], v245 offset:8576
    v_mfma_f32_16x16x32_bf16 v[204:207], a[208:211], v[48:51], v[204:207]
    v_exp_f32 v123, v195
    v_mfma_f32_16x16x32_bf16 v[204:207], a[212:215], v[60:63], v[204:207]
    ds_read_b64_tr_b16 a[244:245], v245 offset:160
    v_mfma_f32_16x16x32_bf16 v[204:207], a[216:219], v[72:75], v[204:207]
    s_waitcnt lgkmcnt(9)
    ds_read_b64_tr_b16 a[246:247], v245 offset:8608
    v_mfma_f32_16x16x32_bf16 v[204:207], a[220:223], v[84:87], v[204:207]
    v_exp_f32 v124, v212
    v_mfma_f32_16x16x32_bf16 v[144:147], a[224:227], v[108:111], v[144:147]
    ds_read_b64_tr_b16 a[248:249], v245 offset:192
    v_cvt_pk_bf16_f32 v97, v122, v123
    v_mfma_f32_16x16x32_bf16 v[148:151], a[224:227], v[112:115], v[148:151]
    s_waitcnt lgkmcnt(9)
    ds_read_b64_tr_b16 a[250:251], v245 offset:8640
    v_mfma_f32_16x16x32_bf16 v[152:155], a[224:227], v[116:119], v[152:155]
    v_exp_f32 v125, v213
    v_mfma_f32_16x16x32_bf16 v[164:167], a[228:231], v[116:119], v[164:167]
    ds_read_b64_tr_b16 a[252:253], v245 offset:224
    v_mfma_f32_16x16x32_bf16 v[160:163], a[228:231], v[112:115], v[160:163]
    s_waitcnt lgkmcnt(9)
    ds_read_b64_tr_b16 a[254:255], v245 offset:8672
    v_mfma_f32_16x16x32_bf16 v[156:159], a[228:231], v[108:111], v[156:159]
    v_exp_f32 v126, v214
    v_mfma_f32_16x16x32_bf16 v[168:171], a[232:235], v[108:111], v[168:171]
    ds_read_b64_tr_b16 a[208:209], v245 offset:256
    v_cvt_pk_bf16_f32 v106, v124, v125
    v_mfma_f32_16x16x32_bf16 v[172:175], a[232:235], v[112:115], v[172:175]
    s_waitcnt lgkmcnt(9)
    ds_read_b64_tr_b16 a[210:211], v245 offset:8704
    v_mfma_f32_16x16x32_bf16 v[176:179], a[232:235], v[116:119], v[176:179]
    v_exp_f32 v127, v215
    v_mfma_f32_16x16x32_bf16 v[188:191], a[236:239], v[116:119], v[188:191]
    ds_read_b64_tr_b16 a[212:213], v245 offset:288
    v_mfma_f32_16x16x32_bf16 v[184:187], a[236:239], v[112:115], v[184:187]
    s_waitcnt lgkmcnt(9)
    ds_read_b64_tr_b16 a[214:215], v245 offset:8736
    v_mfma_f32_16x16x32_bf16 v[180:183], a[236:239], v[108:111], v[180:183]
    v_exp_f32 v120, v208
    v_mfma_f32_16x16x32_bf16 a[48:51], a[240:243], v[108:111], a[48:51]
    ds_read_b64_tr_b16 a[216:217], v245 offset:320
    v_cvt_pk_bf16_f32 v107, v126, v127
    v_mfma_f32_16x16x32_bf16 a[52:55], a[240:243], v[112:115], a[52:55]
    s_waitcnt lgkmcnt(9)
    ds_read_b64_tr_b16 a[218:219], v245 offset:8768
    v_mfma_f32_16x16x32_bf16 a[56:59], a[240:243], v[116:119], a[56:59]
    v_exp_f32 v121, v209
    v_mfma_f32_16x16x32_bf16 a[68:71], a[244:247], v[116:119], a[68:71]
    ds_read_b64_tr_b16 a[220:221], v245 offset:352
    v_mfma_f32_16x16x32_bf16 a[64:67], a[244:247], v[112:115], a[64:67]
    s_waitcnt lgkmcnt(9)
    ds_read_b64_tr_b16 a[222:223], v245 offset:8800
    v_mfma_f32_16x16x32_bf16 a[60:63], a[244:247], v[108:111], a[60:63]
    v_exp_f32 v122, v210
    v_mfma_f32_16x16x32_bf16 a[72:75], a[248:251], v[108:111], a[72:75]
    ds_read_b64_tr_b16 a[224:225], v245 offset:384
    v_cvt_pk_bf16_f32 v102, v120, v121
    v_mfma_f32_16x16x32_bf16 a[76:79], a[248:251], v[112:115], a[76:79]
    s_waitcnt lgkmcnt(9)
    ds_read_b64_tr_b16 a[226:227], v245 offset:8832
    v_mfma_f32_16x16x32_bf16 a[80:83], a[248:251], v[116:119], a[80:83]
    v_exp_f32 v123, v211
    v_mfma_f32_16x16x32_bf16 a[92:95], a[252:255], v[116:119], a[92:95]
    ds_read_b64_tr_b16 a[228:229], v245 offset:416
    v_mfma_f32_16x16x32_bf16 a[88:91], a[252:255], v[112:115], a[88:91]
    s_waitcnt lgkmcnt(9)
    ds_read_b64_tr_b16 a[230:231], v245 offset:8864
    v_mfma_f32_16x16x32_bf16 a[84:87], a[252:255], v[108:111], a[84:87]
    v_exp_f32 v124, v204
    v_mfma_f32_16x16x32_bf16 a[96:99], a[208:211], v[108:111], a[96:99]
    ds_read_b64_tr_b16 a[232:233], v245 offset:448
    v_cvt_pk_bf16_f32 v103, v122, v123
    v_mfma_f32_16x16x32_bf16 a[100:103], a[208:211], v[112:115], a[100:103]
    s_waitcnt lgkmcnt(9)
    ds_read_b64_tr_b16 a[234:235], v245 offset:8896
    v_mfma_f32_16x16x32_bf16 a[104:107], a[208:211], v[116:119], a[104:107]
    v_exp_f32 v125, v205
    v_mfma_f32_16x16x32_bf16 a[116:119], a[212:215], v[116:119], a[116:119]
    s_waitcnt lgkmcnt(8)
    ds_read_b64_tr_b16 a[236:237], v245 offset:480
    v_mfma_f32_16x16x32_bf16 a[112:115], a[212:215], v[112:115], a[112:115]
    s_waitcnt vmcnt(13)
    ds_read_b64_tr_b16 a[238:239], v245 offset:8928
    s_add_u32 m0, s33, 68128
    v_mfma_f32_16x16x32_bf16 a[108:111], a[212:215], v[108:111], a[108:111]
    v_exp_f32 v126, v206
    v_mfma_f32_16x16x32_bf16 a[120:123], a[216:219], v[108:111], a[120:123]
    s_barrier
    ds_read_b128 a[240:243], v242 offset:33792
    v_cvt_pk_bf16_f32 v98, v124, v125
    v_mfma_f32_16x16x32_bf16 a[124:127], a[216:219], v[112:115], a[124:127]
    v_exp_f32 v127, v207
    v_mfma_f32_16x16x32_bf16 a[128:131], a[216:219], v[116:119], a[128:131]
    s_waitcnt lgkmcnt(9)
    v_cvt_pk_bf16_f32 v99, v126, v127
    v_mfma_f32_16x16x32_bf16 a[140:143], a[220:223], v[116:119], a[140:143]
    s_waitcnt lgkmcnt(7)
    ds_read_b128 a[244:247], v242 offset:33856
    v_mfma_f32_16x16x32_bf16 a[136:139], a[220:223], v[112:115], a[136:139]
    buffer_load_dwordx4 v240, s[20:23], s51 offen offset:512 nt lds
    v_mfma_f32_16x16x32_bf16 a[132:135], a[220:223], v[108:111], a[132:135]
    s_add_u32 m0, s33, 68672
    v_mfma_f32_16x16x32_bf16 a[144:147], a[224:227], v[108:111], a[144:147]
    ds_read_b128 a[248:251], v242 offset:33920
    v_mfma_f32_16x16x32_bf16 a[148:151], a[224:227], v[112:115], a[148:151]
    buffer_load_dwordx4 v240, s[20:23], s51 offen offset:1024 nt lds
    v_mfma_f32_16x16x32_bf16 a[152:155], a[224:227], v[116:119], a[152:155]
    s_add_u32 m0, s33, 69216
    v_mfma_f32_16x16x32_bf16 v[128:131], a[192:195], v[96:99], v[132:135]
    v_mfma_f32_16x16x32_bf16 v[128:131], a[196:199], v[100:103], v[128:131]
    buffer_load_dwordx4 v240, s[20:23], s51 offen offset:1536 nt lds
    v_mfma_f32_16x16x32_bf16 v[128:131], a[200:203], v[104:107], v[128:131]
    s_waitcnt lgkmcnt(7)
    v_mfma_f32_16x16x32_bf16 a[164:167], a[228:231], v[116:119], a[164:167]
    s_waitcnt lgkmcnt(5)
    ds_read_b128 a[252:255], v242 offset:33984
    v_mfma_f32_16x16x32_bf16 a[160:163], a[228:231], v[112:115], a[160:163]
    s_xor_b32 s51, s95, 131072
    s_add_u32 m0, s33, 16896
    v_mfma_f32_16x16x32_bf16 a[156:159], a[228:231], v[108:111], a[156:159]
    v_mfma_f32_16x16x32_bf16 a[168:171], a[232:235], v[108:111], a[168:171]
    s_waitcnt lgkmcnt(4)
    ds_read_b128 a[208:211], v242 offset:34048
    v_mfma_f32_16x16x32_bf16 a[172:175], a[232:235], v[112:115], a[172:175]
    v_max3_f32 v136, v128, v129, v130
    v_cmp_nge_f32 vcc, s53, v136
    v_mfma_f32_16x16x32_bf16 a[176:179], a[232:235], v[116:119], a[176:179]
    v_mfma_f32_16x16x32_bf16 a[188:191], a[236:239], v[116:119], a[188:191]
    s_waitcnt lgkmcnt(4)
    ds_read_b128 a[212:215], v242 offset:34112
    v_mfma_f32_16x16x32_bf16 a[184:187], a[236:239], v[112:115], a[184:187]
    buffer_load_dwordx4 v240, s[16:19], s51 offen nt lds
    v_mfma_f32_16x16x32_bf16 a[180:183], a[236:239], v[108:111], a[180:183]
    s_cbranch_vccnz L_stub4
L_back4:
    v_mfma_f32_16x16x32_bf16 v[192:195], a[240:243], v[0:3], v[216:219]
    s_waitcnt lgkmcnt(2)
    ds_read_b128 a[216:219], v242 offset:34176
    v_mfma_f32_16x16x32_bf16 v[192:195], a[244:247], v[12:15], v[192:195]
    v_mfma_f32_16x16x32_bf16 v[192:195], a[248:251], v[24:27], v[192:195]
    v_mfma_f32_16x16x32_bf16 v[192:195], a[252:255], v[36:39], v[192:195]
    ds_read_b128 a[220:223], v242 offset:34240
    v_mfma_f32_16x16x32_bf16 v[196:199], a[252:255], v[40:43], v[220:223]
    v_mfma_f32_16x16x32_bf16 v[196:199], a[248:251], v[28:31], v[196:199]
    s_add_u32 m0, s33, 17440
    v_mfma_f32_16x16x32_bf16 v[196:199], a[244:247], v[16:19], v[196:199]
    ds_read_b128 a[224:227], v242 offset:42240
    v_mfma_f32_16x16x32_bf16 v[196:199], a[240:243], v[4:7], v[196:199]
    v_mfma_f32_16x16x32_bf16 v[200:203], a[240:243], v[8:11], v[224:227]
    v_mfma_f32_16x16x32_bf16 v[200:203], a[244:247], v[20:23], v[200:203]
    s_waitcnt lgkmcnt(4)
    ds_read_b128 a[228:231], v242 offset:42304
    v_mfma_f32_16x16x32_bf16 v[200:203], a[248:251], v[32:35], v[200:203]
    v_mfma_f32_16x16x32_bf16 v[200:203], a[252:255], v[44:47], v[200:203]
    buffer_load_dwordx4 v240, s[16:19], s51 offen offset:512 nt lds
    v_mfma_f32_16x16x32_bf16 v[200:203], a[208:211], v[56:59], v[200:203]
    s_waitcnt lgkmcnt(2)
    ds_read_b128 a[232:235], v242 offset:42368
    v_mfma_f32_16x16x32_bf16 v[200:203], a[212:215], v[68:71], v[200:203]
    v_mfma_f32_16x16x32_bf16 v[200:203], a[216:219], v[80:83], v[200:203]
    v_mfma_f32_16x16x32_bf16 v[200:203], a[220:223], v[92:95], v[200:203]
    ds_read_b128 a[236:239], v242 offset:42432
    v_mfma_f32_16x16x32_bf16 v[196:199], a[220:223], v[88:91], v[196:199]
    v_mfma_f32_16x16x32_bf16 v[196:199], a[216:219], v[76:79], v[196:199]
    v_mfma_f32_16x16x32_bf16 v[196:199], a[212:215], v[64:67], v[196:199]
    ds_read_b128 a[240:243], v242 offset:42496
    v_mfma_f32_16x16x32_bf16 v[196:199], a[208:211], v[52:55], v[196:199]
    s_add_u32 m0, s33, 17984
    v_mfma_f32_16x16x32_bf16 v[192:195], a[208:211], v[48:51], v[192:195]
    v_exp_f32 v120, v200
    v_mfma_f32_16x16x32_bf16 v[192:195], a[212:215], v[60:63], v[192:195]
    s_waitcnt lgkmcnt(4)
    ds_read_b128 a[244:247], v242 offset:42560
    v_mfma_f32_16x16x32_bf16 v[192:195], a[216:219], v[72:75], v[192:195]
    v_exp_f32 v121, v201
    v_mfma_f32_16x16x32_bf16 v[192:195], a[220:223], v[84:87], v[192:195]
    v_exp_f32 v122, v202
    v_mfma_f32_16x16x32_bf16 v[204:207], a[224:227], v[0:3], v[216:219]
    s_waitcnt lgkmcnt(2)
    ds_read_b128 a[248:251], v242 offset:42624
    v_cvt_pk_bf16_f32 v116, v120, v121
    v_mfma_f32_16x16x32_bf16 v[204:207], a[228:231], v[12:15], v[204:207]
    buffer_load_dwordx4 v240, s[16:19], s51 offen offset:1024 nt lds
    v_exp_f32 v123, v203
    v_mfma_f32_16x16x32_bf16 v[204:207], a[232:235], v[24:27], v[204:207]
    v_exp_f32 v124, v196
    v_mfma_f32_16x16x32_bf16 v[204:207], a[236:239], v[36:39], v[204:207]
    ds_read_b128 a[252:255], v242 offset:42688
    v_cvt_pk_bf16_f32 v117, v122, v123
    v_mfma_f32_16x16x32_bf16 v[208:211], a[236:239], v[40:43], v[220:223]
    v_exp_f32 v125, v197
    v_mfma_f32_16x16x32_bf16 v[208:211], a[232:235], v[28:31], v[208:211]
    v_exp_f32 v126, v198
    v_mfma_f32_16x16x32_bf16 v[208:211], a[228:231], v[16:19], v[208:211]
    ds_read_b64_tr_b16 a[208:209], v246 offset:16896
    v_cvt_pk_bf16_f32 v112, v124, v125
    v_mfma_f32_16x16x32_bf16 v[208:211], a[224:227], v[4:7], v[208:211]
    ds_read_b64_tr_b16 a[210:211], v246 offset:25344
    v_mfma_f32_16x16x32_bf16 v[212:215], a[224:227], v[8:11], v[224:227]
    v_exp_f32 v127, v199
    v_mfma_f32_16x16x32_bf16 v[212:215], a[228:231], v[20:23], v[212:215]
    s_add_u32 m0, s33, 18528
    ds_read_b64_tr_b16 a[212:213], v246 offset:16928
    v_mfma_f32_16x16x32_bf16 v[212:215], a[232:235], v[32:35], v[212:215]
    s_waitcnt lgkmcnt(6)
    ds_read_b64_tr_b16 a[214:215], v246 offset:25376
    v_mfma_f32_16x16x32_bf16 v[212:215], a[236:239], v[44:47], v[212:215]
    v_exp_f32 v120, v192
    v_mfma_f32_16x16x32_bf16 v[212:215], a[240:243], v[56:59], v[212:215]
    s_waitcnt lgkmcnt(4)
    ds_read_b64_tr_b16 a[216:217], v246 offset:16960
    v_cvt_pk_bf16_f32 v113, v126, v127
    v_mfma_f32_16x16x32_bf16 v[212:215], a[244:247], v[68:71], v[212:215]
    ds_read_b64_tr_b16 a[218:219], v246 offset:25408
    v_mfma_f32_16x16x32_bf16 v[212:215], a[248:251], v[80:83], v[212:215]
    v_exp_f32 v121, v193
    v_mfma_f32_16x16x32_bf16 v[212:215], a[252:255], v[92:95], v[212:215]
    ds_read_b64_tr_b16 a[220:221], v246 offset:16992
    buffer_load_dwordx4 v240, s[16:19], s51 offen offset:1536 nt lds
    v_mfma_f32_16x16x32_bf16 v[208:211], a[252:255], v[88:91], v[208:211]
    ds_read_b64_tr_b16 a[222:223], v246 offset:25440
    v_mfma_f32_16x16x32_bf16 v[208:211], a[248:251], v[76:79], v[208:211]
    v_exp_f32 v122, v194
    v_mfma_f32_16x16x32_bf16 v[208:211], a[244:247], v[64:67], v[208:211]
    ds_read_b64_tr_b16 a[224:225], v246 offset:17024
    v_cvt_pk_bf16_f32 v108, v120, v121
    v_mfma_f32_16x16x32_bf16 v[208:211], a[240:243], v[52:55], v[208:211]
    ds_read_b64_tr_b16 a[226:227], v246 offset:25472
    v_mfma_f32_16x16x32_bf16 v[204:207], a[240:243], v[48:51], v[204:207]
    v_exp_f32 v123, v195
    v_mfma_f32_16x16x32_bf16 v[204:207], a[244:247], v[60:63], v[204:207]
    ds_read_b64_tr_b16 a[228:229], v246 offset:17056
    v_mfma_f32_16x16x32_bf16 v[204:207], a[248:251], v[72:75], v[204:207]
    s_waitcnt lgkmcnt(9)
    ds_read_b64_tr_b16 a[230:231], v246 offset:25504
    v_mfma_f32_16x16x32_bf16 v[204:207], a[252:255], v[84:87], v[204:207]
    v_exp_f32 v124, v212
    v_mfma_f32_16x16x32_bf16 v[144:147], a[208:211], v[96:99], v[144:147]
    ds_read_b64_tr_b16 a[232:233], v246 offset:17088
    v_cvt_pk_bf16_f32 v109, v122, v123
    v_mfma_f32_16x16x32_bf16 v[148:151], a[208:211], v[100:103], v[148:151]
    s_waitcnt lgkmcnt(9)
    ds_read_b64_tr_b16 a[234:235], v246 offset:25536
    v_mfma_f32_16x16x32_bf16 v[152:155], a[208:211], v[104:107], v[152:155]
    v_exp_f32 v125, v213
    v_mfma_f32_16x16x32_bf16 v[164:167], a[212:215], v[104:107], v[164:167]
    ds_read_b64_tr_b16 a[236:237], v246 offset:17120
    v_mfma_f32_16x16x32_bf16 v[160:163], a[212:215], v[100:103], v[160:163]
    s_waitcnt lgkmcnt(9)
    ds_read_b64_tr_b16 a[238:239], v246 offset:25568
    v_mfma_f32_16x16x32_bf16 v[156:159], a[212:215], v[96:99], v[156:159]
    v_exp_f32 v126, v214
    v_mfma_f32_16x16x32_bf16 v[168:171], a[216:219], v[96:99], v[168:171]
    ds_read_b64_tr_b16 a[240:241], v246 offset:17152
    v_cvt_pk_bf16_f32 v118, v124, v125
    v_mfma_f32_16x16x32_bf16 v[172:175], a[216:219], v[100:103], v[172:175]
    s_waitcnt lgkmcnt(9)
    ds_read_b64_tr_b16 a[242:243], v246 offset:25600
    v_mfma_f32_16x16x32_bf16 v[176:179], a[216:219], v[104:107], v[176:179]
    v_exp_f32 v127, v215
    v_mfma_f32_16x16x32_bf16 v[188:191], a[220:223], v[104:107], v[188:191]
    ds_read_b64_tr_b16 a[244:245], v246 offset:17184
    v_mfma_f32_16x16x32_bf16 v[184:187], a[220:223], v[100:103], v[184:187]
    s_waitcnt lgkmcnt(9)
    ds_read_b64_tr_b16 a[246:247], v246 offset:25632
    v_mfma_f32_16x16x32_bf16 v[180:183], a[220:223], v[96:99], v[180:183]
    v_exp_f32 v120, v208
    v_mfma_f32_16x16x32_bf16 a[48:51], a[224:227], v[96:99], a[48:51]
    ds_read_b64_tr_b16 a[248:249], v246 offset:17216
    v_cvt_pk_bf16_f32 v119, v126, v127
    v_mfma_f32_16x16x32_bf16 a[52:55], a[224:227], v[100:103], a[52:55]
    s_waitcnt lgkmcnt(9)
    ds_read_b64_tr_b16 a[250:251], v246 offset:25664
    v_mfma_f32_16x16x32_bf16 a[56:59], a[224:227], v[104:107], a[56:59]
    v_exp_f32 v121, v209
    v_mfma_f32_16x16x32_bf16 a[68:71], a[228:231], v[104:107], a[68:71]
    ds_read_b64_tr_b16 a[252:253], v246 offset:17248
    v_mfma_f32_16x16x32_bf16 a[64:67], a[228:231], v[100:103], a[64:67]
    s_waitcnt lgkmcnt(9)
    ds_read_b64_tr_b16 a[254:255], v246 offset:25696
    v_mfma_f32_16x16x32_bf16 a[60:63], a[228:231], v[96:99], a[60:63]
    v_exp_f32 v122, v210
    v_mfma_f32_16x16x32_bf16 a[72:75], a[232:235], v[96:99], a[72:75]
    ds_read_b64_tr_b16 a[208:209], v246 offset:17280
    v_cvt_pk_bf16_f32 v114, v120, v121
    v_mfma_f32_16x16x32_bf16 a[76:79], a[232:235], v[100:103], a[76:79]
    s_waitcnt lgkmcnt(9)
    ds_read_b64_tr_b16 a[210:211], v246 offset:25728
    v_mfma_f32_16x16x32_bf16 a[80:83], a[232:235], v[104:107], a[80:83]
    v_exp_f32 v123, v211
    v_mfma_f32_16x16x32_bf16 a[92:95], a[236:239], v[104:107], a[92:95]
    ds_read_b64_tr_b16 a[212:213], v246 offset:17312
    v_mfma_f32_16x16x32_bf16 a[88:91], a[236:239], v[100:103], a[88:91]
    s_waitcnt lgkmcnt(9)
    ds_read_b64_tr_b16 a[214:215], v246 offset:25760
    v_mfma_f32_16x16x32_bf16 a[84:87], a[236:239], v[96:99], a[84:87]
    v_exp_f32 v124, v204
    v_mfma_f32_16x16x32_bf16 a[96:99], a[240:243], v[96:99], a[96:99]
    ds_read_b64_tr_b16 a[216:217], v246 offset:17344
    v_cvt_pk_bf16_f32 v115, v122, v123
    v_mfma_f32_16x16x32_bf16 a[100:103], a[240:243], v[100:103], a[100:103]
    s_waitcnt lgkmcnt(9)
    ds_read_b64_tr_b16 a[218:219], v246 offset:25792
    v_mfma_f32_16x16x32_bf16 a[104:107], a[240:243], v[104:107], a[104:107]
    v_exp_f32 v125, v205
    v_mfma_f32_16x16x32_bf16 a[116:119], a[244:247], v[104:107], a[116:119]
    s_waitcnt lgkmcnt(8)
    ds_read_b64_tr_b16 a[220:221], v246 offset:17376
    v_mfma_f32_16x16x32_bf16 a[112:115], a[244:247], v[100:103], a[112:115]
    s_waitcnt vmcnt(12)
    ds_read_b64_tr_b16 a[222:223], v246 offset:25824
    s_xor_b32 s51, s95, 22528
    v_mfma_f32_16x16x32_bf16 a[108:111], a[244:247], v[96:99], a[108:111]
    s_add_u32 m0, s33, 33792
    v_exp_f32 v126, v206
    v_mfma_f32_16x16x32_bf16 a[120:123], a[248:251], v[96:99], a[120:123]
    s_barrier
    ds_read_b128 a[224:227], v243 offset:0
    v_cvt_pk_bf16_f32 v110, v124, v125
    v_mfma_f32_16x16x32_bf16 a[124:127], a[248:251], v[100:103], a[124:127]
    v_exp_f32 v127, v207
    v_mfma_f32_16x16x32_bf16 a[128:131], a[248:251], v[104:107], a[128:131]
    s_waitcnt lgkmcnt(9)
    v_cvt_pk_bf16_f32 v111, v126, v127
    v_mfma_f32_16x16x32_bf16 a[140:143], a[252:255], v[104:107], a[140:143]
    s_waitcnt lgkmcnt(7)
    ds_read_b128 a[228:231], v243 offset:64
    v_mfma_f32_16x16x32_bf16 a[136:139], a[252:255], v[100:103], a[136:139]
    buffer_load_dwordx4 v240, s[20:23], s51 offen nt lds
    v_mfma_f32_16x16x32_bf16 a[132:135], a[252:255], v[96:99], a[132:135]
    s_add_u32 m0, s33, 34336
    v_mfma_f32_16x16x32_bf16 a[144:147], a[208:211], v[96:99], a[144:147]
L_pad5:
    s_cbranch_execz L_pad9
    ds_read_b128 a[232:235], v243 offset:128
    v_mfma_f32_16x16x32_bf16 a[148:151], a[208:211], v[100:103], a[148:151]
    buffer_load_dwordx4 v240, s[20:23], s51 offen offset:512 nt lds
    v_mfma_f32_16x16x32_bf16 a[152:155], a[208:211], v[104:107], a[152:155]
    s_add_u32 m0, s33, 34880
    v_mfma_f32_16x16x32_bf16 v[132:135], a[192:195], v[108:111], v[128:131]
    v_mfma_f32_16x16x32_bf16 v[132:135], a[196:199], v[112:115], v[132:135]
    buffer_load_dwordx4 v240, s[20:23], s51 offen offset:1024 nt lds
    v_mfma_f32_16x16x32_bf16 v[132:135], a[200:203], v[116:119], v[132:135]
    s_waitcnt lgkmcnt(7)
    v_mfma_f32_16x16x32_bf16 a[164:167], a[212:215], v[104:107], a[164:167]
    s_waitcnt lgkmcnt(5)
    ds_read_b128 a[236:239], v243 offset:192
    v_mfma_f32_16x16x32_bf16 a[160:163], a[212:215], v[100:103], a[160:163]
    s_add_u32 m0, s33, 35424
    v_mfma_f32_16x16x32_bf16 a[156:159], a[212:215], v[96:99], a[156:159]
    v_mfma_f32_16x16x32_bf16 a[168:171], a[216:219], v[96:99], a[168:171]
    s_waitcnt lgkmcnt(4)
    ds_read_b128 a[240:243], v243 offset:256
    v_mfma_f32_16x16x32_bf16 a[172:175], a[216:219], v[100:103], a[172:175]
    v_max3_f32 v136, v132, v133, v134
    v_cmp_nge_f32 vcc, s53, v136
    v_mfma_f32_16x16x32_bf16 a[176:179], a[216:219], v[104:107], a[176:179]
    v_mfma_f32_16x16x32_bf16 a[188:191], a[220:223], v[104:107], a[188:191]
    s_waitcnt lgkmcnt(4)
    ds_read_b128 a[244:247], v243 offset:320
    v_mfma_f32_16x16x32_bf16 a[184:187], a[220:223], v[100:103], a[184:187]
    buffer_load_dwordx4 v240, s[20:23], s51 offen offset:1536 nt lds
    v_mfma_f32_16x16x32_bf16 a[180:183], a[220:223], v[96:99], a[180:183]
    s_cbranch_vccnz L_stub5
L_back5:
    v_mfma_f32_16x16x32_bf16 v[192:195], a[224:227], v[0:3], v[216:219]
    s_waitcnt lgkmcnt(2)
    ds_read_b128 a[248:251], v243 offset:384
    v_mfma_f32_16x16x32_bf16 v[192:195], a[228:231], v[12:15], v[192:195]
    v_mfma_f32_16x16x32_bf16 v[192:195], a[232:235], v[24:27], v[192:195]
    v_mfma_f32_16x16x32_bf16 v[192:195], a[236:239], v[36:39], v[192:195]
    ds_read_b128 a[252:255], v243 offset:448
    v_mfma_f32_16x16x32_bf16 v[196:199], a[236:239], v[40:43], v[220:223]
    v_mfma_f32_16x16x32_bf16 v[196:199], a[232:235], v[28:31], v[196:199]
    v_mfma_f32_16x16x32_bf16 v[196:199], a[228:231], v[16:19], v[196:199]
    ds_read_b128 a[208:211], v243 offset:8448
    v_mfma_f32_16x16x32_bf16 v[196:199], a[224:227], v[4:7], v[196:199]
    v_mfma_f32_16x16x32_bf16 v[200:203], a[224:227], v[8:11], v[224:227]
    s_xor_b32 s51, s95, 133120
    s_add_u32 m0, s33, 50688
    v_mfma_f32_16x16x32_bf16 v[200:203], a[228:231], v[20:23], v[200:203]
    s_waitcnt lgkmcnt(4)
    ds_read_b128 a[212:215], v243 offset:8512
    v_mfma_f32_16x16x32_bf16 v[200:203], a[232:235], v[32:35], v[200:203]
    v_mfma_f32_16x16x32_bf16 v[200:203], a[236:239], v[44:47], v[200:203]
    v_mfma_f32_16x16x32_bf16 v[200:203], a[240:243], v[56:59], v[200:203]
    s_waitcnt lgkmcnt(2)
    ds_read_b128 a[216:219], v243 offset:8576
    v_mfma_f32_16x16x32_bf16 v[200:203], a[244:247], v[68:71], v[200:203]
    v_mfma_f32_16x16x32_bf16 v[200:203], a[248:251], v[80:83], v[200:203]
    buffer_load_dwordx4 v240, s[16:19], s51 offen nt lds
    v_mfma_f32_16x16x32_bf16 v[200:203], a[252:255], v[92:95], v[200:203]
    ds_read_b128 a[220:223], v243 offset:8640
    v_mfma_f32_16x16x32_bf16 v[196:199], a[252:255], v[88:91], v[196:199]
    v_mfma_f32_16x16x32_bf16 v[196:199], a[248:251], v[76:79], v[196:199]
    v_mfma_f32_16x16x32_bf16 v[196:199], a[244:247], v[64:67], v[196:199]
    ds_read_b128 a[224:227], v243 offset:8704
    v_mfma_f32_16x16x32_bf16 v[196:199], a[240:243], v[52:55], v[196:199]
    v_mfma_f32_16x16x32_bf16 v[192:195], a[240:243], v[48:51], v[192:195]
    s_nop 0
    v_exp_f32 v120, v200
    v_mfma_f32_16x16x32_bf16 v[192:195], a[244:247], v[60:63], v[192:195]
    s_waitcnt lgkmcnt(4)
    ds_read_b128 a[228:231], v243 offset:8768
    v_mfma_f32_16x16x32_bf16 v[192:195], a[248:251], v[72:75], v[192:195]
    s_add_u32 m0, s33, 51232
    v_exp_f32 v121, v201
    v_mfma_f32_16x16x32_bf16 v[192:195], a[252:255], v[84:87], v[192:195]
    v_exp_f32 v122, v202
    v_mfma_f32_16x16x32_bf16 v[204:207], a[208:211], v[0:3], v[216:219]
    s_waitcnt lgkmcnt(2)
    ds_read_b128 a[232:235], v243 offset:8832
    v_cvt_pk_bf16_f32 v104, v120, v121
    v_mfma_f32_16x16x32_bf16 v[204:207], a[212:215], v[12:15], v[204:207]
    v_exp_f32 v123, v203
    v_mfma_f32_16x16x32_bf16 v[204:207], a[216:219], v[24:27], v[204:207]
    v_exp_f32 v124, v196
    v_mfma_f32_16x16x32_bf16 v[204:207], a[220:223], v[36:39], v[204:207]
    ds_read_b128 a[236:239], v243 offset:8896
    v_cvt_pk_bf16_f32 v105, v122, v123
    v_mfma_f32_16x16x32_bf16 v[208:211], a[220:223], v[40:43], v[220:223]
    buffer_load_dwordx4 v240, s[16:19], s51 offen offset:512 nt lds
    v_exp_f32 v125, v197
    v_mfma_f32_16x16x32_bf16 v[208:211], a[216:219], v[28:31], v[208:211]
    v_exp_f32 v126, v198
    v_mfma_f32_16x16x32_bf16 v[208:211], a[212:215], v[16:19], v[208:211]
    ds_read_b64_tr_b16 a[240:241], v246 offset:33792
    v_cvt_pk_bf16_f32 v100, v124, v125
    v_mfma_f32_16x16x32_bf16 v[208:211], a[208:211], v[4:7], v[208:211]
    ds_read_b64_tr_b16 a[242:243], v246 offset:42240
    v_mfma_f32_16x16x32_bf16 v[212:215], a[208:211], v[8:11], v[224:227]
    v_exp_f32 v127, v199
    v_mfma_f32_16x16x32_bf16 v[212:215], a[212:215], v[20:23], v[212:215]
    ds_read_b64_tr_b16 a[244:245], v246 offset:33824
    v_mfma_f32_16x16x32_bf16 v[212:215], a[216:219], v[32:35], v[212:215]
    s_waitcnt lgkmcnt(6)
    ds_read_b64_tr_b16 a[246:247], v246 offset:42272
    v_mfma_f32_16x16x32_bf16 v[212:215], a[220:223], v[44:47], v[212:215]
    v_exp_f32 v120, v192
    v_mfma_f32_16x16x32_bf16 v[212:215], a[224:227], v[56:59], v[212:215]
    s_waitcnt lgkmcnt(4)
    ds_read_b64_tr_b16 a[248:249], v246 offset:33856
    v_cvt_pk_bf16_f32 v101, v126, v127
    v_mfma_f32_16x16x32_bf16 v[212:215], a[228:231], v[68:71], v[212:215]
    ds_read_b64_tr_b16 a[250:251], v246 offset:42304
    v_mfma_f32_16x16x32_bf16 v[212:215], a[232:235], v[80:83], v[212:215]
    v_exp_f32 v121, v193
    v_mfma_f32_16x16x32_bf16 v[212:215], a[236:239], v[92:95], v[212:215]
    ds_read_b64_tr_b16 a[252:253], v246 offset:33888
    v_mfma_f32_16x16x32_bf16 v[208:211], a[236:239], v[88:91], v[208:211]
    ds_read_b64_tr_b16 a[254:255], v246 offset:42336
    v_mfma_f32_16x16x32_bf16 v[208:211], a[232:235], v[76:79], v[208:211]
    v_exp_f32 v122, v194
    v_mfma_f32_16x16x32_bf16 v[208:211], a[228:231], v[64:67], v[208:211]
    ds_read_b64_tr_b16 a[208:209], v246 offset:33920
    v_cvt_pk_bf16_f32 v96, v120, v121
    v_mfma_f32_16x16x32_bf16 v[208:211], a[224:227], v[52:55], v[208:211]
    ds_read_b64_tr_b16 a[210:211], v246 offset:42368
    v_mfma_f32_16x16x32_bf16 v[204:207], a[224:227], v[48:51], v[204:207]
    v_exp_f32 v123, v195
    v_mfma_f32_16x16x32_bf16 v[204:207], a[228:231], v[60:63], v[204:207]
    ds_read_b64_tr_b16 a[212:213], v246 offset:33952
    v_mfma_f32_16x16x32_bf16 v[204:207], a[232:235], v[72:75], v[204:207]
    s_waitcnt lgkmcnt(9)
    ds_read_b64_tr_b16 a[214:215], v246 offset:42400
    v_mfma_f32_16x16x32_bf16 v[204:207], a[236:239], v[84:87], v[204:207]
    v_exp_f32 v124, v212
    v_mfma_f32_16x16x32_bf16 v[144:147], a[240:243], v[108:111], v[144:147]
    ds_read_b64_tr_b16 a[216:217], v246 offset:33984
    v_cvt_pk_bf16_f32 v97, v122, v123
    v_mfma_f32_16x16x32_bf16 v[148:151], a[240:243], v[112:115], v[148:151]
    s_waitcnt lgkmcnt(9)
    ds_read_b64_tr_b16 a[218:219], v246 offset:42432
    v_mfma_f32_16x16x32_bf16 v[152:155], a[240:243], v[116:119], v[152:155]
    v_exp_f32 v125, v213
    v_mfma_f32_16x16x32_bf16 v[164:167], a[244:247], v[116:119], v[164:167]
    ds_read_b64_tr_b16 a[220:221], v246 offset:34016
    v_mfma_f32_16x16x32_bf16 v[160:163], a[244:247], v[112:115], v[160:163]
    s_waitcnt lgkmcnt(9)
    ds_read_b64_tr_b16 a[222:223], v246 offset:42464
    v_mfma_f32_16x16x32_bf16 v[156:159], a[244:247], v[108:111], v[156:159]
    v_exp_f32 v126, v214
    v_mfma_f32_16x16x32_bf16 v[168:171], a[248:251], v[108:111], v[168:171]
    ds_read_b64_tr_b16 a[224:225], v246 offset:34048
    v_cvt_pk_bf16_f32 v106, v124, v125
    v_mfma_f32_16x16x32_bf16 v[172:175], a[248:251], v[112:115], v[172:175]
    s_waitcnt lgkmcnt(9)
    ds_read_b64_tr_b16 a[226:227], v246 offset:42496
    v_mfma_f32_16x16x32_bf16 v[176:179], a[248:251], v[116:119], v[176:179]
    v_exp_f32 v127, v215
    v_mfma_f32_16x16x32_bf16 v[188:191], a[252:255], v[116:119], v[188:191]
    ds_read_b64_tr_b16 a[228:229], v246 offset:34080
    v_mfma_f32_16x16x32_bf16 v[184:187], a[252:255], v[112:115], v[184:187]
    s_waitcnt lgkmcnt(9)
    ds_read_b64_tr_b16 a[230:231], v246 offset:42528
    v_mfma_f32_16x16x32_bf16 v[180:183], a[252:255], v[108:111], v[180:183]
    v_exp_f32 v120, v208
    v_mfma_f32_16x16x32_bf16 a[48:51], a[208:211], v[108:111], a[48:51]
    ds_read_b64_tr_b16 a[232:233], v246 offset:34112
    v_cvt_pk_bf16_f32 v107, v126, v127
    v_mfma_f32_16x16x32_bf16 a[52:55], a[208:211], v[112:115], a[52:55]
    s_waitcnt lgkmcnt(9)
    ds_read_b64_tr_b16 a[234:235], v246 offset:42560
    v_mfma_f32_16x16x32_bf16 a[56:59], a[208:211], v[116:119], a[56:59]
    v_exp_f32 v121, v209
    v_mfma_f32_16x16x32_bf16 a[68:71], a[212:215], v[116:119], a[68:71]
    ds_read_b64_tr_b16 a[236:237], v246 offset:34144
    v_mfma_f32_16x16x32_bf16 a[64:67], a[212:215], v[112:115], a[64:67]
    s_waitcnt lgkmcnt(9)
    ds_read_b64_tr_b16 a[238:239], v246 offset:42592
    v_mfma_f32_16x16x32_bf16 a[60:63], a[212:215], v[108:111], a[60:63]
    v_exp_f32 v122, v210
    v_mfma_f32_16x16x32_bf16 a[72:75], a[216:219], v[108:111], a[72:75]
    ds_read_b64_tr_b16 a[240:241], v246 offset:34176
    v_cvt_pk_bf16_f32 v102, v120, v121
    v_mfma_f32_16x16x32_bf16 a[76:79], a[216:219], v[112:115], a[76:79]
    s_waitcnt lgkmcnt(9)
    ds_read_b64_tr_b16 a[242:243], v246 offset:42624
    v_mfma_f32_16x16x32_bf16 a[80:83], a[216:219], v[116:119], a[80:83]
    v_exp_f32 v123, v211
    v_mfma_f32_16x16x32_bf16 a[92:95], a[220:223], v[116:119], a[92:95]
    ds_read_b64_tr_b16 a[244:245], v246 offset:34208
    v_mfma_f32_16x16x32_bf16 a[88:91], a[220:223], v[112:115], a[88:91]
    s_waitcnt lgkmcnt(9)
    ds_read_b64_tr_b16 a[246:247], v246 offset:42656
    v_mfma_f32_16x16x32_bf16 a[84:87], a[220:223], v[108:111], a[84:87]
    v_exp_f32 v124, v204
    v_mfma_f32_16x16x32_bf16 a[96:99], a[224:227], v[108:111], a[96:99]
    ds_read_b64_tr_b16 a[248:249], v246 offset:34240
    v_cvt_pk_bf16_f32 v103, v122, v123
    v_mfma_f32_16x16x32_bf16 a[100:103], a[224:227], v[112:115], a[100:103]
    s_waitcnt lgkmcnt(9)
    ds_read_b64_tr_b16 a[250:251], v246 offset:42688
    v_mfma_f32_16x16x32_bf16 a[104:107], a[224:227], v[116:119], a[104:107]
    v_exp_f32 v125, v205
    v_mfma_f32_16x16x32_bf16 a[116:119], a[228:231], v[116:119], a[116:119]
    s_waitcnt lgkmcnt(8)
    ds_read_b64_tr_b16 a[252:253], v246 offset:34272
    v_mfma_f32_16x16x32_bf16 a[112:115], a[228:231], v[112:115], a[112:115]
    s_waitcnt vmcnt(10)
    ds_read_b64_tr_b16 a[254:255], v246 offset:42720
    s_add_u32 m0, s33, 51776
    v_mfma_f32_16x16x32_bf16 a[108:111], a[228:231], v[108:111], a[108:111]
    v_exp_f32 v126, v206
    v_mfma_f32_16x16x32_bf16 a[120:123], a[232:235], v[108:111], a[120:123]
    s_barrier
    ds_read_b128 a[208:211], v241 offset:0
    v_cvt_pk_bf16_f32 v98, v124, v125
    v_mfma_f32_16x16x32_bf16 a[124:127], a[232:235], v[112:115], a[124:127]
    v_exp_f32 v127, v207
    v_mfma_f32_16x16x32_bf16 a[128:131], a[232:235], v[116:119], a[128:131]
    s_waitcnt lgkmcnt(9)
    v_cvt_pk_bf16_f32 v99, v126, v127
    v_mfma_f32_16x16x32_bf16 a[140:143], a[236:239], v[116:119], a[140:143]
    s_waitcnt lgkmcnt(7)
    ds_read_b128 a[212:215], v241 offset:64
    v_mfma_f32_16x16x32_bf16 a[136:139], a[236:239], v[112:115], a[136:139]
    buffer_load_dwordx4 v240, s[16:19], s51 offen offset:1024 nt lds
    v_mfma_f32_16x16x32_bf16 a[132:135], a[236:239], v[108:111], a[132:135]
    s_add_u32 m0, s33, 52320
    v_mfma_f32_16x16x32_bf16 a[144:147], a[240:243], v[108:111], a[144:147]
    ds_read_b128 a[216:219], v241 offset:128
    v_mfma_f32_16x16x32_bf16 a[148:151], a[240:243], v[112:115], a[148:151]
    buffer_load_dwordx4 v240, s[16:19], s51 offen offset:1536 nt lds
    v_mfma_f32_16x16x32_bf16 a[152:155], a[240:243], v[116:119], a[152:155]
    s_xor_b32 s51, s95, 131072
    s_add_u32 m0, s33, 84480
    v_mfma_f32_16x16x32_bf16 v[128:131], a[192:195], v[96:99], v[132:135]
    v_mfma_f32_16x16x32_bf16 v[128:131], a[196:199], v[100:103], v[128:131]
    buffer_load_dwordx4 v240, s[20:23], s51 offen nt lds
    v_mfma_f32_16x16x32_bf16 v[128:131], a[200:203], v[104:107], v[128:131]
    s_waitcnt lgkmcnt(7)
    s_add_u32 m0, s33, 85024
    v_mfma_f32_16x16x32_bf16 a[164:167], a[244:247], v[116:119], a[164:167]
    s_waitcnt lgkmcnt(5)
    ds_read_b128 a[220:223], v241 offset:192
    v_mfma_f32_16x16x32_bf16 a[160:163], a[244:247], v[112:115], a[160:163]
    buffer_load_dwordx4 v240, s[20:23], s51 offen offset:512 nt lds
    v_mfma_f32_16x16x32_bf16 a[156:159], a[244:247], v[108:111], a[156:159]
    v_mfma_f32_16x16x32_bf16 a[168:171], a[248:251], v[108:111], a[168:171]
    s_waitcnt lgkmcnt(4)
    ds_read_b128 a[224:227], v241 offset:256
    v_mfma_f32_16x16x32_bf16 a[172:175], a[248:251], v[112:115], a[172:175]
    v_max3_f32 v136, v128, v129, v130
    v_cmp_nge_f32 vcc, s53, v136
    v_mfma_f32_16x16x32_bf16 a[176:179], a[248:251], v[116:119], a[176:179]
    s_add_u32 m0, s33, 85568
    v_mfma_f32_16x16x32_bf16 a[188:191], a[252:255], v[116:119], a[188:191]
    s_waitcnt lgkmcnt(4)
    ds_read_b128 a[228:231], v241 offset:320
    v_mfma_f32_16x16x32_bf16 a[184:187], a[252:255], v[112:115], a[184:187]
    v_mfma_f32_16x16x32_bf16 a[180:183], a[252:255], v[108:111], a[180:183]
    s_cbranch_vccnz L_stub6
L_back6:
    v_mfma_f32_16x16x32_bf16 v[192:195], a[208:211], v[0:3], v[216:219]
    s_waitcnt lgkmcnt(2)
    ds_read_b128 a[232:235], v241 offset:384
    v_mfma_f32_16x16x32_bf16 v[192:195], a[212:215], v[12:15], v[192:195]
    v_mfma_f32_16x16x32_bf16 v[192:195], a[216:219], v[24:27], v[192:195]
    buffer_load_dwordx4 v240, s[20:23], s51 offen offset:1024 nt lds
    v_mfma_f32_16x16x32_bf16 v[192:195], a[220:223], v[36:39], v[192:195]
    ds_read_b128 a[236:239], v241 offset:448
    v_mfma_f32_16x16x32_bf16 v[196:199], a[220:223], v[40:43], v[220:223]
    v_mfma_f32_16x16x32_bf16 v[196:199], a[216:219], v[28:31], v[196:199]
    v_mfma_f32_16x16x32_bf16 v[196:199], a[212:215], v[16:19], v[196:199]
    ds_read_b128 a[240:243], v241 offset:8448
    v_mfma_f32_16x16x32_bf16 v[196:199], a[208:211], v[4:7], v[196:199]
    v_mfma_f32_16x16x32_bf16 v[200:203], a[208:211], v[8:11], v[224:227]
    v_mfma_f32_16x16x32_bf16 v[200:203], a[212:215], v[20:23], v[200:203]
    s_waitcnt lgkmcnt(4)
    ds_read_b128 a[244:247], v241 offset:8512
    v_mfma_f32_16x16x32_bf16 v[200:203], a[216:219], v[32:35], v[200:203]
    s_add_u32 m0, s33, 86112
    v_mfma_f32_16x16x32_bf16 v[200:203], a[220:223], v[44:47], v[200:203]
    v_mfma_f32_16x16x32_bf16 v[200:203], a[224:227], v[56:59], v[200:203]
    s_waitcnt lgkmcnt(2)
    ds_read_b128 a[248:251], v241 offset:8576
    v_mfma_f32_16x16x32_bf16 v[200:203], a[228:231], v[68:71], v[200:203]
    v_mfma_f32_16x16x32_bf16 v[200:203], a[232:235], v[80:83], v[200:203]
    v_mfma_f32_16x16x32_bf16 v[200:203], a[236:239], v[92:95], v[200:203]
    ds_read_b128 a[252:255], v241 offset:8640
    v_mfma_f32_16x16x32_bf16 v[196:199], a[236:239], v[88:91], v[196:199]
    buffer_load_dwordx4 v240, s[20:23], s51 offen offset:1536 nt lds
    v_mfma_f32_16x16x32_bf16 v[196:199], a[232:235], v[76:79], v[196:199]
    v_mfma_f32_16x16x32_bf16 v[196:199], a[228:231], v[64:67], v[196:199]
    ds_read_b128 a[208:211], v241 offset:8704
    v_mfma_f32_16x16x32_bf16 v[196:199], a[224:227], v[52:55], v[196:199]
    v_mfma_f32_16x16x32_bf16 v[192:195], a[224:227], v[48:51], v[192:195]
    v_exp_f32 v120, v200
    v_mfma_f32_16x16x32_bf16 v[192:195], a[228:231], v[60:63], v[192:195]
    s_waitcnt lgkmcnt(4)
    ds_read_b128 a[212:215], v241 offset:8768
    v_mfma_f32_16x16x32_bf16 v[192:195], a[232:235], v[72:75], v[192:195]
    v_exp_f32 v121, v201
    v_mfma_f32_16x16x32_bf16 v[192:195], a[236:239], v[84:87], v[192:195]
    v_exp_f32 v122, v202
    v_mfma_f32_16x16x32_bf16 v[204:207], a[240:243], v[0:3], v[216:219]
    s_waitcnt lgkmcnt(2)
    ds_read_b128 a[216:219], v241 offset:8832
    v_cvt_pk_bf16_f32 v116, v120, v121
    v_mfma_f32_16x16x32_bf16 v[204:207], a[244:247], v[12:15], v[204:207]
    s_xor_b32 s51, s95, 135168
    v_exp_f32 v123, v203
    v_mfma_f32_16x16x32_bf16 v[204:207], a[248:251], v[24:27], v[204:207]
    s_add_u32 m0, s33, 101376
    v_exp_f32 v124, v196
    v_mfma_f32_16x16x32_bf16 v[204:207], a[252:255], v[36:39], v[204:207]
    ds_read_b128 a[220:223], v241 offset:8896
    v_cvt_pk_bf16_f32 v117, v122, v123
    v_mfma_f32_16x16x32_bf16 v[208:211], a[252:255], v[40:43], v[220:223]
    v_exp_f32 v125, v197
    v_mfma_f32_16x16x32_bf16 v[208:211], a[248:251], v[28:31], v[208:211]
    v_exp_f32 v126, v198
    v_mfma_f32_16x16x32_bf16 v[208:211], a[244:247], v[16:19], v[208:211]
    ds_read_b64_tr_b16 a[224:225], v245 offset:16896
    v_cvt_pk_bf16_f32 v112, v124, v125
    v_mfma_f32_16x16x32_bf16 v[208:211], a[240:243], v[4:7], v[208:211]
    ds_read_b64_tr_b16 a[226:227], v245 offset:25344
    buffer_load_dwordx4 v240, s[16:19], s51 offen nt lds
    v_mfma_f32_16x16x32_bf16 v[212:215], a[240:243], v[8:11], v[224:227]
    v_exp_f32 v127, v199
    v_mfma_f32_16x16x32_bf16 v[212:215], a[244:247], v[20:23], v[212:215]
    ds_read_b64_tr_b16 a[228:229], v245 offset:16928
    v_mfma_f32_16x16x32_bf16 v[212:215], a[248:251], v[32:35], v[212:215]
    s_waitcnt lgkmcnt(6)
    ds_read_b64_tr_b16 a[230:231], v245 offset:25376
    v_mfma_f32_16x16x32_bf16 v[212:215], a[252:255], v[44:47], v[212:215]
    v_exp_f32 v120, v192
    v_mfma_f32_16x16x32_bf16 v[212:215], a[208:211], v[56:59], v[212:215]
    s_waitcnt lgkmcnt(4)
    ds_read_b64_tr_b16 a[232:233], v245 offset:16960
    v_cvt_pk_bf16_f32 v113, v126, v127
    v_mfma_f32_16x16x32_bf16 v[212:215], a[212:215], v[68:71], v[212:215]
    ds_read_b64_tr_b16 a[234:235], v245 offset:25408
    v_mfma_f32_16x16x32_bf16 v[212:215], a[216:219], v[80:83], v[212:215]
    v_exp_f32 v121, v193
    v_mfma_f32_16x16x32_bf16 v[212:215], a[220:223], v[92:95], v[212:215]
    ds_read_b64_tr_b16 a[236:237], v245 offset:16992
    v_mfma_f32_16x16x32_bf16 v[208:211], a[220:223], v[88:91], v[208:211]
    ds_read_b64_tr_b16 a[238:239], v245 offset:25440
    v_mfma_f32_16x16x32_bf16 v[208:211], a[216:219], v[76:79], v[208:211]
    v_exp_f32 v122, v194
    v_mfma_f32_16x16x32_bf16 v[208:211], a[212:215], v[64:67], v[208:211]
    ds_read_b64_tr_b16 a[240:241], v245 offset:17024
    v_cvt_pk_bf16_f32 v108, v120, v121
    v_mfma_f32_16x16x32_bf16 v[208:211], a[208:211], v[52:55], v[208:211]
    ds_read_b64_tr_b16 a[242:243], v245 offset:25472
    v_mfma_f32_16x16x32_bf16 v[204:207], a[208:211], v[48:51], v[204:207]
    v_exp_f32 v123, v195
    v_mfma_f32_16x16x32_bf16 v[204:207], a[212:215], v[60:63], v[204:207]
    ds_read_b64_tr_b16 a[244:245], v245 offset:17056
    v_mfma_f32_16x16x32_bf16 v[204:207], a[216:219], v[72:75], v[204:207]
    s_waitcnt lgkmcnt(9)
    ds_read_b64_tr_b16 a[246:247], v245 offset:25504
    v_mfma_f32_16x16x32_bf16 v[204:207], a[220:223], v[84:87], v[204:207]
    v_exp_f32 v124, v212
    v_mfma_f32_16x16x32_bf16 v[144:147], a[224:227], v[96:99], v[144:147]
    ds_read_b64_tr_b16 a[248:249], v245 offset:17088
    v_cvt_pk_bf16_f32 v109, v122, v123
    v_mfma_f32_16x16x32_bf16 v[148:151], a[224:227], v[100:103], v[148:151]
    s_waitcnt lgkmcnt(9)
    ds_read_b64_tr_b16 a[250:251], v245 offset:25536
    v_mfma_f32_16x16x32_bf16 v[152:155], a[224:227], v[104:107], v[152:155]
    v_exp_f32 v125, v213
    v_mfma_f32_16x16x32_bf16 v[164:167], a[228:231], v[104:107], v[164:167]
    ds_read_b64_tr_b16 a[252:253], v245 offset:17120
    v_mfma_f32_16x16x32_bf16 v[160:163], a[228:231], v[100:103], v[160:163]
    s_waitcnt lgkmcnt(9)
    ds_read_b64_tr_b16 a[254:255], v245 offset:25568
    v_mfma_f32_16x16x32_bf16 v[156:159], a[228:231], v[96:99], v[156:159]
    v_exp_f32 v126, v214
    v_mfma_f32_16x16x32_bf16 v[168:171], a[232:235], v[96:99], v[168:171]
    ds_read_b64_tr_b16 a[208:209], v245 offset:17152
    v_cvt_pk_bf16_f32 v118, v124, v125
    v_mfma_f32_16x16x32_bf16 v[172:175], a[232:235], v[100:103], v[172:175]
    s_waitcnt lgkmcnt(9)
    ds_read_b64_tr_b16 a[210:211], v245 offset:25600
    v_mfma_f32_16x16x32_bf16 v[176:179], a[232:235], v[104:107], v[176:179]
    v_exp_f32 v127, v215
    v_mfma_f32_16x16x32_bf16 v[188:191], a[236:239], v[104:107], v[188:191]
    ds_read_b64_tr_b16 a[212:213], v245 offset:17184
    v_mfma_f32_16x16x32_bf16 v[184:187], a[236:239], v[100:103], v[184:187]
    s_waitcnt lgkmcnt(9)
    ds_read_b64_tr_b16 a[214:215], v245 offset:25632
    v_mfma_f32_16x16x32_bf16 v[180:183], a[236:239], v[96:99], v[180:183]
    v_exp_f32 v120, v208
    v_mfma_f32_16x16x32_bf16 a[48:51], a[240:243], v[96:99], a[48:51]
    ds_read_b64_tr_b16 a[216:217], v245 offset:17216
    v_cvt_pk_bf16_f32 v119, v126, v127
    v_mfma_f32_16x16x32_bf16 a[52:55], a[240:243], v[100:103], a[52:55]
    s_waitcnt lgkmcnt(9)
    ds_read_b64_tr_b16 a[218:219], v245 offset:25664
    v_mfma_f32_16x16x32_bf16 a[56:59], a[240:243], v[104:107], a[56:59]
    v_exp_f32 v121, v209
    v_mfma_f32_16x16x32_bf16 a[68:71], a[244:247], v[104:107], a[68:71]
    ds_read_b64_tr_b16 a[220:221], v245 offset:17248
    v_mfma_f32_16x16x32_bf16 a[64:67], a[244:247], v[100:103], a[64:67]
    s_waitcnt lgkmcnt(9)
    ds_read_b64_tr_b16 a[222:223], v245 offset:25696
    v_mfma_f32_16x16x32_bf16 a[60:63], a[244:247], v[96:99], a[60:63]
    v_exp_f32 v122, v210
    v_mfma_f32_16x16x32_bf16 a[72:75], a[248:251], v[96:99], a[72:75]
    ds_read_b64_tr_b16 a[224:225], v245 offset:17280
    v_cvt_pk_bf16_f32 v114, v120, v121
    v_mfma_f32_16x16x32_bf16 a[76:79], a[248:251], v[100:103], a[76:79]
    s_waitcnt lgkmcnt(9)
    ds_read_b64_tr_b16 a[226:227], v245 offset:25728
    v_mfma_f32_16x16x32_bf16 a[80:83], a[248:251], v[104:107], a[80:83]
    v_exp_f32 v123, v211
    v_mfma_f32_16x16x32_bf16 a[92:95], a[252:255], v[104:107], a[92:95]
    ds_read_b64_tr_b16 a[228:229], v245 offset:17312
    v_mfma_f32_16x16x32_bf16 a[88:91], a[252:255], v[100:103], a[88:91]
    s_waitcnt lgkmcnt(9)
    ds_read_b64_tr_b16 a[230:231], v245 offset:25760
    v_mfma_f32_16x16x32_bf16 a[84:87], a[252:255], v[96:99], a[84:87]
    v_exp_f32 v124, v204
    v_mfma_f32_16x16x32_bf16 a[96:99], a[208:211], v[96:99], a[96:99]
    ds_read_b64_tr_b16 a[232:233], v245 offset:17344
    v_cvt_pk_bf16_f32 v115, v122, v123
    v_mfma_f32_16x16x32_bf16 a[100:103], a[208:211], v[100:103], a[100:103]
    s_waitcnt lgkmcnt(9)
    ds_read_b64_tr_b16 a[234:235], v245 offset:25792
    v_mfma_f32_16x16x32_bf16 a[104:107], a[208:211], v[104:107], a[104:107]
    v_exp_f32 v125, v205
    v_mfma_f32_16x16x32_bf16 a[116:119], a[212:215], v[104:107], a[116:119]
    s_waitcnt lgkmcnt(8)
    ds_read_b64_tr_b16 a[236:237], v245 offset:17376
    v_mfma_f32_16x16x32_bf16 a[112:115], a[212:215], v[100:103], a[112:115]
    s_waitcnt vmcnt(9)
    ds_read_b64_tr_b16 a[238:239], v245 offset:25824
    s_add_u32 m0, s33, 101920
    v_mfma_f32_16x16x32_bf16 a[108:111], a[212:215], v[96:99], a[108:111]
    v_exp_f32 v126, v206
    v_mfma_f32_16x16x32_bf16 a[120:123], a[216:219], v[96:99], a[120:123]
    s_barrier
    ds_read_b128 a[240:243], v241 offset:16896
    v_cvt_pk_bf16_f32 v110, v124, v125
    v_mfma_f32_16x16x32_bf16 a[124:127], a[216:219], v[100:103], a[124:127]
    v_exp_f32 v127, v207
    v_mfma_f32_16x16x32_bf16 a[128:131], a[216:219], v[104:107], a[128:131]
    s_waitcnt lgkmcnt(9)
    v_cvt_pk_bf16_f32 v111, v126, v127
    v_mfma_f32_16x16x32_bf16 a[140:143], a[220:223], v[104:107], a[140:143]
    s_waitcnt lgkmcnt(7)
    ds_read_b128 a[244:247], v241 offset:16960
    v_mfma_f32_16x16x32_bf16 a[136:139], a[220:223], v[100:103], a[136:139]
    buffer_load_dwordx4 v240, s[16:19], s51 offen offset:512 nt lds
    v_mfma_f32_16x16x32_bf16 a[132:135], a[220:223], v[96:99], a[132:135]
    s_add_u32 m0, s33, 102464
    v_mfma_f32_16x16x32_bf16 a[144:147], a[224:227], v[96:99], a[144:147]
    ds_read_b128 a[248:251], v241 offset:17024
    v_mfma_f32_16x16x32_bf16 a[148:151], a[224:227], v[100:103], a[148:151]
    buffer_load_dwordx4 v240, s[16:19], s51 offen offset:1024 nt lds
    v_mfma_f32_16x16x32_bf16 a[152:155], a[224:227], v[104:107], a[152:155]
    s_add_u32 m0, s33, 103008
    v_mfma_f32_16x16x32_bf16 v[132:135], a[192:195], v[108:111], v[128:131]
    v_mfma_f32_16x16x32_bf16 v[132:135], a[196:199], v[112:115], v[132:135]
    buffer_load_dwordx4 v240, s[16:19], s51 offen offset:1536 nt lds
    v_mfma_f32_16x16x32_bf16 v[132:135], a[200:203], v[116:119], v[132:135]
    s_waitcnt lgkmcnt(7)
    s_xor_b32 s51, s95, 133120
    s_add_u32 m0, s33, 118272
    v_mfma_f32_16x16x32_bf16 a[164:167], a[228:231], v[104:107], a[164:167]
    s_waitcnt lgkmcnt(5)
    ds_read_b128 a[252:255], v241 offset:17088
    v_mfma_f32_16x16x32_bf16 a[160:163], a[228:231], v[100:103], a[160:163]
    buffer_load_dwordx4 v240, s[20:23], s51 offen nt lds
    v_mfma_f32_16x16x32_bf16 a[156:159], a[228:231], v[96:99], a[156:159]
    v_mfma_f32_16x16x32_bf16 a[168:171], a[232:235], v[96:99], a[168:171]
    s_waitcnt lgkmcnt(4)
    ds_read_b128 a[208:211], v241 offset:17152
    v_mfma_f32_16x16x32_bf16 a[172:175], a[232:235], v[100:103], a[172:175]
    v_max3_f32 v136, v132, v133, v134
    v_cmp_nge_f32 vcc, s53, v136
    v_mfma_f32_16x16x32_bf16 a[176:179], a[232:235], v[104:107], a[176:179]
    v_mfma_f32_16x16x32_bf16 a[188:191], a[236:239], v[104:107], a[188:191]
    s_waitcnt lgkmcnt(4)
    ds_read_b128 a[212:215], v241 offset:17216
    v_mfma_f32_16x16x32_bf16 a[184:187], a[236:239], v[100:103], a[184:187]
    s_add_u32 m0, s33, 118816
    v_mfma_f32_16x16x32_bf16 a[180:183], a[236:239], v[96:99], a[180:183]
    s_cbranch_vccnz L_stub7
L_back7:
    v_mfma_f32_16x16x32_bf16 v[192:195], a[240:243], v[0:3], v[216:219]
    s_waitcnt lgkmcnt(2)
    ds_read_b128 a[216:219], v241 offset:17280
    v_mfma_f32_16x16x32_bf16 v[192:195], a[244:247], v[12:15], v[192:195]
    v_mfma_f32_16x16x32_bf16 v[192:195], a[248:251], v[24:27], v[192:195]
    v_mfma_f32_16x16x32_bf16 v[192:195], a[252:255], v[36:39], v[192:195]
    ds_read_b128 a[220:223], v241 offset:17344
    v_mfma_f32_16x16x32_bf16 v[196:199], a[252:255], v[40:43], v[220:223]
    buffer_load_dwordx4 v240, s[20:23], s51 offen offset:512 nt lds
    v_mfma_f32_16x16x32_bf16 v[196:199], a[248:251], v[28:31], v[196:199]
    v_mfma_f32_16x16x32_bf16 v[196:199], a[244:247], v[16:19], v[196:199]
    ds_read_b128 a[224:227], v241 offset:25344
    v_mfma_f32_16x16x32_bf16 v[196:199], a[240:243], v[4:7], v[196:199]
    v_mfma_f32_16x16x32_bf16 v[200:203], a[240:243], v[8:11], v[224:227]
    v_mfma_f32_16x16x32_bf16 v[200:203], a[244:247], v[20:23], v[200:203]
    s_waitcnt lgkmcnt(4)
    ds_read_b128 a[228:231], v241 offset:25408
    v_mfma_f32_16x16x32_bf16 v[200:203], a[248:251], v[32:35], v[200:203]
    v_mfma_f32_16x16x32_bf16 v[200:203], a[252:255], v[44:47], v[200:203]
    v_mfma_f32_16x16x32_bf16 v[200:203], a[208:211], v[56:59], v[200:203]
    s_waitcnt lgkmcnt(2)
    ds_read_b128 a[232:235], v241 offset:25472
    v_mfma_f32_16x16x32_bf16 v[200:203], a[212:215], v[68:71], v[200:203]
    s_add_u32 m0, s33, 119360
    v_mfma_f32_16x16x32_bf16 v[200:203], a[216:219], v[80:83], v[200:203]
    v_mfma_f32_16x16x32_bf16 v[200:203], a[220:223], v[92:95], v[200:203]
    ds_read_b128 a[236:239], v241 offset:25536
    v_mfma_f32_16x16x32_bf16 v[196:199], a[220:223], v[88:91], v[196:199]
    v_mfma_f32_16x16x32_bf16 v[196:199], a[216:219], v[76:79], v[196:199]
    v_mfma_f32_16x16x32_bf16 v[196:199], a[212:215], v[64:67], v[196:199]
    ds_read_b128 a[240:243], v241 offset:25600
    v_mfma_f32_16x16x32_bf16 v[196:199], a[208:211], v[52:55], v[196:199]
    buffer_load_dwordx4 v240, s[20:23], s51 offen offset:1024 nt lds
    v_mfma_f32_16x16x32_bf16 v[192:195], a[208:211], v[48:51], v[192:195]
    v_exp_f32 v120, v200
    v_exp_f32 v121, v201
    v_exp_f32 v122, v202
    v_cvt_pk_bf16_f32 v104, v120, v121
    v_exp_f32 v123, v203
    v_mfma_f32_16x16x32_bf16 v[192:195], a[212:215], v[60:63], v[192:195]
    s_waitcnt lgkmcnt(4)
    ds_read_b128 a[244:247], v241 offset:25664
    v_mfma_f32_16x16x32_bf16 v[192:195], a[216:219], v[72:75], v[192:195]
    v_mfma_f32_16x16x32_bf16 v[192:195], a[220:223], v[84:87], v[192:195]
    v_mfma_f32_16x16x32_bf16 v[204:207], a[224:227], v[0:3], v[216:219]
    s_waitcnt lgkmcnt(2)
    ds_read_b128 a[248:251], v241 offset:25728
    v_exp_f32 v124, v196
    v_cvt_pk_bf16_f32 v105, v122, v123
    v_exp_f32 v125, v197
    v_exp_f32 v126, v198
    v_cvt_pk_bf16_f32 v100, v124, v125
    v_exp_f32 v127, v199
    v_mfma_f32_16x16x32_bf16 v[204:207], a[228:231], v[12:15], v[204:207]
    v_mfma_f32_16x16x32_bf16 v[204:207], a[232:235], v[24:27], v[204:207]
    s_add_u32 m0, s33, 119904
    v_mfma_f32_16x16x32_bf16 v[204:207], a[236:239], v[36:39], v[204:207]
    ds_read_b128 a[252:255], v241 offset:25792
    v_mfma_f32_16x16x32_bf16 v[208:211], a[236:239], v[40:43], v[220:223]
    v_exp_f32 v120, v192
    v_cvt_pk_bf16_f32 v101, v126, v127
    v_exp_f32 v121, v193
    v_exp_f32 v122, v194
    v_cvt_pk_bf16_f32 v96, v120, v121
    v_exp_f32 v123, v195
    v_mfma_f32_16x16x32_bf16 v[208:211], a[232:235], v[28:31], v[208:211]
    v_mfma_f32_16x16x32_bf16 v[208:211], a[228:231], v[16:19], v[208:211]
    ds_read_b64_tr_b16 a[208:209], v244 offset:33792
    v_mfma_f32_16x16x32_bf16 v[208:211], a[224:227], v[4:7], v[208:211]
    ds_read_b64_tr_b16 a[210:211], v244 offset:42240
    v_mfma_f32_16x16x32_bf16 v[212:215], a[224:227], v[8:11], v[224:227]
    buffer_load_dwordx4 v240, s[20:23], s51 offen offset:1536 nt lds
    v_mfma_f32_16x16x32_bf16 v[212:215], a[228:231], v[20:23], v[212:215]
    ds_read_b64_tr_b16 a[212:213], v244 offset:33824
    v_mfma_f32_16x16x32_bf16 v[212:215], a[232:235], v[32:35], v[212:215]
    s_waitcnt lgkmcnt(6)
    ds_read_b64_tr_b16 a[214:215], v244 offset:42272
    v_mfma_f32_16x16x32_bf16 v[212:215], a[236:239], v[44:47], v[212:215]
    v_mfma_f32_16x16x32_bf16 v[212:215], a[240:243], v[56:59], v[212:215]
    s_waitcnt lgkmcnt(4)
    ds_read_b64_tr_b16 a[216:217], v244 offset:33856
    v_mfma_f32_16x16x32_bf16 v[212:215], a[244:247], v[68:71], v[212:215]
    ds_read_b64_tr_b16 a[218:219], v244 offset:42304
    v_mfma_f32_16x16x32_bf16 v[212:215], a[248:251], v[80:83], v[212:215]
    v_mfma_f32_16x16x32_bf16 v[212:215], a[252:255], v[92:95], v[212:215]
    ds_read_b64_tr_b16 a[220:221], v244 offset:33888
    v_mfma_f32_16x16x32_bf16 v[208:211], a[252:255], v[88:91], v[208:211]
    ds_read_b64_tr_b16 a[222:223], v244 offset:42336
    v_mfma_f32_16x16x32_bf16 v[208:211], a[248:251], v[76:79], v[208:211]
    v_mfma_f32_16x16x32_bf16 v[208:211], a[244:247], v[64:67], v[208:211]
L_pad6:
    s_cbranch_execz L_pad10
    ds_read_b64_tr_b16 a[224:225], v244 offset:33920
    v_mfma_f32_16x16x32_bf16 v[208:211], a[240:243], v[52:55], v[208:211]
    ds_read_b64_tr_b16 a[226:227], v244 offset:42368
    v_mfma_f32_16x16x32_bf16 v[204:207], a[240:243], v[48:51], v[204:207]
    v_exp_f32 v124, v212
    v_cvt_pk_bf16_f32 v97, v122, v123
    v_exp_f32 v125, v213
    v_exp_f32 v126, v214
    v_cvt_pk_bf16_f32 v106, v124, v125
    v_exp_f32 v127, v215
    v_mfma_f32_16x16x32_bf16 v[204:207], a[244:247], v[60:63], v[204:207]
    ds_read_b64_tr_b16 a[228:229], v244 offset:33952
    v_mfma_f32_16x16x32_bf16 v[204:207], a[248:251], v[72:75], v[204:207]
    s_waitcnt lgkmcnt(9)
    ds_read_b64_tr_b16 a[230:231], v244 offset:42400
    v_mfma_f32_16x16x32_bf16 v[204:207], a[252:255], v[84:87], v[204:207]
    v_mfma_f32_16x16x32_bf16 v[144:147], a[208:211], v[108:111], v[144:147]
    ds_read_b64_tr_b16 a[232:233], v244 offset:33984
    v_exp_f32 v120, v208
    v_cvt_pk_bf16_f32 v107, v126, v127
    v_exp_f32 v121, v209
    v_exp_f32 v122, v210
    v_cvt_pk_bf16_f32 v102, v120, v121
    v_exp_f32 v123, v211
    v_mfma_f32_16x16x32_bf16 v[148:151], a[208:211], v[112:115], v[148:151]
    s_waitcnt lgkmcnt(9)
    ds_read_b64_tr_b16 a[234:235], v244 offset:42432
    v_mfma_f32_16x16x32_bf16 v[152:155], a[208:211], v[116:119], v[152:155]
    v_mfma_f32_16x16x32_bf16 v[164:167], a[212:215], v[116:119], v[164:167]
    ds_read_b64_tr_b16 a[236:237], v244 offset:34016
    v_mfma_f32_16x16x32_bf16 v[160:163], a[212:215], v[112:115], v[160:163]
    s_waitcnt lgkmcnt(9)
    ds_read_b64_tr_b16 a[238:239], v244 offset:42464
    v_exp_f32 v124, v204
    v_cvt_pk_bf16_f32 v103, v122, v123
    v_exp_f32 v125, v205
    v_exp_f32 v126, v206
    v_cvt_pk_bf16_f32 v98, v124, v125
    v_exp_f32 v127, v207
    v_mfma_f32_16x16x32_bf16 v[156:159], a[212:215], v[108:111], v[156:159]
    v_mfma_f32_16x16x32_bf16 v[168:171], a[216:219], v[108:111], v[168:171]
    ds_read_b64_tr_b16 a[240:241], v244 offset:34048
    v_mfma_f32_16x16x32_bf16 v[172:175], a[216:219], v[112:115], v[172:175]
    s_waitcnt lgkmcnt(9)
    ds_read_b64_tr_b16 a[242:243], v244 offset:42496
    v_mfma_f32_16x16x32_bf16 v[176:179], a[216:219], v[116:119], v[176:179]
    v_mfma_f32_16x16x32_bf16 v[188:191], a[220:223], v[116:119], v[188:191]
    ds_read_b64_tr_b16 a[244:245], v244 offset:34080
    v_mfma_f32_16x16x32_bf16 v[184:187], a[220:223], v[112:115], v[184:187]
    s_waitcnt lgkmcnt(9)
    ds_read_b64_tr_b16 a[246:247], v244 offset:42528
    v_mfma_f32_16x16x32_bf16 v[180:183], a[220:223], v[108:111], v[180:183]
    v_mfma_f32_16x16x32_bf16 a[48:51], a[224:227], v[108:111], a[48:51]
    ds_read_b64_tr_b16 a[248:249], v244 offset:34112
    v_mfma_f32_16x16x32_bf16 a[52:55], a[224:227], v[112:115], a[52:55]
    s_waitcnt lgkmcnt(9)
    ds_read_b64_tr_b16 a[250:251], v244 offset:42560
    v_mfma_f32_16x16x32_bf16 a[56:59], a[224:227], v[116:119], a[56:59]
    v_mfma_f32_16x16x32_bf16 a[68:71], a[228:231], v[116:119], a[68:71]
    ds_read_b64_tr_b16 a[252:253], v244 offset:34144
    v_mfma_f32_16x16x32_bf16 a[64:67], a[228:231], v[112:115], a[64:67]
    s_waitcnt lgkmcnt(9)
    ds_read_b64_tr_b16 a[254:255], v244 offset:42592
    v_mfma_f32_16x16x32_bf16 a[60:63], a[228:231], v[108:111], a[60:63]
    v_mfma_f32_16x16x32_bf16 a[72:75], a[232:235], v[108:111], a[72:75]
    ds_read_b64_tr_b16 a[208:209], v244 offset:34176
    v_mfma_f32_16x16x32_bf16 a[76:79], a[232:235], v[112:115], a[76:79]
    s_waitcnt lgkmcnt(9)
    ds_read_b64_tr_b16 a[210:211], v244 offset:42624
    v_mfma_f32_16x16x32_bf16 a[80:83], a[232:235], v[116:119], a[80:83]
    v_mfma_f32_16x16x32_bf16 a[92:95], a[236:239], v[116:119], a[92:95]
    ds_read_b64_tr_b16 a[212:213], v244 offset:34208
    v_mfma_f32_16x16x32_bf16 a[88:91], a[236:239], v[112:115], a[88:91]
    s_waitcnt lgkmcnt(9)
    ds_read_b64_tr_b16 a[214:215], v244 offset:42656
    v_mfma_f32_16x16x32_bf16 a[84:87], a[236:239], v[108:111], a[84:87]
    v_mfma_f32_16x16x32_bf16 a[96:99], a[240:243], v[108:111], a[96:99]
    ds_read_b64_tr_b16 a[216:217], v244 offset:34240
    v_mfma_f32_16x16x32_bf16 a[100:103], a[240:243], v[112:115], a[100:103]
    s_waitcnt lgkmcnt(9)
    ds_read_b64_tr_b16 a[218:219], v244 offset:42688
    v_mfma_f32_16x16x32_bf16 a[104:107], a[240:243], v[116:119], a[104:107]
    v_mfma_f32_16x16x32_bf16 a[116:119], a[244:247], v[116:119], a[116:119]
    s_waitcnt lgkmcnt(8)
    ds_read_b64_tr_b16 a[220:221], v244 offset:34272
    v_mfma_f32_16x16x32_bf16 a[112:115], a[244:247], v[112:115], a[112:115]
    s_waitcnt vmcnt(8)
    ds_read_b64_tr_b16 a[222:223], v244 offset:42720
    s_xor_b32 s51, s95, 137216
    v_mfma_f32_16x16x32_bf16 a[108:111], a[244:247], v[108:111], a[108:111]
    s_add_u32 m0, s33, 0
    v_mfma_f32_16x16x32_bf16 a[120:123], a[248:251], v[108:111], a[120:123]
    s_barrier
    ds_read_b128 a[224:227], v242 offset:0
    v_mfma_f32_16x16x32_bf16 a[124:127], a[248:251], v[112:115], a[124:127]
    v_mfma_f32_16x16x32_bf16 a[128:131], a[248:251], v[116:119], a[128:131]
    s_waitcnt lgkmcnt(9)
    v_cvt_pk_bf16_f32 v99, v126, v127
    v_mfma_f32_16x16x32_bf16 a[140:143], a[252:255], v[116:119], a[140:143]
    s_waitcnt lgkmcnt(7)
    ds_read_b128 a[228:231], v242 offset:64
    v_mfma_f32_16x16x32_bf16 a[136:139], a[252:255], v[112:115], a[136:139]
    buffer_load_dwordx4 v240, s[16:19], s51 offen nt lds
    v_mfma_f32_16x16x32_bf16 a[132:135], a[252:255], v[108:111], a[132:135]
    s_add_u32 m0, s33, 544
    v_mfma_f32_16x16x32_bf16 a[144:147], a[208:211], v[108:111], a[144:147]
    ds_read_b128 a[232:235], v242 offset:128
    v_mfma_f32_16x16x32_bf16 a[148:151], a[208:211], v[112:115], a[148:151]
    buffer_load_dwordx4 v240, s[16:19], s51 offen offset:512 nt lds
    v_mfma_f32_16x16x32_bf16 a[152:155], a[208:211], v[116:119], a[152:155]
    s_add_u32 m0, s33, 1088
    v_mfma_f32_16x16x32_bf16 v[128:131], a[192:195], v[96:99], v[132:135]
    v_mfma_f32_16x16x32_bf16 v[128:131], a[196:199], v[100:103], v[128:131]
    buffer_load_dwordx4 v240, s[16:19], s51 offen offset:1024 nt lds
    v_mfma_f32_16x16x32_bf16 v[128:131], a[200:203], v[104:107], v[128:131]
    s_waitcnt lgkmcnt(7)
    s_add_u32 m0, s33, 1632
    v_mfma_f32_16x16x32_bf16 a[164:167], a[212:215], v[116:119], a[164:167]
    s_waitcnt lgkmcnt(5)
    ds_read_b128 a[236:239], v242 offset:192
    v_mfma_f32_16x16x32_bf16 a[160:163], a[212:215], v[112:115], a[160:163]
    v_mfma_f32_16x16x32_bf16 a[156:159], a[212:215], v[108:111], a[156:159]
    v_mfma_f32_16x16x32_bf16 a[168:171], a[216:219], v[108:111], a[168:171]
    s_waitcnt lgkmcnt(4)
    ds_read_b128 a[240:243], v242 offset:256
    v_mfma_f32_16x16x32_bf16 a[172:175], a[216:219], v[112:115], a[172:175]
    v_max3_f32 v136, v128, v129, v130
    v_cmp_nge_f32 vcc, s53, v136
    v_mfma_f32_16x16x32_bf16 a[176:179], a[216:219], v[116:119], a[176:179]
    buffer_load_dwordx4 v240, s[16:19], s51 offen offset:1536 nt lds
    v_mfma_f32_16x16x32_bf16 a[188:191], a[220:223], v[116:119], a[188:191]
    s_waitcnt lgkmcnt(4)
    ds_read_b128 a[244:247], v242 offset:320
    v_mfma_f32_16x16x32_bf16 a[184:187], a[220:223], v[112:115], a[184:187]
    v_mfma_f32_16x16x32_bf16 a[180:183], a[220:223], v[108:111], a[180:183]
    s_cbranch_vccnz L_stub8
L_back8:
    v_mfma_f32_16x16x32_bf16 v[192:195], a[224:227], v[0:3], v[216:219]
    s_waitcnt lgkmcnt(2)
    ds_read_b128 a[248:251], v242 offset:384
    v_mfma_f32_16x16x32_bf16 v[192:195], a[228:231], v[12:15], v[192:195]
    v_mfma_f32_16x16x32_bf16 v[192:195], a[232:235], v[24:27], v[192:195]
    v_mfma_f32_16x16x32_bf16 v[192:195], a[236:239], v[36:39], v[192:195]
    ds_read_b128 a[252:255], v242 offset:448
    v_mfma_f32_16x16x32_bf16 v[196:199], a[236:239], v[40:43], v[220:223]
    v_mfma_f32_16x16x32_bf16 v[196:199], a[232:235], v[28:31], v[196:199]
    s_xor_b32 s51, s95, 135168
    s_add_u32 m0, s33, 135168
    v_mfma_f32_16x16x32_bf16 v[196:199], a[228:231], v[16:19], v[196:199]
    ds_read_b128 a[208:211], v242 offset:8448
    v_mfma_f32_16x16x32_bf16 v[196:199], a[224:227], v[4:7], v[196:199]
    v_mfma_f32_16x16x32_bf16 v[200:203], a[224:227], v[8:11], v[224:227]
    v_mfma_f32_16x16x32_bf16 v[200:203], a[228:231], v[20:23], v[200:203]
    s_waitcnt lgkmcnt(4)
    ds_read_b128 a[212:215], v242 offset:8512
    v_mfma_f32_16x16x32_bf16 v[200:203], a[232:235], v[32:35], v[200:203]
    v_mfma_f32_16x16x32_bf16 v[200:203], a[236:239], v[44:47], v[200:203]
    buffer_load_dwordx4 v240, s[20:23], s51 offen nt lds
    v_mfma_f32_16x16x32_bf16 v[200:203], a[240:243], v[56:59], v[200:203]
    s_waitcnt lgkmcnt(2)
    ds_read_b128 a[216:219], v242 offset:8576
    v_mfma_f32_16x16x32_bf16 v[200:203], a[244:247], v[68:71], v[200:203]
    v_mfma_f32_16x16x32_bf16 v[200:203], a[248:251], v[80:83], v[200:203]
    v_mfma_f32_16x16x32_bf16 v[200:203], a[252:255], v[92:95], v[200:203]
    ds_read_b128 a[220:223], v242 offset:8640
    v_mfma_f32_16x16x32_bf16 v[196:199], a[252:255], v[88:91], v[196:199]
    v_mfma_f32_16x16x32_bf16 v[196:199], a[248:251], v[76:79], v[196:199]
    v_mfma_f32_16x16x32_bf16 v[196:199], a[244:247], v[64:67], v[196:199]
    ds_read_b128 a[224:227], v242 offset:8704
    v_mfma_f32_16x16x32_bf16 v[196:199], a[240:243], v[52:55], v[196:199]
    v_mfma_f32_16x16x32_bf16 v[192:195], a[240:243], v[48:51], v[192:195]
    s_add_u32 m0, s33, 135712
    v_exp_f32 v120, v200
    v_exp_f32 v121, v201
    v_exp_f32 v122, v202
    v_cvt_pk_bf16_f32 v116, v120, v121
    v_exp_f32 v123, v203
    v_mfma_f32_16x16x32_bf16 v[192:195], a[244:247], v[60:63], v[192:195]
    s_waitcnt lgkmcnt(4)
    ds_read_b128 a[228:231], v242 offset:8768
    v_mfma_f32_16x16x32_bf16 v[192:195], a[248:251], v[72:75], v[192:195]
    v_mfma_f32_16x16x32_bf16 v[192:195], a[252:255], v[84:87], v[192:195]
    v_mfma_f32_16x16x32_bf16 v[204:207], a[208:211], v[0:3], v[216:219]
    s_waitcnt lgkmcnt(2)
    ds_read_b128 a[232:235], v242 offset:8832
    v_exp_f32 v124, v196
    v_cvt_pk_bf16_f32 v117, v122, v123
    v_exp_f32 v125, v197
    v_exp_f32 v126, v198
    v_cvt_pk_bf16_f32 v112, v124, v125
    v_exp_f32 v127, v199
    v_mfma_f32_16x16x32_bf16 v[204:207], a[212:215], v[12:15], v[204:207]
    v_mfma_f32_16x16x32_bf16 v[204:207], a[216:219], v[24:27], v[204:207]
    buffer_load_dwordx4 v240, s[20:23], s51 offen offset:512 nt lds
    v_mfma_f32_16x16x32_bf16 v[204:207], a[220:223], v[36:39], v[204:207]
    ds_read_b128 a[236:239], v242 offset:8896
    v_mfma_f32_16x16x32_bf16 v[208:211], a[220:223], v[40:43], v[220:223]
    v_exp_f32 v120, v192
    v_cvt_pk_bf16_f32 v113, v126, v127
    v_exp_f32 v121, v193
    v_exp_f32 v122, v194
    v_cvt_pk_bf16_f32 v108, v120, v121
    v_exp_f32 v123, v195
    v_mfma_f32_16x16x32_bf16 v[208:211], a[216:219], v[28:31], v[208:211]
    v_mfma_f32_16x16x32_bf16 v[208:211], a[212:215], v[16:19], v[208:211]
    ds_read_b64_tr_b16 a[240:241], v245 offset:33792
    v_mfma_f32_16x16x32_bf16 v[208:211], a[208:211], v[4:7], v[208:211]
    ds_read_b64_tr_b16 a[242:243], v245 offset:42240
    v_mfma_f32_16x16x32_bf16 v[212:215], a[208:211], v[8:11], v[224:227]
    v_mfma_f32_16x16x32_bf16 v[212:215], a[212:215], v[20:23], v[212:215]
    ds_read_b64_tr_b16 a[244:245], v245 offset:33824
    v_mfma_f32_16x16x32_bf16 v[212:215], a[216:219], v[32:35], v[212:215]
    s_waitcnt lgkmcnt(6)
    ds_read_b64_tr_b16 a[246:247], v245 offset:42272
    v_mfma_f32_16x16x32_bf16 v[212:215], a[220:223], v[44:47], v[212:215]
    s_add_u32 m0, s33, 136256
    v_mfma_f32_16x16x32_bf16 v[212:215], a[224:227], v[56:59], v[212:215]
    s_waitcnt lgkmcnt(4)
    ds_read_b64_tr_b16 a[248:249], v245 offset:33856
    v_mfma_f32_16x16x32_bf16 v[212:215], a[228:231], v[68:71], v[212:215]
    ds_read_b64_tr_b16 a[250:251], v245 offset:42304
    v_mfma_f32_16x16x32_bf16 v[212:215], a[232:235], v[80:83], v[212:215]
    v_mfma_f32_16x16x32_bf16 v[212:215], a[236:239], v[92:95], v[212:215]
    ds_read_b64_tr_b16 a[252:253], v245 offset:33888
    v_mfma_f32_16x16x32_bf16 v[208:211], a[236:239], v[88:91], v[208:211]
    ds_read_b64_tr_b16 a[254:255], v245 offset:42336
    v_mfma_f32_16x16x32_bf16 v[208:211], a[232:235], v[76:79], v[208:211]
    buffer_load_dwordx4 v240, s[20:23], s51 offen offset:1024 nt lds
    v_mfma_f32_16x16x32_bf16 v[208:211], a[228:231], v[64:67], v[208:211]
    ds_read_b64_tr_b16 a[208:209], v245 offset:33920
    v_mfma_f32_16x16x32_bf16 v[208:211], a[224:227], v[52:55], v[208:211]
    ds_read_b64_tr_b16 a[210:211], v245 offset:42368
    v_mfma_f32_16x16x32_bf16 v[204:207], a[224:227], v[48:51], v[204:207]
    v_exp_f32 v124, v212
    v_cvt_pk_bf16_f32 v109, v122, v123
    v_exp_f32 v125, v213
    v_exp_f32 v126, v214
    v_cvt_pk_bf16_f32 v118, v124, v125
    v_exp_f32 v127, v215
    v_mfma_f32_16x16x32_bf16 v[204:207], a[228:231], v[60:63], v[204:207]
    ds_read_b64_tr_b16 a[212:213], v245 offset:33952
    v_mfma_f32_16x16x32_bf16 v[204:207], a[232:235], v[72:75], v[204:207]
    s_waitcnt lgkmcnt(9)
    ds_read_b64_tr_b16 a[214:215], v245 offset:42400
    v_mfma_f32_16x16x32_bf16 v[204:207], a[236:239], v[84:87], v[204:207]
    v_mfma_f32_16x16x32_bf16 v[144:147], a[240:243], v[96:99], v[144:147]
    ds_read_b64_tr_b16 a[216:217], v245 offset:33984
    v_exp_f32 v120, v208
    v_cvt_pk_bf16_f32 v119, v126, v127
    v_exp_f32 v121, v209
    v_exp_f32 v122, v210
    v_cvt_pk_bf16_f32 v114, v120, v121
    v_exp_f32 v123, v211
    v_mfma_f32_16x16x32_bf16 v[148:151], a[240:243], v[100:103], v[148:151]
    s_waitcnt lgkmcnt(9)
    ds_read_b64_tr_b16 a[218:219], v245 offset:42432
    v_mfma_f32_16x16x32_bf16 v[152:155], a[240:243], v[104:107], v[152:155]
    v_mfma_f32_16x16x32_bf16 v[164:167], a[244:247], v[104:107], v[164:167]
    ds_read_b64_tr_b16 a[220:221], v245 offset:34016
    v_mfma_f32_16x16x32_bf16 v[160:163], a[244:247], v[100:103], v[160:163]
    s_waitcnt lgkmcnt(9)
    ds_read_b64_tr_b16 a[222:223], v245 offset:42464
    v_exp_f32 v124, v204
    v_cvt_pk_bf16_f32 v115, v122, v123
    v_exp_f32 v125, v205
    v_exp_f32 v126, v206
    v_cvt_pk_bf16_f32 v110, v124, v125
    v_exp_f32 v127, v207
    v_mfma_f32_16x16x32_bf16 v[156:159], a[244:247], v[96:99], v[156:159]
    v_mfma_f32_16x16x32_bf16 v[168:171], a[248:251], v[96:99], v[168:171]
    ds_read_b64_tr_b16 a[224:225], v245 offset:34048
    v_mfma_f32_16x16x32_bf16 v[172:175], a[248:251], v[100:103], v[172:175]
    s_waitcnt lgkmcnt(9)
    ds_read_b64_tr_b16 a[226:227], v245 offset:42496
    v_mfma_f32_16x16x32_bf16 v[176:179], a[248:251], v[104:107], v[176:179]
    v_mfma_f32_16x16x32_bf16 v[188:191], a[252:255], v[104:107], v[188:191]
    ds_read_b64_tr_b16 a[228:229], v245 offset:34080
    v_mfma_f32_16x16x32_bf16 v[184:187], a[252:255], v[100:103], v[184:187]
    s_waitcnt lgkmcnt(9)
    ds_read_b64_tr_b16 a[230:231], v245 offset:42528
    v_mfma_f32_16x16x32_bf16 v[180:183], a[252:255], v[96:99], v[180:183]
    v_mfma_f32_16x16x32_bf16 a[48:51], a[208:211], v[96:99], a[48:51]
    ds_read_b64_tr_b16 a[232:233], v245 offset:34112
    v_mfma_f32_16x16x32_bf16 a[52:55], a[208:211], v[100:103], a[52:55]
    s_waitcnt lgkmcnt(9)
    ds_read_b64_tr_b16 a[234:235], v245 offset:42560
    v_mfma_f32_16x16x32_bf16 a[56:59], a[208:211], v[104:107], a[56:59]
    v_mfma_f32_16x16x32_bf16 a[68:71], a[212:215], v[104:107], a[68:71]
    ds_read_b64_tr_b16 a[236:237], v245 offset:34144
    v_mfma_f32_16x16x32_bf16 a[64:67], a[212:215], v[100:103], a[64:67]
    s_waitcnt lgkmcnt(9)
    ds_read_b64_tr_b16 a[238:239], v245 offset:42592
    v_mfma_f32_16x16x32_bf16 a[60:63], a[212:215], v[96:99], a[60:63]
    v_mfma_f32_16x16x32_bf16 a[72:75], a[216:219], v[96:99], a[72:75]
    ds_read_b64_tr_b16 a[240:241], v245 offset:34176
    v_mfma_f32_16x16x32_bf16 a[76:79], a[216:219], v[100:103], a[76:79]
    s_waitcnt lgkmcnt(9)
    ds_read_b64_tr_b16 a[242:243], v245 offset:42624
    v_mfma_f32_16x16x32_bf16 a[80:83], a[216:219], v[104:107], a[80:83]
    v_mfma_f32_16x16x32_bf16 a[92:95], a[220:223], v[104:107], a[92:95]
    ds_read_b64_tr_b16 a[244:245], v245 offset:34208
    v_mfma_f32_16x16x32_bf16 a[88:91], a[220:223], v[100:103], a[88:91]
    s_waitcnt lgkmcnt(9)
    ds_read_b64_tr_b16 a[246:247], v245 offset:42656
    v_mfma_f32_16x16x32_bf16 a[84:87], a[220:223], v[96:99], a[84:87]
    v_mfma_f32_16x16x32_bf16 a[96:99], a[224:227], v[96:99], a[96:99]
    ds_read_b64_tr_b16 a[248:249], v245 offset:34240
    v_mfma_f32_16x16x32_bf16 a[100:103], a[224:227], v[100:103], a[100:103]
    s_waitcnt lgkmcnt(9)
    ds_read_b64_tr_b16 a[250:251], v245 offset:42688
    v_mfma_f32_16x16x32_bf16 a[104:107], a[224:227], v[104:107], a[104:107]
    v_mfma_f32_16x16x32_bf16 a[116:119], a[228:231], v[104:107], a[116:119]
    s_waitcnt lgkmcnt(8)
    ds_read_b64_tr_b16 a[252:253], v245 offset:34272
    v_mfma_f32_16x16x32_bf16 a[112:115], a[228:231], v[100:103], a[112:115]
    s_waitcnt vmcnt(7)
    ds_read_b64_tr_b16 a[254:255], v245 offset:42720
    s_add_u32 m0, s33, 136800
    v_mfma_f32_16x16x32_bf16 a[108:111], a[228:231], v[96:99], a[108:111]
    v_mfma_f32_16x16x32_bf16 a[120:123], a[232:235], v[96:99], a[120:123]
    s_barrier
    ds_read_b128 a[208:211], v243 offset:0
    v_mfma_f32_16x16x32_bf16 a[124:127], a[232:235], v[100:103], a[124:127]
    v_mfma_f32_16x16x32_bf16 a[128:131], a[232:235], v[104:107], a[128:131]
    s_waitcnt lgkmcnt(9)
    v_cvt_pk_bf16_f32 v111, v126, v127
    v_mfma_f32_16x16x32_bf16 a[140:143], a[236:239], v[104:107], a[140:143]
    s_waitcnt lgkmcnt(7)
    ds_read_b128 a[212:215], v243 offset:64
    v_mfma_f32_16x16x32_bf16 a[136:139], a[236:239], v[100:103], a[136:139]
    buffer_load_dwordx4 v240, s[20:23], s51 offen offset:1536 nt lds
    v_mfma_f32_16x16x32_bf16 a[132:135], a[236:239], v[96:99], a[132:135]
    s_xor_b32 s51, s95, 147456
    s_add_u32 m0, s33, 16896
    v_mfma_f32_16x16x32_bf16 a[144:147], a[240:243], v[96:99], a[144:147]
    ds_read_b128 a[216:219], v243 offset:128
    v_mfma_f32_16x16x32_bf16 a[148:151], a[240:243], v[100:103], a[148:151]
    buffer_load_dwordx4 v240, s[16:19], s51 offen nt lds
    v_mfma_f32_16x16x32_bf16 a[152:155], a[240:243], v[104:107], a[152:155]
    s_add_u32 m0, s33, 17440
    v_mfma_f32_16x16x32_bf16 v[132:135], a[192:195], v[108:111], v[128:131]
    v_mfma_f32_16x16x32_bf16 v[132:135], a[196:199], v[112:115], v[132:135]
    v_mfma_f32_16x16x32_bf16 v[132:135], a[200:203], v[116:119], v[132:135]
    s_waitcnt lgkmcnt(7)
    v_mfma_f32_16x16x32_bf16 a[164:167], a[244:247], v[104:107], a[164:167]
    s_waitcnt lgkmcnt(5)
    ds_read_b128 a[220:223], v243 offset:192
    v_mfma_f32_16x16x32_bf16 a[160:163], a[244:247], v[100:103], a[160:163]
    buffer_load_dwordx4 v240, s[16:19], s51 offen offset:512 nt lds
    v_mfma_f32_16x16x32_bf16 a[156:159], a[244:247], v[96:99], a[156:159]
    v_mfma_f32_16x16x32_bf16 a[168:171], a[248:251], v[96:99], a[168:171]
    s_waitcnt lgkmcnt(4)
    ds_read_b128 a[224:227], v243 offset:256
    v_mfma_f32_16x16x32_bf16 a[172:175], a[248:251], v[100:103], a[172:175]
    v_max3_f32 v136, v132, v133, v134
    v_cmp_nge_f32 vcc, s53, v136
    v_mfma_f32_16x16x32_bf16 a[176:179], a[248:251], v[104:107], a[176:179]
    v_mfma_f32_16x16x32_bf16 a[188:191], a[252:255], v[104:107], a[188:191]
    s_waitcnt lgkmcnt(4)
    ds_read_b128 a[228:231], v243 offset:320
    v_mfma_f32_16x16x32_bf16 a[184:187], a[252:255], v[100:103], a[184:187]
    v_mfma_f32_16x16x32_bf16 a[180:183], a[252:255], v[96:99], a[180:183]
    s_cbranch_vccnz L_stub9
L_back9:
    s_add_u32 m0, s33, 17984
    v_mfma_f32_16x16x32_bf16 v[192:195], a[208:211], v[0:3], v[216:219]
    s_waitcnt lgkmcnt(2)
    ds_read_b128 a[232:235], v243 offset:384
    v_mfma_f32_16x16x32_bf16 v[192:195], a[212:215], v[12:15], v[192:195]
    v_mfma_f32_16x16x32_bf16 v[192:195], a[216:219], v[24:27], v[192:195]
    v_mfma_f32_16x16x32_bf16 v[192:195], a[220:223], v[36:39], v[192:195]
    ds_read_b128 a[236:239], v243 offset:448
    v_mfma_f32_16x16x32_bf16 v[196:199], a[220:223], v[40:43], v[220:223]
    v_mfma_f32_16x16x32_bf16 v[196:199], a[216:219], v[28:31], v[196:199]
    buffer_load_dwordx4 v240, s[16:19], s51 offen offset:1024 nt lds
    v_mfma_f32_16x16x32_bf16 v[196:199], a[212:215], v[16:19], v[196:199]
    ds_read_b128 a[240:243], v243 offset:8448
    v_mfma_f32_16x16x32_bf16 v[196:199], a[208:211], v[4:7], v[196:199]
    v_mfma_f32_16x16x32_bf16 v[200:203], a[208:211], v[8:11], v[224:227]
    v_mfma_f32_16x16x32_bf16 v[200:203], a[212:215], v[20:23], v[200:203]
    s_waitcnt lgkmcnt(4)
    ds_read_b128 a[244:247], v243 offset:8512
    v_mfma_f32_16x16x32_bf16 v[200:203], a[216:219], v[32:35], v[200:203]
    v_mfma_f32_16x16x32_bf16 v[200:203], a[220:223], v[44:47], v[200:203]
    v_mfma_f32_16x16x32_bf16 v[200:203], a[224:227], v[56:59], v[200:203]
    s_waitcnt lgkmcnt(2)
    ds_read_b128 a[248:251], v243 offset:8576
    v_mfma_f32_16x16x32_bf16 v[200:203], a[228:231], v[68:71], v[200:203]
    v_mfma_f32_16x16x32_bf16 v[200:203], a[232:235], v[80:83], v[200:203]
    s_add_u32 m0, s33, 18528
    v_mfma_f32_16x16x32_bf16 v[200:203], a[236:239], v[92:95], v[200:203]
    ds_read_b128 a[252:255], v243 offset:8640
    v_mfma_f32_16x16x32_bf16 v[196:199], a[236:239], v[88:91], v[196:199]
    v_mfma_f32_16x16x32_bf16 v[196:199], a[232:235], v[76:79], v[196:199]
    v_mfma_f32_16x16x32_bf16 v[196:199], a[228:231], v[64:67], v[196:199]
    ds_read_b128 a[208:211], v243 offset:8704
    v_mfma_f32_16x16x32_bf16 v[196:199], a[224:227], v[52:55], v[196:199]
    v_mfma_f32_16x16x32_bf16 v[192:195], a[224:227], v[48:51], v[192:195]
    buffer_load_dwordx4 v240, s[16:19], s51 offen offset:1536 nt lds
    v_exp_f32 v120, v200
    v_exp_f32 v121, v201
    v_exp_f32 v122, v202
    v_cvt_pk_bf16_f32 v104, v120, v121
    v_exp_f32 v123, v203
    v_mfma_f32_16x16x32_bf16 v[192:195], a[228:231], v[60:63], v[192:195]
    s_waitcnt lgkmcnt(4)
    ds_read_b128 a[212:215], v243 offset:8768
    v_mfma_f32_16x16x32_bf16 v[192:195], a[232:235], v[72:75], v[192:195]
    v_mfma_f32_16x16x32_bf16 v[192:195], a[236:239], v[84:87], v[192:195]
    v_mfma_f32_16x16x32_bf16 v[204:207], a[240:243], v[0:3], v[216:219]
    s_waitcnt lgkmcnt(2)
    ds_read_b128 a[216:219], v243 offset:8832
    v_exp_f32 v124, v196
    v_cvt_pk_bf16_f32 v105, v122, v123
    v_exp_f32 v125, v197
    v_exp_f32 v126, v198
    v_cvt_pk_bf16_f32 v100, v124, v125
    v_exp_f32 v127, v199
    v_mfma_f32_16x16x32_bf16 v[204:207], a[244:247], v[12:15], v[204:207]
    v_mfma_f32_16x16x32_bf16 v[204:207], a[248:251], v[24:27], v[204:207]
    v_mfma_f32_16x16x32_bf16 v[204:207], a[252:255], v[36:39], v[204:207]
    ds_read_b128 a[220:223], v243 offset:8896
    v_mfma_f32_16x16x32_bf16 v[208:211], a[252:255], v[40:43], v[220:223]
    v_exp_f32 v120, v192
    v_cvt_pk_bf16_f32 v101, v126, v127
    v_exp_f32 v121, v193
    v_exp_f32 v122, v194
    v_cvt_pk_bf16_f32 v96, v120, v121
    v_exp_f32 v123, v195
    v_mfma_f32_16x16x32_bf16 v[208:211], a[248:251], v[28:31], v[208:211]
    v_mfma_f32_16x16x32_bf16 v[208:211], a[244:247], v[16:19], v[208:211]
    ds_read_b64_tr_b16 a[224:225], v246 offset:16896
    v_mfma_f32_16x16x32_bf16 v[208:211], a[240:243], v[4:7], v[208:211]
    s_xor_b32 s51, s95, 137216
    ds_read_b64_tr_b16 a[226:227], v246 offset:25344
    s_add_u32 m0, s33, 67584
    v_mfma_f32_16x16x32_bf16 v[212:215], a[240:243], v[8:11], v[224:227]
    v_mfma_f32_16x16x32_bf16 v[212:215], a[244:247], v[20:23], v[212:215]
    ds_read_b64_tr_b16 a[228:229], v246 offset:16928
    v_mfma_f32_16x16x32_bf16 v[212:215], a[248:251], v[32:35], v[212:215]
    s_waitcnt lgkmcnt(6)
    ds_read_b64_tr_b16 a[230:231], v246 offset:25376
    v_mfma_f32_16x16x32_bf16 v[212:215], a[252:255], v[44:47], v[212:215]
    v_mfma_f32_16x16x32_bf16 v[212:215], a[208:211], v[56:59], v[212:215]
    s_waitcnt lgkmcnt(4)
    ds_read_b64_tr_b16 a[232:233], v246 offset:16960
    v_mfma_f32_16x16x32_bf16 v[212:215], a[212:215], v[68:71], v[212:215]
    ds_read_b64_tr_b16 a[234:235], v246 offset:25408
    buffer_load_dwordx4 v240, s[20:23], s51 offen nt lds
    v_mfma_f32_16x16x32_bf16 v[212:215], a[216:219], v[80:83], v[212:215]
    v_mfma_f32_16x16x32_bf16 v[212:215], a[220:223], v[92:95], v[212:215]
    ds_read_b64_tr_b16 a[236:237], v246 offset:16992
    v_mfma_f32_16x16x32_bf16 v[208:211], a[220:223], v[88:91], v[208:211]
    ds_read_b64_tr_b16 a[238:239], v246 offset:25440
    v_mfma_f32_16x16x32_bf16 v[208:211], a[216:219], v[76:79], v[208:211]
    v_mfma_f32_16x16x32_bf16 v[208:211], a[212:215], v[64:67], v[208:211]
    ds_read_b64_tr_b16 a[240:241], v246 offset:17024
    v_mfma_f32_16x16x32_bf16 v[208:211], a[208:211], v[52:55], v[208:211]
    ds_read_b64_tr_b16 a[242:243], v246 offset:25472
    v_mfma_f32_16x16x32_bf16 v[204:207], a[208:211], v[48:51], v[204:207]
    v_exp_f32 v124, v212
    v_cvt_pk_bf16_f32 v97, v122, v123
    v_exp_f32 v125, v213
    v_exp_f32 v126, v214
    v_cvt_pk_bf16_f32 v106, v124, v125
    v_exp_f32 v127, v215
    v_mfma_f32_16x16x32_bf16 v[204:207], a[212:215], v[60:63], v[204:207]
    ds_read_b64_tr_b16 a[244:245], v246 offset:17056
    v_mfma_f32_16x16x32_bf16 v[204:207], a[216:219], v[72:75], v[204:207]
    s_waitcnt lgkmcnt(9)
    ds_read_b64_tr_b16 a[246:247], v246 offset:25504
    v_mfma_f32_16x16x32_bf16 v[204:207], a[220:223], v[84:87], v[204:207]
    v_mfma_f32_16x16x32_bf16 v[144:147], a[224:227], v[108:111], v[144:147]
    ds_read_b64_tr_b16 a[248:249], v246 offset:17088
    v_exp_f32 v120, v208
    v_cvt_pk_bf16_f32 v107, v126, v127
    v_exp_f32 v121, v209
    v_exp_f32 v122, v210
    v_cvt_pk_bf16_f32 v102, v120, v121
    v_exp_f32 v123, v211
    v_mfma_f32_16x16x32_bf16 v[148:151], a[224:227], v[112:115], v[148:151]
    s_waitcnt lgkmcnt(9)
    ds_read_b64_tr_b16 a[250:251], v246 offset:25536
    v_mfma_f32_16x16x32_bf16 v[152:155], a[224:227], v[116:119], v[152:155]
    v_mfma_f32_16x16x32_bf16 v[164:167], a[228:231], v[116:119], v[164:167]
    ds_read_b64_tr_b16 a[252:253], v246 offset:17120
    v_mfma_f32_16x16x32_bf16 v[160:163], a[228:231], v[112:115], v[160:163]
    s_waitcnt lgkmcnt(9)
    ds_read_b64_tr_b16 a[254:255], v246 offset:25568
    v_exp_f32 v124, v204
    v_cvt_pk_bf16_f32 v103, v122, v123
    v_exp_f32 v125, v205
    v_exp_f32 v126, v206
    v_cvt_pk_bf16_f32 v98, v124, v125
    v_exp_f32 v127, v207
    v_mfma_f32_16x16x32_bf16 v[156:159], a[228:231], v[108:111], v[156:159]
    v_mfma_f32_16x16x32_bf16 v[168:171], a[232:235], v[108:111], v[168:171]
    ds_read_b64_tr_b16 a[208:209], v246 offset:17152
    v_mfma_f32_16x16x32_bf16 v[172:175], a[232:235], v[112:115], v[172:175]
    s_waitcnt lgkmcnt(9)
    ds_read_b64_tr_b16 a[210:211], v246 offset:25600
    v_mfma_f32_16x16x32_bf16 v[176:179], a[232:235], v[116:119], v[176:179]
    v_mfma_f32_16x16x32_bf16 v[188:191], a[236:239], v[116:119], v[188:191]
    ds_read_b64_tr_b16 a[212:213], v246 offset:17184
    v_mfma_f32_16x16x32_bf16 v[184:187], a[236:239], v[112:115], v[184:187]
    s_waitcnt lgkmcnt(9)
    ds_read_b64_tr_b16 a[214:215], v246 offset:25632
    v_mfma_f32_16x16x32_bf16 v[180:183], a[236:239], v[108:111], v[180:183]
    v_mfma_f32_16x16x32_bf16 a[48:51], a[240:243], v[108:111], a[48:51]
    ds_read_b64_tr_b16 a[216:217], v246 offset:17216
    v_mfma_f32_16x16x32_bf16 a[52:55], a[240:243], v[112:115], a[52:55]
    s_waitcnt lgkmcnt(9)
    ds_read_b64_tr_b16 a[218:219], v246 offset:25664
    v_mfma_f32_16x16x32_bf16 a[56:59], a[240:243], v[116:119], a[56:59]
    v_mfma_f32_16x16x32_bf16 a[68:71], a[244:247], v[116:119], a[68:71]
    ds_read_b64_tr_b16 a[220:221], v246 offset:17248
    v_mfma_f32_16x16x32_bf16 a[64:67], a[244:247], v[112:115], a[64:67]
    s_waitcnt lgkmcnt(9)
    ds_read_b64_tr_b16 a[222:223], v246 offset:25696
    v_mfma_f32_16x16x32_bf16 a[60:63], a[244:247], v[108:111], a[60:63]
    v_mfma_f32_16x16x32_bf16 a[72:75], a[248:251], v[108:111], a[72:75]
    ds_read_b64_tr_b16 a[224:225], v246 offset:17280
    v_mfma_f32_16x16x32_bf16 a[76:79], a[248:251], v[112:115], a[76:79]
    s_waitcnt lgkmcnt(9)
    ds_read_b64_tr_b16 a[226:227], v246 offset:25728
    v_mfma_f32_16x16x32_bf16 a[80:83], a[248:251], v[116:119], a[80:83]
    v_mfma_f32_16x16x32_bf16 a[92:95], a[252:255], v[116:119], a[92:95]
    ds_read_b64_tr_b16 a[228:229], v246 offset:17312
    v_mfma_f32_16x16x32_bf16 a[88:91], a[252:255], v[112:115], a[88:91]
    s_waitcnt lgkmcnt(9)
    ds_read_b64_tr_b16 a[230:231], v246 offset:25760
    v_mfma_f32_16x16x32_bf16 a[84:87], a[252:255], v[108:111], a[84:87]
    v_mfma_f32_16x16x32_bf16 a[96:99], a[208:211], v[108:111], a[96:99]
    ds_read_b64_tr_b16 a[232:233], v246 offset:17344
    v_mfma_f32_16x16x32_bf16 a[100:103], a[208:211], v[112:115], a[100:103]
    s_waitcnt lgkmcnt(9)
    ds_read_b64_tr_b16 a[234:235], v246 offset:25792
    v_mfma_f32_16x16x32_bf16 a[104:107], a[208:211], v[116:119], a[104:107]
    v_mfma_f32_16x16x32_bf16 a[116:119], a[212:215], v[116:119], a[116:119]
    s_waitcnt lgkmcnt(8)
    ds_read_b64_tr_b16 a[236:237], v246 offset:17376
    v_mfma_f32_16x16x32_bf16 a[112:115], a[212:215], v[112:115], a[112:115]
    s_waitcnt vmcnt(5)
    ds_read_b64_tr_b16 a[238:239], v246 offset:25824
    s_add_u32 m0, s33, 68128
    v_mfma_f32_16x16x32_bf16 a[108:111], a[212:215], v[108:111], a[108:111]
    v_mfma_f32_16x16x32_bf16 a[120:123], a[216:219], v[108:111], a[120:123]
    s_barrier
    ds_read_b128 a[240:243], v241 offset:0
    v_mfma_f32_16x16x32_bf16 a[124:127], a[216:219], v[112:115], a[124:127]
    v_mfma_f32_16x16x32_bf16 a[128:131], a[216:219], v[116:119], a[128:131]
    s_waitcnt lgkmcnt(9)
    v_cvt_pk_bf16_f32 v99, v126, v127
    v_mfma_f32_16x16x32_bf16 a[140:143], a[220:223], v[116:119], a[140:143]
    s_waitcnt lgkmcnt(7)
    ds_read_b128 a[244:247], v241 offset:64
    v_mfma_f32_16x16x32_bf16 a[136:139], a[220:223], v[112:115], a[136:139]
    buffer_load_dwordx4 v240, s[20:23], s51 offen offset:512 nt lds
    v_mfma_f32_16x16x32_bf16 a[132:135], a[220:223], v[108:111], a[132:135]
    s_add_u32 m0, s33, 68672
    v_mfma_f32_16x16x32_bf16 a[144:147], a[224:227], v[108:111], a[144:147]
    ds_read_b128 a[248:251], v241 offset:128
    v_mfma_f32_16x16x32_bf16 a[148:151], a[224:227], v[112:115], a[148:151]
    buffer_load_dwordx4 v240, s[20:23], s51 offen offset:1024 nt lds
    v_mfma_f32_16x16x32_bf16 a[152:155], a[224:227], v[116:119], a[152:155]
    s_add_u32 m0, s33, 69216
    v_mfma_f32_16x16x32_bf16 v[128:131], a[192:195], v[96:99], v[132:135]
    v_mfma_f32_16x16x32_bf16 v[128:131], a[196:199], v[100:103], v[128:131]
    buffer_load_dwordx4 v240, s[20:23], s51 offen offset:1536 nt lds
    v_mfma_f32_16x16x32_bf16 v[128:131], a[200:203], v[104:107], v[128:131]
    s_waitcnt lgkmcnt(7)
    v_mfma_f32_16x16x32_bf16 a[164:167], a[228:231], v[116:119], a[164:167]
    s_waitcnt lgkmcnt(5)
    ds_read_b128 a[252:255], v241 offset:192
    v_mfma_f32_16x16x32_bf16 a[160:163], a[228:231], v[112:115], a[160:163]
    v_mfma_f32_16x16x32_bf16 a[156:159], a[228:231], v[108:111], a[156:159]
    v_mfma_f32_16x16x32_bf16 a[168:171], a[232:235], v[108:111], a[168:171]
    s_waitcnt lgkmcnt(4)
    ds_read_b128 a[208:211], v241 offset:256
    v_mfma_f32_16x16x32_bf16 a[172:175], a[232:235], v[112:115], a[172:175]
    s_waitcnt vmcnt(8)
    v_max3_f32 v136, v128, v129, v130
    v_cmp_nge_f32 vcc, s53, v136
    v_mfma_f32_16x16x32_bf16 a[176:179], a[232:235], v[116:119], a[176:179]
    s_add_u32 s50, s33, 33792
    v_add_u32 v143, s50, v251
    v_mfma_f32_16x16x32_bf16 a[188:191], a[236:239], v[116:119], a[188:191]
    s_waitcnt lgkmcnt(4)
    ds_read_b128 a[212:215], v241 offset:320
L_pad7:
    s_cbranch_execz L_pad11
    v_mfma_f32_16x16x32_bf16 a[184:187], a[236:239], v[112:115], a[184:187]
    v_mfma_f32_16x16x32_bf16 a[180:183], a[236:239], v[108:111], a[180:183]
    s_cbranch_vccnz L_stub10
L_back10:
    v_mfma_f32_16x16x32_bf16 v[192:195], a[240:243], v[0:3], v[216:219]
    s_waitcnt lgkmcnt(2)
    ds_read_b128 a[216:219], v241 offset:384
    v_mfma_f32_16x16x32_bf16 v[192:195], a[244:247], v[12:15], v[192:195]
    ds_write_b128 v143, a[0:3] offset:0
    v_mfma_f32_16x16x32_bf16 v[192:195], a[248:251], v[24:27], v[192:195]
    s_xor_b32 s51, s95, 147456
    s_add_u32 m0, s33, 50688
    v_mfma_f32_16x16x32_bf16 v[192:195], a[252:255], v[36:39], v[192:195]
    ds_read_b128 a[220:223], v241 offset:448
    v_mfma_f32_16x16x32_bf16 v[196:199], a[252:255], v[40:43], v[220:223]
    buffer_load_dwordx4 v240, s[20:23], s51 offen nt lds
    v_mfma_f32_16x16x32_bf16 v[196:199], a[248:251], v[28:31], v[196:199]
    v_mfma_f32_16x16x32_bf16 v[196:199], a[244:247], v[16:19], v[196:199]
    ds_read_b128 a[224:227], v241 offset:8448
    v_mfma_f32_16x16x32_bf16 v[196:199], a[240:243], v[4:7], v[196:199]
    ds_write_b128 v143, a[4:7] offset:1056
    v_mfma_f32_16x16x32_bf16 v[200:203], a[240:243], v[8:11], v[224:227]
    v_mfma_f32_16x16x32_bf16 v[200:203], a[244:247], v[20:23], v[200:203]
    s_waitcnt lgkmcnt(6)
    ds_read_b128 a[228:231], v241 offset:8512
    v_mfma_f32_16x16x32_bf16 v[200:203], a[248:251], v[32:35], v[200:203]
    v_mfma_f32_16x16x32_bf16 v[200:203], a[252:255], v[44:47], v[200:203]
    v_mfma_f32_16x16x32_bf16 v[200:203], a[208:211], v[56:59], v[200:203]
    s_waitcnt lgkmcnt(3)
    ds_read_b128 a[232:235], v241 offset:8576
    v_mfma_f32_16x16x32_bf16 v[200:203], a[212:215], v[68:71], v[200:203]
    ds_write_b128 v143, a[8:11] offset:2112
    v_mfma_f32_16x16x32_bf16 v[200:203], a[216:219], v[80:83], v[200:203]
    s_add_u32 m0, s33, 51232
    v_mfma_f32_16x16x32_bf16 v[200:203], a[220:223], v[92:95], v[200:203]
    ds_read_b128 a[236:239], v241 offset:8640
    v_mfma_f32_16x16x32_bf16 v[196:199], a[220:223], v[88:91], v[196:199]
    buffer_load_dwordx4 v240, s[20:23], s51 offen offset:512 nt lds
    v_mfma_f32_16x16x32_bf16 v[196:199], a[216:219], v[76:79], v[196:199]
    v_mfma_f32_16x16x32_bf16 v[196:199], a[212:215], v[64:67], v[196:199]
    ds_read_b128 a[240:243], v241 offset:8704
    v_mfma_f32_16x16x32_bf16 v[196:199], a[208:211], v[52:55], v[196:199]
    ds_write_b128 v143, a[12:15] offset:3168
    v_mfma_f32_16x16x32_bf16 v[192:195], a[208:211], v[48:51], v[192:195]
    v_exp_f32 v120, v200
    v_exp_f32 v121, v201
    v_exp_f32 v122, v202
    v_cvt_pk_bf16_f32 v116, v120, v121
    v_exp_f32 v123, v203
    v_mfma_f32_16x16x32_bf16 v[192:195], a[212:215], v[60:63], v[192:195]
    s_waitcnt lgkmcnt(7)
    ds_read_b128 a[244:247], v241 offset:8768
    v_mfma_f32_16x16x32_bf16 v[192:195], a[216:219], v[72:75], v[192:195]
    v_mfma_f32_16x16x32_bf16 v[192:195], a[220:223], v[84:87], v[192:195]
    v_mfma_f32_16x16x32_bf16 v[204:207], a[224:227], v[0:3], v[216:219]
    s_waitcnt lgkmcnt(3)
    ds_read_b128 a[248:251], v241 offset:8832
    v_exp_f32 v124, v196
    v_cvt_pk_bf16_f32 v117, v122, v123
    v_exp_f32 v125, v197
    v_exp_f32 v126, v198
    v_cvt_pk_bf16_f32 v112, v124, v125
    v_exp_f32 v127, v199
    v_mfma_f32_16x16x32_bf16 v[204:207], a[228:231], v[12:15], v[204:207]
    s_add_u32 m0, s33, 51776
    v_mfma_f32_16x16x32_bf16 v[204:207], a[232:235], v[24:27], v[204:207]
    v_mfma_f32_16x16x32_bf16 v[204:207], a[236:239], v[36:39], v[204:207]
    ds_read_b128 a[252:255], v241 offset:8896
    v_mfma_f32_16x16x32_bf16 v[208:211], a[236:239], v[40:43], v[220:223]
    v_exp_f32 v120, v192
    v_cvt_pk_bf16_f32 v113, v126, v127
    v_exp_f32 v121, v193
    v_exp_f32 v122, v194
    v_cvt_pk_bf16_f32 v108, v120, v121
    v_exp_f32 v123, v195
    v_mfma_f32_16x16x32_bf16 v[208:211], a[232:235], v[28:31], v[208:211]
    v_mfma_f32_16x16x32_bf16 v[208:211], a[228:231], v[16:19], v[208:211]
    ds_read_b64_tr_b16 a[208:209], v246 offset:33792
    v_mfma_f32_16x16x32_bf16 v[208:211], a[224:227], v[4:7], v[208:211]
    ds_read_b64_tr_b16 a[210:211], v246 offset:42240
    buffer_load_dwordx4 v240, s[20:23], s51 offen offset:1024 nt lds
    v_mfma_f32_16x16x32_bf16 v[212:215], a[224:227], v[8:11], v[224:227]
    v_mfma_f32_16x16x32_bf16 v[212:215], a[228:231], v[20:23], v[212:215]
    ds_read_b64_tr_b16 a[212:213], v246 offset:33824
    v_mfma_f32_16x16x32_bf16 v[212:215], a[232:235], v[32:35], v[212:215]
    s_waitcnt lgkmcnt(7)
    ds_read_b64_tr_b16 a[214:215], v246 offset:42272
    v_mfma_f32_16x16x32_bf16 v[212:215], a[236:239], v[44:47], v[212:215]
    v_mfma_f32_16x16x32_bf16 v[212:215], a[240:243], v[56:59], v[212:215]
    s_waitcnt lgkmcnt(4)
    ds_read_b64_tr_b16 a[216:217], v246 offset:33856
    v_mfma_f32_16x16x32_bf16 v[212:215], a[244:247], v[68:71], v[212:215]
    ds_read_b64_tr_b16 a[218:219], v246 offset:42304
    v_mfma_f32_16x16x32_bf16 v[212:215], a[248:251], v[80:83], v[212:215]
    v_mfma_f32_16x16x32_bf16 v[212:215], a[252:255], v[92:95], v[212:215]
    ds_read_b64_tr_b16 a[220:221], v246 offset:33888
    v_mfma_f32_16x16x32_bf16 v[208:211], a[252:255], v[88:91], v[208:211]
    ds_read_b64_tr_b16 a[222:223], v246 offset:42336
    v_mfma_f32_16x16x32_bf16 v[208:211], a[248:251], v[76:79], v[208:211]
    v_mfma_f32_16x16x32_bf16 v[208:211], a[244:247], v[64:67], v[208:211]
    ds_read_b64_tr_b16 a[224:225], v246 offset:33920
    v_mfma_f32_16x16x32_bf16 v[208:211], a[240:243], v[52:55], v[208:211]
    ds_read_b64_tr_b16 a[226:227], v246 offset:42368
    v_mfma_f32_16x16x32_bf16 v[204:207], a[240:243], v[48:51], v[204:207]
    v_exp_f32 v124, v212
    v_cvt_pk_bf16_f32 v109, v122, v123
    v_exp_f32 v125, v213
    v_exp_f32 v126, v214
    v_cvt_pk_bf16_f32 v118, v124, v125
    v_exp_f32 v127, v215
    v_mfma_f32_16x16x32_bf16 v[204:207], a[244:247], v[60:63], v[204:207]
    ds_read_b64_tr_b16 a[228:229], v246 offset:33952
    v_mfma_f32_16x16x32_bf16 v[204:207], a[248:251], v[72:75], v[204:207]
    s_waitcnt lgkmcnt(9)
    ds_read_b64_tr_b16 a[230:231], v246 offset:42400
    v_mfma_f32_16x16x32_bf16 v[204:207], a[252:255], v[84:87], v[204:207]
    v_mfma_f32_16x16x32_bf16 v[144:147], a[208:211], v[96:99], v[144:147]
    ds_read_b64_tr_b16 a[232:233], v246 offset:33984
    v_exp_f32 v120, v208
    v_cvt_pk_bf16_f32 v119, v126, v127
    v_exp_f32 v121, v209
    v_exp_f32 v122, v210
    v_cvt_pk_bf16_f32 v114, v120, v121
    v_exp_f32 v123, v211
    v_mfma_f32_16x16x32_bf16 v[148:151], a[208:211], v[100:103], v[148:151]
    s_waitcnt lgkmcnt(9)
    ds_read_b64_tr_b16 a[234:235], v246 offset:42432
    v_mfma_f32_16x16x32_bf16 v[152:155], a[208:211], v[104:107], v[152:155]
    v_mfma_f32_16x16x32_bf16 v[164:167], a[212:215], v[104:107], v[164:167]
    ds_read_b64_tr_b16 a[236:237], v246 offset:34016
    v_mfma_f32_16x16x32_bf16 v[160:163], a[212:215], v[100:103], v[160:163]
    s_waitcnt lgkmcnt(9)
    ds_read_b64_tr_b16 a[238:239], v246 offset:42464
    v_exp_f32 v124, v204
    v_cvt_pk_bf16_f32 v115, v122, v123
    v_exp_f32 v125, v205
    v_exp_f32 v126, v206
    v_cvt_pk_bf16_f32 v110, v124, v125
    v_exp_f32 v127, v207
    v_mfma_f32_16x16x32_bf16 v[156:159], a[212:215], v[96:99], v[156:159]
    v_mfma_f32_16x16x32_bf16 v[168:171], a[216:219], v[96:99], v[168:171]
    ds_read_b64_tr_b16 a[240:241], v246 offset:34048
    v_mfma_f32_16x16x32_bf16 v[172:175], a[216:219], v[100:103], v[172:175]
    s_waitcnt lgkmcnt(9)
    ds_read_b64_tr_b16 a[242:243], v246 offset:42496
    v_mfma_f32_16x16x32_bf16 v[176:179], a[216:219], v[104:107], v[176:179]
    v_mfma_f32_16x16x32_bf16 v[188:191], a[220:223], v[104:107], v[188:191]
    ds_read_b64_tr_b16 a[244:245], v246 offset:34080
    v_mfma_f32_16x16x32_bf16 v[184:187], a[220:223], v[100:103], v[184:187]
    s_waitcnt lgkmcnt(9)
    ds_read_b64_tr_b16 a[246:247], v246 offset:42528
    v_mfma_f32_16x16x32_bf16 v[180:183], a[220:223], v[96:99], v[180:183]
    v_mfma_f32_16x16x32_bf16 a[48:51], a[224:227], v[96:99], a[48:51]
    ds_read_b64_tr_b16 a[248:249], v246 offset:34112
    v_mfma_f32_16x16x32_bf16 a[52:55], a[224:227], v[100:103], a[52:55]
    s_waitcnt lgkmcnt(9)
    ds_read_b64_tr_b16 a[250:251], v246 offset:42560
    v_mfma_f32_16x16x32_bf16 a[56:59], a[224:227], v[104:107], a[56:59]
    v_mfma_f32_16x16x32_bf16 a[68:71], a[228:231], v[104:107], a[68:71]
    ds_read_b64_tr_b16 a[252:253], v246 offset:34144
    v_mfma_f32_16x16x32_bf16 a[64:67], a[228:231], v[100:103], a[64:67]
    s_waitcnt lgkmcnt(9)
    ds_read_b64_tr_b16 a[254:255], v246 offset:42592
    v_mfma_f32_16x16x32_bf16 a[60:63], a[228:231], v[96:99], a[60:63]
    v_mfma_f32_16x16x32_bf16 a[72:75], a[232:235], v[96:99], a[72:75]
    ds_read_b64_tr_b16 a[208:209], v246 offset:34176
    v_mfma_f32_16x16x32_bf16 a[76:79], a[232:235], v[100:103], a[76:79]
    s_waitcnt lgkmcnt(9)
    ds_read_b64_tr_b16 a[210:211], v246 offset:42624
    v_mfma_f32_16x16x32_bf16 a[80:83], a[232:235], v[104:107], a[80:83]
    v_mfma_f32_16x16x32_bf16 a[92:95], a[236:239], v[104:107], a[92:95]
    ds_read_b64_tr_b16 a[212:213], v246 offset:34208
    v_mfma_f32_16x16x32_bf16 a[88:91], a[236:239], v[100:103], a[88:91]
    s_waitcnt lgkmcnt(9)
    ds_read_b64_tr_b16 a[214:215], v246 offset:42656
    v_mfma_f32_16x16x32_bf16 a[84:87], a[236:239], v[96:99], a[84:87]
    v_mfma_f32_16x16x32_bf16 a[96:99], a[240:243], v[96:99], a[96:99]
    ds_read_b64_tr_b16 a[216:217], v246 offset:34240
    v_mfma_f32_16x16x32_bf16 a[100:103], a[240:243], v[100:103], a[100:103]
    s_waitcnt lgkmcnt(9)
    ds_read_b64_tr_b16 a[218:219], v246 offset:42688
    v_mfma_f32_16x16x32_bf16 a[104:107], a[240:243], v[104:107], a[104:107]
    v_mfma_f32_16x16x32_bf16 a[116:119], a[244:247], v[104:107], a[116:119]
    s_waitcnt lgkmcnt(8)
    ds_read_b64_tr_b16 a[220:221], v246 offset:34272
    v_mfma_f32_16x16x32_bf16 a[112:115], a[244:247], v[100:103], a[112:115]
    s_waitcnt vmcnt(3)
    ds_read_b64_tr_b16 a[222:223], v246 offset:42720
    s_add_u32 m0, s33, 52320
    v_mfma_f32_16x16x32_bf16 a[108:111], a[244:247], v[96:99], a[108:111]
    v_mfma_f32_16x16x32_bf16 a[120:123], a[248:251], v[96:99], a[120:123]
    s_barrier
    ds_read_b128 a[224:227], v241 offset:16896
    v_mfma_f32_16x16x32_bf16 a[124:127], a[248:251], v[100:103], a[124:127]
    v_mfma_f32_16x16x32_bf16 a[128:131], a[248:251], v[104:107], a[128:131]
    s_waitcnt lgkmcnt(9)
    v_cvt_pk_bf16_f32 v111, v126, v127
    v_mfma_f32_16x16x32_bf16 a[140:143], a[252:255], v[104:107], a[140:143]
    s_waitcnt lgkmcnt(7)
    ds_read_b128 a[228:231], v241 offset:16960
    v_mfma_f32_16x16x32_bf16 a[136:139], a[252:255], v[100:103], a[136:139]
    buffer_load_dwordx4 v240, s[20:23], s51 offen offset:1536 nt lds
    v_mfma_f32_16x16x32_bf16 a[132:135], a[252:255], v[96:99], a[132:135]
    s_xor_b32 s51, s95, 151552
    s_add_u32 m0, s33, 84480
    v_mfma_f32_16x16x32_bf16 a[144:147], a[208:211], v[96:99], a[144:147]
    ds_read_b128 a[232:235], v241 offset:17024
    v_mfma_f32_16x16x32_bf16 a[148:151], a[208:211], v[100:103], a[148:151]
    buffer_load_dwordx4 v240, s[16:19], s51 offen nt lds
    v_mfma_f32_16x16x32_bf16 a[152:155], a[208:211], v[104:107], a[152:155]
    s_add_u32 m0, s33, 85024
    v_mfma_f32_16x16x32_bf16 v[132:135], a[192:195], v[108:111], v[128:131]
    v_mfma_f32_16x16x32_bf16 v[132:135], a[196:199], v[112:115], v[132:135]
    buffer_load_dwordx4 v240, s[16:19], s51 offen offset:512 nt lds
    v_mfma_f32_16x16x32_bf16 v[132:135], a[200:203], v[116:119], v[132:135]
    s_waitcnt lgkmcnt(7)
    s_add_u32 m0, s33, 85568
    v_mfma_f32_16x16x32_bf16 a[164:167], a[212:215], v[104:107], a[164:167]
    s_waitcnt lgkmcnt(5)
    ds_read_b128 a[236:239], v241 offset:17088
    v_mfma_f32_16x16x32_bf16 a[160:163], a[212:215], v[100:103], a[160:163]
    v_mfma_f32_16x16x32_bf16 a[156:159], a[212:215], v[96:99], a[156:159]
    v_mfma_f32_16x16x32_bf16 a[168:171], a[216:219], v[96:99], a[168:171]
    s_waitcnt lgkmcnt(4)
    ds_read_b128 a[240:243], v241 offset:17152
    v_mfma_f32_16x16x32_bf16 a[172:175], a[216:219], v[100:103], a[172:175]
    v_max3_f32 v136, v132, v133, v134
    v_cmp_nge_f32 vcc, s53, v136
    v_mfma_f32_16x16x32_bf16 a[176:179], a[216:219], v[104:107], a[176:179]
    buffer_load_dwordx4 v240, s[16:19], s51 offen offset:1024 nt lds
    v_mfma_f32_16x16x32_bf16 a[188:191], a[220:223], v[104:107], a[188:191]
    s_waitcnt lgkmcnt(4)
    ds_read_b128 a[244:247], v241 offset:17216
    v_mfma_f32_16x16x32_bf16 a[184:187], a[220:223], v[100:103], a[184:187]
    v_mfma_f32_16x16x32_bf16 a[180:183], a[220:223], v[96:99], a[180:183]
    s_cbranch_vccnz L_stub11
L_back11:
    v_mfma_f32_16x16x32_bf16 v[192:195], a[224:227], v[0:3], v[216:219]
    s_waitcnt lgkmcnt(2)
    ds_read_b128 a[248:251], v241 offset:17280
    v_mfma_f32_16x16x32_bf16 v[192:195], a[228:231], v[12:15], v[192:195]
    v_mfma_f32_16x16x32_bf16 v[192:195], a[232:235], v[24:27], v[192:195]
    v_mfma_f32_16x16x32_bf16 v[192:195], a[236:239], v[36:39], v[192:195]
    ds_read_b128 a[252:255], v241 offset:17344
    v_mfma_f32_16x16x32_bf16 v[196:199], a[236:239], v[40:43], v[220:223]
    s_add_u32 m0, s33, 86112
    v_mfma_f32_16x16x32_bf16 v[196:199], a[232:235], v[28:31], v[196:199]
    v_mfma_f32_16x16x32_bf16 v[196:199], a[228:231], v[16:19], v[196:199]
    ds_read_b128 a[208:211], v241 offset:25344
    v_mfma_f32_16x16x32_bf16 v[196:199], a[224:227], v[4:7], v[196:199]
    v_mfma_f32_16x16x32_bf16 v[200:203], a[224:227], v[8:11], v[224:227]
    v_mfma_f32_16x16x32_bf16 v[200:203], a[228:231], v[20:23], v[200:203]
    s_waitcnt lgkmcnt(4)
    ds_read_b128 a[212:215], v241 offset:25408
    v_mfma_f32_16x16x32_bf16 v[200:203], a[232:235], v[32:35], v[200:203]
    buffer_load_dwordx4 v240, s[16:19], s51 offen offset:1536 nt lds
    v_mfma_f32_16x16x32_bf16 v[200:203], a[236:239], v[44:47], v[200:203]
    v_mfma_f32_16x16x32_bf16 v[200:203], a[240:243], v[56:59], v[200:203]
    s_waitcnt lgkmcnt(2)
    ds_read_b128 a[216:219], v241 offset:25472
    v_mfma_f32_16x16x32_bf16 v[200:203], a[244:247], v[68:71], v[200:203]
    v_mfma_f32_16x16x32_bf16 v[200:203], a[248:251], v[80:83], v[200:203]
    v_mfma_f32_16x16x32_bf16 v[200:203], a[252:255], v[92:95], v[200:203]
    ds_read_b128 a[220:223], v241 offset:25536
    v_mfma_f32_16x16x32_bf16 v[196:199], a[252:255], v[88:91], v[196:199]
    v_mfma_f32_16x16x32_bf16 v[196:199], a[248:251], v[76:79], v[196:199]
    v_mfma_f32_16x16x32_bf16 v[196:199], a[244:247], v[64:67], v[196:199]
    ds_read_b128 a[224:227], v241 offset:25600
    v_mfma_f32_16x16x32_bf16 v[196:199], a[240:243], v[52:55], v[196:199]
    v_mfma_f32_16x16x32_bf16 v[192:195], a[240:243], v[48:51], v[192:195]
    s_xor_b32 s51, s95, 149504
    v_exp_f32 v120, v200
    v_exp_f32 v121, v201
    v_exp_f32 v122, v202
    v_cvt_pk_bf16_f32 v104, v120, v121
    v_exp_f32 v123, v203
    v_mfma_f32_16x16x32_bf16 v[192:195], a[244:247], v[60:63], v[192:195]
    s_waitcnt lgkmcnt(4)
    ds_read_b128 a[228:231], v241 offset:25664
    s_add_u32 m0, s33, 101376
    v_mfma_f32_16x16x32_bf16 v[192:195], a[248:251], v[72:75], v[192:195]
    v_mfma_f32_16x16x32_bf16 v[192:195], a[252:255], v[84:87], v[192:195]
    v_mfma_f32_16x16x32_bf16 v[204:207], a[208:211], v[0:3], v[216:219]
    s_waitcnt lgkmcnt(2)
    ds_read_b128 a[232:235], v241 offset:25728
    v_exp_f32 v124, v196
    v_cvt_pk_bf16_f32 v105, v122, v123
    v_exp_f32 v125, v197
    v_exp_f32 v126, v198
    v_cvt_pk_bf16_f32 v100, v124, v125
    v_exp_f32 v127, v199
    v_mfma_f32_16x16x32_bf16 v[204:207], a[212:215], v[12:15], v[204:207]
    v_mfma_f32_16x16x32_bf16 v[204:207], a[216:219], v[24:27], v[204:207]
    buffer_load_dwordx4 v240, s[20:23], s51 offen nt lds
    v_mfma_f32_16x16x32_bf16 v[204:207], a[220:223], v[36:39], v[204:207]
    ds_read_b128 a[236:239], v241 offset:25792
    v_mfma_f32_16x16x32_bf16 v[208:211], a[220:223], v[40:43], v[220:223]
    v_exp_f32 v120, v192
    v_cvt_pk_bf16_f32 v101, v126, v127
    v_exp_f32 v121, v193
    v_exp_f32 v122, v194
    v_cvt_pk_bf16_f32 v96, v120, v121
    v_exp_f32 v123, v195
    v_mfma_f32_16x16x32_bf16 v[208:211], a[216:219], v[28:31], v[208:211]
    v_mfma_f32_16x16x32_bf16 v[208:211], a[212:215], v[16:19], v[208:211]
    ds_read_b64_tr_b16 a[240:241], v245 offset:16896
    v_mfma_f32_16x16x32_bf16 v[208:211], a[208:211], v[4:7], v[208:211]
    ds_read_b64_tr_b16 a[242:243], v245 offset:25344
    v_mfma_f32_16x16x32_bf16 v[212:215], a[208:211], v[8:11], v[224:227]
    v_mfma_f32_16x16x32_bf16 v[212:215], a[212:215], v[20:23], v[212:215]
    ds_read_b64_tr_b16 a[244:245], v245 offset:16928
    v_mfma_f32_16x16x32_bf16 v[212:215], a[216:219], v[32:35], v[212:215]
    s_waitcnt lgkmcnt(6)
    ds_read_b64_tr_b16 a[246:247], v245 offset:25376
    v_mfma_f32_16x16x32_bf16 v[212:215], a[220:223], v[44:47], v[212:215]
    s_add_u32 m0, s33, 101920
    v_mfma_f32_16x16x32_bf16 v[212:215], a[224:227], v[56:59], v[212:215]
    s_waitcnt lgkmcnt(4)
    ds_read_b64_tr_b16 a[248:249], v245 offset:16960
    v_mfma_f32_16x16x32_bf16 v[212:215], a[228:231], v[68:71], v[212:215]
    ds_read_b64_tr_b16 a[250:251], v245 offset:25408
    v_mfma_f32_16x16x32_bf16 v[212:215], a[232:235], v[80:83], v[212:215]
    v_mfma_f32_16x16x32_bf16 v[212:215], a[236:239], v[92:95], v[212:215]
    ds_read_b64_tr_b16 a[252:253], v245 offset:16992
    v_mfma_f32_16x16x32_bf16 v[208:211], a[236:239], v[88:91], v[208:211]
    ds_read_b64_tr_b16 a[254:255], v245 offset:25440
    v_mfma_f32_16x16x32_bf16 v[208:211], a[232:235], v[76:79], v[208:211]
    buffer_load_dwordx4 v240, s[20:23], s51 offen offset:512 nt lds
    v_mfma_f32_16x16x32_bf16 v[208:211], a[228:231], v[64:67], v[208:211]
    ds_read_b64_tr_b16 a[208:209], v245 offset:17024
    v_mfma_f32_16x16x32_bf16 v[208:211], a[224:227], v[52:55], v[208:211]
    ds_read_b64_tr_b16 a[210:211], v245 offset:25472
    v_mfma_f32_16x16x32_bf16 v[204:207], a[224:227], v[48:51], v[204:207]
    v_exp_f32 v124, v212
    v_cvt_pk_bf16_f32 v97, v122, v123
    v_exp_f32 v125, v213
    v_exp_f32 v126, v214
    v_cvt_pk_bf16_f32 v106, v124, v125
    v_exp_f32 v127, v215
    v_mfma_f32_16x16x32_bf16 v[204:207], a[228:231], v[60:63], v[204:207]
    ds_read_b64_tr_b16 a[212:213], v245 offset:17056
    v_mfma_f32_16x16x32_bf16 v[204:207], a[232:235], v[72:75], v[204:207]
    s_waitcnt lgkmcnt(9)
    ds_read_b64_tr_b16 a[214:215], v245 offset:25504
    v_mfma_f32_16x16x32_bf16 v[204:207], a[236:239], v[84:87], v[204:207]
    v_mfma_f32_16x16x32_bf16 v[144:147], a[240:243], v[108:111], v[144:147]
    ds_read_b64_tr_b16 a[216:217], v245 offset:17088
    v_exp_f32 v120, v208
    v_cvt_pk_bf16_f32 v107, v126, v127
    v_exp_f32 v121, v209
    v_exp_f32 v122, v210
    v_cvt_pk_bf16_f32 v102, v120, v121
    v_exp_f32 v123, v211
    v_mfma_f32_16x16x32_bf16 v[148:151], a[240:243], v[112:115], v[148:151]
    s_waitcnt lgkmcnt(9)
    ds_read_b64_tr_b16 a[218:219], v245 offset:25536
    v_mfma_f32_16x16x32_bf16 v[152:155], a[240:243], v[116:119], v[152:155]
    v_mfma_f32_16x16x32_bf16 v[164:167], a[244:247], v[116:119], v[164:167]
    ds_read_b64_tr_b16 a[220:221], v245 offset:17120
    v_mfma_f32_16x16x32_bf16 v[160:163], a[244:247], v[112:115], v[160:163]
    s_waitcnt lgkmcnt(9)
    ds_read_b64_tr_b16 a[222:223], v245 offset:25568
    v_exp_f32 v124, v204
    v_cvt_pk_bf16_f32 v103, v122, v123
    v_exp_f32 v125, v205
    v_exp_f32 v126, v206
    v_cvt_pk_bf16_f32 v98, v124, v125
    v_exp_f32 v127, v207
    v_mfma_f32_16x16x32_bf16 v[156:159], a[244:247], v[108:111], v[156:159]
    v_mfma_f32_16x16x32_bf16 v[168:171], a[248:251], v[108:111], v[168:171]
    ds_read_b64_tr_b16 a[224:225], v245 offset:17152
    v_mfma_f32_16x16x32_bf16 v[172:175], a[248:251], v[112:115], v[172:175]
    s_waitcnt lgkmcnt(9)
    ds_read_b64_tr_b16 a[226:227], v245 offset:25600
    v_mfma_f32_16x16x32_bf16 v[176:179], a[248:251], v[116:119], v[176:179]
    v_mfma_f32_16x16x32_bf16 v[188:191], a[252:255], v[116:119], v[188:191]
    ds_read_b64_tr_b16 a[228:229], v245 offset:17184
    v_mfma_f32_16x16x32_bf16 v[184:187], a[252:255], v[112:115], v[184:187]
    s_waitcnt lgkmcnt(9)
    ds_read_b64_tr_b16 a[230:231], v245 offset:25632
    v_mfma_f32_16x16x32_bf16 v[180:183], a[252:255], v[108:111], v[180:183]
    v_mfma_f32_16x16x32_bf16 a[48:51], a[208:211], v[108:111], a[48:51]
    ds_read_b64_tr_b16 a[232:233], v245 offset:17216
    v_mfma_f32_16x16x32_bf16 a[52:55], a[208:211], v[112:115], a[52:55]
    s_waitcnt lgkmcnt(9)
    ds_read_b64_tr_b16 a[234:235], v245 offset:25664
    v_mfma_f32_16x16x32_bf16 a[56:59], a[208:211], v[116:119], a[56:59]
    v_mfma_f32_16x16x32_bf16 a[68:71], a[212:215], v[116:119], a[68:71]
    ds_read_b64_tr_b16 a[236:237], v245 offset:17248
    v_mfma_f32_16x16x32_bf16 a[64:67], a[212:215], v[112:115], a[64:67]
    s_waitcnt lgkmcnt(9)
    ds_read_b64_tr_b16 a[238:239], v245 offset:25696
    v_mfma_f32_16x16x32_bf16 a[60:63], a[212:215], v[108:111], a[60:63]
    v_mfma_f32_16x16x32_bf16 a[72:75], a[216:219], v[108:111], a[72:75]
    ds_read_b64_tr_b16 a[240:241], v245 offset:17280
    v_mfma_f32_16x16x32_bf16 a[76:79], a[216:219], v[112:115], a[76:79]
    s_waitcnt lgkmcnt(9)
    ds_read_b64_tr_b16 a[242:243], v245 offset:25728
    v_mfma_f32_16x16x32_bf16 a[80:83], a[216:219], v[116:119], a[80:83]
    v_mfma_f32_16x16x32_bf16 a[92:95], a[220:223], v[116:119], a[92:95]
    ds_read_b64_tr_b16 a[244:245], v245 offset:17312
    v_mfma_f32_16x16x32_bf16 a[88:91], a[220:223], v[112:115], a[88:91]
    s_waitcnt lgkmcnt(9)
    ds_read_b64_tr_b16 a[246:247], v245 offset:25760
    v_mfma_f32_16x16x32_bf16 a[84:87], a[220:223], v[108:111], a[84:87]
    v_mfma_f32_16x16x32_bf16 a[96:99], a[224:227], v[108:111], a[96:99]
    ds_read_b64_tr_b16 a[248:249], v245 offset:17344
    v_mfma_f32_16x16x32_bf16 a[100:103], a[224:227], v[112:115], a[100:103]
    s_waitcnt lgkmcnt(9)
    ds_read_b64_tr_b16 a[250:251], v245 offset:25792
    v_mfma_f32_16x16x32_bf16 a[104:107], a[224:227], v[116:119], a[104:107]
    v_mfma_f32_16x16x32_bf16 a[116:119], a[228:231], v[116:119], a[116:119]
    s_waitcnt lgkmcnt(8)
    ds_read_b64_tr_b16 a[252:253], v245 offset:17376
    v_mfma_f32_16x16x32_bf16 a[112:115], a[228:231], v[112:115], a[112:115]
    s_waitcnt vmcnt(6)
    ds_read_b64_tr_b16 a[254:255], v245 offset:25824
    s_add_u32 m0, s33, 102464
    v_mfma_f32_16x16x32_bf16 a[108:111], a[228:231], v[108:111], a[108:111]
    v_mfma_f32_16x16x32_bf16 a[120:123], a[232:235], v[108:111], a[120:123]
    s_barrier
    ds_read_b128 a[208:211], v241 offset:33792
    v_mfma_f32_16x16x32_bf16 a[124:127], a[232:235], v[112:115], a[124:127]
    v_mfma_f32_16x16x32_bf16 a[128:131], a[232:235], v[116:119], a[128:131]
    s_waitcnt lgkmcnt(9)
    v_cvt_pk_bf16_f32 v99, v126, v127
    v_mfma_f32_16x16x32_bf16 a[140:143], a[236:239], v[116:119], a[140:143]
    s_waitcnt lgkmcnt(7)
    ds_read_b128 a[212:215], v241 offset:33856
    v_mfma_f32_16x16x32_bf16 a[136:139], a[236:239], v[112:115], a[136:139]
    buffer_load_dwordx4 v240, s[20:23], s51 offen offset:1024 nt lds
    v_mfma_f32_16x16x32_bf16 a[132:135], a[236:239], v[108:111], a[132:135]
    s_add_u32 m0, s33, 103008
    v_mfma_f32_16x16x32_bf16 a[144:147], a[240:243], v[108:111], a[144:147]
    ds_read_b128 a[216:219], v241 offset:33920
    v_mfma_f32_16x16x32_bf16 a[148:151], a[240:243], v[112:115], a[148:151]
    buffer_load_dwordx4 v240, s[20:23], s51 offen offset:1536 nt lds
    v_mfma_f32_16x16x32_bf16 a[152:155], a[240:243], v[116:119], a[152:155]
    s_xor_b32 s51, s95, 153600
    s_add_u32 m0, s33, 0
    v_mfma_f32_16x16x32_bf16 v[128:131], a[192:195], v[96:99], v[132:135]
    v_mfma_f32_16x16x32_bf16 v[128:131], a[196:199], v[100:103], v[128:131]
    v_mfma_f32_16x16x32_bf16 v[128:131], a[200:203], v[104:107], v[128:131]
    s_waitcnt lgkmcnt(7)
    v_mfma_f32_16x16x32_bf16 a[164:167], a[244:247], v[116:119], a[164:167]
    s_waitcnt lgkmcnt(5)
    ds_read_b128 a[220:223], v241 offset:33984
    v_mfma_f32_16x16x32_bf16 a[160:163], a[244:247], v[112:115], a[160:163]
    buffer_load_dwordx4 v240, s[16:19], s51 offen nt lds
    v_mfma_f32_16x16x32_bf16 a[156:159], a[244:247], v[108:111], a[156:159]
    v_mfma_f32_16x16x32_bf16 a[168:171], a[248:251], v[108:111], a[168:171]
    s_waitcnt lgkmcnt(4)
    ds_read_b128 a[224:227], v241 offset:34048
    v_mfma_f32_16x16x32_bf16 a[172:175], a[248:251], v[112:115], a[172:175]
    v_max3_f32 v136, v128, v129, v130
    v_cmp_nge_f32 vcc, s53, v136
    v_mfma_f32_16x16x32_bf16 a[176:179], a[248:251], v[116:119], a[176:179]
    v_mfma_f32_16x16x32_bf16 a[188:191], a[252:255], v[116:119], a[188:191]
    s_waitcnt lgkmcnt(4)
    ds_read_b128 a[228:231], v241 offset:34112
    v_mfma_f32_16x16x32_bf16 a[184:187], a[252:255], v[112:115], a[184:187]
    v_mfma_f32_16x16x32_bf16 a[180:183], a[252:255], v[108:111], a[180:183]
    s_cbranch_vccnz L_stub12
L_back12:
    s_add_u32 m0, s33, 544
    v_mfma_f32_16x16x32_bf16 v[192:195], a[208:211], v[0:3], v[216:219]
    s_waitcnt lgkmcnt(2)
    ds_read_b128 a[232:235], v241 offset:34176
    v_mfma_f32_16x16x32_bf16 v[192:195], a[212:215], v[12:15], v[192:195]
    buffer_load_dword v253, off, s[80:83], s6 sc1
    v_mfma_f32_16x16x32_bf16 v[192:195], a[216:219], v[24:27], v[192:195]
    v_mfma_f32_16x16x32_bf16 v[192:195], a[220:223], v[36:39], v[192:195]
    ds_read_b128 a[236:239], v241 offset:34240
    v_mfma_f32_16x16x32_bf16 v[196:199], a[220:223], v[40:43], v[220:223]
    v_mfma_f32_16x16x32_bf16 v[196:199], a[216:219], v[28:31], v[196:199]
    buffer_load_dwordx4 v240, s[16:19], s51 offen offset:512 nt lds
    v_mfma_f32_16x16x32_bf16 v[196:199], a[212:215], v[16:19], v[196:199]
    ds_read_b128 a[240:243], v241 offset:42240
    v_mfma_f32_16x16x32_bf16 v[196:199], a[208:211], v[4:7], v[196:199]
    v_mfma_f32_16x16x32_bf16 v[200:203], a[208:211], v[8:11], v[224:227]
    v_mfma_f32_16x16x32_bf16 v[200:203], a[212:215], v[20:23], v[200:203]
    s_waitcnt lgkmcnt(4)
    ds_read_b128 a[244:247], v241 offset:42304
    v_mfma_f32_16x16x32_bf16 v[200:203], a[216:219], v[32:35], v[200:203]
    v_mfma_f32_16x16x32_bf16 v[200:203], a[220:223], v[44:47], v[200:203]
    v_mfma_f32_16x16x32_bf16 v[200:203], a[224:227], v[56:59], v[200:203]
    s_waitcnt lgkmcnt(2)
    ds_read_b128 a[248:251], v241 offset:42368
    v_mfma_f32_16x16x32_bf16 v[200:203], a[228:231], v[68:71], v[200:203]
    v_mfma_f32_16x16x32_bf16 v[200:203], a[232:235], v[80:83], v[200:203]
    s_add_u32 m0, s33, 1088
    v_mfma_f32_16x16x32_bf16 v[200:203], a[236:239], v[92:95], v[200:203]
    ds_read_b128 a[252:255], v241 offset:42432
    v_mfma_f32_16x16x32_bf16 v[196:199], a[236:239], v[88:91], v[196:199]
    v_mfma_f32_16x16x32_bf16 v[196:199], a[232:235], v[76:79], v[196:199]
    v_mfma_f32_16x16x32_bf16 v[196:199], a[228:231], v[64:67], v[196:199]
    ds_read_b128 a[208:211], v241 offset:42496
    v_mfma_f32_16x16x32_bf16 v[196:199], a[224:227], v[52:55], v[196:199]
    v_mfma_f32_16x16x32_bf16 v[192:195], a[224:227], v[48:51], v[192:195]
    buffer_load_dwordx4 v240, s[16:19], s51 offen offset:1024 nt lds
    v_exp_f32 v120, v200
    v_exp_f32 v121, v201
    v_exp_f32 v122, v202
    v_cvt_pk_bf16_f32 v116, v120, v121
    v_exp_f32 v123, v203
    v_mfma_f32_16x16x32_bf16 v[192:195], a[228:231], v[60:63], v[192:195]
    s_waitcnt lgkmcnt(4)
    ds_read_b128 a[212:215], v241 offset:42560
    v_mfma_f32_16x16x32_bf16 v[192:195], a[232:235], v[72:75], v[192:195]
    v_mfma_f32_16x16x32_bf16 v[192:195], a[236:239], v[84:87], v[192:195]
    v_mfma_f32_16x16x32_bf16 v[204:207], a[240:243], v[0:3], v[216:219]
    s_waitcnt lgkmcnt(2)
    ds_read_b128 a[216:219], v241 offset:42624
    v_exp_f32 v124, v196
    v_cvt_pk_bf16_f32 v117, v122, v123
    v_exp_f32 v125, v197
    v_exp_f32 v126, v198
    v_cvt_pk_bf16_f32 v112, v124, v125
    v_exp_f32 v127, v199
    v_mfma_f32_16x16x32_bf16 v[204:207], a[244:247], v[12:15], v[204:207]
    v_mfma_f32_16x16x32_bf16 v[204:207], a[248:251], v[24:27], v[204:207]
    v_mfma_f32_16x16x32_bf16 v[204:207], a[252:255], v[36:39], v[204:207]
    ds_read_b128 a[220:223], v241 offset:42688
    v_mfma_f32_16x16x32_bf16 v[208:211], a[252:255], v[40:43], v[220:223]
    v_exp_f32 v120, v192
    v_cvt_pk_bf16_f32 v113, v126, v127
    v_exp_f32 v121, v193
    v_exp_f32 v122, v194
    v_cvt_pk_bf16_f32 v108, v120, v121
    v_exp_f32 v123, v195
    v_mfma_f32_16x16x32_bf16 v[208:211], a[248:251], v[28:31], v[208:211]
    s_add_u32 m0, s33, 1632
    v_mfma_f32_16x16x32_bf16 v[208:211], a[244:247], v[16:19], v[208:211]
    ds_read_b64_tr_b16 a[224:225], v245 offset:0
    v_mfma_f32_16x16x32_bf16 v[208:211], a[240:243], v[4:7], v[208:211]
    ds_read_b64_tr_b16 a[226:227], v245 offset:8448
    v_mfma_f32_16x16x32_bf16 v[212:215], a[240:243], v[8:11], v[224:227]
    v_mfma_f32_16x16x32_bf16 v[212:215], a[244:247], v[20:23], v[212:215]
    ds_read_b64_tr_b16 a[228:229], v245 offset:32
    v_mfma_f32_16x16x32_bf16 v[212:215], a[248:251], v[32:35], v[212:215]
    s_waitcnt lgkmcnt(6)
    ds_read_b64_tr_b16 a[230:231], v245 offset:8480
    v_mfma_f32_16x16x32_bf16 v[212:215], a[252:255], v[44:47], v[212:215]
    buffer_load_dwordx4 v240, s[16:19], s51 offen offset:1536 nt lds
    v_mfma_f32_16x16x32_bf16 v[212:215], a[208:211], v[56:59], v[212:215]
    s_waitcnt lgkmcnt(4)
    ds_read_b64_tr_b16 a[232:233], v245 offset:64
    v_mfma_f32_16x16x32_bf16 v[212:215], a[212:215], v[68:71], v[212:215]
    ds_read_b64_tr_b16 a[234:235], v245 offset:8512
    v_mfma_f32_16x16x32_bf16 v[212:215], a[216:219], v[80:83], v[212:215]
    v_mfma_f32_16x16x32_bf16 v[212:215], a[220:223], v[92:95], v[212:215]
    ds_read_b64_tr_b16 a[236:237], v245 offset:96
    v_mfma_f32_16x16x32_bf16 v[208:211], a[220:223], v[88:91], v[208:211]
    ds_read_b64_tr_b16 a[238:239], v245 offset:8544
    v_mfma_f32_16x16x32_bf16 v[208:211], a[216:219], v[76:79], v[208:211]
    v_mfma_f32_16x16x32_bf16 v[208:211], a[212:215], v[64:67], v[208:211]
    ds_read_b64_tr_b16 a[240:241], v245 offset:128
    v_mfma_f32_16x16x32_bf16 v[208:211], a[208:211], v[52:55], v[208:211]
    ds_read_b64_tr_b16 a[242:243], v245 offset:8576
    v_mfma_f32_16x16x32_bf16 v[204:207], a[208:211], v[48:51], v[204:207]
    v_exp_f32 v124, v212
    v_cvt_pk_bf16_f32 v109, v122, v123
    v_exp_f32 v125, v213
    v_exp_f32 v126, v214
    v_cvt_pk_bf16_f32 v118, v124, v125
    v_exp_f32 v127, v215
    v_mfma_f32_16x16x32_bf16 v[204:207], a[212:215], v[60:63], v[204:207]
    ds_read_b64_tr_b16 a[244:245], v245 offset:160
    v_mfma_f32_16x16x32_bf16 v[204:207], a[216:219], v[72:75], v[204:207]
    s_waitcnt lgkmcnt(9)
    ds_read_b64_tr_b16 a[246:247], v245 offset:8608
    v_mfma_f32_16x16x32_bf16 v[204:207], a[220:223], v[84:87], v[204:207]
    v_mfma_f32_16x16x32_bf16 v[144:147], a[224:227], v[96:99], v[144:147]
L_pad8:
    s_cbranch_execz L_pad12
    ds_read_b64_tr_b16 a[248:249], v245 offset:192
    v_exp_f32 v120, v208
    v_cvt_pk_bf16_f32 v119, v126, v127
    v_exp_f32 v121, v209
    v_exp_f32 v122, v210
    v_cvt_pk_bf16_f32 v114, v120, v121
    v_exp_f32 v123, v211
    v_mfma_f32_16x16x32_bf16 v[148:151], a[224:227], v[100:103], v[148:151]
    s_waitcnt lgkmcnt(9)
    ds_read_b64_tr_b16 a[250:251], v245 offset:8640
    v_mfma_f32_16x16x32_bf16 v[152:155], a[224:227], v[104:107], v[152:155]
    v_mfma_f32_16x16x32_bf16 v[164:167], a[228:231], v[104:107], v[164:167]
    ds_read_b64_tr_b16 a[252:253], v245 offset:224
    v_mfma_f32_16x16x32_bf16 v[160:163], a[228:231], v[100:103], v[160:163]
    s_waitcnt lgkmcnt(9)
    ds_read_b64_tr_b16 a[254:255], v245 offset:8672
    v_exp_f32 v124, v204
    v_cvt_pk_bf16_f32 v115, v122, v123
    v_exp_f32 v125, v205
    v_exp_f32 v126, v206
    v_cvt_pk_bf16_f32 v110, v124, v125
    v_exp_f32 v127, v207
    v_mfma_f32_16x16x32_bf16 v[156:159], a[228:231], v[96:99], v[156:159]
    v_mfma_f32_16x16x32_bf16 v[168:171], a[232:235], v[96:99], v[168:171]
    ds_read_b64_tr_b16 a[208:209], v245 offset:256
    v_mfma_f32_16x16x32_bf16 v[172:175], a[232:235], v[100:103], v[172:175]
    s_waitcnt lgkmcnt(9)
    ds_read_b64_tr_b16 a[210:211], v245 offset:8704
    v_mfma_f32_16x16x32_bf16 v[176:179], a[232:235], v[104:107], v[176:179]
    v_mfma_f32_16x16x32_bf16 v[188:191], a[236:239], v[104:107], v[188:191]
    ds_read_b64_tr_b16 a[212:213], v245 offset:288
    v_mfma_f32_16x16x32_bf16 v[184:187], a[236:239], v[100:103], v[184:187]
    s_waitcnt lgkmcnt(9)
    ds_read_b64_tr_b16 a[214:215], v245 offset:8736
    v_mfma_f32_16x16x32_bf16 v[180:183], a[236:239], v[96:99], v[180:183]
    v_mfma_f32_16x16x32_bf16 a[48:51], a[240:243], v[96:99], a[48:51]
    ds_read_b64_tr_b16 a[216:217], v245 offset:320
    v_mfma_f32_16x16x32_bf16 a[52:55], a[240:243], v[100:103], a[52:55]
    s_waitcnt lgkmcnt(9)
    ds_read_b64_tr_b16 a[218:219], v245 offset:8768
    v_mfma_f32_16x16x32_bf16 a[56:59], a[240:243], v[104:107], a[56:59]
    v_mfma_f32_16x16x32_bf16 a[68:71], a[244:247], v[104:107], a[68:71]
    ds_read_b64_tr_b16 a[220:221], v245 offset:352
    v_mfma_f32_16x16x32_bf16 a[64:67], a[244:247], v[100:103], a[64:67]
    s_waitcnt lgkmcnt(9)
    ds_read_b64_tr_b16 a[222:223], v245 offset:8800
    v_mfma_f32_16x16x32_bf16 a[60:63], a[244:247], v[96:99], a[60:63]
    v_mfma_f32_16x16x32_bf16 a[72:75], a[248:251], v[96:99], a[72:75]
    ds_read_b64_tr_b16 a[224:225], v245 offset:384
    v_mfma_f32_16x16x32_bf16 a[76:79], a[248:251], v[100:103], a[76:79]
    s_waitcnt lgkmcnt(9)
    ds_read_b64_tr_b16 a[226:227], v245 offset:8832
    v_mfma_f32_16x16x32_bf16 a[80:83], a[248:251], v[104:107], a[80:83]
    v_mfma_f32_16x16x32_bf16 a[92:95], a[252:255], v[104:107], a[92:95]
    ds_read_b64_tr_b16 a[228:229], v245 offset:416
    v_mfma_f32_16x16x32_bf16 a[88:91], a[252:255], v[100:103], a[88:91]
    s_waitcnt lgkmcnt(9)
    ds_read_b64_tr_b16 a[230:231], v245 offset:8864
    v_mfma_f32_16x16x32_bf16 a[84:87], a[252:255], v[96:99], a[84:87]
    v_mfma_f32_16x16x32_bf16 a[96:99], a[208:211], v[96:99], a[96:99]
    ds_read_b64_tr_b16 a[232:233], v245 offset:448
    v_mfma_f32_16x16x32_bf16 a[100:103], a[208:211], v[100:103], a[100:103]
    s_waitcnt lgkmcnt(9)
    ds_read_b64_tr_b16 a[234:235], v245 offset:8896
    v_mfma_f32_16x16x32_bf16 a[104:107], a[208:211], v[104:107], a[104:107]
    v_mfma_f32_16x16x32_bf16 a[116:119], a[212:215], v[104:107], a[116:119]
    s_waitcnt lgkmcnt(8)
    ds_read_b64_tr_b16 a[236:237], v245 offset:480
    v_mfma_f32_16x16x32_bf16 a[112:115], a[212:215], v[100:103], a[112:115]
    s_waitcnt vmcnt(5)
    ds_read_b64_tr_b16 a[238:239], v245 offset:8928
    s_xor_b32 s51, s95, 151552
    v_mfma_f32_16x16x32_bf16 a[108:111], a[212:215], v[96:99], a[108:111]
    s_add_u32 m0, s33, 118272
    v_mfma_f32_16x16x32_bf16 a[120:123], a[216:219], v[96:99], a[120:123]
    s_barrier
    ds_read_b128 a[240:243], v242 offset:33792
    v_mfma_f32_16x16x32_bf16 a[124:127], a[216:219], v[100:103], a[124:127]
    v_mfma_f32_16x16x32_bf16 a[128:131], a[216:219], v[104:107], a[128:131]
    s_waitcnt lgkmcnt(9)
    v_cvt_pk_bf16_f32 v111, v126, v127
    v_mfma_f32_16x16x32_bf16 a[140:143], a[220:223], v[104:107], a[140:143]
    s_waitcnt lgkmcnt(7)
    ds_read_b128 a[244:247], v242 offset:33856
    v_mfma_f32_16x16x32_bf16 a[136:139], a[220:223], v[100:103], a[136:139]
    buffer_load_dwordx4 v240, s[20:23], s51 offen nt lds
    v_mfma_f32_16x16x32_bf16 a[132:135], a[220:223], v[96:99], a[132:135]
    s_add_u32 m0, s33, 118816
    v_mfma_f32_16x16x32_bf16 a[144:147], a[224:227], v[96:99], a[144:147]
    ds_read_b128 a[248:251], v242 offset:33920
    v_mfma_f32_16x16x32_bf16 a[148:151], a[224:227], v[100:103], a[148:151]
    buffer_load_dwordx4 v240, s[20:23], s51 offen offset:512 nt lds
    v_mfma_f32_16x16x32_bf16 a[152:155], a[224:227], v[104:107], a[152:155]
    s_add_u32 m0, s33, 119360
    v_mfma_f32_16x16x32_bf16 v[132:135], a[192:195], v[108:111], v[128:131]
    v_mfma_f32_16x16x32_bf16 v[132:135], a[196:199], v[112:115], v[132:135]
    buffer_load_dwordx4 v240, s[20:23], s51 offen offset:1024 nt lds
    v_mfma_f32_16x16x32_bf16 v[132:135], a[200:203], v[116:119], v[132:135]
    s_waitcnt lgkmcnt(7)
    v_mfma_f32_16x16x32_bf16 a[164:167], a[228:231], v[104:107], a[164:167]
    s_waitcnt lgkmcnt(5)
    ds_read_b128 a[252:255], v242 offset:33984
    v_mfma_f32_16x16x32_bf16 a[160:163], a[228:231], v[100:103], a[160:163]
    s_add_u32 m0, s33, 119904
    v_mfma_f32_16x16x32_bf16 a[156:159], a[228:231], v[96:99], a[156:159]
    v_mfma_f32_16x16x32_bf16 a[168:171], a[232:235], v[96:99], a[168:171]
    s_waitcnt lgkmcnt(4)
    ds_read_b128 a[208:211], v242 offset:34048
    v_mfma_f32_16x16x32_bf16 a[172:175], a[232:235], v[100:103], a[172:175]
    v_max3_f32 v136, v132, v133, v134
    v_cmp_nge_f32 vcc, s53, v136
    v_mfma_f32_16x16x32_bf16 a[176:179], a[232:235], v[104:107], a[176:179]
    v_mfma_f32_16x16x32_bf16 a[188:191], a[236:239], v[104:107], a[188:191]
    s_waitcnt lgkmcnt(4)
    ds_read_b128 a[212:215], v242 offset:34112
    v_mfma_f32_16x16x32_bf16 a[184:187], a[236:239], v[100:103], a[184:187]
    buffer_load_dwordx4 v240, s[20:23], s51 offen offset:1536 nt lds
    v_mfma_f32_16x16x32_bf16 a[180:183], a[236:239], v[96:99], a[180:183]
    s_cbranch_vccnz L_stub13
L_back13:
    v_mfma_f32_16x16x32_bf16 v[192:195], a[240:243], v[0:3], v[216:219]
    s_waitcnt lgkmcnt(2)
    ds_read_b128 a[216:219], v242 offset:34176
    v_mfma_f32_16x16x32_bf16 v[192:195], a[244:247], v[12:15], v[192:195]
    v_mfma_f32_16x16x32_bf16 v[192:195], a[248:251], v[24:27], v[192:195]
    v_mfma_f32_16x16x32_bf16 v[192:195], a[252:255], v[36:39], v[192:195]
    ds_read_b128 a[220:223], v242 offset:34240
    v_mfma_f32_16x16x32_bf16 v[196:199], a[252:255], v[40:43], v[220:223]
    v_mfma_f32_16x16x32_bf16 v[196:199], a[248:251], v[28:31], v[196:199]
    v_mfma_f32_16x16x32_bf16 v[196:199], a[244:247], v[16:19], v[196:199]
    ds_read_b128 a[224:227], v242 offset:42240
    v_mfma_f32_16x16x32_bf16 v[196:199], a[240:243], v[4:7], v[196:199]
    v_mfma_f32_16x16x32_bf16 v[200:203], a[240:243], v[8:11], v[224:227]
    v_mfma_f32_16x16x32_bf16 v[200:203], a[244:247], v[20:23], v[200:203]
    s_waitcnt lgkmcnt(4)
    ds_read_b128 a[228:231], v242 offset:42304
    v_mfma_f32_16x16x32_bf16 v[200:203], a[248:251], v[32:35], v[200:203]
    s_xor_b32 s51, s95, 153600
    s_add_u32 m0, s33, 16896
    v_mfma_f32_16x16x32_bf16 v[200:203], a[252:255], v[44:47], v[200:203]
    v_mfma_f32_16x16x32_bf16 v[200:203], a[208:211], v[56:59], v[200:203]
    s_waitcnt lgkmcnt(2)
    ds_read_b128 a[232:235], v242 offset:42368
    v_mfma_f32_16x16x32_bf16 v[200:203], a[212:215], v[68:71], v[200:203]
    v_mfma_f32_16x16x32_bf16 v[200:203], a[216:219], v[80:83], v[200:203]
    v_mfma_f32_16x16x32_bf16 v[200:203], a[220:223], v[92:95], v[200:203]
    ds_read_b128 a[236:239], v242 offset:42432
    v_mfma_f32_16x16x32_bf16 v[196:199], a[220:223], v[88:91], v[196:199]
    buffer_load_dwordx4 v240, s[20:23], s51 offen nt lds
    v_mfma_f32_16x16x32_bf16 v[196:199], a[216:219], v[76:79], v[196:199]
    v_mfma_f32_16x16x32_bf16 v[196:199], a[212:215], v[64:67], v[196:199]
    ds_read_b128 a[240:243], v242 offset:42496
    v_mfma_f32_16x16x32_bf16 v[196:199], a[208:211], v[52:55], v[196:199]
    v_mfma_f32_16x16x32_bf16 v[192:195], a[208:211], v[48:51], v[192:195]
    v_exp_f32 v120, v200
    v_exp_f32 v121, v201
    v_exp_f32 v122, v202
    v_cvt_pk_bf16_f32 v104, v120, v121
    v_exp_f32 v123, v203
    v_mfma_f32_16x16x32_bf16 v[192:195], a[212:215], v[60:63], v[192:195]
    s_waitcnt lgkmcnt(4)
    ds_read_b128 a[244:247], v242 offset:42560
    v_mfma_f32_16x16x32_bf16 v[192:195], a[216:219], v[72:75], v[192:195]
    v_mfma_f32_16x16x32_bf16 v[192:195], a[220:223], v[84:87], v[192:195]
    v_mfma_f32_16x16x32_bf16 v[204:207], a[224:227], v[0:3], v[216:219]
    s_waitcnt lgkmcnt(2)
    ds_read_b128 a[248:251], v242 offset:42624
    v_exp_f32 v124, v196
    v_cvt_pk_bf16_f32 v105, v122, v123
    v_exp_f32 v125, v197
    v_exp_f32 v126, v198
    v_cvt_pk_bf16_f32 v100, v124, v125
    v_exp_f32 v127, v199
    v_mfma_f32_16x16x32_bf16 v[204:207], a[228:231], v[12:15], v[204:207]
    s_add_u32 m0, s33, 17440
    v_mfma_f32_16x16x32_bf16 v[204:207], a[232:235], v[24:27], v[204:207]
    v_mfma_f32_16x16x32_bf16 v[204:207], a[236:239], v[36:39], v[204:207]
    ds_read_b128 a[252:255], v242 offset:42688
    v_mfma_f32_16x16x32_bf16 v[208:211], a[236:239], v[40:43], v[220:223]
    v_exp_f32 v120, v192
    v_cvt_pk_bf16_f32 v101, v126, v127
    v_exp_f32 v121, v193
    v_exp_f32 v122, v194
    v_cvt_pk_bf16_f32 v96, v120, v121
    v_exp_f32 v123, v195
    v_mfma_f32_16x16x32_bf16 v[208:211], a[232:235], v[28:31], v[208:211]
    v_mfma_f32_16x16x32_bf16 v[208:211], a[228:231], v[16:19], v[208:211]
    ds_read_b64_tr_b16 a[208:209], v246 offset:0
    v_mfma_f32_16x16x32_bf16 v[208:211], a[224:227], v[4:7], v[208:211]
    ds_read_b64_tr_b16 a[210:211], v246 offset:8448
    buffer_load_dwordx4 v240, s[20:23], s51 offen offset:512 nt lds
    v_mfma_f32_16x16x32_bf16 v[212:215], a[224:227], v[8:11], v[224:227]
    v_mfma_f32_16x16x32_bf16 v[212:215], a[228:231], v[20:23], v[212:215]
    ds_read_b64_tr_b16 a[212:213], v246 offset:32
    v_mfma_f32_16x16x32_bf16 v[212:215], a[232:235], v[32:35], v[212:215]
    s_waitcnt lgkmcnt(6)
    ds_read_b64_tr_b16 a[214:215], v246 offset:8480
    v_mfma_f32_16x16x32_bf16 v[212:215], a[236:239], v[44:47], v[212:215]
    v_mfma_f32_16x16x32_bf16 v[212:215], a[240:243], v[56:59], v[212:215]
    s_waitcnt lgkmcnt(4)
    ds_read_b64_tr_b16 a[216:217], v246 offset:64
    v_mfma_f32_16x16x32_bf16 v[212:215], a[244:247], v[68:71], v[212:215]
    ds_read_b64_tr_b16 a[218:219], v246 offset:8512
    v_mfma_f32_16x16x32_bf16 v[212:215], a[248:251], v[80:83], v[212:215]
    v_mfma_f32_16x16x32_bf16 v[212:215], a[252:255], v[92:95], v[212:215]
    ds_read_b64_tr_b16 a[220:221], v246 offset:96
    v_mfma_f32_16x16x32_bf16 v[208:211], a[252:255], v[88:91], v[208:211]
    ds_read_b64_tr_b16 a[222:223], v246 offset:8544
    v_mfma_f32_16x16x32_bf16 v[208:211], a[248:251], v[76:79], v[208:211]
    v_mfma_f32_16x16x32_bf16 v[208:211], a[244:247], v[64:67], v[208:211]
    ds_read_b64_tr_b16 a[224:225], v246 offset:128
    v_mfma_f32_16x16x32_bf16 v[208:211], a[240:243], v[52:55], v[208:211]
    ds_read_b64_tr_b16 a[226:227], v246 offset:8576
    v_mfma_f32_16x16x32_bf16 v[204:207], a[240:243], v[48:51], v[204:207]
    v_exp_f32 v124, v212
    v_cvt_pk_bf16_f32 v97, v122, v123
    v_exp_f32 v125, v213
    v_exp_f32 v126, v214
    v_cvt_pk_bf16_f32 v106, v124, v125
    v_exp_f32 v127, v215
    v_mfma_f32_16x16x32_bf16 v[204:207], a[244:247], v[60:63], v[204:207]
    ds_read_b64_tr_b16 a[228:229], v246 offset:160
    v_mfma_f32_16x16x32_bf16 v[204:207], a[248:251], v[72:75], v[204:207]
    s_waitcnt lgkmcnt(9)
    ds_read_b64_tr_b16 a[230:231], v246 offset:8608
    v_mfma_f32_16x16x32_bf16 v[204:207], a[252:255], v[84:87], v[204:207]
    v_mfma_f32_16x16x32_bf16 v[144:147], a[208:211], v[108:111], v[144:147]
    ds_read_b64_tr_b16 a[232:233], v246 offset:192
    v_exp_f32 v120, v208
    v_cvt_pk_bf16_f32 v107, v126, v127
    v_exp_f32 v121, v209
    v_exp_f32 v122, v210
    v_cvt_pk_bf16_f32 v102, v120, v121
    v_exp_f32 v123, v211
    v_mfma_f32_16x16x32_bf16 v[148:151], a[208:211], v[112:115], v[148:151]
    s_waitcnt lgkmcnt(9)
    ds_read_b64_tr_b16 a[234:235], v246 offset:8640
    v_mfma_f32_16x16x32_bf16 v[152:155], a[208:211], v[116:119], v[152:155]
    v_mfma_f32_16x16x32_bf16 v[164:167], a[212:215], v[116:119], v[164:167]
    ds_read_b64_tr_b16 a[236:237], v246 offset:224
    v_mfma_f32_16x16x32_bf16 v[160:163], a[212:215], v[112:115], v[160:163]
    s_waitcnt lgkmcnt(9)
    ds_read_b64_tr_b16 a[238:239], v246 offset:8672
    v_exp_f32 v124, v204
    v_cvt_pk_bf16_f32 v103, v122, v123
    v_exp_f32 v125, v205
    v_exp_f32 v126, v206
    v_cvt_pk_bf16_f32 v98, v124, v125
    v_exp_f32 v127, v207
    v_mfma_f32_16x16x32_bf16 v[156:159], a[212:215], v[108:111], v[156:159]
    v_mfma_f32_16x16x32_bf16 v[168:171], a[216:219], v[108:111], v[168:171]
    ds_read_b64_tr_b16 a[240:241], v246 offset:256
    v_mfma_f32_16x16x32_bf16 v[172:175], a[216:219], v[112:115], v[172:175]
    s_waitcnt lgkmcnt(9)
    ds_read_b64_tr_b16 a[242:243], v246 offset:8704
    v_mfma_f32_16x16x32_bf16 v[176:179], a[216:219], v[116:119], v[176:179]
    v_mfma_f32_16x16x32_bf16 v[188:191], a[220:223], v[116:119], v[188:191]
    ds_read_b64_tr_b16 a[244:245], v246 offset:288
    v_mfma_f32_16x16x32_bf16 v[184:187], a[220:223], v[112:115], v[184:187]
    s_waitcnt lgkmcnt(9)
    ds_read_b64_tr_b16 a[246:247], v246 offset:8736
    v_mfma_f32_16x16x32_bf16 v[180:183], a[220:223], v[108:111], v[180:183]
    v_mfma_f32_16x16x32_bf16 a[48:51], a[224:227], v[108:111], a[48:51]
    ds_read_b64_tr_b16 a[248:249], v246 offset:320
    v_mfma_f32_16x16x32_bf16 a[52:55], a[224:227], v[112:115], a[52:55]
    s_waitcnt lgkmcnt(9)
    ds_read_b64_tr_b16 a[250:251], v246 offset:8768
    v_mfma_f32_16x16x32_bf16 a[56:59], a[224:227], v[116:119], a[56:59]
    v_mfma_f32_16x16x32_bf16 a[68:71], a[228:231], v[116:119], a[68:71]
    ds_read_b64_tr_b16 a[252:253], v246 offset:352
    v_mfma_f32_16x16x32_bf16 a[64:67], a[228:231], v[112:115], a[64:67]
    s_waitcnt lgkmcnt(9)
    ds_read_b64_tr_b16 a[254:255], v246 offset:8800
    v_mfma_f32_16x16x32_bf16 a[60:63], a[228:231], v[108:111], a[60:63]
    v_mfma_f32_16x16x32_bf16 a[72:75], a[232:235], v[108:111], a[72:75]
    ds_read_b64_tr_b16 a[208:209], v246 offset:384
    v_mfma_f32_16x16x32_bf16 a[76:79], a[232:235], v[112:115], a[76:79]
    s_waitcnt lgkmcnt(9)
    ds_read_b64_tr_b16 a[210:211], v246 offset:8832
    v_mfma_f32_16x16x32_bf16 a[80:83], a[232:235], v[116:119], a[80:83]
    v_mfma_f32_16x16x32_bf16 a[92:95], a[236:239], v[116:119], a[92:95]
    ds_read_b64_tr_b16 a[212:213], v246 offset:416
    v_mfma_f32_16x16x32_bf16 a[88:91], a[236:239], v[112:115], a[88:91]
    s_waitcnt lgkmcnt(9)
    ds_read_b64_tr_b16 a[214:215], v246 offset:8864
    v_mfma_f32_16x16x32_bf16 a[84:87], a[236:239], v[108:111], a[84:87]
    v_mfma_f32_16x16x32_bf16 a[96:99], a[240:243], v[108:111], a[96:99]
    ds_read_b64_tr_b16 a[216:217], v246 offset:448
    v_mfma_f32_16x16x32_bf16 a[100:103], a[240:243], v[112:115], a[100:103]
    s_waitcnt lgkmcnt(9)
    ds_read_b64_tr_b16 a[218:219], v246 offset:8896
    v_mfma_f32_16x16x32_bf16 a[104:107], a[240:243], v[116:119], a[104:107]
    v_mfma_f32_16x16x32_bf16 a[116:119], a[244:247], v[116:119], a[116:119]
    s_waitcnt lgkmcnt(8)
    ds_read_b64_tr_b16 a[220:221], v246 offset:480
    v_mfma_f32_16x16x32_bf16 a[112:115], a[244:247], v[112:115], a[112:115]
    s_waitcnt vmcnt(2)
    ds_read_b64_tr_b16 a[222:223], v246 offset:8928
    s_add_u32 m0, s33, 17984
    v_mfma_f32_16x16x32_bf16 a[108:111], a[244:247], v[108:111], a[108:111]
    v_mfma_f32_16x16x32_bf16 a[120:123], a[248:251], v[108:111], a[120:123]
    s_barrier
    ds_read_b128 a[224:227], v241 offset:0
    v_mfma_f32_16x16x32_bf16 a[124:127], a[248:251], v[112:115], a[124:127]
    v_mfma_f32_16x16x32_bf16 a[128:131], a[248:251], v[116:119], a[128:131]
    s_waitcnt lgkmcnt(9)
    v_cvt_pk_bf16_f32 v99, v126, v127
    v_mfma_f32_16x16x32_bf16 a[140:143], a[252:255], v[116:119], a[140:143]
    s_waitcnt lgkmcnt(7)
    ds_read_b128 a[228:231], v241 offset:64
    v_mfma_f32_16x16x32_bf16 a[136:139], a[252:255], v[112:115], a[136:139]
    buffer_load_dwordx4 v240, s[20:23], s51 offen offset:1024 nt lds
    v_mfma_f32_16x16x32_bf16 a[132:135], a[252:255], v[108:111], a[132:135]
    s_add_u32 m0, s33, 18528
    v_mfma_f32_16x16x32_bf16 a[144:147], a[208:211], v[108:111], a[144:147]
    ds_read_b128 a[232:235], v241 offset:128
    v_mfma_f32_16x16x32_bf16 a[148:151], a[208:211], v[112:115], a[148:151]
    buffer_load_dwordx4 v240, s[20:23], s51 offen offset:1536 nt lds
    v_mfma_f32_16x16x32_bf16 a[152:155], a[208:211], v[116:119], a[152:155]
    s_add_u32 s51, s56, 0
    s_add_u32 m0, s33, 135168
    v_mfma_f32_16x16x32_bf16 v[128:131], a[192:195], v[96:99], v[132:135]
    v_mfma_f32_16x16x32_bf16 v[128:131], a[196:199], v[100:103], v[128:131]
    buffer_load_dwordx4 v247, s[24:27], s51 offen lds
    v_mfma_f32_16x16x32_bf16 v[128:131], a[200:203], v[104:107], v[128:131]
    s_waitcnt lgkmcnt(7)
    s_add_u32 m0, s33, 135328
    v_mfma_f32_16x16x32_bf16 a[164:167], a[212:215], v[116:119], a[164:167]
    s_waitcnt lgkmcnt(5)
    ds_read_b128 a[236:239], v241 offset:192
    v_mfma_f32_16x16x32_bf16 a[160:163], a[212:215], v[112:115], a[160:163]
    buffer_load_dwordx4 v247, s[24:27], s51 offen offset:896 lds
    v_mfma_f32_16x16x32_bf16 a[156:159], a[212:215], v[108:111], a[156:159]
    s_add_u32 m0, s33, 135488
    v_mfma_f32_16x16x32_bf16 a[168:171], a[216:219], v[108:111], a[168:171]
    s_waitcnt lgkmcnt(4)
    ds_read_b128 a[240:243], v241 offset:256
    v_mfma_f32_16x16x32_bf16 a[172:175], a[216:219], v[112:115], a[172:175]
    v_max3_f32 v136, v128, v129, v130
    v_cmp_nge_f32 vcc, s53, v136
    v_mfma_f32_16x16x32_bf16 a[176:179], a[216:219], v[116:119], a[176:179]
    buffer_load_dwordx4 v247, s[24:27], s51 offen offset:1792 lds
    v_mfma_f32_16x16x32_bf16 a[188:191], a[220:223], v[116:119], a[188:191]
    s_waitcnt lgkmcnt(4)
    ds_read_b128 a[244:247], v241 offset:320
    s_add_u32 m0, s33, 135648
    v_mfma_f32_16x16x32_bf16 a[184:187], a[220:223], v[112:115], a[184:187]
    v_mfma_f32_16x16x32_bf16 a[180:183], a[220:223], v[108:111], a[180:183]
    s_cbranch_vccnz L_stub14
L_back14:
    v_mfma_f32_16x16x32_bf16 v[192:195], a[224:227], v[0:3], v[216:219]
    s_waitcnt lgkmcnt(2)
    ds_read_b128 a[248:251], v241 offset:384
    s_waitcnt vmcnt(7)
    v_mfma_f32_16x16x32_bf16 v[192:195], a[228:231], v[12:15], v[192:195]
    buffer_load_dwordx4 v247, s[24:27], s51 offen offset:2688 lds
    v_mfma_f32_16x16x32_bf16 v[192:195], a[232:235], v[24:27], v[192:195]
    s_add_u32 s51, s56, 114688
    s_add_u32 m0, s33, 33792
    v_cmp_gt_u32 vcc, 1, v253
    v_mfma_f32_16x16x32_bf16 v[192:195], a[236:239], v[36:39], v[192:195]
    ds_read_b128 a[252:255], v241 offset:448
    v_mfma_f32_16x16x32_bf16 v[196:199], a[236:239], v[40:43], v[220:223]
    s_cbranch_vccnz L_dbgspin
L_dbgback:
    v_mfma_f32_16x16x32_bf16 v[196:199], a[232:235], v[28:31], v[196:199]
    v_readfirstlane_b32 s87, v253
    v_mfma_f32_16x16x32_bf16 v[196:199], a[228:231], v[16:19], v[196:199]
    s_mul_i32 s86, s99, 3
    ds_read_b128 a[208:211], v241 offset:8448
    s_xor_b32 s87, s87, s86
    v_mfma_f32_16x16x32_bf16 v[196:199], a[224:227], v[4:7], v[196:199]
    buffer_load_dwordx4 v247, s[24:27], s51 offen lds
    v_mfma_f32_16x16x32_bf16 v[200:203], a[224:227], v[8:11], v[224:227]
    s_add_u32 m0, s33, 33952
    s_and_b32 s86, s87, 2
    s_lshl_b32 s86, s86, 12
    v_mfma_f32_16x16x32_bf16 v[200:203], a[228:231], v[20:23], v[200:203]
    s_waitcnt lgkmcnt(4)
    ds_read_b128 a[212:215], v241 offset:8512
    s_add_u32 s89, s88, s86
    v_mfma_f32_16x16x32_bf16 v[200:203], a[232:235], v[32:35], v[200:203]
    buffer_load_dwordx4 v247, s[24:27], s51 offen offset:896 lds
    v_mfma_f32_16x16x32_bf16 v[200:203], a[236:239], v[44:47], v[200:203]
    s_add_u32 m0, s33, 34112
    s_and_b32 s86, s87, 1
    s_lshl_b32 s86, s86, 13
    v_mfma_f32_16x16x32_bf16 v[200:203], a[240:243], v[56:59], v[200:203]
    s_waitcnt lgkmcnt(2)
    ds_read_b128 a[216:219], v241 offset:8576
    s_add_u32 s88, s88, s86
    v_mfma_f32_16x16x32_bf16 v[200:203], a[244:247], v[68:71], v[200:203]
    buffer_load_dwordx4 v247, s[24:27], s51 offen offset:1792 lds
    v_mfma_f32_16x16x32_bf16 v[200:203], a[248:251], v[80:83], v[200:203]
    s_add_u32 m0, s33, 34272
    s_add_u32 s97, s97, s86
    s_add_u32 s64, s63, s89
    v_mfma_f32_16x16x32_bf16 v[200:203], a[252:255], v[92:95], v[200:203]
    s_add_u32 s63, s63, s88
    ds_read_b128 a[220:223], v241 offset:8640
    s_sub_u32 s89, s89, s88
    v_mfma_f32_16x16x32_bf16 v[196:199], a[252:255], v[88:91], v[196:199]
    buffer_load_dwordx4 v247, s[24:27], s51 offen offset:2688 lds
    v_mfma_f32_16x16x32_bf16 v[196:199], a[248:251], v[76:79], v[196:199]
    v_mfma_f32_16x16x32_bf16 v[196:199], a[244:247], v[64:67], v[196:199]
    ds_read_b128 a[224:227], v241 offset:8704
    v_mfma_f32_16x16x32_bf16 v[196:199], a[240:243], v[52:55], v[196:199]
    v_mfma_f32_16x16x32_bf16 v[192:195], a[240:243], v[48:51], v[192:195]
    v_exp_f32 v120, v200
    v_exp_f32 v121, v201
    v_exp_f32 v122, v202
    v_cvt_pk_bf16_f32 v116, v120, v121
    v_exp_f32 v123, v203
    v_mfma_f32_16x16x32_bf16 v[192:195], a[244:247], v[60:63], v[192:195]
    s_waitcnt lgkmcnt(4)
    ds_read_b128 a[228:231], v241 offset:8768
    v_mfma_f32_16x16x32_bf16 v[192:195], a[248:251], v[72:75], v[192:195]
    v_mfma_f32_16x16x32_bf16 v[192:195], a[252:255], v[84:87], v[192:195]
    v_mfma_f32_16x16x32_bf16 v[204:207], a[208:211], v[0:3], v[216:219]
    s_waitcnt lgkmcnt(2)
    ds_read_b128 a[232:235], v241 offset:8832
    v_exp_f32 v124, v196
    v_cvt_pk_bf16_f32 v117, v122, v123
    v_exp_f32 v125, v197
    v_exp_f32 v126, v198
    v_cvt_pk_bf16_f32 v112, v124, v125
    v_exp_f32 v127, v199
    v_mfma_f32_16x16x32_bf16 v[204:207], a[212:215], v[12:15], v[204:207]
    v_mfma_f32_16x16x32_bf16 v[204:207], a[216:219], v[24:27], v[204:207]
    v_mfma_f32_16x16x32_bf16 v[204:207], a[220:223], v[36:39], v[204:207]
    s_add_u32 s51, s57, 0
    ds_read_b128 a[236:239], v241 offset:8896
    v_mfma_f32_16x16x32_bf16 v[208:211], a[220:223], v[40:43], v[220:223]
    s_add_u32 m0, s33, 67584
    v_exp_f32 v120, v192
    v_cvt_pk_bf16_f32 v113, v126, v127
    v_exp_f32 v121, v193
    v_exp_f32 v122, v194
    v_cvt_pk_bf16_f32 v108, v120, v121
    v_exp_f32 v123, v195
    v_mfma_f32_16x16x32_bf16 v[208:211], a[216:219], v[28:31], v[208:211]
    v_mfma_f32_16x16x32_bf16 v[208:211], a[212:215], v[16:19], v[208:211]
    ds_read_b64_tr_b16 a[240:241], v246 offset:16896
    v_mfma_f32_16x16x32_bf16 v[208:211], a[208:211], v[4:7], v[208:211]
    ds_read_b64_tr_b16 a[242:243], v246 offset:25344
    v_mfma_f32_16x16x32_bf16 v[212:215], a[208:211], v[8:11], v[224:227]
    v_mfma_f32_16x16x32_bf16 v[212:215], a[212:215], v[20:23], v[212:215]
    ds_read_b64_tr_b16 a[244:245], v246 offset:16928
    buffer_load_dwordx4 v247, s[24:27], s51 offen lds
    v_mfma_f32_16x16x32_bf16 v[212:215], a[216:219], v[32:35], v[212:215]
    s_waitcnt lgkmcnt(6)
    ds_read_b64_tr_b16 a[246:247], v246 offset:25376
    s_add_u32 m0, s33, 67744
    v_mfma_f32_16x16x32_bf16 v[212:215], a[220:223], v[44:47], v[212:215]
    v_mfma_f32_16x16x32_bf16 v[212:215], a[224:227], v[56:59], v[212:215]
    s_waitcnt lgkmcnt(4)
    ds_read_b64_tr_b16 a[248:249], v246 offset:16960
    v_mfma_f32_16x16x32_bf16 v[212:215], a[228:231], v[68:71], v[212:215]
    ds_read_b64_tr_b16 a[250:251], v246 offset:25408
    buffer_load_dwordx4 v247, s[24:27], s51 offen offset:896 lds
    v_mfma_f32_16x16x32_bf16 v[212:215], a[232:235], v[80:83], v[212:215]
    s_add_u32 m0, s33, 67904
    v_mfma_f32_16x16x32_bf16 v[212:215], a[236:239], v[92:95], v[212:215]
    ds_read_b64_tr_b16 a[252:253], v246 offset:16992
    v_mfma_f32_16x16x32_bf16 v[208:211], a[236:239], v[88:91], v[208:211]
    ds_read_b64_tr_b16 a[254:255], v246 offset:25440
    buffer_load_dwordx4 v247, s[24:27], s51 offen offset:1792 lds
    v_mfma_f32_16x16x32_bf16 v[208:211], a[232:235], v[76:79], v[208:211]
    v_mfma_f32_16x16x32_bf16 v[208:211], a[228:231], v[64:67], v[208:211]
    ds_read_b64_tr_b16 a[208:209], v246 offset:17024
    v_mfma_f32_16x16x32_bf16 v[208:211], a[224:227], v[52:55], v[208:211]
    ds_read_b64_tr_b16 a[210:211], v246 offset:25472
    v_mfma_f32_16x16x32_bf16 v[204:207], a[224:227], v[48:51], v[204:207]
    v_exp_f32 v124, v212
    v_cvt_pk_bf16_f32 v109, v122, v123
    v_exp_f32 v125, v213
    v_exp_f32 v126, v214
    v_cvt_pk_bf16_f32 v118, v124, v125
    v_exp_f32 v127, v215
    v_mfma_f32_16x16x32_bf16 v[204:207], a[228:231], v[60:63], v[204:207]
    ds_read_b64_tr_b16 a[212:213], v246 offset:17056
    v_mfma_f32_16x16x32_bf16 v[204:207], a[232:235], v[72:75], v[204:207]
    s_waitcnt lgkmcnt(9)
    ds_read_b64_tr_b16 a[214:215], v246 offset:25504
    v_mfma_f32_16x16x32_bf16 v[204:207], a[236:239], v[84:87], v[204:207]
    v_mfma_f32_16x16x32_bf16 v[144:147], a[240:243], v[96:99], v[144:147]
    ds_read_b64_tr_b16 a[216:217], v246 offset:17088
    v_exp_f32 v120, v208
    v_cvt_pk_bf16_f32 v119, v126, v127
    v_exp_f32 v121, v209
    v_exp_f32 v122, v210
    v_cvt_pk_bf16_f32 v114, v120, v121
    v_exp_f32 v123, v211
    v_mfma_f32_16x16x32_bf16 v[148:151], a[240:243], v[100:103], v[148:151]
    s_waitcnt lgkmcnt(9)
    ds_read_b64_tr_b16 a[218:219], v246 offset:25536
    v_mfma_f32_16x16x32_bf16 v[152:155], a[240:243], v[104:107], v[152:155]
    v_mfma_f32_16x16x32_bf16 v[164:167], a[244:247], v[104:107], v[164:167]
    ds_read_b64_tr_b16 a[220:221], v246 offset:17120
    v_mfma_f32_16x16x32_bf16 v[160:163], a[244:247], v[100:103], v[160:163]
    s_waitcnt lgkmcnt(9)
    ds_read_b64_tr_b16 a[222:223], v246 offset:25568
    v_exp_f32 v124, v204
    v_cvt_pk_bf16_f32 v115, v122, v123
    v_exp_f32 v125, v205
    v_exp_f32 v126, v206
    v_cvt_pk_bf16_f32 v110, v124, v125
    v_exp_f32 v127, v207
    v_mfma_f32_16x16x32_bf16 v[156:159], a[244:247], v[96:99], v[156:159]
    v_mfma_f32_16x16x32_bf16 v[168:171], a[248:251], v[96:99], v[168:171]
    ds_read_b64_tr_b16 a[224:225], v246 offset:17152
    v_mfma_f32_16x16x32_bf16 v[172:175], a[248:251], v[100:103], v[172:175]
    s_waitcnt lgkmcnt(9)
    ds_read_b64_tr_b16 a[226:227], v246 offset:25600
    v_mfma_f32_16x16x32_bf16 v[176:179], a[248:251], v[104:107], v[176:179]
    v_mfma_f32_16x16x32_bf16 v[188:191], a[252:255], v[104:107], v[188:191]
    ds_read_b64_tr_b16 a[228:229], v246 offset:17184
    v_mfma_f32_16x16x32_bf16 v[184:187], a[252:255], v[100:103], v[184:187]
    s_waitcnt lgkmcnt(9)
    ds_read_b64_tr_b16 a[230:231], v246 offset:25632
    v_mfma_f32_16x16x32_bf16 v[180:183], a[252:255], v[96:99], v[180:183]
    v_mfma_f32_16x16x32_bf16 a[48:51], a[208:211], v[96:99], a[48:51]
    ds_read_b64_tr_b16 a[232:233], v246 offset:17216
    v_mfma_f32_16x16x32_bf16 a[52:55], a[208:211], v[100:103], a[52:55]
    s_waitcnt lgkmcnt(9)
    ds_read_b64_tr_b16 a[234:235], v246 offset:25664
    v_mfma_f32_16x16x32_bf16 a[56:59], a[208:211], v[104:107], a[56:59]
    v_mfma_f32_16x16x32_bf16 a[68:71], a[212:215], v[104:107], a[68:71]
    ds_read_b64_tr_b16 a[236:237], v246 offset:17248
    v_mfma_f32_16x16x32_bf16 a[64:67], a[212:215], v[100:103], a[64:67]
    s_waitcnt lgkmcnt(9)
    ds_read_b64_tr_b16 a[238:239], v246 offset:25696
    v_mfma_f32_16x16x32_bf16 a[60:63], a[212:215], v[96:99], a[60:63]
    v_mfma_f32_16x16x32_bf16 a[72:75], a[216:219], v[96:99], a[72:75]
    ds_read_b64_tr_b16 a[240:241], v246 offset:17280
    v_mfma_f32_16x16x32_bf16 a[76:79], a[216:219], v[100:103], a[76:79]
    s_waitcnt lgkmcnt(9)
    ds_read_b64_tr_b16 a[242:243], v246 offset:25728
    v_mfma_f32_16x16x32_bf16 a[80:83], a[216:219], v[104:107], a[80:83]
    v_mfma_f32_16x16x32_bf16 a[92:95], a[220:223], v[104:107], a[92:95]
    ds_read_b64_tr_b16 a[244:245], v246 offset:17312
    v_mfma_f32_16x16x32_bf16 a[88:91], a[220:223], v[100:103], a[88:91]
    s_waitcnt lgkmcnt(9)
    ds_read_b64_tr_b16 a[246:247], v246 offset:25760
    v_mfma_f32_16x16x32_bf16 a[84:87], a[220:223], v[96:99], a[84:87]
    v_mfma_f32_16x16x32_bf16 a[96:99], a[224:227], v[96:99], a[96:99]
    ds_read_b64_tr_b16 a[248:249], v246 offset:17344
    v_mfma_f32_16x16x32_bf16 a[100:103], a[224:227], v[100:103], a[100:103]
    s_waitcnt lgkmcnt(9)
    ds_read_b64_tr_b16 a[250:251], v246 offset:25792
    v_mfma_f32_16x16x32_bf16 a[104:107], a[224:227], v[104:107], a[104:107]
    v_mfma_f32_16x16x32_bf16 a[116:119], a[228:231], v[104:107], a[116:119]
    s_waitcnt lgkmcnt(8)
    ds_read_b64_tr_b16 a[252:253], v246 offset:17376
    v_mfma_f32_16x16x32_bf16 a[112:115], a[228:231], v[100:103], a[112:115]
    s_waitcnt vmcnt(11)
    ds_read_b64_tr_b16 a[254:255], v246 offset:25824
    v_mfma_f32_16x16x32_bf16 a[108:111], a[228:231], v[96:99], a[108:111]
    s_add_u32 m0, s33, 68064
    v_mfma_f32_16x16x32_bf16 a[120:123], a[232:235], v[96:99], a[120:123]
    s_barrier
    ds_read_b64_tr_b16 a[208:209], v244 offset:16896
    v_mfma_f32_16x16x32_bf16 a[124:127], a[232:235], v[100:103], a[124:127]
    s_waitcnt lgkmcnt(9)
    ds_read_b64_tr_b16 a[210:211], v244 offset:25344
    v_mfma_f32_16x16x32_bf16 a[128:131], a[232:235], v[104:107], a[128:131]
    v_mfma_f32_16x16x32_bf16 a[140:143], a[236:239], v[104:107], a[140:143]
    ds_read_b64_tr_b16 a[212:213], v244 offset:16928
    v_cvt_pk_bf16_f32 v111, v126, v127
    v_mfma_f32_16x16x32_bf16 a[136:139], a[236:239], v[100:103], a[136:139]
    s_waitcnt lgkmcnt(9)
    ds_read_b64_tr_b16 a[214:215], v244 offset:25376
    v_mfma_f32_16x16x32_bf16 a[132:135], a[236:239], v[96:99], a[132:135]
    buffer_load_dwordx4 v247, s[24:27], s51 offen offset:2688 lds
    v_mfma_f32_16x16x32_bf16 a[144:147], a[240:243], v[96:99], a[144:147]
    s_add_u32 s51, s57, 114688
    ds_read_b64_tr_b16 a[216:217], v244 offset:16960
    s_add_u32 m0, s33, 50688
    v_mfma_f32_16x16x32_bf16 a[148:151], a[240:243], v[100:103], a[148:151]
    ds_read_b64_tr_b16 a[218:219], v244 offset:25408
    v_mfma_f32_16x16x32_bf16 a[152:155], a[240:243], v[104:107], a[152:155]
    buffer_load_dwordx4 v247, s[24:27], s51 offen lds
    v_mfma_f32_16x16x32_bf16 v[132:135], a[192:195], v[108:111], v[128:131]
    s_add_u32 m0, s33, 50848
    v_mfma_f32_16x16x32_bf16 v[132:135], a[196:199], v[112:115], v[132:135]
    v_mfma_f32_16x16x32_bf16 v[132:135], a[200:203], v[116:119], v[132:135]
    s_waitcnt lgkmcnt(10)
    v_mfma_f32_16x16x32_bf16 a[164:167], a[244:247], v[104:107], a[164:167]
L_pad9:
    s_cbranch_execz L_pad13
    ds_read_b64_tr_b16 a[220:221], v244 offset:16992
    v_mfma_f32_16x16x32_bf16 a[160:163], a[244:247], v[100:103], a[160:163]
    s_waitcnt lgkmcnt(9)
    ds_read_b64_tr_b16 a[222:223], v244 offset:25440
    v_mfma_f32_16x16x32_bf16 a[156:159], a[244:247], v[96:99], a[156:159]
    buffer_load_dwordx4 v247, s[24:27], s51 offen offset:896 lds
    v_mfma_f32_16x16x32_bf16 a[168:171], a[248:251], v[96:99], a[168:171]
    ds_read_b64_tr_b16 a[224:225], v244 offset:17024
    v_mfma_f32_16x16x32_bf16 a[172:175], a[248:251], v[100:103], a[172:175]
    s_waitcnt lgkmcnt(9)
    ds_read_b64_tr_b16 a[226:227], v244 offset:25472
    v_max3_f32 v136, v132, v133, v134
    v_mfma_f32_16x16x32_bf16 a[176:179], a[248:251], v[104:107], a[176:179]
    s_add_u32 m0, s33, 51008
    v_cmp_nge_f32 vcc, s53, v136
    v_mfma_f32_16x16x32_bf16 a[188:191], a[252:255], v[104:107], a[188:191]
    ds_read_b64_tr_b16 a[228:229], v244 offset:17056
    v_mfma_f32_16x16x32_bf16 a[184:187], a[252:255], v[100:103], a[184:187]
    s_waitcnt lgkmcnt(9)
    ds_read_b64_tr_b16 a[230:231], v244 offset:25504
    v_mfma_f32_16x16x32_bf16 a[180:183], a[252:255], v[96:99], a[180:183]
    s_cbranch_vccnz L_stub15
L_back15:
    v_mfma_f32_16x16x32_bf16 v[144:147], a[208:211], v[108:111], v[144:147]
    ds_read_b64_tr_b16 a[232:233], v244 offset:17088
    v_mfma_f32_16x16x32_bf16 v[148:151], a[208:211], v[112:115], v[148:151]
    s_waitcnt lgkmcnt(9)
    ds_read_b64_tr_b16 a[234:235], v244 offset:25536
    v_rcp_f32 v228, v132
    v_mfma_f32_16x16x32_bf16 v[152:155], a[208:211], v[116:119], v[152:155]
    buffer_load_dwordx4 v247, s[24:27], s51 offen offset:1792 lds
    v_mfma_f32_16x16x32_bf16 v[164:167], a[212:215], v[116:119], v[164:167]
    s_add_u32 m0, s33, 51168
    ds_read_b64_tr_b16 a[236:237], v244 offset:17120
    v_mfma_f32_16x16x32_bf16 v[160:163], a[212:215], v[112:115], v[160:163]
    s_waitcnt lgkmcnt(9)
    ds_read_b64_tr_b16 a[238:239], v244 offset:25568
    v_rcp_f32 v229, v133
    v_mfma_f32_16x16x32_bf16 v[156:159], a[212:215], v[108:111], v[156:159]
    buffer_load_dwordx4 v247, s[24:27], s51 offen offset:2688 lds
    v_mfma_f32_16x16x32_bf16 v[168:171], a[216:219], v[108:111], v[168:171]
    ds_read_b64_tr_b16 a[240:241], v244 offset:17152
    v_cvt_pk_bf16_f32 v0, v144, v145
    v_cvt_pk_bf16_f32 v1, v146, v147
    v_mfma_f32_16x16x32_bf16 v[172:175], a[216:219], v[112:115], v[172:175]
    s_waitcnt lgkmcnt(9)
    ds_read_b64_tr_b16 a[242:243], v244 offset:25600
    v_rcp_f32 v230, v134
    v_mfma_f32_16x16x32_bf16 v[176:179], a[216:219], v[116:119], v[176:179]
    s_add_u32 s51, s58, 0
    s_add_u32 m0, s33, 84480
    v_cvt_pk_bf16_f32 v4, v148, v149
    v_cvt_pk_bf16_f32 v5, v150, v151
    v_mfma_f32_16x16x32_bf16 v[188:191], a[220:223], v[116:119], v[188:191]
    ds_read_b64_tr_b16 a[244:245], v244 offset:17184
    v_cvt_pk_bf16_f32 v8, v152, v153
    v_cvt_pk_bf16_f32 v9, v154, v155
    v_mfma_f32_16x16x32_bf16 v[184:187], a[220:223], v[112:115], v[184:187]
    s_waitcnt lgkmcnt(9)
    ds_read_b64_tr_b16 a[246:247], v244 offset:25632
    v_cvt_pk_bf16_f32 v10, v164, v165
    v_cvt_pk_bf16_f32 v11, v166, v167
    v_mfma_f32_16x16x32_bf16 v[180:183], a[220:223], v[108:111], v[180:183]
    v_cvt_pk_bf16_f32 v6, v160, v161
    v_cvt_pk_bf16_f32 v7, v162, v163
    v_cvt_pk_bf16_f32 v2, v156, v157
    v_cvt_pk_bf16_f32 v3, v158, v159
    v_mfma_f32_16x16x32_bf16 a[48:51], a[224:227], v[108:111], a[48:51]
    ds_read_b64_tr_b16 a[248:249], v244 offset:17216
    v_cvt_pk_bf16_f32 v12, v168, v169
    v_cvt_pk_bf16_f32 v13, v170, v171
    v_cvt_pk_bf16_f32 v16, v172, v173
    v_mfma_f32_16x16x32_bf16 a[52:55], a[224:227], v[112:115], a[52:55]
    s_waitcnt lgkmcnt(9)
    ds_read_b64_tr_b16 a[250:251], v244 offset:25664
    v_cvt_pk_bf16_f32 v17, v174, v175
    v_cvt_pk_bf16_f32 v20, v176, v177
    v_mfma_f32_16x16x32_bf16 a[56:59], a[224:227], v[116:119], a[56:59]
    buffer_load_dwordx4 v247, s[24:27], s51 offen lds
    v_mfma_f32_16x16x32_bf16 a[68:71], a[228:231], v[116:119], a[68:71]
    s_add_u32 m0, s33, 84640
    ds_read_b64_tr_b16 a[252:253], v244 offset:17248
    v_cvt_pk_bf16_f32 v21, v178, v179
    v_cvt_pk_bf16_f32 v22, v188, v189
    v_mfma_f32_16x16x32_bf16 a[64:67], a[228:231], v[112:115], a[64:67]
    s_waitcnt lgkmcnt(9)
    ds_read_b64_tr_b16 a[254:255], v244 offset:25696
    v_cvt_pk_bf16_f32 v23, v190, v191
    v_cvt_pk_bf16_f32 v18, v184, v185
    v_mfma_f32_16x16x32_bf16 a[60:63], a[228:231], v[108:111], a[60:63]
    buffer_load_dwordx4 v247, s[24:27], s51 offen offset:896 lds
    v_mfma_f32_16x16x32_bf16 a[72:75], a[232:235], v[108:111], a[72:75]
    s_add_u32 m0, s33, 84800
    ds_read_b64_tr_b16 a[208:209], v244 offset:17280
    v_cvt_pk_bf16_f32 v19, v186, v187
    v_cvt_pk_bf16_f32 v14, v180, v181
    v_cvt_pk_bf16_f32 v15, v182, v183
    v_mfma_f32_16x16x32_bf16 a[76:79], a[232:235], v[112:115], a[76:79]
    s_waitcnt lgkmcnt(9)
    ds_read_b64_tr_b16 a[210:211], v244 offset:25728
    v_accvgpr_read_b32 v216, a48
    v_accvgpr_read_b32 v217, a49
    v_mfma_f32_16x16x32_bf16 a[80:83], a[232:235], v[116:119], a[80:83]
    buffer_load_dwordx4 v247, s[24:27], s51 offen offset:1792 lds
    v_mfma_f32_16x16x32_bf16 a[92:95], a[236:239], v[116:119], a[92:95]
    s_add_u32 m0, s33, 84960
    ds_read_b64_tr_b16 a[212:213], v244 offset:17312
    v_accvgpr_read_b32 v218, a50
    v_accvgpr_read_b32 v219, a51
    v_mfma_f32_16x16x32_bf16 a[88:91], a[236:239], v[112:115], a[88:91]
    s_waitcnt lgkmcnt(9)
    ds_read_b64_tr_b16 a[214:215], v244 offset:25760
    v_cvt_pk_bf16_f32 v24, v216, v217
    v_cvt_pk_bf16_f32 v25, v218, v219
    v_mfma_f32_16x16x32_bf16 a[84:87], a[236:239], v[108:111], a[84:87]
    buffer_load_dwordx4 v247, s[24:27], s51 offen offset:2688 lds
    v_mfma_f32_16x16x32_bf16 a[96:99], a[240:243], v[108:111], a[96:99]
    ds_read_b64_tr_b16 a[216:217], v244 offset:17344
    v_accvgpr_read_b32 v220, a52
    v_accvgpr_read_b32 v221, a53
    v_mfma_f32_16x16x32_bf16 a[100:103], a[240:243], v[112:115], a[100:103]
    s_waitcnt lgkmcnt(9)
    ds_read_b64_tr_b16 a[218:219], v244 offset:25792
    v_accvgpr_read_b32 v222, a54
    v_accvgpr_read_b32 v223, a55
    v_mfma_f32_16x16x32_bf16 a[104:107], a[240:243], v[116:119], a[104:107]
    v_cvt_pk_bf16_f32 v28, v220, v221
    v_cvt_pk_bf16_f32 v29, v222, v223
    v_accvgpr_read_b32 v216, a56
    v_mfma_f32_16x16x32_bf16 a[116:119], a[244:247], v[116:119], a[116:119]
    s_waitcnt lgkmcnt(8)
    ds_read_b64_tr_b16 a[220:221], v244 offset:17376
    v_accvgpr_read_b32 v217, a57
    v_accvgpr_read_b32 v218, a58
    v_mfma_f32_16x16x32_bf16 a[112:115], a[244:247], v[112:115], a[112:115]
    s_waitcnt vmcnt(12)
    ds_read_b64_tr_b16 a[222:223], v244 offset:25824
    v_accvgpr_read_b32 v219, a59
    v_cvt_pk_bf16_f32 v32, v216, v217
    v_mfma_f32_16x16x32_bf16 a[108:111], a[244:247], v[108:111], a[108:111]
    v_cvt_pk_bf16_f32 v33, v218, v219
    v_accvgpr_read_b32 v220, a68
    v_accvgpr_read_b32 v221, a69
    v_mfma_f32_16x16x32_bf16 a[120:123], a[248:251], v[108:111], a[120:123]
    s_barrier
    ds_read_b64_tr_b16 a[224:225], v250 offset:33792
    v_accvgpr_read_b32 v222, a70
    v_accvgpr_read_b32 v223, a71
    v_mfma_f32_16x16x32_bf16 a[124:127], a[248:251], v[112:115], a[124:127]
    s_waitcnt lgkmcnt(9)
    ds_read_b64_tr_b16 a[226:227], v250 offset:34048
    v_cvt_pk_bf16_f32 v34, v220, v221
    v_cvt_pk_bf16_f32 v35, v222, v223
    v_mfma_f32_16x16x32_bf16 a[128:131], a[248:251], v[116:119], a[128:131]
    s_add_u32 s51, s58, 114688
    s_add_u32 m0, s33, 0
    v_accvgpr_read_b32 v216, a64
    v_accvgpr_read_b32 v217, a65
    v_mfma_f32_16x16x32_bf16 a[140:143], a[252:255], v[116:119], a[140:143]
    ds_read_b64_tr_b16 a[228:229], v250 offset:33824
    v_accvgpr_read_b32 v218, a66
    v_accvgpr_read_b32 v219, a67
    v_mfma_f32_16x16x32_bf16 a[136:139], a[252:255], v[112:115], a[136:139]
    s_waitcnt lgkmcnt(9)
    ds_read_b64_tr_b16 a[230:231], v250 offset:34080
    v_cvt_pk_bf16_f32 v30, v216, v217
    v_cvt_pk_bf16_f32 v31, v218, v219
    v_mfma_f32_16x16x32_bf16 a[132:135], a[252:255], v[108:111], a[132:135]
    v_accvgpr_read_b32 v220, a60
    v_accvgpr_read_b32 v221, a61
    v_accvgpr_read_b32 v222, a62
    v_mfma_f32_16x16x32_bf16 a[144:147], a[208:211], v[108:111], a[144:147]
    ds_read_b64_tr_b16 a[232:233], v250 offset:33856
    v_accvgpr_read_b32 v223, a63
    v_cvt_pk_bf16_f32 v26, v220, v221
    v_mfma_f32_16x16x32_bf16 a[148:151], a[208:211], v[112:115], a[148:151]
    s_waitcnt lgkmcnt(9)
    ds_read_b64_tr_b16 a[234:235], v250 offset:34112
    v_cvt_pk_bf16_f32 v27, v222, v223
    v_accvgpr_read_b32 v216, a72
    v_mfma_f32_16x16x32_bf16 a[152:155], a[208:211], v[116:119], a[152:155]
    buffer_load_dwordx4 v247, s[24:27], s51 offen lds
    v_accvgpr_read_b32 v217, a73
    v_mfma_f32_16x16x32_bf16 a[164:167], a[212:215], v[116:119], a[164:167]
    s_add_u32 m0, s33, 160
    ds_read_b64_tr_b16 a[236:237], v250 offset:33888
    v_accvgpr_read_b32 v218, a74
    v_accvgpr_read_b32 v219, a75
    v_mfma_f32_16x16x32_bf16 a[160:163], a[212:215], v[112:115], a[160:163]
    s_waitcnt lgkmcnt(9)
    ds_read_b64_tr_b16 a[238:239], v250 offset:34144
    v_cvt_pk_bf16_f32 v36, v216, v217
    v_cvt_pk_bf16_f32 v37, v218, v219
    v_mfma_f32_16x16x32_bf16 a[156:159], a[212:215], v[108:111], a[156:159]
    buffer_load_dwordx4 v247, s[24:27], s51 offen offset:896 lds
    v_mfma_f32_16x16x32_bf16 a[168:171], a[216:219], v[108:111], a[168:171]
    s_add_u32 m0, s33, 320
    ds_read_b64_tr_b16 a[240:241], v250 offset:34304
    v_accvgpr_read_b32 v220, a76
    v_accvgpr_read_b32 v221, a77
    v_mfma_f32_16x16x32_bf16 a[172:175], a[216:219], v[112:115], a[172:175]
    s_waitcnt lgkmcnt(9)
    ds_read_b64_tr_b16 a[242:243], v250 offset:34560
    v_accvgpr_read_b32 v222, a78
    v_accvgpr_read_b32 v223, a79
    v_mfma_f32_16x16x32_bf16 a[176:179], a[216:219], v[116:119], a[176:179]
    buffer_load_dwordx4 v247, s[24:27], s51 offen offset:1792 lds
    v_cvt_pk_bf16_f32 v40, v220, v221
    v_mfma_f32_16x16x32_bf16 a[188:191], a[220:223], v[116:119], a[188:191]
    s_add_u32 m0, s33, 480
    ds_read_b64_tr_b16 a[244:245], v250 offset:34336
    v_cvt_pk_bf16_f32 v41, v222, v223
    v_accvgpr_read_b32 v216, a80
    v_mfma_f32_16x16x32_bf16 a[184:187], a[220:223], v[112:115], a[184:187]
    s_waitcnt lgkmcnt(9)
    ds_read_b64_tr_b16 a[246:247], v250 offset:34592
    v_accvgpr_read_b32 v217, a81
    v_accvgpr_read_b32 v218, a82
    v_mfma_f32_16x16x32_bf16 a[180:183], a[220:223], v[108:111], a[180:183]
    buffer_load_dwordx4 v247, s[24:27], s51 offen offset:2688 lds
    v_mfma_f32_16x16x32_bf16 v[96:99], a[224:227], v[0:3], 0
    ds_read_b64_tr_b16 a[248:249], v250 offset:34368
    v_accvgpr_read_b32 v219, a83
    v_cvt_pk_bf16_f32 v44, v216, v217
    v_mfma_f32_16x16x32_bf16 v[112:115], a[224:227], v[4:7], 0
    s_waitcnt lgkmcnt(9)
    ds_read_b64_tr_b16 a[250:251], v250 offset:34624
    v_cvt_pk_bf16_f32 v45, v218, v219
    v_accvgpr_read_b32 v220, a92
    v_mfma_f32_16x16x32_bf16 v[128:131], a[224:227], v[8:11], 0
    v_accvgpr_read_b32 v221, a93
    v_accvgpr_read_b32 v222, a94
    v_accvgpr_read_b32 v223, a95
    v_cvt_pk_bf16_f32 v46, v220, v221
    v_mfma_f32_16x16x32_bf16 v[132:135], a[228:231], v[8:11], 0
    ds_read_b64_tr_b16 a[252:253], v250 offset:34400
    v_cvt_pk_bf16_f32 v47, v222, v223
    v_accvgpr_read_b32 v216, a88
    v_mfma_f32_16x16x32_bf16 v[116:119], a[228:231], v[4:7], 0
    s_waitcnt lgkmcnt(9)
    ds_read_b64_tr_b16 a[254:255], v250 offset:34656
    v_accvgpr_read_b32 v217, a89
    v_accvgpr_read_b32 v218, a90
    v_mfma_f32_16x16x32_bf16 v[100:103], a[228:231], v[0:3], 0
    v_accvgpr_read_b32 v219, a91
    v_cvt_pk_bf16_f32 v42, v216, v217
    v_cvt_pk_bf16_f32 v43, v218, v219
    v_mfma_f32_16x16x32_bf16 v[104:107], a[232:235], v[0:3], 0
    ds_read_b64_tr_b16 a[208:209], v250 offset:42240
    v_accvgpr_read_b32 v220, a84
    v_accvgpr_read_b32 v221, a85
    v_mfma_f32_16x16x32_bf16 v[120:123], a[232:235], v[4:7], 0
    s_waitcnt lgkmcnt(9)
    ds_read_b64_tr_b16 a[210:211], v250 offset:42496
    v_accvgpr_read_b32 v222, a86
    v_accvgpr_read_b32 v223, a87
    v_mfma_f32_16x16x32_bf16 v[136:139], a[232:235], v[8:11], 0
    s_add_u32 s51, s59, 0
    s_add_u32 m0, s33, 101376
    v_cvt_pk_bf16_f32 v38, v220, v221
    v_cvt_pk_bf16_f32 v39, v222, v223
    v_mfma_f32_16x16x32_bf16 v[140:143], a[236:239], v[8:11], 0
    ds_read_b64_tr_b16 a[212:213], v250 offset:42272
    v_accvgpr_read_b32 v216, a96
    v_accvgpr_read_b32 v217, a97
    v_accvgpr_read_b32 v218, a98
    v_mfma_f32_16x16x32_bf16 v[124:127], a[236:239], v[4:7], 0
    s_waitcnt lgkmcnt(9)
    ds_read_b64_tr_b16 a[214:215], v250 offset:42528
    v_accvgpr_read_b32 v219, a99
    v_cvt_pk_bf16_f32 v48, v216, v217
    v_mfma_f32_16x16x32_bf16 v[108:111], a[236:239], v[0:3], 0
    v_cvt_pk_bf16_f32 v49, v218, v219
    v_accvgpr_read_b32 v220, a100
    v_accvgpr_read_b32 v221, a101
    v_mfma_f32_16x16x32_bf16 v[96:99], a[240:243], v[12:15], v[96:99]
    ds_read_b64_tr_b16 a[216:217], v250 offset:42304
    v_accvgpr_read_b32 v222, a102
    v_accvgpr_read_b32 v223, a103
    v_mfma_f32_16x16x32_bf16 v[112:115], a[240:243], v[16:19], v[112:115]
    s_waitcnt lgkmcnt(9)
    ds_read_b64_tr_b16 a[218:219], v250 offset:42560
    v_cvt_pk_bf16_f32 v52, v220, v221
    v_cvt_pk_bf16_f32 v53, v222, v223
    v_mfma_f32_16x16x32_bf16 v[128:131], a[240:243], v[20:23], v[128:131]
    buffer_load_dwordx4 v247, s[24:27], s51 offen lds
    v_mfma_f32_16x16x32_bf16 v[132:135], a[244:247], v[20:23], v[132:135]
    s_add_u32 m0, s33, 101536
    ds_read_b64_tr_b16 a[220:221], v250 offset:42336
    v_accvgpr_read_b32 v216, a104
    v_accvgpr_read_b32 v217, a105
    v_accvgpr_read_b32 v218, a106
    v_mfma_f32_16x16x32_bf16 v[116:119], a[244:247], v[16:19], v[116:119]
    s_waitcnt lgkmcnt(9)
    ds_read_b64_tr_b16 a[222:223], v250 offset:42592
    v_accvgpr_read_b32 v219, a107
    v_cvt_pk_bf16_f32 v56, v216, v217
    v_mfma_f32_16x16x32_bf16 v[100:103], a[244:247], v[12:15], v[100:103]
    buffer_load_dwordx4 v247, s[24:27], s51 offen offset:896 lds
    v_mfma_f32_16x16x32_bf16 v[104:107], a[248:251], v[12:15], v[104:107]
    s_add_u32 m0, s33, 101696
    ds_read_b64_tr_b16 a[224:225], v250 offset:42752
    v_cvt_pk_bf16_f32 v57, v218, v219
    v_accvgpr_read_b32 v220, a116
    v_mfma_f32_16x16x32_bf16 v[120:123], a[248:251], v[16:19], v[120:123]
    s_waitcnt lgkmcnt(9)
    ds_read_b64_tr_b16 a[226:227], v250 offset:43008
    v_accvgpr_read_b32 v221, a117
    v_accvgpr_read_b32 v222, a118
    v_mfma_f32_16x16x32_bf16 v[136:139], a[248:251], v[20:23], v[136:139]
    buffer_load_dwordx4 v247, s[24:27], s51 offen offset:1792 lds
    v_mfma_f32_16x16x32_bf16 v[140:143], a[252:255], v[20:23], v[140:143]
    s_add_u32 m0, s33, 101856
    ds_read_b64_tr_b16 a[228:229], v250 offset:42784
    v_accvgpr_read_b32 v223, a119
    v_cvt_pk_bf16_f32 v58, v220, v221
    v_cvt_pk_bf16_f32 v59, v222, v223
    v_mfma_f32_16x16x32_bf16 v[124:127], a[252:255], v[16:19], v[124:127]
    s_waitcnt lgkmcnt(9)
    ds_read_b64_tr_b16 a[230:231], v250 offset:43040
    v_accvgpr_read_b32 v216, a112
    v_accvgpr_read_b32 v217, a113
    v_mfma_f32_16x16x32_bf16 v[108:111], a[252:255], v[12:15], v[108:111]
    buffer_load_dwordx4 v247, s[24:27], s51 offen offset:2688 lds
    v_mfma_f32_16x16x32_bf16 v[96:99], a[208:211], v[24:27], v[96:99]
    ds_read_b64_tr_b16 a[232:233], v250 offset:42816
    v_accvgpr_read_b32 v218, a114
    v_accvgpr_read_b32 v219, a115
    v_mfma_f32_16x16x32_bf16 v[112:115], a[208:211], v[28:31], v[112:115]
    s_waitcnt lgkmcnt(9)
    ds_read_b64_tr_b16 a[234:235], v250 offset:43072
    v_cvt_pk_bf16_f32 v54, v216, v217
    v_cvt_pk_bf16_f32 v55, v218, v219
    v_mfma_f32_16x16x32_bf16 v[128:131], a[208:211], v[32:35], v[128:131]
    v_accvgpr_read_b32 v220, a108
    v_accvgpr_read_b32 v221, a109
    v_accvgpr_read_b32 v222, a110
    v_mfma_f32_16x16x32_bf16 v[132:135], a[212:215], v[32:35], v[132:135]
    ds_read_b64_tr_b16 a[236:237], v250 offset:42848
    v_accvgpr_read_b32 v223, a111
    v_cvt_pk_bf16_f32 v50, v220, v221
    v_cvt_pk_bf16_f32 v51, v222, v223
    v_mfma_f32_16x16x32_bf16 v[116:119], a[212:215], v[28:31], v[116:119]
    s_waitcnt lgkmcnt(9)
    ds_read_b64_tr_b16 a[238:239], v250 offset:43104
    v_accvgpr_read_b32 v216, a120
    v_mfma_f32_16x16x32_bf16 v[100:103], a[212:215], v[24:27], v[100:103]
    v_accvgpr_read_b32 v217, a121
    v_accvgpr_read_b32 v218, a122
    v_accvgpr_read_b32 v219, a123
    v_mfma_f32_16x16x32_bf16 v[104:107], a[216:219], v[24:27], v[104:107]
    ds_read_b64_tr_b16 a[240:241], v248 offset:33792
    v_cvt_pk_bf16_f32 v60, v216, v217
    v_cvt_pk_bf16_f32 v61, v218, v219
    v_mfma_f32_16x16x32_bf16 v[120:123], a[216:219], v[28:31], v[120:123]
    s_waitcnt lgkmcnt(9)
    ds_read_b64_tr_b16 a[242:243], v248 offset:34048
    v_accvgpr_read_b32 v220, a124
    v_mfma_f32_16x16x32_bf16 v[136:139], a[216:219], v[32:35], v[136:139]
    v_accvgpr_read_b32 v221, a125
    v_accvgpr_read_b32 v222, a126
    v_accvgpr_read_b32 v223, a127
    v_mfma_f32_16x16x32_bf16 v[140:143], a[220:223], v[32:35], v[140:143]
    ds_read_b64_tr_b16 a[244:245], v248 offset:33824
    v_cvt_pk_bf16_f32 v64, v220, v221
    v_cvt_pk_bf16_f32 v65, v222, v223
    v_mfma_f32_16x16x32_bf16 v[124:127], a[220:223], v[28:31], v[124:127]
    s_waitcnt lgkmcnt(9)
    ds_read_b64_tr_b16 a[246:247], v248 offset:34080
    v_accvgpr_read_b32 v216, a128
    v_mfma_f32_16x16x32_bf16 v[108:111], a[220:223], v[24:27], v[108:111]
    v_accvgpr_read_b32 v217, a129
    v_accvgpr_read_b32 v218, a130
    v_accvgpr_read_b32 v219, a131
    v_mfma_f32_16x16x32_bf16 v[96:99], a[224:227], v[36:39], v[96:99]
    ds_read_b64_tr_b16 a[248:249], v248 offset:33856
    v_cvt_pk_bf16_f32 v68, v216, v217
    v_cvt_pk_bf16_f32 v69, v218, v219
    v_mfma_f32_16x16x32_bf16 v[112:115], a[224:227], v[40:43], v[112:115]
    s_waitcnt lgkmcnt(9)
    ds_read_b64_tr_b16 a[250:251], v248 offset:34112
    v_accvgpr_read_b32 v220, a140
    v_mfma_f32_16x16x32_bf16 v[128:131], a[224:227], v[44:47], v[128:131]
    v_accvgpr_read_b32 v221, a141
    v_accvgpr_read_b32 v222, a142
    v_accvgpr_read_b32 v223, a143
    v_mfma_f32_16x16x32_bf16 v[132:135], a[228:231], v[44:47], v[132:135]
    ds_read_b64_tr_b16 a[252:253], v248 offset:33888
    v_cvt_pk_bf16_f32 v70, v220, v221
    v_cvt_pk_bf16_f32 v71, v222, v223
    v_mfma_f32_16x16x32_bf16 v[116:119], a[228:231], v[40:43], v[116:119]
    s_waitcnt lgkmcnt(9)
    ds_read_b64_tr_b16 a[254:255], v248 offset:34144
    v_accvgpr_read_b32 v216, a136
    v_mfma_f32_16x16x32_bf16 v[100:103], a[228:231], v[36:39], v[100:103]
    v_accvgpr_read_b32 v217, a137
    v_accvgpr_read_b32 v218, a138
    v_accvgpr_read_b32 v219, a139
    v_mfma_f32_16x16x32_bf16 v[104:107], a[232:235], v[36:39], v[104:107]
    ds_read_b64_tr_b16 a[208:209], v248 offset:34304
    v_cvt_pk_bf16_f32 v66, v216, v217
    v_cvt_pk_bf16_f32 v67, v218, v219
    v_mfma_f32_16x16x32_bf16 v[120:123], a[232:235], v[40:43], v[120:123]
    s_waitcnt lgkmcnt(9)
    ds_read_b64_tr_b16 a[210:211], v248 offset:34560
    v_accvgpr_read_b32 v220, a132
    v_mfma_f32_16x16x32_bf16 v[136:139], a[232:235], v[44:47], v[136:139]
    v_accvgpr_read_b32 v221, a133
    v_accvgpr_read_b32 v222, a134
    v_accvgpr_read_b32 v223, a135
    v_mfma_f32_16x16x32_bf16 v[140:143], a[236:239], v[44:47], v[140:143]
    ds_read_b64_tr_b16 a[212:213], v248 offset:34336
    v_cvt_pk_bf16_f32 v62, v220, v221
    v_cvt_pk_bf16_f32 v63, v222, v223
    v_mfma_f32_16x16x32_bf16 v[124:127], a[236:239], v[40:43], v[124:127]
    s_waitcnt lgkmcnt(9)
    ds_read_b64_tr_b16 a[214:215], v248 offset:34592
    v_accvgpr_read_b32 v216, a144
    v_mfma_f32_16x16x32_bf16 v[108:111], a[236:239], v[36:39], v[108:111]
    v_accvgpr_read_b32 v217, a145
    v_accvgpr_read_b32 v218, a146
    v_accvgpr_read_b32 v219, a147
    v_mfma_f32_16x16x32_bf16 v[96:99], a[240:243], v[48:51], v[96:99]
    ds_read_b64_tr_b16 a[216:217], v248 offset:34368
    v_cvt_pk_bf16_f32 v72, v216, v217
    v_cvt_pk_bf16_f32 v73, v218, v219
    v_mfma_f32_16x16x32_bf16 v[112:115], a[240:243], v[52:55], v[112:115]
    s_waitcnt lgkmcnt(9)
    ds_read_b64_tr_b16 a[218:219], v248 offset:34624
    v_accvgpr_read_b32 v220, a148
    v_mfma_f32_16x16x32_bf16 v[128:131], a[240:243], v[56:59], v[128:131]
    v_accvgpr_read_b32 v221, a149
    v_accvgpr_read_b32 v222, a150
    v_accvgpr_read_b32 v223, a151
    v_mfma_f32_16x16x32_bf16 v[132:135], a[244:247], v[56:59], v[132:135]
    ds_read_b64_tr_b16 a[220:221], v248 offset:34400
    v_cvt_pk_bf16_f32 v76, v220, v221
    v_cvt_pk_bf16_f32 v77, v222, v223
    v_mfma_f32_16x16x32_bf16 v[116:119], a[244:247], v[52:55], v[116:119]
    s_waitcnt lgkmcnt(9)
    ds_read_b64_tr_b16 a[222:223], v248 offset:34656
    v_accvgpr_read_b32 v216, a152
    v_mfma_f32_16x16x32_bf16 v[100:103], a[244:247], v[48:51], v[100:103]
    v_accvgpr_read_b32 v217, a153
    v_accvgpr_read_b32 v218, a154
    v_accvgpr_read_b32 v219, a155
    v_mfma_f32_16x16x32_bf16 v[104:107], a[248:251], v[48:51], v[104:107]
    ds_read_b64_tr_b16 a[224:225], v248 offset:42240
    v_cvt_pk_bf16_f32 v80, v216, v217
    v_cvt_pk_bf16_f32 v81, v218, v219
    v_mfma_f32_16x16x32_bf16 v[120:123], a[248:251], v[52:55], v[120:123]
    s_waitcnt lgkmcnt(9)
    ds_read_b64_tr_b16 a[226:227], v248 offset:42496
    v_accvgpr_read_b32 v220, a164
    v_mfma_f32_16x16x32_bf16 v[136:139], a[248:251], v[56:59], v[136:139]
    v_accvgpr_read_b32 v221, a165
    v_accvgpr_read_b32 v222, a166
    v_accvgpr_read_b32 v223, a167
    v_mfma_f32_16x16x32_bf16 v[140:143], a[252:255], v[56:59], v[140:143]
    ds_read_b64_tr_b16 a[228:229], v248 offset:42272
    v_cvt_pk_bf16_f32 v82, v220, v221
    v_cvt_pk_bf16_f32 v83, v222, v223
    v_mfma_f32_16x16x32_bf16 v[124:127], a[252:255], v[52:55], v[124:127]
    s_waitcnt lgkmcnt(9)
    ds_read_b64_tr_b16 a[230:231], v248 offset:42528
    v_accvgpr_read_b32 v216, a160
    v_mfma_f32_16x16x32_bf16 v[108:111], a[252:255], v[48:51], v[108:111]
    v_accvgpr_read_b32 v217, a161
    v_accvgpr_read_b32 v218, a162
    v_accvgpr_read_b32 v219, a163
    v_mfma_f32_16x16x32_bf16 v[96:99], a[208:211], v[60:63], v[96:99]
    ds_read_b64_tr_b16 a[232:233], v248 offset:42304
    v_cvt_pk_bf16_f32 v78, v216, v217
    v_cvt_pk_bf16_f32 v79, v218, v219
    v_mfma_f32_16x16x32_bf16 v[112:115], a[208:211], v[64:67], v[112:115]
    s_waitcnt lgkmcnt(9)
    ds_read_b64_tr_b16 a[234:235], v248 offset:42560
    v_accvgpr_read_b32 v220, a156
    v_mfma_f32_16x16x32_bf16 v[128:131], a[208:211], v[68:71], v[128:131]
    v_accvgpr_read_b32 v221, a157
    v_accvgpr_read_b32 v222, a158
    v_accvgpr_read_b32 v223, a159
    v_mfma_f32_16x16x32_bf16 v[132:135], a[212:215], v[68:71], v[132:135]
    ds_read_b64_tr_b16 a[236:237], v248 offset:42336
    v_cvt_pk_bf16_f32 v74, v220, v221
    v_cvt_pk_bf16_f32 v75, v222, v223
    v_mfma_f32_16x16x32_bf16 v[116:119], a[212:215], v[64:67], v[116:119]
    s_waitcnt lgkmcnt(9)
    ds_read_b64_tr_b16 a[238:239], v248 offset:42592
    v_accvgpr_read_b32 v216, a168
    v_mfma_f32_16x16x32_bf16 v[100:103], a[212:215], v[60:63], v[100:103]
    v_accvgpr_read_b32 v217, a169
    v_accvgpr_read_b32 v218, a170
    v_accvgpr_read_b32 v219, a171
    v_mfma_f32_16x16x32_bf16 v[104:107], a[216:219], v[60:63], v[104:107]
    ds_read_b64_tr_b16 a[240:241], v248 offset:42752
    v_cvt_pk_bf16_f32 v84, v216, v217
    v_cvt_pk_bf16_f32 v85, v218, v219
    v_mfma_f32_16x16x32_bf16 v[120:123], a[216:219], v[64:67], v[120:123]
    s_waitcnt lgkmcnt(9)
    ds_read_b64_tr_b16 a[242:243], v248 offset:43008
    v_accvgpr_read_b32 v220, a172
    v_mfma_f32_16x16x32_bf16 v[136:139], a[216:219], v[68:71], v[136:139]
    v_accvgpr_read_b32 v221, a173
    v_accvgpr_read_b32 v222, a174
    v_accvgpr_read_b32 v223, a175
    v_mfma_f32_16x16x32_bf16 v[140:143], a[220:223], v[68:71], v[140:143]
    ds_read_b64_tr_b16 a[244:245], v248 offset:42784
    v_cvt_pk_bf16_f32 v88, v220, v221
    v_cvt_pk_bf16_f32 v89, v222, v223
    v_mfma_f32_16x16x32_bf16 v[124:127], a[220:223], v[64:67], v[124:127]
    s_waitcnt lgkmcnt(9)
    ds_read_b64_tr_b16 a[246:247], v248 offset:43040
    v_accvgpr_read_b32 v216, a176
    v_mfma_f32_16x16x32_bf16 v[108:111], a[220:223], v[60:63], v[108:111]
    v_accvgpr_read_b32 v217, a177
    v_accvgpr_read_b32 v218, a178
    v_accvgpr_read_b32 v219, a179
    v_mfma_f32_16x16x32_bf16 v[96:99], a[224:227], v[72:75], v[96:99]
    ds_read_b64_tr_b16 a[248:249], v248 offset:42816
    v_cvt_pk_bf16_f32 v92, v216, v217
    v_cvt_pk_bf16_f32 v93, v218, v219
    v_mfma_f32_16x16x32_bf16 v[112:115], a[224:227], v[76:79], v[112:115]
    s_waitcnt lgkmcnt(9)
    ds_read_b64_tr_b16 a[250:251], v248 offset:43072
    v_accvgpr_read_b32 v220, a188
    v_mfma_f32_16x16x32_bf16 v[128:131], a[224:227], v[80:83], v[128:131]
    v_accvgpr_read_b32 v221, a189
    v_accvgpr_read_b32 v222, a190
    v_accvgpr_read_b32 v223, a191
    v_mfma_f32_16x16x32_bf16 v[132:135], a[228:231], v[80:83], v[132:135]
    s_waitcnt lgkmcnt(8)
    ds_read_b64_tr_b16 a[252:253], v248 offset:42848
    v_cvt_pk_bf16_f32 v94, v220, v221
    v_cvt_pk_bf16_f32 v95, v222, v223
    v_mfma_f32_16x16x32_bf16 v[116:119], a[228:231], v[76:79], v[116:119]
    s_waitcnt vmcnt(12)
    ds_read_b64_tr_b16 a[254:255], v248 offset:43104
    v_accvgpr_read_b32 v216, a184
    v_mfma_f32_16x16x32_bf16 v[100:103], a[228:231], v[72:75], v[100:103]
    s_add_u32 s51, s59, 114688
    s_add_u32 m0, s33, 118272
    v_accvgpr_read_b32 v217, a185
    v_accvgpr_read_b32 v218, a186
    v_mfma_f32_16x16x32_bf16 v[104:107], a[232:235], v[72:75], v[104:107]
    s_barrier
    ds_read_b64_tr_b16 a[208:209], v249 offset:16896
L_pad10:
    s_cbranch_execz L_main
    v_accvgpr_read_b32 v219, a187
    v_cvt_pk_bf16_f32 v90, v216, v217
    v_mfma_f32_16x16x32_bf16 v[120:123], a[232:235], v[76:79], v[120:123]
    s_waitcnt lgkmcnt(9)
    ds_read_b64_tr_b16 a[210:211], v249 offset:17152
    v_cvt_pk_bf16_f32 v91, v218, v219
    v_mfma_f32_16x16x32_bf16 v[136:139], a[232:235], v[80:83], v[136:139]
    v_accvgpr_read_b32 v220, a180
    v_accvgpr_read_b32 v221, a181
    v_accvgpr_read_b32 v222, a182
    v_mfma_f32_16x16x32_bf16 v[140:143], a[236:239], v[80:83], v[140:143]
    ds_read_b64_tr_b16 a[212:213], v249 offset:17408
    v_accvgpr_read_b32 v223, a183
    v_cvt_pk_bf16_f32 v86, v220, v221
    v_mfma_f32_16x16x32_bf16 v[124:127], a[236:239], v[76:79], v[124:127]
    s_waitcnt lgkmcnt(9)
    ds_read_b64_tr_b16 a[214:215], v249 offset:17664
    v_cvt_pk_bf16_f32 v87, v222, v223
    v_mfma_f32_16x16x32_bf16 v[108:111], a[236:239], v[72:75], v[108:111]
    buffer_load_dwordx4 v247, s[24:27], s51 offen lds
    v_mfma_f32_16x16x32_bf16 v[96:99], a[240:243], v[84:87], v[96:99]
    s_add_u32 m0, s33, 118432
    ds_read_b64_tr_b16 a[216:217], v249 offset:25344
    v_mfma_f32_16x16x32_bf16 v[112:115], a[240:243], v[88:91], v[112:115]
    s_waitcnt lgkmcnt(9)
    ds_read_b64_tr_b16 a[218:219], v249 offset:25600
    v_mfma_f32_16x16x32_bf16 v[128:131], a[240:243], v[92:95], v[128:131]
    buffer_load_dwordx4 v247, s[24:27], s51 offen offset:896 lds
    v_mfma_f32_16x16x32_bf16 v[132:135], a[244:247], v[92:95], v[132:135]
    s_add_u32 m0, s33, 118592
    ds_read_b64_tr_b16 a[220:221], v249 offset:25856
    v_mfma_f32_16x16x32_bf16 v[116:119], a[244:247], v[88:91], v[116:119]
    s_waitcnt lgkmcnt(9)
    ds_read_b64_tr_b16 a[222:223], v249 offset:26112
    v_mfma_f32_16x16x32_bf16 v[100:103], a[244:247], v[84:87], v[100:103]
    buffer_load_dwordx4 v247, s[24:27], s51 offen offset:1792 lds
    v_mfma_f32_16x16x32_bf16 v[104:107], a[248:251], v[84:87], v[104:107]
    s_add_u32 m0, s33, 118752
    ds_read_b64_tr_b16 a[224:225], v249 offset:16928
    s_add_u32 s65, s63, 0
    s_add_u32 s66, s63, 4096
    v_mfma_f32_16x16x32_bf16 v[120:123], a[248:251], v[88:91], v[120:123]
    s_waitcnt lgkmcnt(9)
    ds_read_b64_tr_b16 a[226:227], v249 offset:17184
    v_mul_f32 v128, v128, v230
    v_mfma_f32_16x16x32_bf16 v[136:139], a[248:251], v[92:95], v[136:139]
    buffer_load_dwordx4 v247, s[24:27], s51 offen offset:2688 lds
    v_mfma_f32_16x16x32_bf16 v[140:143], a[252:255], v[92:95], v[140:143]
    ds_read_b64_tr_b16 a[228:229], v249 offset:17440
    v_mul_f32 v129, v129, v230
    v_mfma_f32_16x16x32_bf16 v[124:127], a[252:255], v[88:91], v[124:127]
    s_waitcnt lgkmcnt(9)
    ds_read_b64_tr_b16 a[230:231], v249 offset:17696
    v_mul_f32 v130, v130, v230
    v_mul_f32 v131, v131, v230
    v_mfma_f32_16x16x32_bf16 v[108:111], a[252:255], v[84:87], v[108:111]
    v_mul_f32 v132, v132, v230
    v_mul_f32 v133, v133, v230
    v_mfma_f32_16x16x32_bf16 v[144:147], a[208:211], v[0:3], 0
    s_waitcnt lgkmcnt(4)
    ds_read_b64_tr_b16 a[232:233], v249 offset:25376
    v_mul_f32 v134, v134, v230
    v_mfma_f32_16x16x32_bf16 v[144:147], a[212:215], v[12:15], v[144:147]
    ds_read_b64_tr_b16 a[234:235], v249 offset:25632
    v_mul_f32 v135, v135, v230
    v_mfma_f32_16x16x32_bf16 v[144:147], a[216:219], v[24:27], v[144:147]
    v_cvt_pk_bf16_f32 v208, v128, v129
    v_cvt_pk_bf16_f32 v209, v130, v131
    v_cvt_pk_bf16_f32 v210, v132, v133
    v_mfma_f32_16x16x32_bf16 v[144:147], a[220:223], v[36:39], v[144:147]
    ds_read_b64_tr_b16 a[236:237], v249 offset:25888
    v_cvt_pk_bf16_f32 v211, v134, v135
    v_mfma_f32_16x16x32_bf16 v[160:163], a[220:223], v[40:43], 0
    ds_read_b64_tr_b16 a[238:239], v249 offset:26144
    v_mfma_f32_16x16x32_bf16 v[160:163], a[216:219], v[28:31], v[160:163]
    s_add_u32 s51, s60, 0
    s_add_u32 m0, s33, 16896
    v_mfma_f32_16x16x32_bf16 v[160:163], a[212:215], v[16:19], v[160:163]
    ds_read_b64_tr_b16 a[240:241], v249 offset:16960
    v_mfma_f32_16x16x32_bf16 v[160:163], a[208:211], v[4:7], v[160:163]
    ds_read_b64_tr_b16 a[242:243], v249 offset:17216
    v_mfma_f32_16x16x32_bf16 v[176:179], a[208:211], v[8:11], 0
    buffer_store_dwordx4 v[208:211], v251, s[28:31], s66 offen offset:0 sc1
    v_mfma_f32_16x16x32_bf16 v[176:179], a[212:215], v[20:23], v[176:179]
    ds_read_b64_tr_b16 a[244:245], v249 offset:17472
    v_mul_f32 v112, v112, v229
    v_mfma_f32_16x16x32_bf16 v[176:179], a[216:219], v[32:35], v[176:179]
    s_waitcnt lgkmcnt(9)
    ds_read_b64_tr_b16 a[246:247], v249 offset:17728
    v_mul_f32 v113, v113, v229
    v_mul_f32 v114, v114, v229
    v_mfma_f32_16x16x32_bf16 v[176:179], a[220:223], v[44:47], v[176:179]
    buffer_load_dwordx4 v247, s[24:27], s51 offen lds
    v_mfma_f32_16x16x32_bf16 v[180:183], a[224:227], v[8:11], 0
    s_waitcnt lgkmcnt(4)
    ds_read_b64_tr_b16 a[248:249], v249 offset:25408
    s_add_u32 m0, s33, 17056
    v_mfma_f32_16x16x32_bf16 v[180:183], a[228:231], v[20:23], v[180:183]
    ds_read_b64_tr_b16 a[250:251], v249 offset:25664
    v_mul_f32 v115, v115, v229
    v_mfma_f32_16x16x32_bf16 v[180:183], a[232:235], v[32:35], v[180:183]
    buffer_load_dwordx4 v247, s[24:27], s51 offen offset:896 lds
    v_mfma_f32_16x16x32_bf16 v[180:183], a[236:239], v[44:47], v[180:183]
    s_add_u32 m0, s33, 17216
    ds_read_b64_tr_b16 a[252:253], v249 offset:25920
    v_mul_f32 v116, v116, v229
    v_mfma_f32_16x16x32_bf16 v[164:167], a[236:239], v[40:43], 0
    ds_read_b64_tr_b16 a[254:255], v249 offset:26176
    v_mul_f32 v117, v117, v229
    v_mfma_f32_16x16x32_bf16 v[164:167], a[232:235], v[28:31], v[164:167]
    buffer_load_dwordx4 v247, s[24:27], s51 offen offset:1792 lds
    v_mfma_f32_16x16x32_bf16 v[164:167], a[228:231], v[16:19], v[164:167]
    s_add_u32 m0, s33, 17376
    ds_read_b64_tr_b16 a[208:209], v249 offset:16992
    v_mul_f32 v118, v118, v229
    v_mul_f32 v119, v119, v229
    v_mfma_f32_16x16x32_bf16 v[164:167], a[224:227], v[4:7], v[164:167]
    ds_read_b64_tr_b16 a[210:211], v249 offset:17248
    v_cvt_pk_bf16_f32 v200, v112, v113
    v_mfma_f32_16x16x32_bf16 v[148:151], a[224:227], v[0:3], 0
    buffer_load_dwordx4 v247, s[24:27], s51 offen offset:2688 lds
    v_mfma_f32_16x16x32_bf16 v[148:151], a[228:231], v[12:15], v[148:151]
    ds_read_b64_tr_b16 a[212:213], v249 offset:17504
    v_cvt_pk_bf16_f32 v201, v114, v115
    v_mfma_f32_16x16x32_bf16 v[148:151], a[232:235], v[24:27], v[148:151]
    s_waitcnt lgkmcnt(9)
    ds_read_b64_tr_b16 a[214:215], v249 offset:17760
    v_cvt_pk_bf16_f32 v202, v116, v117
    v_cvt_pk_bf16_f32 v203, v118, v119
    v_mfma_f32_16x16x32_bf16 v[148:151], a[236:239], v[36:39], v[148:151]
    buffer_store_dwordx4 v[200:203], v251, s[28:31], s65 offen offset:2048 sc1
    v_mfma_f32_16x16x32_bf16 v[152:155], a[240:243], v[0:3], 0
    s_waitcnt lgkmcnt(4)
    ds_read_b64_tr_b16 a[216:217], v249 offset:25440
    v_mul_f32 v96, v96, v228
    v_mfma_f32_16x16x32_bf16 v[152:155], a[244:247], v[12:15], v[152:155]
    ds_read_b64_tr_b16 a[218:219], v249 offset:25696
    v_mul_f32 v97, v97, v228
    v_mfma_f32_16x16x32_bf16 v[152:155], a[248:251], v[24:27], v[152:155]
    v_mul_f32 v98, v98, v228
    v_mul_f32 v99, v99, v228
    v_mul_f32 v100, v100, v228
    v_mfma_f32_16x16x32_bf16 v[152:155], a[252:255], v[36:39], v[152:155]
    ds_read_b64_tr_b16 a[220:221], v249 offset:25952
    v_mul_f32 v101, v101, v228
    v_mfma_f32_16x16x32_bf16 v[168:171], a[252:255], v[40:43], 0
    ds_read_b64_tr_b16 a[222:223], v249 offset:26208
    v_mul_f32 v102, v102, v228
    v_mfma_f32_16x16x32_bf16 v[168:171], a[248:251], v[28:31], v[168:171]
    v_mul_f32 v103, v103, v228
    v_cvt_pk_bf16_f32 v192, v96, v97
    v_mfma_f32_16x16x32_bf16 v[168:171], a[244:247], v[16:19], v[168:171]
    ds_read_b64_tr_b16 a[224:225], v249 offset:0
    v_cvt_pk_bf16_f32 v193, v98, v99
    v_cvt_pk_bf16_f32 v194, v100, v101
    v_mfma_f32_16x16x32_bf16 v[168:171], a[240:243], v[4:7], v[168:171]
    ds_read_b64_tr_b16 a[226:227], v249 offset:256
    v_cvt_pk_bf16_f32 v195, v102, v103
    v_mfma_f32_16x16x32_bf16 v[184:187], a[240:243], v[8:11], 0
    buffer_store_dwordx4 v[192:195], v251, s[28:31], s65 offen offset:0 sc1
    v_mfma_f32_16x16x32_bf16 v[184:187], a[244:247], v[20:23], v[184:187]
    ds_read_b64_tr_b16 a[228:229], v249 offset:512
    v_mul_f32 v136, v136, v230
    v_mfma_f32_16x16x32_bf16 v[184:187], a[248:251], v[32:35], v[184:187]
    s_waitcnt lgkmcnt(9)
    ds_read_b64_tr_b16 a[230:231], v249 offset:768
    v_mul_f32 v137, v137, v230
    v_mul_f32 v138, v138, v230
    v_mfma_f32_16x16x32_bf16 v[184:187], a[252:255], v[44:47], v[184:187]
    v_mul_f32 v139, v139, v230
    v_mul_f32 v140, v140, v230
    v_mfma_f32_16x16x32_bf16 v[188:191], a[208:211], v[8:11], 0
    s_waitcnt lgkmcnt(4)
    ds_read_b64_tr_b16 a[232:233], v249 offset:8448
    v_mul_f32 v141, v141, v230
    v_mfma_f32_16x16x32_bf16 v[188:191], a[212:215], v[20:23], v[188:191]
    ds_read_b64_tr_b16 a[234:235], v249 offset:8704
    v_mul_f32 v142, v142, v230
    v_mfma_f32_16x16x32_bf16 v[188:191], a[216:219], v[32:35], v[188:191]
    v_mul_f32 v143, v143, v230
    v_cvt_pk_bf16_f32 v212, v136, v137
    v_cvt_pk_bf16_f32 v213, v138, v139
    v_mfma_f32_16x16x32_bf16 v[188:191], a[220:223], v[44:47], v[188:191]
    ds_read_b64_tr_b16 a[236:237], v249 offset:8960
    v_cvt_pk_bf16_f32 v214, v140, v141
    v_mfma_f32_16x16x32_bf16 v[172:175], a[220:223], v[40:43], 0
    ds_read_b64_tr_b16 a[238:239], v249 offset:9216
    v_cvt_pk_bf16_f32 v215, v142, v143
    v_mfma_f32_16x16x32_bf16 v[172:175], a[216:219], v[28:31], v[172:175]
    buffer_store_dwordx4 v[212:215], v251, s[28:31], s66 offen offset:1024 sc1
    v_mfma_f32_16x16x32_bf16 v[172:175], a[212:215], v[16:19], v[172:175]
    ds_read_b64_tr_b16 a[240:241], v249 offset:32
    v_mul_f32 v120, v120, v229
    v_mul_f32 v121, v121, v229
    v_mfma_f32_16x16x32_bf16 v[172:175], a[208:211], v[4:7], v[172:175]
    ds_read_b64_tr_b16 a[242:243], v249 offset:288
    v_mul_f32 v122, v122, v229
    v_mfma_f32_16x16x32_bf16 v[156:159], a[208:211], v[0:3], 0
    v_mul_f32 v123, v123, v229
    v_mul_f32 v124, v124, v229
    v_mfma_f32_16x16x32_bf16 v[156:159], a[212:215], v[12:15], v[156:159]
    ds_read_b64_tr_b16 a[244:245], v249 offset:544
    v_mul_f32 v125, v125, v229
    v_mfma_f32_16x16x32_bf16 v[156:159], a[216:219], v[24:27], v[156:159]
    s_waitcnt lgkmcnt(9)
    ds_read_b64_tr_b16 a[246:247], v249 offset:800
    v_mul_f32 v126, v126, v229
    v_mul_f32 v127, v127, v229
    v_mfma_f32_16x16x32_bf16 v[156:159], a[220:223], v[36:39], v[156:159]
    v_cvt_pk_bf16_f32 v204, v120, v121
    v_cvt_pk_bf16_f32 v205, v122, v123
    v_mfma_f32_16x16x32_bf16 v[144:147], a[224:227], v[48:51], v[144:147]
    s_waitcnt lgkmcnt(4)
    ds_read_b64_tr_b16 a[248:249], v249 offset:8480
    v_cvt_pk_bf16_f32 v206, v124, v125
    v_mfma_f32_16x16x32_bf16 v[144:147], a[228:231], v[60:63], v[144:147]
    ds_read_b64_tr_b16 a[250:251], v249 offset:8736
    v_cvt_pk_bf16_f32 v207, v126, v127
    v_mfma_f32_16x16x32_bf16 v[144:147], a[232:235], v[72:75], v[144:147]
    buffer_store_dwordx4 v[204:207], v251, s[28:31], s65 offen offset:3072 sc1
    v_mfma_f32_16x16x32_bf16 v[144:147], a[236:239], v[84:87], v[144:147]
    ds_read_b64_tr_b16 a[252:253], v249 offset:8992
    v_mfma_f32_16x16x32_bf16 v[160:163], a[236:239], v[88:91], v[160:163]
    ds_read_b64_tr_b16 a[254:255], v249 offset:9248
    v_mfma_f32_16x16x32_bf16 v[160:163], a[232:235], v[76:79], v[160:163]
    v_mfma_f32_16x16x32_bf16 v[160:163], a[228:231], v[64:67], v[160:163]
    ds_read_b64_tr_b16 a[208:209], v249 offset:64
    v_mul_f32 v104, v104, v228
    v_mul_f32 v105, v105, v228
    v_mfma_f32_16x16x32_bf16 v[160:163], a[224:227], v[52:55], v[160:163]
    ds_read_b64_tr_b16 a[210:211], v249 offset:320
    v_mul_f32 v106, v106, v228
    v_mfma_f32_16x16x32_bf16 v[176:179], a[224:227], v[56:59], v[176:179]
    v_mul_f32 v107, v107, v228
    v_mul_f32 v108, v108, v228
    v_mfma_f32_16x16x32_bf16 v[176:179], a[228:231], v[68:71], v[176:179]
    ds_read_b64_tr_b16 a[212:213], v249 offset:576
    v_mul_f32 v109, v109, v228
    v_mfma_f32_16x16x32_bf16 v[176:179], a[232:235], v[80:83], v[176:179]
    s_waitcnt lgkmcnt(9)
    ds_read_b64_tr_b16 a[214:215], v249 offset:832
    v_mul_f32 v110, v110, v228
    v_mul_f32 v111, v111, v228
    v_mfma_f32_16x16x32_bf16 v[176:179], a[236:239], v[92:95], v[176:179]
    v_cvt_pk_bf16_f32 v196, v104, v105
    v_cvt_pk_bf16_f32 v197, v106, v107
    v_mfma_f32_16x16x32_bf16 v[180:183], a[240:243], v[56:59], v[180:183]
    s_waitcnt lgkmcnt(4)
    ds_read_b64_tr_b16 a[216:217], v249 offset:8512
    v_cvt_pk_bf16_f32 v198, v108, v109
    v_mfma_f32_16x16x32_bf16 v[180:183], a[244:247], v[68:71], v[180:183]
    ds_read_b64_tr_b16 a[218:219], v249 offset:8768
    v_cvt_pk_bf16_f32 v199, v110, v111
    v_mfma_f32_16x16x32_bf16 v[180:183], a[248:251], v[80:83], v[180:183]
    buffer_store_dwordx4 v[196:199], v251, s[28:31], s65 offen offset:1024 sc1
    v_mfma_f32_16x16x32_bf16 v[180:183], a[252:255], v[92:95], v[180:183]
    s_add_u32 s65, s64, 262144
    ds_read_b64_tr_b16 a[220:221], v249 offset:9024
    s_add_u32 s66, s64, 266240
    v_mfma_f32_16x16x32_bf16 v[164:167], a[252:255], v[88:91], v[164:167]
    ds_read_b64_tr_b16 a[222:223], v249 offset:9280
    v_mul_f32 v176, v176, v230
    v_mfma_f32_16x16x32_bf16 v[164:167], a[248:251], v[76:79], v[164:167]
    v_mul_f32 v177, v177, v230
    v_mul_f32 v178, v178, v230
    v_mfma_f32_16x16x32_bf16 v[164:167], a[244:247], v[64:67], v[164:167]
    ds_read_b64_tr_b16 a[224:225], v249 offset:96
    v_mul_f32 v179, v179, v230
    v_mfma_f32_16x16x32_bf16 v[164:167], a[240:243], v[52:55], v[164:167]
    ds_read_b64_tr_b16 a[226:227], v249 offset:352
    v_mul_f32 v180, v180, v230
    v_mfma_f32_16x16x32_bf16 v[148:151], a[240:243], v[48:51], v[148:151]
    v_mul_f32 v181, v181, v230
    v_mul_f32 v182, v182, v230
    v_mfma_f32_16x16x32_bf16 v[148:151], a[244:247], v[60:63], v[148:151]
    ds_read_b64_tr_b16 a[228:229], v249 offset:608
    v_mul_f32 v183, v183, v230
    v_mfma_f32_16x16x32_bf16 v[148:151], a[248:251], v[72:75], v[148:151]
    s_waitcnt lgkmcnt(9)
    ds_read_b64_tr_b16 a[230:231], v249 offset:864
    v_cvt_pk_bf16_f32 v208, v176, v177
    v_mfma_f32_16x16x32_bf16 v[148:151], a[252:255], v[84:87], v[148:151]
    v_cvt_pk_bf16_f32 v209, v178, v179
    v_cvt_pk_bf16_f32 v210, v180, v181
    v_mfma_f32_16x16x32_bf16 v[152:155], a[208:211], v[48:51], v[152:155]
    s_waitcnt lgkmcnt(4)
    ds_read_b64_tr_b16 a[232:233], v249 offset:8544
    v_cvt_pk_bf16_f32 v211, v182, v183
    v_mfma_f32_16x16x32_bf16 v[152:155], a[212:215], v[60:63], v[152:155]
    ds_read_b64_tr_b16 a[234:235], v249 offset:8800
    v_mfma_f32_16x16x32_bf16 v[152:155], a[216:219], v[72:75], v[152:155]
    buffer_store_dwordx4 v[208:211], v251, s[28:31], s66 offen offset:0 sc1
    v_mfma_f32_16x16x32_bf16 v[152:155], a[220:223], v[84:87], v[152:155]
    ds_read_b64_tr_b16 a[236:237], v249 offset:9056
    v_mul_f32 v160, v160, v229
    v_mfma_f32_16x16x32_bf16 v[168:171], a[220:223], v[88:91], v[168:171]
    s_waitcnt vmcnt(19)
    ds_read_b64_tr_b16 a[238:239], v249 offset:9312
    v_mul_f32 v161, v161, v229
    v_mfma_f32_16x16x32_bf16 v[168:171], a[216:219], v[76:79], v[168:171]
    s_add_u32 s51, s60, 114688
    s_add_u32 m0, s33, 135168
    v_mul_f32 v162, v162, v229
    v_mfma_f32_16x16x32_bf16 v[168:171], a[212:215], v[64:67], v[168:171]
    s_barrier
    ds_read_b64_tr_b16 a[240:241], v249 offset:33792
    v_mul_f32 v163, v163, v229
    v_mfma_f32_16x16x32_bf16 v[168:171], a[208:211], v[52:55], v[168:171]
    ds_read_b64_tr_b16 a[242:243], v249 offset:34048
    v_mul_f32 v164, v164, v229
    v_mfma_f32_16x16x32_bf16 v[184:187], a[208:211], v[56:59], v[184:187]
    v_mul_f32 v165, v165, v229
    v_mul_f32 v166, v166, v229
    v_mfma_f32_16x16x32_bf16 v[184:187], a[212:215], v[68:71], v[184:187]
    ds_read_b64_tr_b16 a[244:245], v249 offset:34304
    v_mul_f32 v167, v167, v229
    v_mfma_f32_16x16x32_bf16 v[184:187], a[216:219], v[80:83], v[184:187]
    s_waitcnt lgkmcnt(9)
    ds_read_b64_tr_b16 a[246:247], v249 offset:34560
    v_cvt_pk_bf16_f32 v200, v160, v161
    v_mfma_f32_16x16x32_bf16 v[184:187], a[220:223], v[92:95], v[184:187]
    buffer_load_dwordx4 v247, s[24:27], s51 offen lds
    v_mfma_f32_16x16x32_bf16 v[188:191], a[224:227], v[56:59], v[188:191]
    s_waitcnt lgkmcnt(4)
    ds_read_b64_tr_b16 a[248:249], v249 offset:42240
    s_add_u32 m0, s33, 135328
    v_mfma_f32_16x16x32_bf16 v[188:191], a[228:231], v[68:71], v[188:191]
    ds_read_b64_tr_b16 a[250:251], v249 offset:42496
    v_cvt_pk_bf16_f32 v201, v162, v163
    v_mfma_f32_16x16x32_bf16 v[188:191], a[232:235], v[80:83], v[188:191]
    buffer_load_dwordx4 v247, s[24:27], s51 offen offset:896 lds
    v_mfma_f32_16x16x32_bf16 v[188:191], a[236:239], v[92:95], v[188:191]
    s_add_u32 m0, s33, 135488
    ds_read_b64_tr_b16 a[252:253], v249 offset:42752
    v_cvt_pk_bf16_f32 v202, v164, v165
    v_mfma_f32_16x16x32_bf16 v[172:175], a[236:239], v[88:91], v[172:175]
    ds_read_b64_tr_b16 a[254:255], v249 offset:43008
    v_cvt_pk_bf16_f32 v203, v166, v167
    v_mfma_f32_16x16x32_bf16 v[172:175], a[232:235], v[76:79], v[172:175]
    buffer_load_dwordx4 v247, s[24:27], s51 offen offset:1792 lds
    v_mfma_f32_16x16x32_bf16 v[172:175], a[228:231], v[64:67], v[172:175]
    s_add_u32 m0, s33, 135648
    ds_read_b64_tr_b16 a[208:209], v249 offset:33824
    v_mfma_f32_16x16x32_bf16 v[172:175], a[224:227], v[52:55], v[172:175]
    ds_read_b64_tr_b16 a[210:211], v249 offset:34080
    v_mfma_f32_16x16x32_bf16 v[156:159], a[224:227], v[48:51], v[156:159]
    buffer_load_dwordx4 v247, s[24:27], s51 offen offset:2688 lds
    v_mfma_f32_16x16x32_bf16 v[156:159], a[228:231], v[60:63], v[156:159]
    ds_read_b64_tr_b16 a[212:213], v249 offset:34336
    v_mfma_f32_16x16x32_bf16 v[156:159], a[232:235], v[72:75], v[156:159]
    s_waitcnt lgkmcnt(9)
    ds_read_b64_tr_b16 a[214:215], v249 offset:34592
    v_mfma_f32_16x16x32_bf16 v[156:159], a[236:239], v[84:87], v[156:159]
    buffer_store_dwordx4 v[200:203], v251, s[28:31], s65 offen offset:2048 sc1
    v_mfma_f32_16x16x32_bf16 v[96:99], a[240:243], v[0:3], 0
    s_waitcnt lgkmcnt(4)
    ds_read_b64_tr_b16 a[216:217], v249 offset:42272
    v_mul_f32 v144, v144, v228
    v_mfma_f32_16x16x32_bf16 v[96:99], a[244:247], v[12:15], v[96:99]
    ds_read_b64_tr_b16 a[218:219], v249 offset:42528
    v_mul_f32 v145, v145, v228
    v_mfma_f32_16x16x32_bf16 v[96:99], a[248:251], v[24:27], v[96:99]
    v_mul_f32 v146, v146, v228
    v_mul_f32 v147, v147, v228
    v_mfma_f32_16x16x32_bf16 v[96:99], a[252:255], v[36:39], v[96:99]
    ds_read_b64_tr_b16 a[220:221], v249 offset:42784
    v_mul_f32 v148, v148, v228
    v_mfma_f32_16x16x32_bf16 v[112:115], a[252:255], v[40:43], 0
    ds_read_b64_tr_b16 a[222:223], v249 offset:43040
    v_mul_f32 v149, v149, v228
    v_mfma_f32_16x16x32_bf16 v[112:115], a[248:251], v[28:31], v[112:115]
    s_add_u32 s51, s61, 0
    s_add_u32 m0, s33, 33792
    v_mul_f32 v150, v150, v228
    v_mfma_f32_16x16x32_bf16 v[112:115], a[244:247], v[16:19], v[112:115]
    ds_read_b64_tr_b16 a[224:225], v249 offset:33856
    v_mul_f32 v151, v151, v228
    v_mfma_f32_16x16x32_bf16 v[112:115], a[240:243], v[4:7], v[112:115]
    ds_read_b64_tr_b16 a[226:227], v249 offset:34112
    v_cvt_pk_bf16_f32 v192, v144, v145
    v_mfma_f32_16x16x32_bf16 v[128:131], a[240:243], v[8:11], 0
    v_cvt_pk_bf16_f32 v193, v146, v147
    v_cvt_pk_bf16_f32 v194, v148, v149
    v_mfma_f32_16x16x32_bf16 v[128:131], a[244:247], v[20:23], v[128:131]
    ds_read_b64_tr_b16 a[228:229], v249 offset:34368
    v_cvt_pk_bf16_f32 v195, v150, v151
    v_mfma_f32_16x16x32_bf16 v[128:131], a[248:251], v[32:35], v[128:131]
    s_waitcnt lgkmcnt(9)
    ds_read_b64_tr_b16 a[230:231], v249 offset:34624
    v_lshrrev_b32 v234, 4, v251
    v_mfma_f32_16x16x32_bf16 v[128:131], a[252:255], v[44:47], v[128:131]
    buffer_load_dwordx4 v247, s[24:27], s51 offen lds
    v_mfma_f32_16x16x32_bf16 v[132:135], a[208:211], v[8:11], 0
    s_waitcnt lgkmcnt(4)
    ds_read_b64_tr_b16 a[232:233], v249 offset:42304
    s_add_u32 m0, s33, 33952
    v_mfma_f32_16x16x32_bf16 v[132:135], a[212:215], v[20:23], v[132:135]
    ds_read_b64_tr_b16 a[234:235], v249 offset:42560
    v_lshrrev_b32 v233, 5, v251
    v_mfma_f32_16x16x32_bf16 v[132:135], a[216:219], v[32:35], v[132:135]
    buffer_load_dwordx4 v247, s[24:27], s51 offen offset:896 lds
    v_mfma_f32_16x16x32_bf16 v[132:135], a[220:223], v[44:47], v[132:135]
    s_add_u32 m0, s33, 34112
    ds_read_b64_tr_b16 a[236:237], v249 offset:42816
    v_min_u32 v233, 1, v233
    v_mfma_f32_16x16x32_bf16 v[116:119], a[220:223], v[40:43], 0
    s_waitcnt vmcnt(8)
    ds_read_b64_tr_b16 a[238:239], v249 offset:43072
    v_mov_b32 v231, 1
    v_mfma_f32_16x16x32_bf16 v[116:119], a[216:219], v[28:31], v[116:119]
    buffer_load_dwordx4 v247, s[24:27], s51 offen offset:1792 lds
    v_mfma_f32_16x16x32_bf16 v[116:119], a[212:215], v[16:19], v[116:119]
    s_add_u32 m0, s33, 34272
    ds_read_b64_tr_b16 a[240:241], v249 offset:33888
    buffer_atomic_add v231, v252, s[28:31], s97 offen sc1
    v_mfma_f32_16x16x32_bf16 v[116:119], a[208:211], v[4:7], v[116:119]
    ds_read_b64_tr_b16 a[242:243], v249 offset:34144
    v_lshlrev_b32 v233, 28, v233
    v_mfma_f32_16x16x32_bf16 v[100:103], a[208:211], v[0:3], 0
    buffer_load_dwordx4 v247, s[24:27], s51 offen offset:2688 lds
    v_mfma_f32_16x16x32_bf16 v[100:103], a[212:215], v[12:15], v[100:103]
    ds_read_b64_tr_b16 a[244:245], v249 offset:34400
    v_lshl_add_u32 v233, v234, 2, v233
    v_mfma_f32_16x16x32_bf16 v[100:103], a[216:219], v[24:27], v[100:103]
    s_waitcnt lgkmcnt(9)
    ds_read_b64_tr_b16 a[246:247], v249 offset:34656
    v_and_b32 v236, 0x70, v251
    v_mfma_f32_16x16x32_bf16 v[100:103], a[220:223], v[36:39], v[100:103]
    buffer_store_dwordx4 v[192:195], v251, s[28:31], s65 offen offset:0 sc1
    v_mfma_f32_16x16x32_bf16 v[104:107], a[224:227], v[0:3], 0
    s_waitcnt lgkmcnt(4)
    ds_read_b64_tr_b16 a[248:249], v249 offset:42336
    v_mul_f32 v184, v184, v230
    v_mfma_f32_16x16x32_bf16 v[104:107], a[228:231], v[12:15], v[104:107]
    ds_read_b64_tr_b16 a[250:251], v249 offset:42592
    v_mul_f32 v185, v185, v230
    v_mfma_f32_16x16x32_bf16 v[104:107], a[232:235], v[24:27], v[104:107]
    v_mul_f32 v186, v186, v230
    v_mul_f32 v187, v187, v230
    v_mfma_f32_16x16x32_bf16 v[104:107], a[236:239], v[36:39], v[104:107]
    ds_read_b64_tr_b16 a[252:253], v249 offset:42848
    v_mul_f32 v188, v188, v230
    v_mfma_f32_16x16x32_bf16 v[120:123], a[236:239], v[40:43], 0
    ds_read_b64_tr_b16 a[254:255], v249 offset:43104
    v_mul_f32 v189, v189, v230
    v_mfma_f32_16x16x32_bf16 v[120:123], a[232:235], v[28:31], v[120:123]
    v_mul_f32 v190, v190, v230
    v_mul_f32 v191, v191, v230
    v_mfma_f32_16x16x32_bf16 v[120:123], a[228:231], v[16:19], v[120:123]
    ds_read_b64_tr_b16 a[208:209], v248 offset:0
    v_cvt_pk_bf16_f32 v212, v184, v185
    v_mfma_f32_16x16x32_bf16 v[120:123], a[224:227], v[4:7], v[120:123]
    ds_read_b64_tr_b16 a[210:211], v248 offset:256
    v_cvt_pk_bf16_f32 v213, v186, v187
    v_mfma_f32_16x16x32_bf16 v[136:139], a[224:227], v[8:11], 0
    v_cvt_pk_bf16_f32 v214, v188, v189
    v_cvt_pk_bf16_f32 v215, v190, v191
    v_mfma_f32_16x16x32_bf16 v[136:139], a[228:231], v[20:23], v[136:139]
    ds_read_b64_tr_b16 a[212:213], v248 offset:512
    v_bfe_u32 v235, v251, 7, 2
    v_mfma_f32_16x16x32_bf16 v[136:139], a[232:235], v[32:35], v[136:139]
    s_waitcnt lgkmcnt(9)
    ds_read_b64_tr_b16 a[214:215], v248 offset:768
    v_lshl_add_u32 v236, v235, 8, v236
    v_mfma_f32_16x16x32_bf16 v[136:139], a[236:239], v[44:47], v[136:139]
    buffer_store_dwordx4 v[212:215], v251, s[28:31], s66 offen offset:1024 sc1
    v_mfma_f32_16x16x32_bf16 v[140:143], a[240:243], v[8:11], 0
    s_waitcnt lgkmcnt(4)
    ds_read_b64_tr_b16 a[216:217], v248 offset:8448
    v_mul_f32 v168, v168, v229
    v_mfma_f32_16x16x32_bf16 v[140:143], a[244:247], v[20:23], v[140:143]
    ds_read_b64_tr_b16 a[218:219], v248 offset:8704
    v_mul_f32 v169, v169, v229
    v_mfma_f32_16x16x32_bf16 v[140:143], a[248:251], v[32:35], v[140:143]
    v_mul_f32 v170, v170, v229
    v_mul_f32 v171, v171, v229
    v_mfma_f32_16x16x32_bf16 v[140:143], a[252:255], v[44:47], v[140:143]
    ds_read_b64_tr_b16 a[220:221], v248 offset:8960
    v_mul_f32 v172, v172, v229
    v_mfma_f32_16x16x32_bf16 v[124:127], a[252:255], v[40:43], 0
    ds_read_b64_tr_b16 a[222:223], v248 offset:9216
    v_mul_f32 v173, v173, v229
    v_mfma_f32_16x16x32_bf16 v[124:127], a[248:251], v[28:31], v[124:127]
    v_mul_f32 v174, v174, v229
    v_mul_f32 v175, v175, v229
    v_mfma_f32_16x16x32_bf16 v[124:127], a[244:247], v[16:19], v[124:127]
    ds_read_b64_tr_b16 a[224:225], v248 offset:32
    v_cvt_pk_bf16_f32 v204, v168, v169
    v_mfma_f32_16x16x32_bf16 v[124:127], a[240:243], v[4:7], v[124:127]
    ds_read_b64_tr_b16 a[226:227], v248 offset:288
    v_cvt_pk_bf16_f32 v205, v170, v171
    v_mfma_f32_16x16x32_bf16 v[108:111], a[240:243], v[0:3], 0
    v_cvt_pk_bf16_f32 v206, v172, v173
    v_cvt_pk_bf16_f32 v207, v174, v175
    v_mfma_f32_16x16x32_bf16 v[108:111], a[244:247], v[12:15], v[108:111]
    ds_read_b64_tr_b16 a[228:229], v248 offset:544
    v_lshrrev_b32 v235, 9, v251
    v_mfma_f32_16x16x32_bf16 v[108:111], a[248:251], v[24:27], v[108:111]
    s_waitcnt lgkmcnt(9)
    ds_read_b64_tr_b16 a[230:231], v248 offset:800
    v_lshl_add_u32 v236, v235, 14, v236
    v_mfma_f32_16x16x32_bf16 v[108:111], a[252:255], v[36:39], v[108:111]
    buffer_store_dwordx4 v[204:207], v251, s[28:31], s65 offen offset:3072 sc1
    v_mfma_f32_16x16x32_bf16 v[96:99], a[208:211], v[48:51], v[96:99]
    s_waitcnt lgkmcnt(4)
    ds_read_b64_tr_b16 a[232:233], v248 offset:8480
    v_mul_f32 v152, v152, v228
    v_mfma_f32_16x16x32_bf16 v[96:99], a[212:215], v[60:63], v[96:99]
    s_mov_b32 s100, 1
    ds_read_b64_tr_b16 a[234:235], v248 offset:8736
    v_mul_f32 v153, v153, v228
    v_mfma_f32_16x16x32_bf16 v[96:99], a[216:219], v[72:75], v[96:99]
    s_mov_b32 s96, 0
    v_mul_f32 v154, v154, v228
    v_mul_f32 v155, v155, v228
    v_mfma_f32_16x16x32_bf16 v[96:99], a[220:223], v[84:87], v[96:99]
    s_mov_b32 s101, 0
    ds_read_b64_tr_b16 a[236:237], v248 offset:8992
    v_mul_f32 v156, v156, v228
    v_mfma_f32_16x16x32_bf16 v[112:115], a[220:223], v[88:91], v[112:115]
    ds_read_b64_tr_b16 a[238:239], v248 offset:9248
    v_mul_f32 v157, v157, v228
    v_mfma_f32_16x16x32_bf16 v[112:115], a[216:219], v[76:79], v[112:115]
    v_mul_f32 v158, v158, v228
    v_mul_f32 v159, v159, v228
    v_mfma_f32_16x16x32_bf16 v[112:115], a[212:215], v[64:67], v[112:115]
    ds_read_b64_tr_b16 a[240:241], v248 offset:64
    v_cvt_pk_bf16_f32 v196, v152, v153
    v_mfma_f32_16x16x32_bf16 v[112:115], a[208:211], v[52:55], v[112:115]
    ds_read_b64_tr_b16 a[242:243], v248 offset:320
    v_cvt_pk_bf16_f32 v197, v154, v155
    v_mfma_f32_16x16x32_bf16 v[128:131], a[208:211], v[56:59], v[128:131]
    v_cvt_pk_bf16_f32 v198, v156, v157
    v_cvt_pk_bf16_f32 v199, v158, v159
    v_mfma_f32_16x16x32_bf16 v[128:131], a[212:215], v[68:71], v[128:131]
    ds_read_b64_tr_b16 a[244:245], v248 offset:576
    v_mfma_f32_16x16x32_bf16 v[128:131], a[216:219], v[80:83], v[128:131]
    s_waitcnt lgkmcnt(9)
    ds_read_b64_tr_b16 a[246:247], v248 offset:832
    v_mfma_f32_16x16x32_bf16 v[128:131], a[220:223], v[92:95], v[128:131]
    buffer_store_dwordx4 v[196:199], v251, s[28:31], s65 offen offset:1024 sc1
    v_mfma_f32_16x16x32_bf16 v[132:135], a[224:227], v[56:59], v[132:135]
    s_waitcnt lgkmcnt(4)
    ds_read_b64_tr_b16 a[248:249], v248 offset:8512
    v_mfma_f32_16x16x32_bf16 v[132:135], a[228:231], v[68:71], v[132:135]
    ds_read_b64_tr_b16 a[250:251], v248 offset:8768
    v_mfma_f32_16x16x32_bf16 v[132:135], a[232:235], v[80:83], v[132:135]
    v_mfma_f32_16x16x32_bf16 v[132:135], a[236:239], v[92:95], v[132:135]
    s_add_u32 s65, s63, 524288
    ds_read_b64_tr_b16 a[252:253], v248 offset:9024
    s_add_u32 s66, s63, 528384
    v_mfma_f32_16x16x32_bf16 v[116:119], a[236:239], v[88:91], v[116:119]
    ds_read_b64_tr_b16 a[254:255], v248 offset:9280
    v_mul_f32 v128, v128, v230
    v_mfma_f32_16x16x32_bf16 v[116:119], a[232:235], v[76:79], v[116:119]
    v_mul_f32 v129, v129, v230
    v_mul_f32 v130, v130, v230
    v_mfma_f32_16x16x32_bf16 v[116:119], a[228:231], v[64:67], v[116:119]
    ds_read_b64_tr_b16 a[208:209], v248 offset:96
    v_mul_f32 v131, v131, v230
    v_mfma_f32_16x16x32_bf16 v[116:119], a[224:227], v[52:55], v[116:119]
    ds_read_b64_tr_b16 a[210:211], v248 offset:352
    v_mul_f32 v132, v132, v230
    v_mfma_f32_16x16x32_bf16 v[100:103], a[224:227], v[48:51], v[100:103]
    v_mul_f32 v133, v133, v230
    v_mul_f32 v134, v134, v230
    v_mfma_f32_16x16x32_bf16 v[100:103], a[228:231], v[60:63], v[100:103]
    ds_read_b64_tr_b16 a[212:213], v248 offset:608
    v_mul_f32 v135, v135, v230
    v_mfma_f32_16x16x32_bf16 v[100:103], a[232:235], v[72:75], v[100:103]
    s_waitcnt lgkmcnt(9)
    ds_read_b64_tr_b16 a[214:215], v248 offset:864
    v_cvt_pk_bf16_f32 v208, v128, v129
    v_mfma_f32_16x16x32_bf16 v[100:103], a[236:239], v[84:87], v[100:103]
    v_cvt_pk_bf16_f32 v209, v130, v131
    v_cvt_pk_bf16_f32 v210, v132, v133
    v_mfma_f32_16x16x32_bf16 v[104:107], a[240:243], v[48:51], v[104:107]
    s_waitcnt lgkmcnt(4)
    ds_read_b64_tr_b16 a[216:217], v248 offset:8544
    v_cvt_pk_bf16_f32 v211, v134, v135
    v_mfma_f32_16x16x32_bf16 v[104:107], a[244:247], v[60:63], v[104:107]
    ds_read_b64_tr_b16 a[218:219], v248 offset:8800
    v_mfma_f32_16x16x32_bf16 v[104:107], a[248:251], v[72:75], v[104:107]
    buffer_store_dwordx4 v[208:211], v251, s[28:31], s66 offen offset:0 sc1
    v_mfma_f32_16x16x32_bf16 v[104:107], a[252:255], v[84:87], v[104:107]
L_pad11:
    s_cbranch_execz L_main
    ds_read_b64_tr_b16 a[220:221], v248 offset:9056
    v_mul_f32 v112, v112, v229
    v_mfma_f32_16x16x32_bf16 v[120:123], a[252:255], v[88:91], v[120:123]
    s_waitcnt vmcnt(16)
    ds_read_b64_tr_b16 a[222:223], v248 offset:9312
    v_mul_f32 v113, v113, v229
    v_mfma_f32_16x16x32_bf16 v[120:123], a[248:251], v[76:79], v[120:123]
    s_add_u32 s51, s61, 114688
    s_add_u32 m0, s33, 67584
    v_mul_f32 v114, v114, v229
    v_mfma_f32_16x16x32_bf16 v[120:123], a[244:247], v[64:67], v[120:123]
    s_barrier
    ds_read_b64_tr_b16 a[224:225], v250 offset:0
    v_mul_f32 v115, v115, v229
    v_mfma_f32_16x16x32_bf16 v[120:123], a[240:243], v[52:55], v[120:123]
    ds_read_b64_tr_b16 a[226:227], v250 offset:256
    v_mul_f32 v116, v116, v229
    v_mfma_f32_16x16x32_bf16 v[136:139], a[240:243], v[56:59], v[136:139]
    v_mul_f32 v117, v117, v229
    v_mul_f32 v118, v118, v229
    v_mfma_f32_16x16x32_bf16 v[136:139], a[244:247], v[68:71], v[136:139]
    ds_read_b64_tr_b16 a[228:229], v250 offset:512
    v_mul_f32 v119, v119, v229
    v_mfma_f32_16x16x32_bf16 v[136:139], a[248:251], v[80:83], v[136:139]
    s_waitcnt lgkmcnt(9)
    ds_read_b64_tr_b16 a[230:231], v250 offset:768
    v_cvt_pk_bf16_f32 v200, v112, v113
    v_mfma_f32_16x16x32_bf16 v[136:139], a[252:255], v[92:95], v[136:139]
    buffer_load_dwordx4 v247, s[24:27], s51 offen lds
    v_mfma_f32_16x16x32_bf16 v[140:143], a[208:211], v[56:59], v[140:143]
    s_waitcnt lgkmcnt(4)
    ds_read_b64_tr_b16 a[232:233], v250 offset:8448
    s_add_u32 m0, s33, 67744
    v_mfma_f32_16x16x32_bf16 v[140:143], a[212:215], v[68:71], v[140:143]
    ds_read_b64_tr_b16 a[234:235], v250 offset:8704
    v_cvt_pk_bf16_f32 v201, v114, v115
    v_mfma_f32_16x16x32_bf16 v[140:143], a[216:219], v[80:83], v[140:143]
    buffer_load_dwordx4 v247, s[24:27], s51 offen offset:896 lds
    v_mfma_f32_16x16x32_bf16 v[140:143], a[220:223], v[92:95], v[140:143]
    s_add_u32 m0, s33, 67904
    ds_read_b64_tr_b16 a[236:237], v250 offset:8960
    v_cvt_pk_bf16_f32 v202, v116, v117
    v_mfma_f32_16x16x32_bf16 v[124:127], a[220:223], v[88:91], v[124:127]
    ds_read_b64_tr_b16 a[238:239], v250 offset:9216
    v_cvt_pk_bf16_f32 v203, v118, v119
    v_mfma_f32_16x16x32_bf16 v[124:127], a[216:219], v[76:79], v[124:127]
    buffer_load_dwordx4 v247, s[24:27], s51 offen offset:1792 lds
    v_mfma_f32_16x16x32_bf16 v[124:127], a[212:215], v[64:67], v[124:127]
    s_add_u32 m0, s33, 68064
    ds_read_b64_tr_b16 a[240:241], v250 offset:32
    v_mfma_f32_16x16x32_bf16 v[124:127], a[208:211], v[52:55], v[124:127]
    ds_read_b64_tr_b16 a[242:243], v250 offset:288
    v_mfma_f32_16x16x32_bf16 v[108:111], a[208:211], v[48:51], v[108:111]
    buffer_load_dwordx4 v247, s[24:27], s51 offen offset:2688 lds
    v_mfma_f32_16x16x32_bf16 v[108:111], a[212:215], v[60:63], v[108:111]
    ds_read_b64_tr_b16 a[244:245], v250 offset:544
    v_mfma_f32_16x16x32_bf16 v[108:111], a[216:219], v[72:75], v[108:111]
    s_waitcnt lgkmcnt(9)
    ds_read_b64_tr_b16 a[246:247], v250 offset:800
    v_mfma_f32_16x16x32_bf16 v[108:111], a[220:223], v[84:87], v[108:111]
    buffer_store_dwordx4 v[200:203], v251, s[28:31], s65 offen offset:2048 sc1
    v_mfma_f32_16x16x32_bf16 v[144:147], a[224:227], v[0:3], 0
    s_waitcnt lgkmcnt(4)
    ds_read_b64_tr_b16 a[248:249], v250 offset:8480
    v_mul_f32 v96, v96, v228
    v_mfma_f32_16x16x32_bf16 v[144:147], a[228:231], v[12:15], v[144:147]
    ds_read_b64_tr_b16 a[250:251], v250 offset:8736
    v_mul_f32 v97, v97, v228
    v_mfma_f32_16x16x32_bf16 v[144:147], a[232:235], v[24:27], v[144:147]
    v_mul_f32 v98, v98, v228
    v_mul_f32 v99, v99, v228
    v_mfma_f32_16x16x32_bf16 v[144:147], a[236:239], v[36:39], v[144:147]
    ds_read_b64_tr_b16 a[252:253], v250 offset:8992
    v_mul_f32 v100, v100, v228
    v_mfma_f32_16x16x32_bf16 v[160:163], a[236:239], v[40:43], 0
    ds_read_b64_tr_b16 a[254:255], v250 offset:9248
    v_mul_f32 v101, v101, v228
    v_mfma_f32_16x16x32_bf16 v[160:163], a[232:235], v[28:31], v[160:163]
    s_add_u32 s51, s62, 0
    s_add_u32 m0, s33, 50688
    v_mul_f32 v102, v102, v228
    v_mfma_f32_16x16x32_bf16 v[160:163], a[228:231], v[16:19], v[160:163]
    ds_read_b64_tr_b16 a[208:209], v250 offset:64
    v_mul_f32 v103, v103, v228
    v_mfma_f32_16x16x32_bf16 v[160:163], a[224:227], v[4:7], v[160:163]
    ds_read_b64_tr_b16 a[210:211], v250 offset:320
    v_cvt_pk_bf16_f32 v192, v96, v97
    v_mfma_f32_16x16x32_bf16 v[176:179], a[224:227], v[8:11], 0
    v_cvt_pk_bf16_f32 v193, v98, v99
    v_cvt_pk_bf16_f32 v194, v100, v101
    v_mfma_f32_16x16x32_bf16 v[176:179], a[228:231], v[20:23], v[176:179]
    ds_read_b64_tr_b16 a[212:213], v250 offset:576
    v_cvt_pk_bf16_f32 v195, v102, v103
    v_mfma_f32_16x16x32_bf16 v[176:179], a[232:235], v[32:35], v[176:179]
    s_waitcnt lgkmcnt(9)
    ds_read_b64_tr_b16 a[214:215], v250 offset:832
    v_mfma_f32_16x16x32_bf16 v[176:179], a[236:239], v[44:47], v[176:179]
    buffer_load_dwordx4 v247, s[24:27], s51 offen lds
    v_mfma_f32_16x16x32_bf16 v[180:183], a[240:243], v[8:11], 0
    s_waitcnt lgkmcnt(4)
    ds_read_b64_tr_b16 a[216:217], v250 offset:8512
    s_add_u32 m0, s33, 50848
    v_mfma_f32_16x16x32_bf16 v[180:183], a[244:247], v[20:23], v[180:183]
    s_waitcnt vmcnt(7)
    ds_read_b64_tr_b16 a[218:219], v250 offset:8768
    v_mov_b32 v231, 32
    v_mfma_f32_16x16x32_bf16 v[180:183], a[248:251], v[32:35], v[180:183]
    buffer_load_dwordx4 v247, s[24:27], s51 offen offset:896 lds
    v_mfma_f32_16x16x32_bf16 v[180:183], a[252:255], v[44:47], v[180:183]
    s_add_u32 m0, s33, 51008
    ds_read_b64_tr_b16 a[220:221], v250 offset:9024
    v_mfma_f32_16x16x32_bf16 v[164:167], a[252:255], v[40:43], 0
    ds_read_b64_tr_b16 a[222:223], v250 offset:9280
    v_mfma_f32_16x16x32_bf16 v[164:167], a[248:251], v[28:31], v[164:167]
    buffer_load_dwordx4 v247, s[24:27], s51 offen offset:1792 lds
    v_mfma_f32_16x16x32_bf16 v[164:167], a[244:247], v[16:19], v[164:167]
    s_add_u32 m0, s33, 51168
    ds_read_b64_tr_b16 a[224:225], v250 offset:96
    v_mfma_f32_16x16x32_bf16 v[164:167], a[240:243], v[4:7], v[164:167]
    ds_read_b64_tr_b16 a[226:227], v250 offset:352
    v_mfma_f32_16x16x32_bf16 v[148:151], a[240:243], v[0:3], 0
    buffer_load_dwordx4 v247, s[24:27], s51 offen offset:2688 lds
    v_mfma_f32_16x16x32_bf16 v[148:151], a[244:247], v[12:15], v[148:151]
    ds_read_b64_tr_b16 a[228:229], v250 offset:608
    buffer_atomic_add v231, v252, s[28:31], s97 offen sc1
    v_mfma_f32_16x16x32_bf16 v[148:151], a[248:251], v[24:27], v[148:151]
    s_waitcnt lgkmcnt(9)
    ds_read_b64_tr_b16 a[230:231], v250 offset:864
    v_mfma_f32_16x16x32_bf16 v[148:151], a[252:255], v[36:39], v[148:151]
    buffer_store_dwordx4 v[192:195], v251, s[28:31], s65 offen offset:0 sc1
    v_mfma_f32_16x16x32_bf16 v[152:155], a[208:211], v[0:3], 0
    s_waitcnt lgkmcnt(4)
    ds_read_b64_tr_b16 a[232:233], v250 offset:8544
    v_mul_f32 v136, v136, v230
    v_mfma_f32_16x16x32_bf16 v[152:155], a[212:215], v[12:15], v[152:155]
    ds_read_b64_tr_b16 a[234:235], v250 offset:8800
    v_mul_f32 v137, v137, v230
    v_mfma_f32_16x16x32_bf16 v[152:155], a[216:219], v[24:27], v[152:155]
    v_mul_f32 v138, v138, v230
    v_mul_f32 v139, v139, v230
    v_mfma_f32_16x16x32_bf16 v[152:155], a[220:223], v[36:39], v[152:155]
    ds_read_b64_tr_b16 a[236:237], v250 offset:9056
    v_mul_f32 v140, v140, v230
    v_mfma_f32_16x16x32_bf16 v[168:171], a[220:223], v[40:43], 0
    ds_read_b64_tr_b16 a[238:239], v250 offset:9312
    v_mul_f32 v141, v141, v230
    v_mfma_f32_16x16x32_bf16 v[168:171], a[216:219], v[28:31], v[168:171]
    v_mul_f32 v142, v142, v230
    v_mul_f32 v143, v143, v230
    v_mfma_f32_16x16x32_bf16 v[168:171], a[212:215], v[16:19], v[168:171]
    ds_read_b64_tr_b16 a[240:241], v250 offset:16896
    v_cvt_pk_bf16_f32 v212, v136, v137
    v_mfma_f32_16x16x32_bf16 v[168:171], a[208:211], v[4:7], v[168:171]
    ds_read_b64_tr_b16 a[242:243], v250 offset:17152
    v_cvt_pk_bf16_f32 v213, v138, v139
    v_mfma_f32_16x16x32_bf16 v[184:187], a[208:211], v[8:11], 0
    v_cvt_pk_bf16_f32 v214, v140, v141
    v_cvt_pk_bf16_f32 v215, v142, v143
    v_mfma_f32_16x16x32_bf16 v[184:187], a[212:215], v[20:23], v[184:187]
    ds_read_b64_tr_b16 a[244:245], v250 offset:17408
    v_mfma_f32_16x16x32_bf16 v[184:187], a[216:219], v[32:35], v[184:187]
    s_waitcnt lgkmcnt(9)
    ds_read_b64_tr_b16 a[246:247], v250 offset:17664
    v_mfma_f32_16x16x32_bf16 v[184:187], a[220:223], v[44:47], v[184:187]
    buffer_store_dwordx4 v[212:215], v251, s[28:31], s66 offen offset:1024 sc1
    v_mfma_f32_16x16x32_bf16 v[188:191], a[224:227], v[8:11], 0
    s_waitcnt lgkmcnt(4)
    ds_read_b64_tr_b16 a[248:249], v250 offset:25344
    v_mul_f32 v120, v120, v229
    v_mfma_f32_16x16x32_bf16 v[188:191], a[228:231], v[20:23], v[188:191]
    ds_read_b64_tr_b16 a[250:251], v250 offset:25600
    v_mul_f32 v121, v121, v229
    v_mfma_f32_16x16x32_bf16 v[188:191], a[232:235], v[32:35], v[188:191]
    v_mul_f32 v122, v122, v229
    v_mul_f32 v123, v123, v229
    v_mfma_f32_16x16x32_bf16 v[188:191], a[236:239], v[44:47], v[188:191]
    ds_read_b64_tr_b16 a[252:253], v250 offset:25856
    v_mul_f32 v124, v124, v229
    v_mfma_f32_16x16x32_bf16 v[172:175], a[236:239], v[40:43], 0
    ds_read_b64_tr_b16 a[254:255], v250 offset:26112
    v_mul_f32 v125, v125, v229
    v_mfma_f32_16x16x32_bf16 v[172:175], a[232:235], v[28:31], v[172:175]
    v_mul_f32 v126, v126, v229
    v_mul_f32 v127, v127, v229
    v_mfma_f32_16x16x32_bf16 v[172:175], a[228:231], v[16:19], v[172:175]
    ds_read_b64_tr_b16 a[208:209], v250 offset:16928
    v_cvt_pk_bf16_f32 v204, v120, v121
    v_mfma_f32_16x16x32_bf16 v[172:175], a[224:227], v[4:7], v[172:175]
    ds_read_b64_tr_b16 a[210:211], v250 offset:17184
    v_cvt_pk_bf16_f32 v205, v122, v123
    v_mfma_f32_16x16x32_bf16 v[156:159], a[224:227], v[0:3], 0
    v_cvt_pk_bf16_f32 v206, v124, v125
    v_cvt_pk_bf16_f32 v207, v126, v127
    v_mfma_f32_16x16x32_bf16 v[156:159], a[228:231], v[12:15], v[156:159]
    ds_read_b64_tr_b16 a[212:213], v250 offset:17440
    v_mfma_f32_16x16x32_bf16 v[156:159], a[232:235], v[24:27], v[156:159]
    s_waitcnt lgkmcnt(9)
    ds_read_b64_tr_b16 a[214:215], v250 offset:17696
    v_mfma_f32_16x16x32_bf16 v[156:159], a[236:239], v[36:39], v[156:159]
    buffer_store_dwordx4 v[204:207], v251, s[28:31], s65 offen offset:3072 sc1
    v_mfma_f32_16x16x32_bf16 v[144:147], a[240:243], v[48:51], v[144:147]
    s_waitcnt lgkmcnt(4)
    ds_read_b64_tr_b16 a[216:217], v250 offset:25376
    v_mul_f32 v104, v104, v228
    v_mfma_f32_16x16x32_bf16 v[144:147], a[244:247], v[60:63], v[144:147]
    ds_read_b64_tr_b16 a[218:219], v250 offset:25632
    v_mul_f32 v105, v105, v228
    v_mfma_f32_16x16x32_bf16 v[144:147], a[248:251], v[72:75], v[144:147]
    v_mul_f32 v106, v106, v228
    v_mul_f32 v107, v107, v228
    v_mfma_f32_16x16x32_bf16 v[144:147], a[252:255], v[84:87], v[144:147]
    ds_read_b64_tr_b16 a[220:221], v250 offset:25888
    v_mul_f32 v108, v108, v228
    v_mfma_f32_16x16x32_bf16 v[160:163], a[252:255], v[88:91], v[160:163]
    ds_read_b64_tr_b16 a[222:223], v250 offset:26144
    v_mul_f32 v109, v109, v228
    v_mfma_f32_16x16x32_bf16 v[160:163], a[248:251], v[76:79], v[160:163]
    v_mul_f32 v110, v110, v228
    v_mul_f32 v111, v111, v228
    v_mfma_f32_16x16x32_bf16 v[160:163], a[244:247], v[64:67], v[160:163]
    ds_read_b64_tr_b16 a[224:225], v250 offset:16960
    v_cvt_pk_bf16_f32 v196, v104, v105
    v_mfma_f32_16x16x32_bf16 v[160:163], a[240:243], v[52:55], v[160:163]
    ds_read_b64_tr_b16 a[226:227], v250 offset:17216
    v_cvt_pk_bf16_f32 v197, v106, v107
    v_mfma_f32_16x16x32_bf16 v[176:179], a[240:243], v[56:59], v[176:179]
    v_cvt_pk_bf16_f32 v198, v108, v109
    v_cvt_pk_bf16_f32 v199, v110, v111
    v_mfma_f32_16x16x32_bf16 v[176:179], a[244:247], v[68:71], v[176:179]
    ds_read_b64_tr_b16 a[228:229], v250 offset:17472
    v_mfma_f32_16x16x32_bf16 v[176:179], a[248:251], v[80:83], v[176:179]
    s_waitcnt lgkmcnt(9)
    ds_read_b64_tr_b16 a[230:231], v250 offset:17728
    v_mfma_f32_16x16x32_bf16 v[176:179], a[252:255], v[92:95], v[176:179]
    buffer_store_dwordx4 v[196:199], v251, s[28:31], s65 offen offset:1024 sc1
    v_mfma_f32_16x16x32_bf16 v[180:183], a[208:211], v[56:59], v[180:183]
    s_waitcnt lgkmcnt(4)
    ds_read_b64_tr_b16 a[232:233], v250 offset:25408
    v_mfma_f32_16x16x32_bf16 v[180:183], a[212:215], v[68:71], v[180:183]
    ds_read_b64_tr_b16 a[234:235], v250 offset:25664
    v_mfma_f32_16x16x32_bf16 v[180:183], a[216:219], v[80:83], v[180:183]
    v_mfma_f32_16x16x32_bf16 v[180:183], a[220:223], v[92:95], v[180:183]
    s_add_u32 s65, s64, 786432
    ds_read_b64_tr_b16 a[236:237], v250 offset:25920
    s_add_u32 s66, s64, 790528
    v_mfma_f32_16x16x32_bf16 v[164:167], a[220:223], v[88:91], v[164:167]
    ds_read_b64_tr_b16 a[238:239], v250 offset:26176
    v_mul_f32 v176, v176, v230
    v_mfma_f32_16x16x32_bf16 v[164:167], a[216:219], v[76:79], v[164:167]
    v_mul_f32 v177, v177, v230
    v_mul_f32 v178, v178, v230
    v_mfma_f32_16x16x32_bf16 v[164:167], a[212:215], v[64:67], v[164:167]
    ds_read_b64_tr_b16 a[240:241], v250 offset:16992
    v_mul_f32 v179, v179, v230
    v_mfma_f32_16x16x32_bf16 v[164:167], a[208:211], v[52:55], v[164:167]
    ds_read_b64_tr_b16 a[242:243], v250 offset:17248
    v_mul_f32 v180, v180, v230
    v_mul_u32_u24 v235, s100, v234
    v_mfma_f32_16x16x32_bf16 v[148:151], a[208:211], v[48:51], v[148:151]
    v_mul_f32 v181, v181, v230
    v_mul_f32 v182, v182, v230
    v_mfma_f32_16x16x32_bf16 v[148:151], a[212:215], v[60:63], v[148:151]
    ds_read_b64_tr_b16 a[244:245], v250 offset:17504
    v_mul_f32 v183, v183, v230
    v_mfma_f32_16x16x32_bf16 v[148:151], a[216:219], v[72:75], v[148:151]
    s_waitcnt lgkmcnt(9)
    ds_read_b64_tr_b16 a[246:247], v250 offset:17760
    v_cvt_pk_bf16_f32 v208, v176, v177
    v_mfma_f32_16x16x32_bf16 v[148:151], a[220:223], v[84:87], v[148:151]
    buffer_atomic_add v235, v233, s[28:31], s97 offen sc0 sc1
    v_cvt_pk_bf16_f32 v209, v178, v179
    v_cvt_pk_bf16_f32 v210, v180, v181
    v_mfma_f32_16x16x32_bf16 v[152:155], a[224:227], v[48:51], v[152:155]
    s_waitcnt lgkmcnt(4)
    ds_read_b64_tr_b16 a[248:249], v250 offset:25440
    v_cvt_pk_bf16_f32 v211, v182, v183
    v_mfma_f32_16x16x32_bf16 v[152:155], a[228:231], v[60:63], v[152:155]
    ds_read_b64_tr_b16 a[250:251], v250 offset:25696
    v_mfma_f32_16x16x32_bf16 v[152:155], a[232:235], v[72:75], v[152:155]
    buffer_store_dwordx4 v[208:211], v251, s[28:31], s66 offen offset:0 sc1
    v_mfma_f32_16x16x32_bf16 v[152:155], a[236:239], v[84:87], v[152:155]
    ds_read_b64_tr_b16 a[252:253], v250 offset:25952
    v_mul_f32 v160, v160, v229
    v_mfma_f32_16x16x32_bf16 v[168:171], a[236:239], v[88:91], v[168:171]
    s_waitcnt vmcnt(17)
    ds_read_b64_tr_b16 a[254:255], v250 offset:26208
    v_mul_f32 v161, v161, v229
    v_mfma_f32_16x16x32_bf16 v[168:171], a[232:235], v[76:79], v[168:171]
    s_add_u32 s51, s62, 114688
    s_add_u32 m0, s33, 84480
    v_mul_f32 v162, v162, v229
    v_mfma_f32_16x16x32_bf16 v[168:171], a[228:231], v[64:67], v[168:171]
    s_barrier
    ds_read_b64_tr_b16 a[208:209], v248 offset:16896
    v_mul_f32 v163, v163, v229
    v_mfma_f32_16x16x32_bf16 v[168:171], a[224:227], v[52:55], v[168:171]
    ds_read_b64_tr_b16 a[210:211], v248 offset:17152
    v_mul_f32 v164, v164, v229
    v_mfma_f32_16x16x32_bf16 v[184:187], a[224:227], v[56:59], v[184:187]
    v_mul_f32 v165, v165, v229
    v_mul_f32 v166, v166, v229
    v_mfma_f32_16x16x32_bf16 v[184:187], a[228:231], v[68:71], v[184:187]
    ds_read_b64_tr_b16 a[212:213], v248 offset:17408
    v_mul_f32 v167, v167, v229
    v_mfma_f32_16x16x32_bf16 v[184:187], a[232:235], v[80:83], v[184:187]
    s_waitcnt lgkmcnt(9)
    ds_read_b64_tr_b16 a[214:215], v248 offset:17664
    v_cvt_pk_bf16_f32 v200, v160, v161
    v_mfma_f32_16x16x32_bf16 v[184:187], a[236:239], v[92:95], v[184:187]
    buffer_load_dwordx4 v247, s[24:27], s51 offen lds
    v_mfma_f32_16x16x32_bf16 v[188:191], a[240:243], v[56:59], v[188:191]
    s_waitcnt lgkmcnt(4)
    ds_read_b64_tr_b16 a[216:217], v248 offset:25344
    s_add_u32 m0, s33, 84640
    v_mfma_f32_16x16x32_bf16 v[188:191], a[244:247], v[68:71], v[188:191]
    ds_read_b64_tr_b16 a[218:219], v248 offset:25600
    v_cvt_pk_bf16_f32 v201, v162, v163
    v_mfma_f32_16x16x32_bf16 v[188:191], a[248:251], v[80:83], v[188:191]
    buffer_load_dwordx4 v247, s[24:27], s51 offen offset:896 lds
    v_mfma_f32_16x16x32_bf16 v[188:191], a[252:255], v[92:95], v[188:191]
    s_add_u32 m0, s33, 84800
    ds_read_b64_tr_b16 a[220:221], v248 offset:25856
    v_cvt_pk_bf16_f32 v202, v164, v165
    v_mfma_f32_16x16x32_bf16 v[172:175], a[252:255], v[88:91], v[172:175]
    ds_read_b64_tr_b16 a[222:223], v248 offset:26112
    v_cvt_pk_bf16_f32 v203, v166, v167
    v_mfma_f32_16x16x32_bf16 v[172:175], a[248:251], v[76:79], v[172:175]
    buffer_load_dwordx4 v247, s[24:27], s51 offen offset:1792 lds
    v_mfma_f32_16x16x32_bf16 v[172:175], a[244:247], v[64:67], v[172:175]
    s_add_u32 m0, s33, 84960
    ds_read_b64_tr_b16 a[224:225], v248 offset:16928
    v_mfma_f32_16x16x32_bf16 v[172:175], a[240:243], v[52:55], v[172:175]
    ds_read_b64_tr_b16 a[226:227], v248 offset:17184
    v_mfma_f32_16x16x32_bf16 v[156:159], a[240:243], v[48:51], v[156:159]
    buffer_load_dwordx4 v247, s[24:27], s51 offen offset:2688 lds
    v_mfma_f32_16x16x32_bf16 v[156:159], a[244:247], v[60:63], v[156:159]
    ds_read_b64_tr_b16 a[228:229], v248 offset:17440
    v_mfma_f32_16x16x32_bf16 v[156:159], a[248:251], v[72:75], v[156:159]
    s_waitcnt lgkmcnt(9)
    ds_read_b64_tr_b16 a[230:231], v248 offset:17696
    v_mfma_f32_16x16x32_bf16 v[156:159], a[252:255], v[84:87], v[156:159]
    buffer_store_dwordx4 v[200:203], v251, s[28:31], s65 offen offset:2048 sc1
    v_mfma_f32_16x16x32_bf16 v[96:99], a[208:211], v[0:3], 0
    s_waitcnt lgkmcnt(4)
    ds_read_b64_tr_b16 a[232:233], v248 offset:25376
    v_mul_f32 v144, v144, v228
    v_mfma_f32_16x16x32_bf16 v[96:99], a[212:215], v[12:15], v[96:99]
    ds_read_b64_tr_b16 a[234:235], v248 offset:25632
    v_mul_f32 v145, v145, v228
    v_mfma_f32_16x16x32_bf16 v[96:99], a[216:219], v[24:27], v[96:99]
    v_mul_f32 v146, v146, v228
    v_mul_f32 v147, v147, v228
    v_mfma_f32_16x16x32_bf16 v[96:99], a[220:223], v[36:39], v[96:99]
    ds_read_b64_tr_b16 a[236:237], v248 offset:25888
    v_mul_f32 v148, v148, v228
    v_mfma_f32_16x16x32_bf16 v[112:115], a[220:223], v[40:43], 0
    ds_read_b64_tr_b16 a[238:239], v248 offset:26144
    v_mul_f32 v149, v149, v228
    v_mfma_f32_16x16x32_bf16 v[112:115], a[216:219], v[28:31], v[112:115]
    v_mul_f32 v150, v150, v228
    v_mul_f32 v151, v151, v228
    v_mfma_f32_16x16x32_bf16 v[112:115], a[212:215], v[16:19], v[112:115]
    ds_read_b64_tr_b16 a[240:241], v248 offset:16960
    v_cvt_pk_bf16_f32 v192, v144, v145
    v_mfma_f32_16x16x32_bf16 v[112:115], a[208:211], v[4:7], v[112:115]
    ds_read_b64_tr_b16 a[242:243], v248 offset:17216
    v_cvt_pk_bf16_f32 v193, v146, v147
    v_mfma_f32_16x16x32_bf16 v[128:131], a[208:211], v[8:11], 0
    v_cvt_pk_bf16_f32 v194, v148, v149
    v_cvt_pk_bf16_f32 v195, v150, v151
    v_mfma_f32_16x16x32_bf16 v[128:131], a[212:215], v[20:23], v[128:131]
    ds_read_b64_tr_b16 a[244:245], v248 offset:17472
    v_mfma_f32_16x16x32_bf16 v[128:131], a[216:219], v[32:35], v[128:131]
    s_waitcnt lgkmcnt(9)
    ds_read_b64_tr_b16 a[246:247], v248 offset:17728
    v_mfma_f32_16x16x32_bf16 v[128:131], a[220:223], v[44:47], v[128:131]
    buffer_store_dwordx4 v[192:195], v251, s[28:31], s65 offen offset:0 sc1
    v_mfma_f32_16x16x32_bf16 v[132:135], a[224:227], v[8:11], 0
    s_waitcnt lgkmcnt(4)
    ds_read_b64_tr_b16 a[248:249], v248 offset:25408
    v_mul_f32 v184, v184, v230
    v_mfma_f32_16x16x32_bf16 v[132:135], a[228:231], v[20:23], v[132:135]
    s_waitcnt vmcnt(8)
    ds_read_b64_tr_b16 a[250:251], v248 offset:25664
    v_mul_f32 v185, v185, v230
    v_mov_b32 v231, 1024
    v_mfma_f32_16x16x32_bf16 v[132:135], a[232:235], v[32:35], v[132:135]
    v_mul_f32 v186, v186, v230
    v_mul_f32 v187, v187, v230
    v_mfma_f32_16x16x32_bf16 v[132:135], a[236:239], v[44:47], v[132:135]
    ds_read_b64_tr_b16 a[252:253], v248 offset:25920
    v_mul_f32 v188, v188, v230
    v_mfma_f32_16x16x32_bf16 v[116:119], a[236:239], v[40:43], 0
    ds_read_b64_tr_b16 a[254:255], v248 offset:26176
    v_mul_f32 v189, v189, v230
    v_mfma_f32_16x16x32_bf16 v[116:119], a[232:235], v[28:31], v[116:119]
    v_mul_f32 v190, v190, v230
    v_mul_f32 v191, v191, v230
    v_mfma_f32_16x16x32_bf16 v[116:119], a[228:231], v[16:19], v[116:119]
    ds_read_b64_tr_b16 a[208:209], v248 offset:16992
    v_cvt_pk_bf16_f32 v212, v184, v185
    v_mfma_f32_16x16x32_bf16 v[116:119], a[224:227], v[4:7], v[116:119]
    ds_read_b64_tr_b16 a[210:211], v248 offset:17248
    v_cvt_pk_bf16_f32 v213, v186, v187
    v_mfma_f32_16x16x32_bf16 v[100:103], a[224:227], v[0:3], 0
    v_cvt_pk_bf16_f32 v214, v188, v189
    v_cvt_pk_bf16_f32 v215, v190, v191
    v_mfma_f32_16x16x32_bf16 v[100:103], a[228:231], v[12:15], v[100:103]
    ds_read_b64_tr_b16 a[212:213], v248 offset:17504
    buffer_atomic_add v231, v252, s[28:31], s97 offen sc1
    v_mfma_f32_16x16x32_bf16 v[100:103], a[232:235], v[24:27], v[100:103]
    s_waitcnt lgkmcnt(9)
    ds_read_b64_tr_b16 a[214:215], v248 offset:17760
    v_mfma_f32_16x16x32_bf16 v[100:103], a[236:239], v[36:39], v[100:103]
    buffer_store_dwordx4 v[212:215], v251, s[28:31], s66 offen offset:1024 sc1
    v_mfma_f32_16x16x32_bf16 v[104:107], a[240:243], v[0:3], 0
    s_waitcnt lgkmcnt(4)
    ds_read_b64_tr_b16 a[216:217], v248 offset:25440
    v_mul_f32 v168, v168, v229
    v_mfma_f32_16x16x32_bf16 v[104:107], a[244:247], v[12:15], v[104:107]
    ds_read_b64_tr_b16 a[218:219], v248 offset:25696
    v_mul_f32 v169, v169, v229
    v_mfma_f32_16x16x32_bf16 v[104:107], a[248:251], v[24:27], v[104:107]
    v_mul_f32 v170, v170, v229
    v_mul_f32 v171, v171, v229
    v_mfma_f32_16x16x32_bf16 v[104:107], a[252:255], v[36:39], v[104:107]
    ds_read_b64_tr_b16 a[220:221], v248 offset:25952
    v_mul_f32 v172, v172, v229
    v_mfma_f32_16x16x32_bf16 v[120:123], a[252:255], v[40:43], 0
    s_waitcnt vmcnt(9)
    ds_read_b64_tr_b16 a[222:223], v248 offset:26208
    v_mul_f32 v173, v173, v229
    v_mfma_f32_16x16x32_bf16 v[120:123], a[248:251], v[28:31], v[120:123]
    v_mul_f32 v174, v174, v229
    v_mul_f32 v175, v175, v229
    v_mfma_f32_16x16x32_bf16 v[120:123], a[244:247], v[16:19], v[120:123]
    ds_read_b64_tr_b16 a[224:225], v250 offset:33792
    v_cvt_pk_bf16_f32 v204, v168, v169
    v_mfma_f32_16x16x32_bf16 v[120:123], a[240:243], v[4:7], v[120:123]
    ds_read_b64_tr_b16 a[226:227], v250 offset:34048
    v_cvt_pk_bf16_f32 v205, v170, v171
    v_mfma_f32_16x16x32_bf16 v[136:139], a[240:243], v[8:11], 0
    v_cvt_pk_bf16_f32 v206, v172, v173
    v_cvt_pk_bf16_f32 v207, v174, v175
    v_mfma_f32_16x16x32_bf16 v[136:139], a[244:247], v[20:23], v[136:139]
    ds_read_b64_tr_b16 a[228:229], v250 offset:34304
    v_readlane_b32 s71, v235, 0
    v_mfma_f32_16x16x32_bf16 v[136:139], a[248:251], v[32:35], v[136:139]
    s_waitcnt lgkmcnt(9)
    ds_read_b64_tr_b16 a[230:231], v250 offset:34560
    v_readlane_b32 s94, v235, 1
    v_mfma_f32_16x16x32_bf16 v[136:139], a[252:255], v[44:47], v[136:139]
    buffer_store_dwordx4 v[204:207], v251, s[28:31], s65 offen offset:3072 sc1
    v_mfma_f32_16x16x32_bf16 v[140:143], a[208:211], v[8:11], 0
    s_waitcnt lgkmcnt(4)
    ds_read_b64_tr_b16 a[232:233], v250 offset:42240
    v_mul_f32 v152, v152, v228
    v_mfma_f32_16x16x32_bf16 v[140:143], a[212:215], v[20:23], v[140:143]
    s_sub_u32 s94, s94, s96
    ds_read_b64_tr_b16 a[234:235], v250 offset:42496
    v_mul_f32 v153, v153, v228
    v_mfma_f32_16x16x32_bf16 v[140:143], a[216:219], v[32:35], v[140:143]
    s_mul_i32 s94, s94, s100
    v_mul_f32 v154, v154, v228
    v_mul_f32 v155, v155, v228
    v_mfma_f32_16x16x32_bf16 v[140:143], a[220:223], v[44:47], v[140:143]
    s_add_u32 s96, s96, s94
    ds_read_b64_tr_b16 a[236:237], v250 offset:42752
    v_mul_f32 v156, v156, v228
    v_mfma_f32_16x16x32_bf16 v[124:127], a[220:223], v[40:43], 0
    s_mul_i32 s87, s96, 171
    ds_read_b64_tr_b16 a[238:239], v250 offset:43008
    v_mul_f32 v157, v157, v228
    v_mfma_f32_16x16x32_bf16 v[124:127], a[216:219], v[28:31], v[124:127]
    s_lshr_b32 s87, s87, 11
    v_mul_f32 v158, v158, v228
    v_mul_f32 v159, v159, v228
    v_mfma_f32_16x16x32_bf16 v[124:127], a[212:215], v[16:19], v[124:127]
    s_mul_i32 s68, s87, 12
    ds_read_b64_tr_b16 a[240:241], v250 offset:33824
    v_cvt_pk_bf16_f32 v196, v152, v153
    v_mfma_f32_16x16x32_bf16 v[124:127], a[208:211], v[4:7], v[124:127]
    s_sub_u32 s68, s96, s68
    ds_read_b64_tr_b16 a[242:243], v250 offset:34080
    v_cvt_pk_bf16_f32 v197, v154, v155
    v_mfma_f32_16x16x32_bf16 v[108:111], a[208:211], v[0:3], 0
    s_and_b32 s70, s87, 1
    v_cvt_pk_bf16_f32 v198, v156, v157
    v_cvt_pk_bf16_f32 v199, v158, v159
    v_mfma_f32_16x16x32_bf16 v[108:111], a[212:215], v[12:15], v[108:111]
    s_mul_i32 s70, s70, s89
    ds_read_b64_tr_b16 a[244:245], v250 offset:34336
    s_add_u32 s92, s88, s70
    v_mfma_f32_16x16x32_bf16 v[108:111], a[216:219], v[24:27], v[108:111]
    s_waitcnt lgkmcnt(9)
    ds_read_b64_tr_b16 a[246:247], v250 offset:34592
    s_lshl_b32 s70, s87, 18
    v_mfma_f32_16x16x32_bf16 v[108:111], a[220:223], v[36:39], v[108:111]
    buffer_store_dwordx4 v[196:199], v251, s[28:31], s65 offen offset:1024 sc1
    v_mfma_f32_16x16x32_bf16 v[96:99], a[224:227], v[48:51], v[96:99]
    s_waitcnt lgkmcnt(4)
    ds_read_b64_tr_b16 a[248:249], v250 offset:42272
    s_add_u32 s92, s92, s70
    v_mfma_f32_16x16x32_bf16 v[96:99], a[228:231], v[60:63], v[96:99]
    s_lshr_b32 s70, s68, 1
    ds_read_b64_tr_b16 a[250:251], v250 offset:42528
    s_lshl_b32 s70, s70, 10
    v_mfma_f32_16x16x32_bf16 v[96:99], a[232:235], v[72:75], v[96:99]
    s_add_u32 s92, s92, s70
    s_and_b32 s45, s68, 1
    s_lshl_b32 s70, s45, 7
    v_mfma_f32_16x16x32_bf16 v[96:99], a[236:239], v[84:87], v[96:99]
    s_add_u32 s92, s92, s70
    ds_read_b64_tr_b16 a[252:253], v250 offset:42784
    s_lshl_b32 s87, s87, 2
    v_mfma_f32_16x16x32_bf16 v[112:115], a[236:239], v[88:91], v[112:115]
    s_lshr_b32 s70, 88289808, s87
    ds_read_b64_tr_b16 a[254:255], v250 offset:43040
    s_and_b32 s70, s70, 15
    v_mfma_f32_16x16x32_bf16 v[112:115], a[232:235], v[76:79], v[112:115]
    s_mul_i32 s70, s70, 5
    s_lshl_b32 s93, 16, s70
    s_andn2_b32 s70, s93, s71
    v_mfma_f32_16x16x32_bf16 v[112:115], a[228:231], v[64:67], v[112:115]
    s_min_u32 s70, s70, 1
    ds_read_b64_tr_b16 a[208:209], v250 offset:33856
    s_sub_u32 s100, 1, s70
    v_mfma_f32_16x16x32_bf16 v[112:115], a[224:227], v[52:55], v[112:115]
    s_lshl_b32 s94, s70, 28
    ds_read_b64_tr_b16 a[210:211], v250 offset:34112
    s_add_u32 s92, s92, s94
    v_mfma_f32_16x16x32_bf16 v[128:131], a[224:227], v[56:59], v[128:131]
    s_mul_i32 s45, s45, 14336
    buffer_load_dwordx4 a[64:67], v236, s[28:31], s92 offen sc1
    s_add_u32 s45, s45, s90
    s_lshr_b32 s70, s91, s87
    v_mfma_f32_16x16x32_bf16 v[128:131], a[228:231], v[68:71], v[128:131]
    s_and_b32 s70, s70, 15
    ds_read_b64_tr_b16 a[212:213], v250 offset:34368
    s_lshl_b32 s70, s70, 7
    v_mfma_f32_16x16x32_bf16 v[128:131], a[232:235], v[80:83], v[128:131]
    s_waitcnt lgkmcnt(9)
    ds_read_b64_tr_b16 a[214:215], v250 offset:34624
    s_add_u32 s45, s45, s70
    v_mfma_f32_16x16x32_bf16 v[128:131], a[236:239], v[92:95], v[128:131]
    s_and_b32 s70, s68, 2
    s_lshl_b32 s70, s70, 5
    s_add_u32 s45, s45, s70
    v_mfma_f32_16x16x32_bf16 v[132:135], a[240:243], v[56:59], v[132:135]
    s_waitcnt lgkmcnt(4)
    ds_read_b64_tr_b16 a[216:217], v250 offset:42304
    s_lshr_b32 s70, s68, 2
    v_mfma_f32_16x16x32_bf16 v[132:135], a[244:247], v[68:71], v[132:135]
    s_mul_i32 s70, s70, 28672
    ds_read_b64_tr_b16 a[218:219], v250 offset:42560
    s_add_u32 s45, s45, s70
    v_mfma_f32_16x16x32_bf16 v[132:135], a[248:251], v[80:83], v[132:135]
    s_add_u32 s45, s45, s94
    s_add_u32 s92, s92, 34816
    v_mfma_f32_16x16x32_bf16 v[132:135], a[252:255], v[92:95], v[132:135]
    s_add_u32 s65, s63, 1048576
    ds_read_b64_tr_b16 a[220:221], v250 offset:42816
    s_add_u32 s66, s63, 1052672
    v_mfma_f32_16x16x32_bf16 v[116:119], a[252:255], v[88:91], v[116:119]
    ds_read_b64_tr_b16 a[222:223], v250 offset:43072
    v_mul_f32 v128, v128, v230
    v_mfma_f32_16x16x32_bf16 v[116:119], a[248:251], v[76:79], v[116:119]
    v_mul_f32 v129, v129, v230
    v_mul_f32 v130, v130, v230
    v_mfma_f32_16x16x32_bf16 v[116:119], a[244:247], v[64:67], v[116:119]
    ds_read_b64_tr_b16 a[224:225], v250 offset:33888
    v_mul_f32 v131, v131, v230
    v_mfma_f32_16x16x32_bf16 v[116:119], a[240:243], v[52:55], v[116:119]
    ds_read_b64_tr_b16 a[226:227], v250 offset:34144
    v_mul_f32 v132, v132, v230
    v_mfma_f32_16x16x32_bf16 v[100:103], a[240:243], v[48:51], v[100:103]
    buffer_load_dwordx4 a[68:71], v236, s[28:31], s92 offen sc1
    v_mul_f32 v133, v133, v230
    v_mul_f32 v134, v134, v230
    v_mfma_f32_16x16x32_bf16 v[100:103], a[244:247], v[60:63], v[100:103]
    s_add_u32 s92, s92, 30720
    ds_read_b64_tr_b16 a[228:229], v250 offset:34400
    v_mul_f32 v135, v135, v230
    v_mfma_f32_16x16x32_bf16 v[100:103], a[248:251], v[72:75], v[100:103]
    s_waitcnt lgkmcnt(9)
    ds_read_b64_tr_b16 a[230:231], v250 offset:34656
    v_cvt_pk_bf16_f32 v208, v128, v129
    v_mfma_f32_16x16x32_bf16 v[100:103], a[252:255], v[84:87], v[100:103]
    v_cvt_pk_bf16_f32 v209, v130, v131
    v_cvt_pk_bf16_f32 v210, v132, v133
    v_mfma_f32_16x16x32_bf16 v[104:107], a[208:211], v[48:51], v[104:107]
    s_waitcnt lgkmcnt(4)
    ds_read_b64_tr_b16 a[232:233], v250 offset:42336
    v_cvt_pk_bf16_f32 v211, v134, v135
    v_mfma_f32_16x16x32_bf16 v[104:107], a[212:215], v[60:63], v[104:107]
    ds_read_b64_tr_b16 a[234:235], v250 offset:42592
    v_mfma_f32_16x16x32_bf16 v[104:107], a[216:219], v[72:75], v[104:107]
    buffer_store_dwordx4 v[208:211], v251, s[28:31], s66 offen offset:0 sc1
    v_mfma_f32_16x16x32_bf16 v[104:107], a[220:223], v[84:87], v[104:107]
L_pad12:
    s_cbranch_execz L_main
    ds_read_b64_tr_b16 a[236:237], v250 offset:42848
    v_mul_f32 v112, v112, v229
    v_mfma_f32_16x16x32_bf16 v[120:123], a[220:223], v[88:91], v[120:123]
    s_waitcnt vmcnt(14)
    ds_read_b64_tr_b16 a[238:239], v250 offset:43104
    v_mul_f32 v113, v113, v229
    v_mfma_f32_16x16x32_bf16 v[120:123], a[216:219], v[76:79], v[120:123]
    v_mul_f32 v114, v114, v229
    v_mul_f32 v115, v115, v229
    v_mfma_f32_16x16x32_bf16 v[120:123], a[212:215], v[64:67], v[120:123]
    s_barrier
    ds_read_b64_tr_b16 a[240:241], v248 offset:33792
    v_mul_f32 v116, v116, v229
    v_mfma_f32_16x16x32_bf16 v[120:123], a[208:211], v[52:55], v[120:123]
    ds_read_b64_tr_b16 a[242:243], v248 offset:34048
    v_mul_f32 v117, v117, v229
    v_mfma_f32_16x16x32_bf16 v[136:139], a[208:211], v[56:59], v[136:139]
    buffer_load_dwordx4 a[72:75], v236, s[28:31], s92 offen sc1
    v_mul_f32 v118, v118, v229
    v_mul_f32 v119, v119, v229
    v_mfma_f32_16x16x32_bf16 v[136:139], a[212:215], v[68:71], v[136:139]
    s_add_u32 s92, s92, 34816
    ds_read_b64_tr_b16 a[244:245], v248 offset:34304
    v_cvt_pk_bf16_f32 v200, v112, v113
    v_mfma_f32_16x16x32_bf16 v[136:139], a[216:219], v[80:83], v[136:139]
    s_waitcnt lgkmcnt(9)
    ds_read_b64_tr_b16 a[246:247], v248 offset:34560
    v_cvt_pk_bf16_f32 v201, v114, v115
    v_mfma_f32_16x16x32_bf16 v[136:139], a[220:223], v[92:95], v[136:139]
    v_cvt_pk_bf16_f32 v202, v116, v117
    v_cvt_pk_bf16_f32 v203, v118, v119
    v_mfma_f32_16x16x32_bf16 v[140:143], a[224:227], v[56:59], v[140:143]
    s_waitcnt lgkmcnt(4)
    ds_read_b64_tr_b16 a[248:249], v248 offset:42240
    v_mfma_f32_16x16x32_bf16 v[140:143], a[228:231], v[68:71], v[140:143]
    ds_read_b64_tr_b16 a[250:251], v248 offset:42496
    v_mfma_f32_16x16x32_bf16 v[140:143], a[232:235], v[80:83], v[140:143]
    buffer_store_dwordx4 v[200:203], v251, s[28:31], s65 offen offset:2048 sc1
    v_mfma_f32_16x16x32_bf16 v[140:143], a[236:239], v[92:95], v[140:143]
    ds_read_b64_tr_b16 a[252:253], v248 offset:42752
    v_mul_f32 v96, v96, v228
    v_mfma_f32_16x16x32_bf16 v[124:127], a[236:239], v[88:91], v[124:127]
    ds_read_b64_tr_b16 a[254:255], v248 offset:43008
    v_mul_f32 v97, v97, v228
    v_mfma_f32_16x16x32_bf16 v[124:127], a[232:235], v[76:79], v[124:127]
    v_mul_f32 v98, v98, v228
    v_mul_f32 v99, v99, v228
    v_mfma_f32_16x16x32_bf16 v[124:127], a[228:231], v[64:67], v[124:127]
    ds_read_b64_tr_b16 a[208:209], v248 offset:33824
    v_mul_f32 v100, v100, v228
    v_mfma_f32_16x16x32_bf16 v[124:127], a[224:227], v[52:55], v[124:127]
    ds_read_b64_tr_b16 a[210:211], v248 offset:34080
    v_mul_f32 v101, v101, v228
    v_mfma_f32_16x16x32_bf16 v[108:111], a[224:227], v[48:51], v[108:111]
    buffer_load_dwordx4 a[76:79], v236, s[28:31], s92 offen sc1
    v_mul_f32 v102, v102, v228
    v_mul_f32 v103, v103, v228
    v_mfma_f32_16x16x32_bf16 v[108:111], a[228:231], v[60:63], v[108:111]
    s_add_u32 s92, s92, 30720
    ds_read_b64_tr_b16 a[212:213], v248 offset:34336
    v_cvt_pk_bf16_f32 v192, v96, v97
    v_mfma_f32_16x16x32_bf16 v[108:111], a[232:235], v[72:75], v[108:111]
    s_waitcnt lgkmcnt(9)
    ds_read_b64_tr_b16 a[214:215], v248 offset:34592
    v_cvt_pk_bf16_f32 v193, v98, v99
    v_mfma_f32_16x16x32_bf16 v[108:111], a[236:239], v[84:87], v[108:111]
    v_cvt_pk_bf16_f32 v194, v100, v101
    v_cvt_pk_bf16_f32 v195, v102, v103
    v_mfma_f32_16x16x32_bf16 v[144:147], a[240:243], v[0:3], 0
    s_waitcnt lgkmcnt(4)
    ds_read_b64_tr_b16 a[216:217], v248 offset:42272
    v_mfma_f32_16x16x32_bf16 v[144:147], a[244:247], v[12:15], v[144:147]
    ds_read_b64_tr_b16 a[218:219], v248 offset:42528
    v_mfma_f32_16x16x32_bf16 v[144:147], a[248:251], v[24:27], v[144:147]
    buffer_store_dwordx4 v[192:195], v251, s[28:31], s65 offen offset:0 sc1
    v_mfma_f32_16x16x32_bf16 v[144:147], a[252:255], v[36:39], v[144:147]
    ds_read_b64_tr_b16 a[220:221], v248 offset:42784
    v_mul_f32 v136, v136, v230
    v_mfma_f32_16x16x32_bf16 v[160:163], a[252:255], v[40:43], 0
    ds_read_b64_tr_b16 a[222:223], v248 offset:43040
    v_mul_f32 v137, v137, v230
    v_mfma_f32_16x16x32_bf16 v[160:163], a[248:251], v[28:31], v[160:163]
    v_mul_f32 v138, v138, v230
    v_mul_f32 v139, v139, v230
    v_mfma_f32_16x16x32_bf16 v[160:163], a[244:247], v[16:19], v[160:163]
    ds_read_b64_tr_b16 a[224:225], v248 offset:33856
    v_mul_f32 v140, v140, v230
    v_mfma_f32_16x16x32_bf16 v[160:163], a[240:243], v[4:7], v[160:163]
    ds_read_b64_tr_b16 a[226:227], v248 offset:34112
    v_mul_f32 v141, v141, v230
    v_mfma_f32_16x16x32_bf16 v[176:179], a[240:243], v[8:11], 0
    buffer_load_dwordx4 a[80:83], v236, s[28:31], s92 offen sc1
    v_mul_f32 v142, v142, v230
    v_mul_f32 v143, v143, v230
    v_mfma_f32_16x16x32_bf16 v[176:179], a[244:247], v[20:23], v[176:179]
    s_add_u32 s92, s92, 34816
    ds_read_b64_tr_b16 a[228:229], v248 offset:34368
    v_cvt_pk_bf16_f32 v212, v136, v137
    v_mul_u32_u24 v235, s100, v234
    v_mfma_f32_16x16x32_bf16 v[176:179], a[248:251], v[32:35], v[176:179]
    s_waitcnt lgkmcnt(9)
    ds_read_b64_tr_b16 a[230:231], v248 offset:34624
    v_cvt_pk_bf16_f32 v213, v138, v139
    v_mfma_f32_16x16x32_bf16 v[176:179], a[252:255], v[44:47], v[176:179]
    v_cvt_pk_bf16_f32 v214, v140, v141
    v_cvt_pk_bf16_f32 v215, v142, v143
    v_mfma_f32_16x16x32_bf16 v[180:183], a[208:211], v[8:11], 0
    s_waitcnt lgkmcnt(4)
    ds_read_b64_tr_b16 a[232:233], v248 offset:42304
    v_mfma_f32_16x16x32_bf16 v[180:183], a[212:215], v[20:23], v[180:183]
    ds_read_b64_tr_b16 a[234:235], v248 offset:42560
    buffer_atomic_add v235, v233, s[28:31], s97 offen sc0 sc1
    v_mfma_f32_16x16x32_bf16 v[180:183], a[216:219], v[32:35], v[180:183]
    buffer_store_dwordx4 v[212:215], v251, s[28:31], s66 offen offset:1024 sc1
    v_mfma_f32_16x16x32_bf16 v[180:183], a[220:223], v[44:47], v[180:183]
    ds_read_b64_tr_b16 a[236:237], v248 offset:42816
    v_mul_f32 v120, v120, v229
    v_mfma_f32_16x16x32_bf16 v[164:167], a[220:223], v[40:43], 0
    ds_read_b64_tr_b16 a[238:239], v248 offset:43072
    v_mul_f32 v121, v121, v229
    v_mfma_f32_16x16x32_bf16 v[164:167], a[216:219], v[28:31], v[164:167]
    v_mul_f32 v122, v122, v229
    v_mul_f32 v123, v123, v229
    v_mfma_f32_16x16x32_bf16 v[164:167], a[212:215], v[16:19], v[164:167]
    ds_read_b64_tr_b16 a[240:241], v248 offset:33888
    v_mul_f32 v124, v124, v229
    v_mfma_f32_16x16x32_bf16 v[164:167], a[208:211], v[4:7], v[164:167]
    ds_read_b64_tr_b16 a[242:243], v248 offset:34144
    v_mul_f32 v125, v125, v229
    v_mfma_f32_16x16x32_bf16 v[148:151], a[208:211], v[0:3], 0
    buffer_load_dwordx4 a[84:87], v236, s[28:31], s92 offen sc1
    v_mul_f32 v126, v126, v229
    v_mul_f32 v127, v127, v229
    v_mfma_f32_16x16x32_bf16 v[148:151], a[212:215], v[12:15], v[148:151]
    s_add_u32 s92, s92, 30720
    ds_read_b64_tr_b16 a[244:245], v248 offset:34400
    v_cvt_pk_bf16_f32 v204, v120, v121
    v_mfma_f32_16x16x32_bf16 v[148:151], a[216:219], v[24:27], v[148:151]
    s_waitcnt lgkmcnt(9)
    ds_read_b64_tr_b16 a[246:247], v248 offset:34656
    v_cvt_pk_bf16_f32 v205, v122, v123
    v_mfma_f32_16x16x32_bf16 v[148:151], a[220:223], v[36:39], v[148:151]
    v_cvt_pk_bf16_f32 v206, v124, v125
    v_cvt_pk_bf16_f32 v207, v126, v127
    v_mfma_f32_16x16x32_bf16 v[152:155], a[224:227], v[0:3], 0
    s_waitcnt lgkmcnt(4)
    ds_read_b64_tr_b16 a[248:249], v248 offset:42336
    v_mfma_f32_16x16x32_bf16 v[152:155], a[228:231], v[12:15], v[152:155]
    ds_read_b64_tr_b16 a[250:251], v248 offset:42592
    v_mfma_f32_16x16x32_bf16 v[152:155], a[232:235], v[24:27], v[152:155]
    buffer_store_dwordx4 v[204:207], v251, s[28:31], s65 offen offset:3072 sc1
    v_mfma_f32_16x16x32_bf16 v[152:155], a[236:239], v[36:39], v[152:155]
    ds_read_b64_tr_b16 a[252:253], v248 offset:42848
    v_mul_f32 v104, v104, v228
    v_mfma_f32_16x16x32_bf16 v[168:171], a[236:239], v[40:43], 0
    ds_read_b64_tr_b16 a[254:255], v248 offset:43104
    v_mul_f32 v105, v105, v228
    v_mfma_f32_16x16x32_bf16 v[168:171], a[232:235], v[28:31], v[168:171]
    v_mul_f32 v106, v106, v228
    v_mul_f32 v107, v107, v228
    v_mfma_f32_16x16x32_bf16 v[168:171], a[228:231], v[16:19], v[168:171]
    ds_read_b64_tr_b16 a[208:209], v249 offset:16896
    v_mul_f32 v108, v108, v228
    v_mfma_f32_16x16x32_bf16 v[168:171], a[224:227], v[4:7], v[168:171]
    ds_read_b64_tr_b16 a[210:211], v249 offset:17152
    v_mul_f32 v109, v109, v228
    v_mfma_f32_16x16x32_bf16 v[184:187], a[224:227], v[8:11], 0
    buffer_load_dwordx4 a[88:91], v236, s[28:31], s92 offen sc1
    v_mul_f32 v110, v110, v228
    v_mul_f32 v111, v111, v228
    v_mfma_f32_16x16x32_bf16 v[184:187], a[228:231], v[20:23], v[184:187]
    s_add_u32 s92, s92, 34816
    ds_read_b64_tr_b16 a[212:213], v249 offset:17408
    v_cvt_pk_bf16_f32 v196, v104, v105
    v_mfma_f32_16x16x32_bf16 v[184:187], a[232:235], v[32:35], v[184:187]
    s_waitcnt lgkmcnt(9)
    ds_read_b64_tr_b16 a[214:215], v249 offset:17664
    v_cvt_pk_bf16_f32 v197, v106, v107
    v_mfma_f32_16x16x32_bf16 v[184:187], a[236:239], v[44:47], v[184:187]
    v_cvt_pk_bf16_f32 v198, v108, v109
    v_cvt_pk_bf16_f32 v199, v110, v111
    v_mfma_f32_16x16x32_bf16 v[188:191], a[240:243], v[8:11], 0
    s_waitcnt lgkmcnt(4)
    ds_read_b64_tr_b16 a[216:217], v249 offset:25344
    v_mfma_f32_16x16x32_bf16 v[188:191], a[244:247], v[20:23], v[188:191]
    ds_read_b64_tr_b16 a[218:219], v249 offset:25600
    v_mfma_f32_16x16x32_bf16 v[188:191], a[248:251], v[32:35], v[188:191]
    buffer_store_dwordx4 v[196:199], v251, s[28:31], s65 offen offset:1024 sc1
    v_mfma_f32_16x16x32_bf16 v[188:191], a[252:255], v[44:47], v[188:191]
    ds_read_b64_tr_b16 a[220:221], v249 offset:25856
    v_mfma_f32_16x16x32_bf16 v[172:175], a[252:255], v[40:43], 0
    ds_read_b64_tr_b16 a[222:223], v249 offset:26112
    v_mfma_f32_16x16x32_bf16 v[172:175], a[248:251], v[28:31], v[172:175]
    v_mfma_f32_16x16x32_bf16 v[172:175], a[244:247], v[16:19], v[172:175]
    ds_read_b64_tr_b16 a[224:225], v249 offset:16928
    v_mfma_f32_16x16x32_bf16 v[172:175], a[240:243], v[4:7], v[172:175]
    ds_read_b64_tr_b16 a[226:227], v249 offset:17184
    v_mfma_f32_16x16x32_bf16 v[156:159], a[240:243], v[0:3], 0
    buffer_load_dwordx4 a[92:95], v236, s[28:31], s92 offen sc1
    v_mfma_f32_16x16x32_bf16 v[156:159], a[244:247], v[12:15], v[156:159]
    ds_read_b64_tr_b16 a[228:229], v249 offset:17440
    v_mfma_f32_16x16x32_bf16 v[156:159], a[248:251], v[24:27], v[156:159]
    s_waitcnt lgkmcnt(9)
    ds_read_b64_tr_b16 a[230:231], v249 offset:17696
    v_mfma_f32_16x16x32_bf16 v[156:159], a[252:255], v[36:39], v[156:159]
    v_mfma_f32_16x16x32_bf16 v[144:147], a[208:211], v[48:51], v[144:147]
    s_waitcnt lgkmcnt(4)
    ds_read_b64_tr_b16 a[232:233], v249 offset:25376
    v_mfma_f32_16x16x32_bf16 v[144:147], a[212:215], v[60:63], v[144:147]
    ds_read_b64_tr_b16 a[234:235], v249 offset:25632
    v_mfma_f32_16x16x32_bf16 v[144:147], a[216:219], v[72:75], v[144:147]
    v_mfma_f32_16x16x32_bf16 v[144:147], a[220:223], v[84:87], v[144:147]
    ds_read_b64_tr_b16 a[236:237], v249 offset:25888
    v_mfma_f32_16x16x32_bf16 v[160:163], a[220:223], v[88:91], v[160:163]
    ds_read_b64_tr_b16 a[238:239], v249 offset:26144
    v_mfma_f32_16x16x32_bf16 v[160:163], a[216:219], v[76:79], v[160:163]
    v_mfma_f32_16x16x32_bf16 v[160:163], a[212:215], v[64:67], v[160:163]
    ds_read_b64_tr_b16 a[240:241], v249 offset:16960
    v_mfma_f32_16x16x32_bf16 v[160:163], a[208:211], v[52:55], v[160:163]
    ds_read_b64_tr_b16 a[242:243], v249 offset:17216
    v_mfma_f32_16x16x32_bf16 v[176:179], a[208:211], v[56:59], v[176:179]
    v_mfma_f32_16x16x32_bf16 v[176:179], a[212:215], v[68:71], v[176:179]
    ds_read_b64_tr_b16 a[244:245], v249 offset:17472
    v_mfma_f32_16x16x32_bf16 v[176:179], a[216:219], v[80:83], v[176:179]
    s_waitcnt lgkmcnt(9)
    ds_read_b64_tr_b16 a[246:247], v249 offset:17728
    v_mfma_f32_16x16x32_bf16 v[176:179], a[220:223], v[92:95], v[176:179]
    v_mfma_f32_16x16x32_bf16 v[180:183], a[224:227], v[56:59], v[180:183]
    s_waitcnt lgkmcnt(4)
    ds_read_b64_tr_b16 a[248:249], v249 offset:25408
    v_mfma_f32_16x16x32_bf16 v[180:183], a[228:231], v[68:71], v[180:183]
    ds_read_b64_tr_b16 a[250:251], v249 offset:25664
    v_mfma_f32_16x16x32_bf16 v[180:183], a[232:235], v[80:83], v[180:183]
    v_mfma_f32_16x16x32_bf16 v[180:183], a[236:239], v[92:95], v[180:183]
    s_add_u32 s65, s64, 1310720
    ds_read_b64_tr_b16 a[252:253], v249 offset:25920
    s_add_u32 s66, s64, 1314816
    v_mfma_f32_16x16x32_bf16 v[164:167], a[236:239], v[88:91], v[164:167]
    ds_read_b64_tr_b16 a[254:255], v249 offset:26176
    v_mul_f32 v176, v176, v230
    v_mfma_f32_16x16x32_bf16 v[164:167], a[232:235], v[76:79], v[164:167]
    v_mul_f32 v177, v177, v230
    v_mul_f32 v178, v178, v230
    v_mfma_f32_16x16x32_bf16 v[164:167], a[228:231], v[64:67], v[164:167]
    ds_read_b64_tr_b16 a[208:209], v249 offset:16992
    v_mul_f32 v179, v179, v230
    v_mfma_f32_16x16x32_bf16 v[164:167], a[224:227], v[52:55], v[164:167]
    s_waitcnt vmcnt(6)
    ds_read_b64_tr_b16 a[210:211], v249 offset:17248
    v_mul_f32 v180, v180, v230
    v_readlane_b32 s71, v235, 0
    v_mfma_f32_16x16x32_bf16 v[148:151], a[224:227], v[48:51], v[148:151]
    v_mul_f32 v181, v181, v230
    v_mul_f32 v182, v182, v230
    v_mfma_f32_16x16x32_bf16 v[148:151], a[228:231], v[60:63], v[148:151]
    ds_read_b64_tr_b16 a[212:213], v249 offset:17504
    v_mul_f32 v183, v183, v230
    v_mfma_f32_16x16x32_bf16 v[148:151], a[232:235], v[72:75], v[148:151]
    s_waitcnt lgkmcnt(9)
    ds_read_b64_tr_b16 a[214:215], v249 offset:17760
    v_cvt_pk_bf16_f32 v208, v176, v177
    v_mfma_f32_16x16x32_bf16 v[148:151], a[236:239], v[84:87], v[148:151]
    v_cvt_pk_bf16_f32 v209, v178, v179
    v_cvt_pk_bf16_f32 v210, v180, v181
    v_mfma_f32_16x16x32_bf16 v[152:155], a[240:243], v[48:51], v[152:155]
    s_waitcnt lgkmcnt(4)
    ds_read_b64_tr_b16 a[216:217], v249 offset:25440
    v_cvt_pk_bf16_f32 v211, v182, v183
    v_mfma_f32_16x16x32_bf16 v[152:155], a[244:247], v[60:63], v[152:155]
    ds_read_b64_tr_b16 a[218:219], v249 offset:25696
    v_readlane_b32 s94, v235, 1
    v_mfma_f32_16x16x32_bf16 v[152:155], a[248:251], v[72:75], v[152:155]
    buffer_store_dwordx4 v[208:211], v251, s[28:31], s66 offen offset:0 sc1
    v_mfma_f32_16x16x32_bf16 v[152:155], a[252:255], v[84:87], v[152:155]
    s_sub_u32 s94, s94, s96
    ds_read_b64_tr_b16 a[220:221], v249 offset:25952
    v_mul_f32 v160, v160, v229
    v_mfma_f32_16x16x32_bf16 v[168:171], a[252:255], v[88:91], v[168:171]
    s_waitcnt vmcnt(7)
    ds_read_b64_tr_b16 a[222:223], v249 offset:26208
    v_mul_f32 v161, v161, v229
    v_mfma_f32_16x16x32_bf16 v[168:171], a[248:251], v[76:79], v[168:171]
    s_mul_i32 s94, s94, s100
    v_mul_f32 v162, v162, v229
    v_mul_f32 v163, v163, v229
    v_mfma_f32_16x16x32_bf16 v[168:171], a[244:247], v[64:67], v[168:171]
    s_barrier
    ds_read_b64_tr_b16 a[224:225], v249 offset:0
    v_mul_f32 v164, v164, v229
    v_mfma_f32_16x16x32_bf16 v[168:171], a[240:243], v[52:55], v[168:171]
    s_add_u32 s96, s96, s94
    ds_read_b64_tr_b16 a[226:227], v249 offset:256
    v_mul_f32 v165, v165, v229
    v_mfma_f32_16x16x32_bf16 v[184:187], a[240:243], v[56:59], v[184:187]
    s_mul_i32 s87, s96, 171
    v_mul_f32 v166, v166, v229
    v_mul_f32 v167, v167, v229
    v_mfma_f32_16x16x32_bf16 v[184:187], a[244:247], v[68:71], v[184:187]
    s_lshr_b32 s87, s87, 11
    ds_read_b64_tr_b16 a[228:229], v249 offset:512
    v_cvt_pk_bf16_f32 v200, v160, v161
    v_mfma_f32_16x16x32_bf16 v[184:187], a[248:251], v[80:83], v[184:187]
    s_waitcnt lgkmcnt(9)
    ds_read_b64_tr_b16 a[230:231], v249 offset:768
    v_cvt_pk_bf16_f32 v201, v162, v163
    v_mfma_f32_16x16x32_bf16 v[184:187], a[252:255], v[92:95], v[184:187]
    s_mul_i32 s68, s87, 12
    v_cvt_pk_bf16_f32 v202, v164, v165
    v_cvt_pk_bf16_f32 v203, v166, v167
    v_mfma_f32_16x16x32_bf16 v[188:191], a[208:211], v[56:59], v[188:191]
    s_waitcnt lgkmcnt(4)
    ds_read_b64_tr_b16 a[232:233], v249 offset:8448
    s_sub_u32 s68, s96, s68
    v_mfma_f32_16x16x32_bf16 v[188:191], a[212:215], v[68:71], v[188:191]
    s_and_b32 s70, s87, 1
    ds_read_b64_tr_b16 a[234:235], v249 offset:8704
    s_mul_i32 s70, s70, s89
    v_mfma_f32_16x16x32_bf16 v[188:191], a[216:219], v[80:83], v[188:191]
    buffer_store_dwordx4 v[200:203], v251, s[28:31], s65 offen offset:2048 sc1
    v_mfma_f32_16x16x32_bf16 v[188:191], a[220:223], v[92:95], v[188:191]
    s_add_u32 s92, s88, s70
    ds_read_b64_tr_b16 a[236:237], v249 offset:8960
    v_mul_f32 v144, v144, v228
    v_mfma_f32_16x16x32_bf16 v[172:175], a[220:223], v[88:91], v[172:175]
    s_waitcnt vmcnt(3)
    ds_read_b64_tr_b16 a[238:239], v249 offset:9216
    v_mul_f32 v145, v145, v228
    v_mov_b32 v231, 32768
    v_mfma_f32_16x16x32_bf16 v[172:175], a[216:219], v[76:79], v[172:175]
    s_lshl_b32 s70, s87, 18
    v_mul_f32 v146, v146, v228
    v_mul_f32 v147, v147, v228
    v_mfma_f32_16x16x32_bf16 v[172:175], a[212:215], v[64:67], v[172:175]
    s_add_u32 s92, s92, s70
    ds_read_b64_tr_b16 a[240:241], v249 offset:32
    v_mul_f32 v148, v148, v228
    v_mfma_f32_16x16x32_bf16 v[172:175], a[208:211], v[52:55], v[172:175]
    s_lshr_b32 s70, s68, 1
    ds_read_b64_tr_b16 a[242:243], v249 offset:288
    v_mul_f32 v149, v149, v228
    v_mfma_f32_16x16x32_bf16 v[156:159], a[208:211], v[48:51], v[156:159]
    s_lshl_b32 s70, s70, 10
    v_mul_f32 v150, v150, v228
    v_mul_f32 v151, v151, v228
    v_mfma_f32_16x16x32_bf16 v[156:159], a[212:215], v[60:63], v[156:159]
    s_add_u32 s92, s92, s70
    ds_read_b64_tr_b16 a[244:245], v249 offset:544
    v_cvt_pk_bf16_f32 v192, v144, v145
    v_mfma_f32_16x16x32_bf16 v[156:159], a[216:219], v[72:75], v[156:159]
    s_waitcnt lgkmcnt(9)
    ds_read_b64_tr_b16 a[246:247], v249 offset:800
    v_cvt_pk_bf16_f32 v193, v146, v147
    v_mfma_f32_16x16x32_bf16 v[156:159], a[220:223], v[84:87], v[156:159]
    s_and_b32 s46, s68, 1
    v_cvt_pk_bf16_f32 v194, v148, v149
    v_cvt_pk_bf16_f32 v195, v150, v151
    v_mfma_f32_16x16x32_bf16 v[96:99], a[224:227], v[0:3], 0
    s_waitcnt lgkmcnt(4)
    ds_read_b64_tr_b16 a[248:249], v249 offset:8480
    buffer_atomic_add v231, v252, s[28:31], s97 offen sc1
    v_mfma_f32_16x16x32_bf16 v[96:99], a[228:231], v[12:15], v[96:99]
    s_lshl_b32 s70, s46, 7
    ds_read_b64_tr_b16 a[250:251], v249 offset:8736
    s_add_u32 s92, s92, s70
    v_mfma_f32_16x16x32_bf16 v[96:99], a[232:235], v[24:27], v[96:99]
    buffer_store_dwordx4 v[192:195], v251, s[28:31], s65 offen offset:0 sc1
    v_mfma_f32_16x16x32_bf16 v[96:99], a[236:239], v[36:39], v[96:99]
    s_lshl_b32 s87, s87, 2
    ds_read_b64_tr_b16 a[252:253], v249 offset:8992
    v_mul_f32 v184, v184, v230
    v_mfma_f32_16x16x32_bf16 v[112:115], a[236:239], v[40:43], 0
    s_lshr_b32 s70, 88289808, s87
    ds_read_b64_tr_b16 a[254:255], v249 offset:9248
    v_mul_f32 v185, v185, v230
    v_mfma_f32_16x16x32_bf16 v[112:115], a[232:235], v[28:31], v[112:115]
    s_and_b32 s70, s70, 15
    v_mul_f32 v186, v186, v230
    v_mul_f32 v187, v187, v230
    v_mfma_f32_16x16x32_bf16 v[112:115], a[228:231], v[16:19], v[112:115]
    s_mul_i32 s70, s70, 5
    ds_read_b64_tr_b16 a[208:209], v249 offset:64
    v_mul_f32 v188, v188, v230
    v_mfma_f32_16x16x32_bf16 v[112:115], a[224:227], v[4:7], v[112:115]
    s_lshl_b32 s93, 16, s70
    ds_read_b64_tr_b16 a[210:211], v249 offset:320
    v_mul_f32 v189, v189, v230
    v_mfma_f32_16x16x32_bf16 v[128:131], a[224:227], v[8:11], 0
    s_andn2_b32 s70, s93, s71
    v_mul_f32 v190, v190, v230
    v_mul_f32 v191, v191, v230
    v_mfma_f32_16x16x32_bf16 v[128:131], a[228:231], v[20:23], v[128:131]
    s_min_u32 s70, s70, 1
    ds_read_b64_tr_b16 a[212:213], v249 offset:576
    v_cvt_pk_bf16_f32 v212, v184, v185
    v_mfma_f32_16x16x32_bf16 v[128:131], a[232:235], v[32:35], v[128:131]
    s_waitcnt lgkmcnt(9)
    ds_read_b64_tr_b16 a[214:215], v249 offset:832
    v_cvt_pk_bf16_f32 v213, v186, v187
    v_mfma_f32_16x16x32_bf16 v[128:131], a[236:239], v[44:47], v[128:131]
    s_sub_u32 s100, 1, s70
    v_cvt_pk_bf16_f32 v214, v188, v189
    v_cvt_pk_bf16_f32 v215, v190, v191
    v_mfma_f32_16x16x32_bf16 v[132:135], a[240:243], v[8:11], 0
    s_waitcnt lgkmcnt(4)
    ds_read_b64_tr_b16 a[216:217], v249 offset:8512
    s_lshl_b32 s94, s70, 28
    v_mfma_f32_16x16x32_bf16 v[132:135], a[244:247], v[20:23], v[132:135]
    s_add_u32 s92, s92, s94
    ds_read_b64_tr_b16 a[218:219], v249 offset:8768
    s_mul_i32 s46, s46, 14336
    v_mfma_f32_16x16x32_bf16 v[132:135], a[248:251], v[32:35], v[132:135]
    buffer_store_dwordx4 v[212:215], v251, s[28:31], s66 offen offset:1024 sc1
    buffer_load_dwordx4 a[96:99], v236, s[28:31], s92 offen sc1
    v_mfma_f32_16x16x32_bf16 v[132:135], a[252:255], v[44:47], v[132:135]
    s_add_u32 s46, s46, s90
    ds_read_b64_tr_b16 a[220:221], v249 offset:9024
    v_mul_f32 v168, v168, v229
    v_mfma_f32_16x16x32_bf16 v[116:119], a[252:255], v[40:43], 0
    s_lshr_b32 s70, s91, s87
    ds_read_b64_tr_b16 a[222:223], v249 offset:9280
    v_mul_f32 v169, v169, v229
    v_mfma_f32_16x16x32_bf16 v[116:119], a[248:251], v[28:31], v[116:119]
    s_and_b32 s70, s70, 15
    v_mul_f32 v170, v170, v229
    v_mul_f32 v171, v171, v229
    v_mfma_f32_16x16x32_bf16 v[116:119], a[244:247], v[16:19], v[116:119]
    s_lshl_b32 s70, s70, 7
    ds_read_b64_tr_b16 a[224:225], v249 offset:96
    v_mul_f32 v172, v172, v229
    v_mfma_f32_16x16x32_bf16 v[116:119], a[240:243], v[4:7], v[116:119]
    s_add_u32 s46, s46, s70
    ds_read_b64_tr_b16 a[226:227], v249 offset:352
    v_mul_f32 v173, v173, v229
    v_mfma_f32_16x16x32_bf16 v[100:103], a[240:243], v[0:3], 0
    s_and_b32 s70, s68, 2
    v_mul_f32 v174, v174, v229
    v_mul_f32 v175, v175, v229
    v_mfma_f32_16x16x32_bf16 v[100:103], a[244:247], v[12:15], v[100:103]
    s_lshl_b32 s70, s70, 5
    ds_read_b64_tr_b16 a[228:229], v249 offset:608
    v_cvt_pk_bf16_f32 v204, v168, v169
    v_mfma_f32_16x16x32_bf16 v[100:103], a[248:251], v[24:27], v[100:103]
    s_waitcnt lgkmcnt(9)
    ds_read_b64_tr_b16 a[230:231], v249 offset:864
    v_cvt_pk_bf16_f32 v205, v170, v171
    v_mfma_f32_16x16x32_bf16 v[100:103], a[252:255], v[36:39], v[100:103]
    s_add_u32 s46, s46, s70
    v_cvt_pk_bf16_f32 v206, v172, v173
    v_cvt_pk_bf16_f32 v207, v174, v175
    v_mfma_f32_16x16x32_bf16 v[104:107], a[208:211], v[0:3], 0
    s_waitcnt lgkmcnt(4)
    ds_read_b64_tr_b16 a[232:233], v249 offset:8544
    s_lshr_b32 s70, s68, 2
    v_mfma_f32_16x16x32_bf16 v[104:107], a[212:215], v[12:15], v[104:107]
    s_mul_i32 s70, s70, 28672
    ds_read_b64_tr_b16 a[234:235], v249 offset:8800
    s_add_u32 s46, s46, s70
    s_add_u32 s92, s92, 34816
    v_mfma_f32_16x16x32_bf16 v[104:107], a[216:219], v[24:27], v[104:107]
    buffer_store_dwordx4 v[204:207], v251, s[28:31], s65 offen offset:3072 sc1
    v_mfma_f32_16x16x32_bf16 v[104:107], a[220:223], v[36:39], v[104:107]
    s_add_u32 s46, s46, s94
    ds_read_b64_tr_b16 a[236:237], v249 offset:9056
    v_mul_f32 v152, v152, v228
    v_mfma_f32_16x16x32_bf16 v[120:123], a[220:223], v[40:43], 0
    ds_read_b64_tr_b16 a[238:239], v249 offset:9312
    v_mul_f32 v153, v153, v228
    v_mfma_f32_16x16x32_bf16 v[120:123], a[216:219], v[28:31], v[120:123]
    buffer_load_dwordx4 a[100:103], v236, s[28:31], s92 offen sc1
    v_mul_f32 v154, v154, v228
    v_mul_f32 v155, v155, v228
    v_mfma_f32_16x16x32_bf16 v[120:123], a[212:215], v[16:19], v[120:123]
    s_add_u32 s92, s92, 30720
    ds_read_b64_tr_b16 a[240:241], v249 offset:33792
    v_mul_f32 v156, v156, v228
    v_mfma_f32_16x16x32_bf16 v[120:123], a[208:211], v[4:7], v[120:123]
    ds_read_b64_tr_b16 a[242:243], v249 offset:34048
    v_mul_f32 v157, v157, v228
    v_mfma_f32_16x16x32_bf16 v[136:139], a[208:211], v[8:11], 0
    v_mul_f32 v158, v158, v228
    v_mul_f32 v159, v159, v228
    v_mfma_f32_16x16x32_bf16 v[136:139], a[212:215], v[20:23], v[136:139]
    ds_read_b64_tr_b16 a[244:245], v249 offset:34304
    v_cvt_pk_bf16_f32 v196, v152, v153
    v_mfma_f32_16x16x32_bf16 v[136:139], a[216:219], v[32:35], v[136:139]
    s_waitcnt lgkmcnt(9)
    ds_read_b64_tr_b16 a[246:247], v249 offset:34560
    v_cvt_pk_bf16_f32 v197, v154, v155
    v_mfma_f32_16x16x32_bf16 v[136:139], a[220:223], v[44:47], v[136:139]
    v_cvt_pk_bf16_f32 v198, v156, v157
    v_cvt_pk_bf16_f32 v199, v158, v159
    v_mfma_f32_16x16x32_bf16 v[140:143], a[224:227], v[8:11], 0
    s_waitcnt lgkmcnt(4)
    ds_read_b64_tr_b16 a[248:249], v249 offset:42240
    v_mfma_f32_16x16x32_bf16 v[140:143], a[228:231], v[20:23], v[140:143]
    ds_read_b64_tr_b16 a[250:251], v249 offset:42496
    v_mfma_f32_16x16x32_bf16 v[140:143], a[232:235], v[32:35], v[140:143]
    buffer_store_dwordx4 v[196:199], v251, s[28:31], s65 offen offset:1024 sc1
    v_mfma_f32_16x16x32_bf16 v[140:143], a[236:239], v[44:47], v[140:143]
    ds_read_b64_tr_b16 a[252:253], v249 offset:42752
    v_mfma_f32_16x16x32_bf16 v[124:127], a[236:239], v[40:43], 0
    ds_read_b64_tr_b16 a[254:255], v249 offset:43008
    v_mfma_f32_16x16x32_bf16 v[124:127], a[232:235], v[28:31], v[124:127]
    buffer_load_dwordx4 a[104:107], v236, s[28:31], s92 offen sc1
    v_mfma_f32_16x16x32_bf16 v[124:127], a[228:231], v[16:19], v[124:127]
    s_add_u32 s92, s92, 34816
    ds_read_b64_tr_b16 a[208:209], v249 offset:33824
    v_mfma_f32_16x16x32_bf16 v[124:127], a[224:227], v[4:7], v[124:127]
    ds_read_b64_tr_b16 a[210:211], v249 offset:34080
    v_mfma_f32_16x16x32_bf16 v[108:111], a[224:227], v[0:3], 0
    v_mfma_f32_16x16x32_bf16 v[108:111], a[228:231], v[12:15], v[108:111]
    ds_read_b64_tr_b16 a[212:213], v249 offset:34336
    v_mfma_f32_16x16x32_bf16 v[108:111], a[232:235], v[24:27], v[108:111]
    s_waitcnt lgkmcnt(9)
    ds_read_b64_tr_b16 a[214:215], v249 offset:34592
    v_mfma_f32_16x16x32_bf16 v[108:111], a[236:239], v[36:39], v[108:111]
    v_mfma_f32_16x16x32_bf16 v[96:99], a[240:243], v[48:51], v[96:99]
    s_waitcnt lgkmcnt(4)
    ds_read_b64_tr_b16 a[216:217], v249 offset:42272
    v_mfma_f32_16x16x32_bf16 v[96:99], a[244:247], v[60:63], v[96:99]
    ds_read_b64_tr_b16 a[218:219], v249 offset:42528
    v_mfma_f32_16x16x32_bf16 v[96:99], a[248:251], v[72:75], v[96:99]
    v_mfma_f32_16x16x32_bf16 v[96:99], a[252:255], v[84:87], v[96:99]
    ds_read_b64_tr_b16 a[220:221], v249 offset:42784
    v_mfma_f32_16x16x32_bf16 v[112:115], a[252:255], v[88:91], v[112:115]
    ds_read_b64_tr_b16 a[222:223], v249 offset:43040
    v_mfma_f32_16x16x32_bf16 v[112:115], a[248:251], v[76:79], v[112:115]
    buffer_load_dwordx4 a[108:111], v236, s[28:31], s92 offen sc1
    v_mfma_f32_16x16x32_bf16 v[112:115], a[244:247], v[64:67], v[112:115]
    s_add_u32 s92, s92, 30720
    ds_read_b64_tr_b16 a[224:225], v249 offset:33856
    v_mfma_f32_16x16x32_bf16 v[112:115], a[240:243], v[52:55], v[112:115]
    ds_read_b64_tr_b16 a[226:227], v249 offset:34112
    v_mfma_f32_16x16x32_bf16 v[128:131], a[240:243], v[56:59], v[128:131]
    v_mfma_f32_16x16x32_bf16 v[128:131], a[244:247], v[68:71], v[128:131]
    ds_read_b64_tr_b16 a[228:229], v249 offset:34368
    v_mfma_f32_16x16x32_bf16 v[128:131], a[248:251], v[80:83], v[128:131]
    s_waitcnt lgkmcnt(9)
    ds_read_b64_tr_b16 a[230:231], v249 offset:34624
    v_mfma_f32_16x16x32_bf16 v[128:131], a[252:255], v[92:95], v[128:131]
    v_mfma_f32_16x16x32_bf16 v[132:135], a[208:211], v[56:59], v[132:135]
    s_waitcnt lgkmcnt(4)
    ds_read_b64_tr_b16 a[232:233], v249 offset:42304
    v_mfma_f32_16x16x32_bf16 v[132:135], a[212:215], v[68:71], v[132:135]
    ds_read_b64_tr_b16 a[234:235], v249 offset:42560
    v_mfma_f32_16x16x32_bf16 v[132:135], a[216:219], v[80:83], v[132:135]
    v_mfma_f32_16x16x32_bf16 v[132:135], a[220:223], v[92:95], v[132:135]
    s_add_u32 s65, s63, 1572864
    ds_read_b64_tr_b16 a[236:237], v249 offset:42816
    s_add_u32 s66, s63, 1576960
    v_mfma_f32_16x16x32_bf16 v[116:119], a[220:223], v[88:91], v[116:119]
    ds_read_b64_tr_b16 a[238:239], v249 offset:43072
    v_mul_f32 v128, v128, v230
    v_mfma_f32_16x16x32_bf16 v[116:119], a[216:219], v[76:79], v[116:119]
    buffer_load_dwordx4 a[112:115], v236, s[28:31], s92 offen sc1
    v_mul_f32 v129, v129, v230
    v_mul_f32 v130, v130, v230
    v_mfma_f32_16x16x32_bf16 v[116:119], a[212:215], v[64:67], v[116:119]
    s_add_u32 s92, s92, 34816
    ds_read_b64_tr_b16 a[240:241], v249 offset:33888
    v_mul_f32 v131, v131, v230
    v_mfma_f32_16x16x32_bf16 v[116:119], a[208:211], v[52:55], v[116:119]
    ds_read_b64_tr_b16 a[242:243], v249 offset:34144
    v_mul_f32 v132, v132, v230
    v_mfma_f32_16x16x32_bf16 v[100:103], a[208:211], v[48:51], v[100:103]
    v_mul_f32 v133, v133, v230
    v_mul_f32 v134, v134, v230
    v_mfma_f32_16x16x32_bf16 v[100:103], a[212:215], v[60:63], v[100:103]
    ds_read_b64_tr_b16 a[244:245], v249 offset:34400
    v_mul_f32 v135, v135, v230
    v_mfma_f32_16x16x32_bf16 v[100:103], a[216:219], v[72:75], v[100:103]
    s_waitcnt lgkmcnt(9)
    ds_read_b64_tr_b16 a[246:247], v249 offset:34656
    v_cvt_pk_bf16_f32 v208, v128, v129
    v_mfma_f32_16x16x32_bf16 v[100:103], a[220:223], v[84:87], v[100:103]
    v_cvt_pk_bf16_f32 v209, v130, v131
    v_cvt_pk_bf16_f32 v210, v132, v133
    v_mfma_f32_16x16x32_bf16 v[104:107], a[224:227], v[48:51], v[104:107]
    s_waitcnt lgkmcnt(4)
    ds_read_b64_tr_b16 a[248:249], v249 offset:42336
    v_cvt_pk_bf16_f32 v211, v134, v135
    v_mfma_f32_16x16x32_bf16 v[104:107], a[228:231], v[60:63], v[104:107]
    ds_read_b64_tr_b16 a[250:251], v249 offset:42592
    v_mfma_f32_16x16x32_bf16 v[104:107], a[232:235], v[72:75], v[104:107]
    buffer_store_dwordx4 v[208:211], v251, s[28:31], s66 offen offset:0 sc1
    v_mfma_f32_16x16x32_bf16 v[104:107], a[236:239], v[84:87], v[104:107]
    ds_read_b64_tr_b16 a[252:253], v249 offset:42848
    v_mul_f32 v112, v112, v229
    v_mfma_f32_16x16x32_bf16 v[120:123], a[236:239], v[88:91], v[120:123]
    ds_read_b64_tr_b16 a[254:255], v249 offset:43104
    v_mul_f32 v113, v113, v229
    v_mfma_f32_16x16x32_bf16 v[120:123], a[232:235], v[76:79], v[120:123]
    buffer_load_dwordx4 a[116:119], v236, s[28:31], s92 offen sc1
    v_mul_f32 v114, v114, v229
    v_mul_f32 v115, v115, v229
    v_mfma_f32_16x16x32_bf16 v[120:123], a[228:231], v[64:67], v[120:123]
    s_add_u32 s92, s92, 30720
    v_mul_f32 v116, v116, v229
    v_mul_f32 v117, v117, v229
    v_mfma_f32_16x16x32_bf16 v[120:123], a[224:227], v[52:55], v[120:123]
L_pad13:
    s_cbranch_execz L_main
    v_mul_f32 v118, v118, v229
    v_mul_f32 v119, v119, v229
    v_mfma_f32_16x16x32_bf16 v[136:139], a[224:227], v[56:59], v[136:139]
    v_cvt_pk_bf16_f32 v200, v112, v113
    v_cvt_pk_bf16_f32 v201, v114, v115
    v_mfma_f32_16x16x32_bf16 v[136:139], a[228:231], v[68:71], v[136:139]
    v_cvt_pk_bf16_f32 v202, v116, v117
    v_cvt_pk_bf16_f32 v203, v118, v119
    v_mfma_f32_16x16x32_bf16 v[136:139], a[232:235], v[80:83], v[136:139]
    buffer_store_dwordx4 v[200:203], v251, s[28:31], s65 offen offset:2048 sc1
    v_mfma_f32_16x16x32_bf16 v[136:139], a[236:239], v[92:95], v[136:139]
    s_waitcnt lgkmcnt(6)
    v_mul_f32 v96, v96, v228
    v_mul_f32 v97, v97, v228
    v_mfma_f32_16x16x32_bf16 v[140:143], a[240:243], v[56:59], v[140:143]
    s_waitcnt lgkmcnt(0)
    v_mul_f32 v98, v98, v228
    v_mul_f32 v99, v99, v228
    v_mfma_f32_16x16x32_bf16 v[140:143], a[244:247], v[68:71], v[140:143]
    v_mul_f32 v100, v100, v228
    v_mul_f32 v101, v101, v228
    v_mfma_f32_16x16x32_bf16 v[140:143], a[248:251], v[80:83], v[140:143]
    v_mul_f32 v102, v102, v228
    v_mul_f32 v103, v103, v228
    v_mfma_f32_16x16x32_bf16 v[140:143], a[252:255], v[92:95], v[140:143]
    v_cvt_pk_bf16_f32 v192, v96, v97
    v_cvt_pk_bf16_f32 v193, v98, v99
    v_mfma_f32_16x16x32_bf16 v[124:127], a[252:255], v[88:91], v[124:127]
    v_cvt_pk_bf16_f32 v194, v100, v101
    v_cvt_pk_bf16_f32 v195, v102, v103
    v_mfma_f32_16x16x32_bf16 v[124:127], a[248:251], v[76:79], v[124:127]
    buffer_store_dwordx4 v[192:195], v251, s[28:31], s65 offen offset:0 sc1
    v_mfma_f32_16x16x32_bf16 v[124:127], a[244:247], v[64:67], v[124:127]
    buffer_load_dwordx4 a[120:123], v236, s[28:31], s92 offen sc1
    v_mfma_f32_16x16x32_bf16 v[124:127], a[240:243], v[52:55], v[124:127]
    s_add_u32 s92, s92, 34816
    v_mfma_f32_16x16x32_bf16 v[108:111], a[240:243], v[48:51], v[108:111]
    v_mfma_f32_16x16x32_bf16 v[108:111], a[244:247], v[60:63], v[108:111]
    v_mfma_f32_16x16x32_bf16 v[108:111], a[248:251], v[72:75], v[108:111]
    v_mfma_f32_16x16x32_bf16 v[108:111], a[252:255], v[84:87], v[108:111]
    s_nop 7
    v_mul_f32 v136, v136, v230
    v_mul_f32 v137, v137, v230
    v_mul_f32 v138, v138, v230
    v_mul_f32 v139, v139, v230
    v_mul_f32 v140, v140, v230
    v_mul_f32 v141, v141, v230
    v_mul_f32 v142, v142, v230
    v_mul_f32 v143, v143, v230
    v_cvt_pk_bf16_f32 v212, v136, v137
    v_cvt_pk_bf16_f32 v213, v138, v139
    v_cvt_pk_bf16_f32 v214, v140, v141
    v_cvt_pk_bf16_f32 v215, v142, v143
    buffer_store_dwordx4 v[212:215], v251, s[28:31], s66 offen offset:1024 sc1
    v_mul_f32 v120, v120, v229
    v_mul_f32 v121, v121, v229
    v_mul_f32 v122, v122, v229
    v_mul_f32 v123, v123, v229
    v_mul_f32 v124, v124, v229
    v_mul_f32 v125, v125, v229
    v_mul_f32 v126, v126, v229
    v_mul_f32 v127, v127, v229
    v_cvt_pk_bf16_f32 v204, v120, v121
    v_cvt_pk_bf16_f32 v205, v122, v123
    v_cvt_pk_bf16_f32 v206, v124, v125
    v_cvt_pk_bf16_f32 v207, v126, v127
    buffer_store_dwordx4 v[204:207], v251, s[28:31], s65 offen offset:3072 sc1
    v_mul_f32 v104, v104, v228
    v_mul_f32 v105, v105, v228
    v_mul_f32 v106, v106, v228
    v_mul_f32 v107, v107, v228
    v_mul_f32 v108, v108, v228
    v_mul_f32 v109, v109, v228
    v_mul_f32 v110, v110, v228
    v_mul_f32 v111, v111, v228
    v_cvt_pk_bf16_f32 v196, v104, v105
    v_cvt_pk_bf16_f32 v197, v106, v107
    v_cvt_pk_bf16_f32 v198, v108, v109
    v_cvt_pk_bf16_f32 v199, v110, v111
    buffer_store_dwordx4 v[196:199], v251, s[28:31], s65 offen offset:1024 sc1
    s_waitcnt lgkmcnt(0)
    buffer_load_dwordx4 a[124:127], v236, s[28:31], s92 offen sc1
    s_waitcnt vmcnt(12)
    v_mov_b32 v231, 1048576
    buffer_atomic_add v231, v252, s[28:31], s97 offen sc1
    v_mul_u32_u24 v235, s100, v234
    s_mov_b32 s68, 33554432
    v_writelane_b32 v235, s68, 0
    s_waitcnt vmcnt(2)
    buffer_atomic_add v235, v233, s[28:31], s97 offen sc0 sc1
    s_mov_b32 s86, 0
    s_waitcnt vmcnt(1)
    v_mfma_f32_16x16x32_bf16 v[16:19], a[204:207], a[64:67], 0
    v_mfma_f32_16x16x32_bf16 v[16:19], a[204:207], a[68:71], v[16:19]
    v_mfma_f32_16x16x32_bf16 v[16:19], a[204:207], a[72:75], v[16:19]
    v_mfma_f32_16x16x32_bf16 v[16:19], a[204:207], a[76:79], v[16:19]
    v_mfma_f32_16x16x32_bf16 v[16:19], a[204:207], a[80:83], v[16:19]
    v_mfma_f32_16x16x32_bf16 v[16:19], a[204:207], a[84:87], v[16:19]
    v_mfma_f32_16x16x32_bf16 v[16:19], a[204:207], a[88:91], v[16:19]
    v_mfma_f32_16x16x32_bf16 v[16:19], a[204:207], a[92:95], v[16:19]
    s_nop 7
    v_cvt_pk_bf16_f32 v20, v16, v17
    v_cvt_pk_bf16_f32 v21, v18, v19
    buffer_store_dwordx2 v[20:21], v254, s[76:79], s45 offen
    v_mfma_f32_16x16x32_bf16 v[24:27], a[204:207], a[96:99], 0
    v_mfma_f32_16x16x32_bf16 v[24:27], a[204:207], a[100:103], v[24:27]
    v_mfma_f32_16x16x32_bf16 v[24:27], a[204:207], a[104:107], v[24:27]
    v_mfma_f32_16x16x32_bf16 v[24:27], a[204:207], a[108:111], v[24:27]
    v_mfma_f32_16x16x32_bf16 v[24:27], a[204:207], a[112:115], v[24:27]
    v_mfma_f32_16x16x32_bf16 v[24:27], a[204:207], a[116:119], v[24:27]
    v_mfma_f32_16x16x32_bf16 v[24:27], a[204:207], a[120:123], v[24:27]
    v_mfma_f32_16x16x32_bf16 v[24:27], a[204:207], a[124:127], v[24:27]
    s_nop 7
    v_cvt_pk_bf16_f32 v28, v24, v25
    v_cvt_pk_bf16_f32 v29, v26, v27
    buffer_store_dwordx2 v[28:29], v254, s[76:79], s46 offen
    s_waitcnt vmcnt(2)
    v_readlane_b32 s71, v235, 0
    v_readlane_b32 s94, v235, 1
    s_nop 0
    s_add_u32 s71, s71, 33554432
    s_sub_u32 s94, s94, s96
    s_mul_i32 s94, s94, s100
    s_add_u32 s96, s96, s94
    s_mov_b32 s100, 0
L_take0:
    s_cmp_ge_u32 s96, 84
    s_cbranch_scc1 L_last1
    s_mul_i32 s87, s96, 171
    s_lshr_b32 s87, s87, 11
    s_mul_i32 s68, s87, 12
    s_sub_u32 s68, s96, s68
    s_and_b32 s70, s87, 1
    s_mul_i32 s70, s70, s89
    s_add_u32 s92, s88, s70
    s_lshl_b32 s70, s87, 18
    s_add_u32 s92, s92, s70
    s_lshr_b32 s70, s68, 1
    s_lshl_b32 s70, s70, 10
    s_add_u32 s92, s92, s70
    s_and_b32 s43, s68, 1
    s_lshl_b32 s70, s43, 7
    s_add_u32 s92, s92, s70
    s_lshl_b32 s87, s87, 2
    s_lshr_b32 s70, 88289808, s87
    s_and_b32 s70, s70, 15
    s_mul_i32 s70, s70, 5
    s_lshl_b32 s93, 16, s70
    s_andn2_b32 s70, s93, s71
    s_cbranch_scc0 L_go0
    s_cmp_eq_u32 s100, 0
    s_cbranch_scc1 L_poll0
    s_waitcnt vmcnt(7)
    v_mfma_f32_16x16x32_bf16 v[8:11], a[204:207], a[32:35], 0
    s_waitcnt vmcnt(6)
    v_mfma_f32_16x16x32_bf16 v[8:11], a[204:207], a[36:39], v[8:11]
    s_waitcnt vmcnt(5)
    v_mfma_f32_16x16x32_bf16 v[8:11], a[204:207], a[40:43], v[8:11]
    s_waitcnt vmcnt(4)
    v_mfma_f32_16x16x32_bf16 v[8:11], a[204:207], a[44:47], v[8:11]
    s_waitcnt vmcnt(3)
    v_mfma_f32_16x16x32_bf16 v[8:11], a[204:207], a[48:51], v[8:11]
    s_waitcnt vmcnt(2)
    v_mfma_f32_16x16x32_bf16 v[8:11], a[204:207], a[52:55], v[8:11]
    s_waitcnt vmcnt(1)
    v_mfma_f32_16x16x32_bf16 v[8:11], a[204:207], a[56:59], v[8:11]
    s_waitcnt vmcnt(0)
    v_mfma_f32_16x16x32_bf16 v[8:11], a[204:207], a[60:63], v[8:11]
    s_nop 7
    v_cvt_pk_bf16_f32 v12, v8, v9
    v_cvt_pk_bf16_f32 v13, v10, v11
    buffer_store_dwordx2 v[12:13], v254, s[76:79], s44 offen
    s_mov_b32 s100, 0
L_poll0:
    v_mov_b32 v232, 0
    buffer_atomic_add v232, v252, s[28:31], s97 offen sc0 sc1
    s_waitcnt vmcnt(0)
    v_readfirstlane_b32 s71, v232
    s_add_u32 s86, s86, 1
    s_cmp_ge_u32 s86, 40000
    s_cselect_b32 s71, -1, s71
    s_andn2_b32 s70, s93, s71
    s_cbranch_scc1 L_poll0
L_go0:
    v_mov_b32 v235, v234
    buffer_atomic_add v235, v233, s[28:31], s97 offen sc0 sc1
    buffer_load_dwordx4 a[0:3], v236, s[28:31], s92 offen sc1
    s_add_u32 s92, s92, 34816
    buffer_load_dwordx4 a[4:7], v236, s[28:31], s92 offen sc1
    s_add_u32 s92, s92, 30720
    buffer_load_dwordx4 a[8:11], v236, s[28:31], s92 offen sc1
    s_add_u32 s92, s92, 34816
    buffer_load_dwordx4 a[12:15], v236, s[28:31], s92 offen sc1
    s_add_u32 s92, s92, 30720
    buffer_load_dwordx4 a[16:19], v236, s[28:31], s92 offen sc1
    s_add_u32 s92, s92, 34816
    buffer_load_dwordx4 a[20:23], v236, s[28:31], s92 offen sc1
    s_add_u32 s92, s92, 30720
    buffer_load_dwordx4 a[24:27], v236, s[28:31], s92 offen sc1
    s_add_u32 s92, s92, 34816
    buffer_load_dwordx4 a[28:31], v236, s[28:31], s92 offen sc1
    s_mul_i32 s43, s43, 14336
    s_add_u32 s43, s43, s90
    s_lshr_b32 s70, s91, s87
    s_and_b32 s70, s70, 15
    s_lshl_b32 s70, s70, 7
    s_add_u32 s43, s43, s70
    s_and_b32 s70, s68, 2
    s_lshl_b32 s70, s70, 5
    s_add_u32 s43, s43, s70
    s_lshr_b32 s70, s68, 2
    s_mul_i32 s70, s70, 28672
    s_add_u32 s43, s43, s70
    s_cmp_eq_u32 s100, 0
    s_mov_b32 s100, 1
    s_cbranch_scc1 L_got0
    s_waitcnt vmcnt(9)
    v_mfma_f32_16x16x32_bf16 v[8:11], a[204:207], a[32:35], 0
    v_mfma_f32_16x16x32_bf16 v[8:11], a[204:207], a[36:39], v[8:11]
    v_mfma_f32_16x16x32_bf16 v[8:11], a[204:207], a[40:43], v[8:11]
    v_mfma_f32_16x16x32_bf16 v[8:11], a[204:207], a[44:47], v[8:11]
    v_mfma_f32_16x16x32_bf16 v[8:11], a[204:207], a[48:51], v[8:11]
    v_mfma_f32_16x16x32_bf16 v[8:11], a[204:207], a[52:55], v[8:11]
    v_mfma_f32_16x16x32_bf16 v[8:11], a[204:207], a[56:59], v[8:11]
    v_mfma_f32_16x16x32_bf16 v[8:11], a[204:207], a[60:63], v[8:11]
    s_nop 7
    v_cvt_pk_bf16_f32 v12, v8, v9
    v_cvt_pk_bf16_f32 v13, v10, v11
    buffer_store_dwordx2 v[12:13], v254, s[76:79], s44 offen
    s_waitcnt vmcnt(9)
    s_branch L_rd0
L_got0:
    s_waitcnt vmcnt(8)
L_rd0:
    v_readlane_b32 s71, v235, 0
    v_readlane_b32 s96, v235, 1
    s_nop 1
L_take1:
    s_cmp_ge_u32 s96, 84
    s_cbranch_scc1 L_last0
    s_mul_i32 s87, s96, 171
    s_lshr_b32 s87, s87, 11
    s_mul_i32 s68, s87, 12
    s_sub_u32 s68, s96, s68
    s_and_b32 s70, s87, 1
    s_mul_i32 s70, s70, s89
    s_add_u32 s92, s88, s70
    s_lshl_b32 s70, s87, 18
    s_add_u32 s92, s92, s70
    s_lshr_b32 s70, s68, 1
    s_lshl_b32 s70, s70, 10
    s_add_u32 s92, s92, s70
    s_and_b32 s44, s68, 1
    s_lshl_b32 s70, s44, 7
    s_add_u32 s92, s92, s70
    s_lshl_b32 s87, s87, 2
    s_lshr_b32 s70, 88289808, s87
    s_and_b32 s70, s70, 15
    s_mul_i32 s70, s70, 5
    s_lshl_b32 s93, 16, s70
    s_andn2_b32 s70, s93, s71
    s_cbranch_scc0 L_go1
    s_cmp_eq_u32 s100, 0
    s_cbranch_scc1 L_poll1
    s_waitcnt vmcnt(7)
    v_mfma_f32_16x16x32_bf16 v[0:3], a[204:207], a[0:3], 0
    s_waitcnt vmcnt(6)
    v_mfma_f32_16x16x32_bf16 v[0:3], a[204:207], a[4:7], v[0:3]
    s_waitcnt vmcnt(5)
    v_mfma_f32_16x16x32_bf16 v[0:3], a[204:207], a[8:11], v[0:3]
    s_waitcnt vmcnt(4)
    v_mfma_f32_16x16x32_bf16 v[0:3], a[204:207], a[12:15], v[0:3]
    s_waitcnt vmcnt(3)
    v_mfma_f32_16x16x32_bf16 v[0:3], a[204:207], a[16:19], v[0:3]
    s_waitcnt vmcnt(2)
    v_mfma_f32_16x16x32_bf16 v[0:3], a[204:207], a[20:23], v[0:3]
    s_waitcnt vmcnt(1)
    v_mfma_f32_16x16x32_bf16 v[0:3], a[204:207], a[24:27], v[0:3]
    s_waitcnt vmcnt(0)
    v_mfma_f32_16x16x32_bf16 v[0:3], a[204:207], a[28:31], v[0:3]
    s_nop 7
    v_cvt_pk_bf16_f32 v4, v0, v1
    v_cvt_pk_bf16_f32 v5, v2, v3
    buffer_store_dwordx2 v[4:5], v254, s[76:79], s43 offen
    s_mov_b32 s100, 0
L_poll1:
    v_mov_b32 v232, 0
    buffer_atomic_add v232, v252, s[28:31], s97 offen sc0 sc1
    s_waitcnt vmcnt(0)
    v_readfirstlane_b32 s71, v232
    s_add_u32 s86, s86, 1
    s_cmp_ge_u32 s86, 40000
    s_cselect_b32 s71, -1, s71
    s_andn2_b32 s70, s93, s71
    s_cbranch_scc1 L_poll1
L_go1:
    v_mov_b32 v235, v234
    buffer_atomic_add v235, v233, s[28:31], s97 offen sc0 sc1
    buffer_load_dwordx4 a[32:35], v236, s[28:31], s92 offen sc1
    s_add_u32 s92, s92, 34816
    buffer_load_dwordx4 a[36:39], v236, s[28:31], s92 offen sc1
    s_add_u32 s92, s92, 30720
    buffer_load_dwordx4 a[40:43], v236, s[28:31], s92 offen sc1
    s_add_u32 s92, s92, 34816
    buffer_load_dwordx4 a[44:47], v236, s[28:31], s92 offen sc1
    s_add_u32 s92, s92, 30720
    buffer_load_dwordx4 a[48:51], v236, s[28:31], s92 offen sc1
    s_add_u32 s92, s92, 34816
    buffer_load_dwordx4 a[52:55], v236, s[28:31], s92 offen sc1
    s_add_u32 s92, s92, 30720
    buffer_load_dwordx4 a[56:59], v236, s[28:31], s92 offen sc1
    s_add_u32 s92, s92, 34816
    buffer_load_dwordx4 a[60:63], v236, s[28:31], s92 offen sc1
    s_mul_i32 s44, s44, 14336
    s_add_u32 s44, s44, s90
    s_lshr_b32 s70, s91, s87
    s_and_b32 s70, s70, 15
    s_lshl_b32 s70, s70, 7
    s_add_u32 s44, s44, s70
    s_and_b32 s70, s68, 2
    s_lshl_b32 s70, s70, 5
    s_add_u32 s44, s44, s70
    s_lshr_b32 s70, s68, 2
    s_mul_i32 s70, s70, 28672
    s_add_u32 s44, s44, s70
    s_cmp_eq_u32 s100, 0
    s_mov_b32 s100, 1
    s_cbranch_scc1 L_got1
    s_waitcnt vmcnt(9)
    v_mfma_f32_16x16x32_bf16 v[0:3], a[204:207], a[0:3], 0
    v_mfma_f32_16x16x32_bf16 v[0:3], a[204:207], a[4:7], v[0:3]
    v_mfma_f32_16x16x32_bf16 v[0:3], a[204:207], a[8:11], v[0:3]
    v_mfma_f32_16x16x32_bf16 v[0:3], a[204:207], a[12:15], v[0:3]
    v_mfma_f32_16x16x32_bf16 v[0:3], a[204:207], a[16:19], v[0:3]
    v_mfma_f32_16x16x32_bf16 v[0:3], a[204:207], a[20:23], v[0:3]
    v_mfma_f32_16x16x32_bf16 v[0:3], a[204:207], a[24:27], v[0:3]
    v_mfma_f32_16x16x32_bf16 v[0:3], a[204:207], a[28:31], v[0:3]
    s_nop 7
    v_cvt_pk_bf16_f32 v4, v0, v1
    v_cvt_pk_bf16_f32 v5, v2, v3
    buffer_store_dwordx2 v[4:5], v254, s[76:79], s43 offen
    s_waitcnt vmcnt(9)
    s_branch L_rd1
L_got1:
    s_waitcnt vmcnt(8)
L_rd1:
    v_readlane_b32 s71, v235, 0
    v_readlane_b32 s96, v235, 1
    s_nop 1
    s_branch L_take0
L_last0:
    s_cmp_eq_u32 s100, 0
    s_cbranch_scc1 L_done
    s_waitcnt vmcnt(7)
    v_mfma_f32_16x16x32_bf16 v[0:3], a[204:207], a[0:3], 0
    s_waitcnt vmcnt(6)
    v_mfma_f32_16x16x32_bf16 v[0:3], a[204:207], a[4:7], v[0:3]
    s_waitcnt vmcnt(5)
    v_mfma_f32_16x16x32_bf16 v[0:3], a[204:207], a[8:11], v[0:3]
    s_waitcnt vmcnt(4)
    v_mfma_f32_16x16x32_bf16 v[0:3], a[204:207], a[12:15], v[0:3]
    s_waitcnt vmcnt(3)
    v_mfma_f32_16x16x32_bf16 v[0:3], a[204:207], a[16:19], v[0:3]
    s_waitcnt vmcnt(2)
    v_mfma_f32_16x16x32_bf16 v[0:3], a[204:207], a[20:23], v[0:3]
    s_waitcnt vmcnt(1)
    v_mfma_f32_16x16x32_bf16 v[0:3], a[204:207], a[24:27], v[0:3]
    s_waitcnt vmcnt(0)
    v_mfma_f32_16x16x32_bf16 v[0:3], a[204:207], a[28:31], v[0:3]
    s_nop 7
    v_cvt_pk_bf16_f32 v4, v0, v1
    v_cvt_pk_bf16_f32 v5, v2, v3
    buffer_store_dwordx2 v[4:5], v254, s[76:79], s43 offen
    s_branch L_done
L_last1:
    s_cmp_eq_u32 s100, 0
    s_cbranch_scc1 L_done
    s_waitcnt vmcnt(7)
    v_mfma_f32_16x16x32_bf16 v[8:11], a[204:207], a[32:35], 0
    s_waitcnt vmcnt(6)
    v_mfma_f32_16x16x32_bf16 v[8:11], a[204:207], a[36:39], v[8:11]
    s_waitcnt vmcnt(5)
    v_mfma_f32_16x16x32_bf16 v[8:11], a[204:207], a[40:43], v[8:11]
    s_waitcnt vmcnt(4)
    v_mfma_f32_16x16x32_bf16 v[8:11], a[204:207], a[44:47], v[8:11]
    s_waitcnt vmcnt(3)
    v_mfma_f32_16x16x32_bf16 v[8:11], a[204:207], a[48:51], v[8:11]
    s_waitcnt vmcnt(2)
    v_mfma_f32_16x16x32_bf16 v[8:11], a[204:207], a[52:55], v[8:11]
    s_waitcnt vmcnt(1)
    v_mfma_f32_16x16x32_bf16 v[8:11], a[204:207], a[56:59], v[8:11]
    s_waitcnt vmcnt(0)
    v_mfma_f32_16x16x32_bf16 v[8:11], a[204:207], a[60:63], v[8:11]
    s_nop 7
    v_cvt_pk_bf16_f32 v12, v8, v9
    v_cvt_pk_bf16_f32 v13, v10, v11
    buffer_store_dwordx2 v[12:13], v254, s[76:79], s44 offen
L_done:
L_end:
    s_endpgm
L_dbgspin:
    s_mov_b32 s71, 0
L_dspin:
    buffer_load_dword v253, off, s[80:83], s6 sc1
    s_waitcnt vmcnt(0)
    v_cmp_gt_u32 vcc, 1, v253
    s_add_u32 s71, s71, 1
    s_cmp_ge_u32 s71, 40000
    s_cbranch_scc1 L_dbgback
    s_cbranch_vccnz L_dspin
    s_branch L_dbgback
L_stub0:
    s_nop 7
    v_max3_f32 v138, v228, v229, v230
    v_max3_f32 v138, v138, v231, v204
    v_max3_f32 v138, v138, v205, v206
    v_max_f32 v138, v138, v207
    v_max3_f32 v139, v232, v233, v234
    v_max3_f32 v139, v139, v235, v208
    v_max3_f32 v139, v139, v209, v210
    v_max_f32 v139, v139, v211
    v_max3_f32 v140, v236, v237, v238
    v_max3_f32 v140, v140, v239, v212
    v_max3_f32 v140, v140, v213, v214
    v_max_f32 v140, v140, v215
    v_mov_b32 v141, v138
    v_mov_b32 v142, v139
    v_mov_b32 v143, v140
    s_nop 1
    v_permlane32_swap_b32 v141, v138
    v_permlane32_swap_b32 v142, v139
    v_permlane32_swap_b32 v143, v140
    v_max_f32 v138, v138, v141
    v_max_f32 v139, v139, v142
    v_max_f32 v140, v140, v143
    v_mov_b32 v141, v138
    v_mov_b32 v142, v139
    v_mov_b32 v143, v140
    s_nop 1
    v_permlane16_swap_b32 v141, v138
    v_permlane16_swap_b32 v142, v139
    v_permlane16_swap_b32 v143, v140
    v_max_f32 v138, v138, v141
    v_max_f32 v139, v139, v142
    v_max_f32 v140, v140, v143
    v_sub_f32 v216, v216, v138
    v_sub_f32 v217, v217, v138
    v_sub_f32 v218, v218, v138
    v_sub_f32 v219, v219, v138
    v_sub_f32 v228, v228, v138
    v_sub_f32 v229, v229, v138
    v_sub_f32 v230, v230, v138
    v_sub_f32 v231, v231, v138
    v_sub_f32 v204, v204, v138
    v_sub_f32 v205, v205, v138
    v_sub_f32 v206, v206, v138
    v_sub_f32 v207, v207, v138
    v_sub_f32 v192, v192, v138
    v_sub_f32 v193, v193, v138
    v_sub_f32 v194, v194, v138
    v_sub_f32 v195, v195, v138
    v_sub_f32 v220, v220, v139
    v_sub_f32 v221, v221, v139
    v_sub_f32 v222, v222, v139
    v_sub_f32 v223, v223, v139
    v_sub_f32 v232, v232, v139
    v_sub_f32 v233, v233, v139
    v_sub_f32 v234, v234, v139
    v_sub_f32 v235, v235, v139
    v_sub_f32 v208, v208, v139
    v_sub_f32 v209, v209, v139
    v_sub_f32 v210, v210, v139
    v_sub_f32 v211, v211, v139
    v_sub_f32 v196, v196, v139
    v_sub_f32 v197, v197, v139
    v_sub_f32 v198, v198, v139
    v_sub_f32 v199, v199, v139
    v_sub_f32 v224, v224, v140
    v_sub_f32 v225, v225, v140
    v_sub_f32 v226, v226, v140
    v_sub_f32 v227, v227, v140
    v_sub_f32 v236, v236, v140
    v_sub_f32 v237, v237, v140
    v_sub_f32 v238, v238, v140
    v_sub_f32 v239, v239, v140
    v_sub_f32 v212, v212, v140
    v_sub_f32 v213, v213, v140
    v_sub_f32 v214, v214, v140
    v_sub_f32 v215, v215, v140
    v_sub_f32 v200, v200, v140
    v_sub_f32 v201, v201, v140
    v_sub_f32 v202, v202, v140
    v_sub_f32 v203, v203, v140
    v_exp_f32 v120, v228
    v_exp_f32 v121, v229
    v_exp_f32 v122, v230
    v_cvt_pk_bf16_f32 v96, v120, v121
    v_exp_f32 v123, v231
    v_exp_f32 v124, v232
    v_cvt_pk_bf16_f32 v97, v122, v123
    v_exp_f32 v125, v233
    v_exp_f32 v126, v234
    v_cvt_pk_bf16_f32 v100, v124, v125
    v_exp_f32 v127, v235
    v_exp_f32 v120, v236
    v_cvt_pk_bf16_f32 v101, v126, v127
    v_exp_f32 v121, v237
    v_exp_f32 v122, v238
    v_cvt_pk_bf16_f32 v104, v120, v121
    v_exp_f32 v123, v239
    s_nop 0
    v_cvt_pk_bf16_f32 v105, v122, v123
    v_exp_f32 v124, v204
    v_exp_f32 v125, v205
    v_exp_f32 v126, v206
    v_cvt_pk_bf16_f32 v98, v124, v125
    v_exp_f32 v127, v207
    v_exp_f32 v120, v208
    v_cvt_pk_bf16_f32 v99, v126, v127
    v_exp_f32 v121, v209
    v_exp_f32 v122, v210
    v_cvt_pk_bf16_f32 v102, v120, v121
    v_exp_f32 v123, v211
    v_exp_f32 v124, v212
    v_cvt_pk_bf16_f32 v103, v122, v123
    v_exp_f32 v125, v213
    v_exp_f32 v126, v214
    v_cvt_pk_bf16_f32 v106, v124, v125
    v_exp_f32 v127, v215
    s_nop 0
    v_cvt_pk_bf16_f32 v107, v126, v127
    s_nop 1
    v_mfma_f32_16x16x32_bf16 v[128:131], a[192:195], v[96:99], 0
    v_mfma_f32_16x16x32_bf16 v[128:131], a[196:199], v[100:103], v[128:131]
    v_mfma_f32_16x16x32_bf16 v[128:131], a[200:203], v[104:107], v[128:131]
    s_nop 7
    s_branch L_back0
L_stub1:
    s_call_b64 s[54:55], L_rare1
    s_branch L_back1
L_stub2:
    s_call_b64 s[54:55], L_rare0
    s_branch L_back2
L_stub3:
    s_call_b64 s[54:55], L_rare1
    s_branch L_back3
L_stub4:
    s_call_b64 s[54:55], L_rare0
    s_branch L_back4
L_stub5:
    s_call_b64 s[54:55], L_rare1
    s_branch L_back5
L_stub6:
    s_call_b64 s[54:55], L_rare0
    s_branch L_back6
L_stub7:
    s_call_b64 s[54:55], L_rare1
    s_branch L_back7
L_stub8:
    s_call_b64 s[54:55], L_rare0
    s_branch L_back8
L_stub9:
    s_call_b64 s[54:55], L_rare1
    s_branch L_back9
L_stub10:
    s_call_b64 s[54:55], L_rare0
    s_branch L_back10
L_stub11:
    s_call_b64 s[54:55], L_rare1
    s_branch L_back11
L_stub12:
    s_call_b64 s[54:55], L_rare0
    s_branch L_back12
L_stub13:
    s_call_b64 s[54:55], L_rare1
    s_branch L_back13
L_stub14:
    s_call_b64 s[54:55], L_rare0
    s_branch L_back14
L_stub15:
    s_call_b64 s[54:55], L_rare1
    s_branch L_back15
L_rare0:
    s_nop 7
    v_max3_f32 v228, v192, v193, v194
    v_max3_f32 v228, v228, v195, v204
    v_max3_f32 v228, v228, v205, v206
    v_max_f32 v228, v228, v207
    v_max3_f32 v229, v196, v197, v198
    v_max3_f32 v229, v229, v199, v208
    v_max3_f32 v229, v229, v209, v210
    v_max_f32 v229, v229, v211
    v_max3_f32 v230, v200, v201, v202
    v_max3_f32 v230, v230, v203, v212
    v_max3_f32 v230, v230, v213, v214
    v_max_f32 v230, v230, v215
    v_mov_b32 v234, v228
    v_mov_b32 v235, v229
    v_mov_b32 v236, v230
    s_nop 1
    v_permlane32_swap_b32 v234, v228
    v_permlane32_swap_b32 v235, v229
    v_permlane32_swap_b32 v236, v230
    v_max_f32 v228, v228, v234
    v_max_f32 v229, v229, v235
    v_max_f32 v230, v230, v236
    v_mov_b32 v234, v228
    v_mov_b32 v235, v229
    v_mov_b32 v236, v230
    s_nop 1
    v_permlane16_swap_b32 v234, v228
    v_permlane16_swap_b32 v235, v229
    v_permlane16_swap_b32 v236, v230
    v_max_f32 v228, v228, v234
    v_max_f32 v229, v229, v235
    v_max_f32 v230, v230, v236
    v_max_f32 v228, 0, v228
    v_max_f32 v229, 0, v229
    v_max_f32 v230, 0, v230
    v_exp_f32 v231, -v228
    v_exp_f32 v232, -v229
    v_exp_f32 v233, -v230
    v_sub_f32 v216, v216, v228
    v_sub_f32 v217, v217, v228
    v_sub_f32 v218, v218, v228
    v_sub_f32 v219, v219, v228
    v_sub_f32 v192, v192, v228
    v_sub_f32 v193, v193, v228
    v_sub_f32 v194, v194, v228
    v_sub_f32 v195, v195, v228
    v_sub_f32 v204, v204, v228
    v_sub_f32 v205, v205, v228
    v_sub_f32 v206, v206, v228
    v_sub_f32 v207, v207, v228
    v_mul_f32 v132, v132, v231
    v_sub_f32 v220, v220, v229
    v_sub_f32 v221, v221, v229
    v_sub_f32 v222, v222, v229
    v_sub_f32 v223, v223, v229
    v_sub_f32 v196, v196, v229
    v_sub_f32 v197, v197, v229
    v_sub_f32 v198, v198, v229
    v_sub_f32 v199, v199, v229
    v_sub_f32 v208, v208, v229
    v_sub_f32 v209, v209, v229
    v_sub_f32 v210, v210, v229
    v_sub_f32 v211, v211, v229
    v_mul_f32 v133, v133, v232
    v_sub_f32 v224, v224, v230
    v_sub_f32 v225, v225, v230
    v_sub_f32 v226, v226, v230
    v_sub_f32 v227, v227, v230
    v_sub_f32 v200, v200, v230
    v_sub_f32 v201, v201, v230
    v_sub_f32 v202, v202, v230
    v_sub_f32 v203, v203, v230
    v_sub_f32 v212, v212, v230
    v_sub_f32 v213, v213, v230
    v_sub_f32 v214, v214, v230
    v_sub_f32 v215, v215, v230
    v_mul_f32 v134, v134, v233
    v_exp_f32 v120, v192
    v_exp_f32 v121, v193
    v_exp_f32 v122, v194
    v_cvt_pk_bf16_f32 v96, v120, v121
    v_exp_f32 v123, v195
    v_exp_f32 v124, v196
    v_cvt_pk_bf16_f32 v97, v122, v123
    v_exp_f32 v125, v197
    v_exp_f32 v126, v198
    v_cvt_pk_bf16_f32 v100, v124, v125
    v_exp_f32 v127, v199
    v_exp_f32 v120, v200
    v_cvt_pk_bf16_f32 v101, v126, v127
    v_exp_f32 v121, v201
    v_exp_f32 v122, v202
    v_cvt_pk_bf16_f32 v104, v120, v121
    v_exp_f32 v123, v203
    s_nop 0
    v_cvt_pk_bf16_f32 v105, v122, v123
    v_exp_f32 v124, v204
    v_exp_f32 v125, v205
    v_exp_f32 v126, v206
    v_cvt_pk_bf16_f32 v98, v124, v125
    v_exp_f32 v127, v207
    v_exp_f32 v120, v208
    v_cvt_pk_bf16_f32 v99, v126, v127
    v_exp_f32 v121, v209
    v_exp_f32 v122, v210
    v_cvt_pk_bf16_f32 v102, v120, v121
    v_exp_f32 v123, v211
    v_exp_f32 v124, v212
    v_cvt_pk_bf16_f32 v103, v122, v123
    v_exp_f32 v125, v213
    v_exp_f32 v126, v214
    v_cvt_pk_bf16_f32 v106, v124, v125
    v_exp_f32 v127, v215
    s_nop 0
    v_cvt_pk_bf16_f32 v107, v126, v127
    v_mul_f32 v144, v144, v231
    v_mul_f32 v145, v145, v231
    v_mul_f32 v146, v146, v231
    v_mul_f32 v147, v147, v231
    v_mul_f32 v148, v148, v232
    v_mul_f32 v149, v149, v232
    v_mul_f32 v150, v150, v232
    v_mul_f32 v151, v151, v232
    v_mul_f32 v152, v152, v233
    v_mul_f32 v153, v153, v233
    v_mul_f32 v154, v154, v233
    v_mul_f32 v155, v155, v233
    v_mul_f32 v156, v156, v231
    v_mul_f32 v157, v157, v231
    v_mul_f32 v158, v158, v231
    v_mul_f32 v159, v159, v231
    v_mul_f32 v160, v160, v232
    v_mul_f32 v161, v161, v232
    v_mul_f32 v162, v162, v232
    v_mul_f32 v163, v163, v232
    v_mul_f32 v164, v164, v233
    v_mul_f32 v165, v165, v233
    v_mul_f32 v166, v166, v233
    v_mul_f32 v167, v167, v233
    v_mul_f32 v168, v168, v231
    v_mul_f32 v169, v169, v231
    v_mul_f32 v170, v170, v231
    v_mul_f32 v171, v171, v231
    v_mul_f32 v172, v172, v232
    v_mul_f32 v173, v173, v232
    v_mul_f32 v174, v174, v232
    v_mul_f32 v175, v175, v232
    v_mul_f32 v176, v176, v233
    v_mul_f32 v177, v177, v233
    v_mul_f32 v178, v178, v233
    v_mul_f32 v179, v179, v233
    v_mul_f32 v180, v180, v231
    v_mul_f32 v181, v181, v231
    v_mul_f32 v182, v182, v231
    v_mul_f32 v183, v183, v231
    v_mul_f32 v184, v184, v232
    v_mul_f32 v185, v185, v232
    v_mul_f32 v186, v186, v232
    v_mul_f32 v187, v187, v232
    v_mul_f32 v188, v188, v233
    v_mul_f32 v189, v189, v233
    v_mul_f32 v190, v190, v233
    v_mul_f32 v191, v191, v233
    v_accvgpr_read_b32 v234, a48
    v_accvgpr_read_b32 v235, a49
    v_accvgpr_read_b32 v236, a50
    v_accvgpr_read_b32 v237, a51
    v_mul_f32 v234, v234, v231
    v_mul_f32 v235, v235, v231
    v_mul_f32 v236, v236, v231
    v_mul_f32 v237, v237, v231
    v_accvgpr_write_b32 a48, v234
    v_accvgpr_write_b32 a49, v235
    v_accvgpr_write_b32 a50, v236
    v_accvgpr_write_b32 a51, v237
    v_accvgpr_read_b32 v234, a52
    v_accvgpr_read_b32 v235, a53
    v_accvgpr_read_b32 v236, a54
    v_accvgpr_read_b32 v237, a55
    v_mul_f32 v234, v234, v232
    v_mul_f32 v235, v235, v232
    v_mul_f32 v236, v236, v232
    v_mul_f32 v237, v237, v232
    v_accvgpr_write_b32 a52, v234
    v_accvgpr_write_b32 a53, v235
    v_accvgpr_write_b32 a54, v236
    v_accvgpr_write_b32 a55, v237
    v_accvgpr_read_b32 v234, a56
    v_accvgpr_read_b32 v235, a57
    v_accvgpr_read_b32 v236, a58
    v_accvgpr_read_b32 v237, a59
    v_mul_f32 v234, v234, v233
    v_mul_f32 v235, v235, v233
    v_mul_f32 v236, v236, v233
    v_mul_f32 v237, v237, v233
    v_accvgpr_write_b32 a56, v234
    v_accvgpr_write_b32 a57, v235
    v_accvgpr_write_b32 a58, v236
    v_accvgpr_write_b32 a59, v237
    v_accvgpr_read_b32 v234, a60
    v_accvgpr_read_b32 v235, a61
    v_accvgpr_read_b32 v236, a62
    v_accvgpr_read_b32 v237, a63
    v_mul_f32 v234, v234, v231
    v_mul_f32 v235, v235, v231
    v_mul_f32 v236, v236, v231
    v_mul_f32 v237, v237, v231
    v_accvgpr_write_b32 a60, v234
    v_accvgpr_write_b32 a61, v235
    v_accvgpr_write_b32 a62, v236
    v_accvgpr_write_b32 a63, v237
    v_accvgpr_read_b32 v234, a64
    v_accvgpr_read_b32 v235, a65
    v_accvgpr_read_b32 v236, a66
    v_accvgpr_read_b32 v237, a67
    v_mul_f32 v234, v234, v232
    v_mul_f32 v235, v235, v232
    v_mul_f32 v236, v236, v232
    v_mul_f32 v237, v237, v232
    v_accvgpr_write_b32 a64, v234
    v_accvgpr_write_b32 a65, v235
    v_accvgpr_write_b32 a66, v236
    v_accvgpr_write_b32 a67, v237
    v_accvgpr_read_b32 v234, a68
    v_accvgpr_read_b32 v235, a69
    v_accvgpr_read_b32 v236, a70
    v_accvgpr_read_b32 v237, a71
    v_mul_f32 v234, v234, v233
    v_mul_f32 v235, v235, v233
    v_mul_f32 v236, v236, v233
    v_mul_f32 v237, v237, v233
    v_accvgpr_write_b32 a68, v234
    v_accvgpr_write_b32 a69, v235
    v_accvgpr_write_b32 a70, v236
    v_accvgpr_write_b32 a71, v237
    v_accvgpr_read_b32 v234, a72
    v_accvgpr_read_b32 v235, a73
    v_accvgpr_read_b32 v236, a74
    v_accvgpr_read_b32 v237, a75
    v_mul_f32 v234, v234, v231
    v_mul_f32 v235, v235, v231
    v_mul_f32 v236, v236, v231
    v_mul_f32 v237, v237, v231
    v_accvgpr_write_b32 a72, v234
    v_accvgpr_write_b32 a73, v235
    v_accvgpr_write_b32 a74, v236
    v_accvgpr_write_b32 a75, v237
    v_accvgpr_read_b32 v234, a76
    v_accvgpr_read_b32 v235, a77
    v_accvgpr_read_b32 v236, a78
    v_accvgpr_read_b32 v237, a79
    v_mul_f32 v234, v234, v232
    v_mul_f32 v235, v235, v232
    v_mul_f32 v236, v236, v232
    v_mul_f32 v237, v237, v232
    v_accvgpr_write_b32 a76, v234
    v_accvgpr_write_b32 a77, v235
    v_accvgpr_write_b32 a78, v236
    v_accvgpr_write_b32 a79, v237
    v_accvgpr_read_b32 v234, a80
    v_accvgpr_read_b32 v235, a81
    v_accvgpr_read_b32 v236, a82
    v_accvgpr_read_b32 v237, a83
    v_mul_f32 v234, v234, v233
    v_mul_f32 v235, v235, v233
    v_mul_f32 v236, v236, v233
    v_mul_f32 v237, v237, v233
    v_accvgpr_write_b32 a80, v234
    v_accvgpr_write_b32 a81, v235
    v_accvgpr_write_b32 a82, v236
    v_accvgpr_write_b32 a83, v237
    v_accvgpr_read_b32 v234, a84
    v_accvgpr_read_b32 v235, a85
    v_accvgpr_read_b32 v236, a86
    v_accvgpr_read_b32 v237, a87
    v_mul_f32 v234, v234, v231
    v_mul_f32 v235, v235, v231
    v_mul_f32 v236, v236, v231
    v_mul_f32 v237, v237, v231
    v_accvgpr_write_b32 a84, v234
    v_accvgpr_write_b32 a85, v235
    v_accvgpr_write_b32 a86, v236
    v_accvgpr_write_b32 a87, v237
    v_accvgpr_read_b32 v234, a88
    v_accvgpr_read_b32 v235, a89
    v_accvgpr_read_b32 v236, a90
    v_accvgpr_read_b32 v237, a91
    v_mul_f32 v234, v234, v232
    v_mul_f32 v235, v235, v232
    v_mul_f32 v236, v236, v232
    v_mul_f32 v237, v237, v232
    v_accvgpr_write_b32 a88, v234
    v_accvgpr_write_b32 a89, v235
    v_accvgpr_write_b32 a90, v236
    v_accvgpr_write_b32 a91, v237
    v_accvgpr_read_b32 v234, a92
    v_accvgpr_read_b32 v235, a93
    v_accvgpr_read_b32 v236, a94
    v_accvgpr_read_b32 v237, a95
    v_mul_f32 v234, v234, v233
    v_mul_f32 v235, v235, v233
    v_mul_f32 v236, v236, v233
    v_mul_f32 v237, v237, v233
    v_accvgpr_write_b32 a92, v234
    v_accvgpr_write_b32 a93, v235
    v_accvgpr_write_b32 a94, v236
    v_accvgpr_write_b32 a95, v237
    v_accvgpr_read_b32 v234, a96
    v_accvgpr_read_b32 v235, a97
    v_accvgpr_read_b32 v236, a98
    v_accvgpr_read_b32 v237, a99
    v_mul_f32 v234, v234, v231
    v_mul_f32 v235, v235, v231
    v_mul_f32 v236, v236, v231
    v_mul_f32 v237, v237, v231
    v_accvgpr_write_b32 a96, v234
    v_accvgpr_write_b32 a97, v235
    v_accvgpr_write_b32 a98, v236
    v_accvgpr_write_b32 a99, v237
    v_accvgpr_read_b32 v234, a100
    v_accvgpr_read_b32 v235, a101
    v_accvgpr_read_b32 v236, a102
    v_accvgpr_read_b32 v237, a103
    v_mul_f32 v234, v234, v232
    v_mul_f32 v235, v235, v232
    v_mul_f32 v236, v236, v232
    v_mul_f32 v237, v237, v232
    v_accvgpr_write_b32 a100, v234
    v_accvgpr_write_b32 a101, v235
    v_accvgpr_write_b32 a102, v236
    v_accvgpr_write_b32 a103, v237
    v_accvgpr_read_b32 v234, a104
    v_accvgpr_read_b32 v235, a105
    v_accvgpr_read_b32 v236, a106
    v_accvgpr_read_b32 v237, a107
    v_mul_f32 v234, v234, v233
    v_mul_f32 v235, v235, v233
    v_mul_f32 v236, v236, v233
    v_mul_f32 v237, v237, v233
    v_accvgpr_write_b32 a104, v234
    v_accvgpr_write_b32 a105, v235
    v_accvgpr_write_b32 a106, v236
    v_accvgpr_write_b32 a107, v237
    v_accvgpr_read_b32 v234, a108
    v_accvgpr_read_b32 v235, a109
    v_accvgpr_read_b32 v236, a110
    v_accvgpr_read_b32 v237, a111
    v_mul_f32 v234, v234, v231
    v_mul_f32 v235, v235, v231
    v_mul_f32 v236, v236, v231
    v_mul_f32 v237, v237, v231
    v_accvgpr_write_b32 a108, v234
    v_accvgpr_write_b32 a109, v235
    v_accvgpr_write_b32 a110, v236
    v_accvgpr_write_b32 a111, v237
    v_accvgpr_read_b32 v234, a112
    v_accvgpr_read_b32 v235, a113
    v_accvgpr_read_b32 v236, a114
    v_accvgpr_read_b32 v237, a115
    v_mul_f32 v234, v234, v232
    v_mul_f32 v235, v235, v232
    v_mul_f32 v236, v236, v232
    v_mul_f32 v237, v237, v232
    v_accvgpr_write_b32 a112, v234
    v_accvgpr_write_b32 a113, v235
    v_accvgpr_write_b32 a114, v236
    v_accvgpr_write_b32 a115, v237
    v_accvgpr_read_b32 v234, a116
    v_accvgpr_read_b32 v235, a117
    v_accvgpr_read_b32 v236, a118
    v_accvgpr_read_b32 v237, a119
    v_mul_f32 v234, v234, v233
    v_mul_f32 v235, v235, v233
    v_mul_f32 v236, v236, v233
    v_mul_f32 v237, v237, v233
    v_accvgpr_write_b32 a116, v234
    v_accvgpr_write_b32 a117, v235
    v_accvgpr_write_b32 a118, v236
    v_accvgpr_write_b32 a119, v237
    v_accvgpr_read_b32 v234, a120
    v_accvgpr_read_b32 v235, a121
    v_accvgpr_read_b32 v236, a122
    v_accvgpr_read_b32 v237, a123
    v_mul_f32 v234, v234, v231
    v_mul_f32 v235, v235, v231
    v_mul_f32 v236, v236, v231
    v_mul_f32 v237, v237, v231
    v_accvgpr_write_b32 a120, v234
    v_accvgpr_write_b32 a121, v235
    v_accvgpr_write_b32 a122, v236
    v_accvgpr_write_b32 a123, v237
    v_accvgpr_read_b32 v234, a124
    v_accvgpr_read_b32 v235, a125
    v_accvgpr_read_b32 v236, a126
    v_accvgpr_read_b32 v237, a127
    v_mul_f32 v234, v234, v232
    v_mul_f32 v235, v235, v232
    v_mul_f32 v236, v236, v232
    v_mul_f32 v237, v237, v232
    v_accvgpr_write_b32 a124, v234
    v_accvgpr_write_b32 a125, v235
    v_accvgpr_write_b32 a126, v236
    v_accvgpr_write_b32 a127, v237
    v_accvgpr_read_b32 v234, a128
    v_accvgpr_read_b32 v235, a129
    v_accvgpr_read_b32 v236, a130
    v_accvgpr_read_b32 v237, a131
    v_mul_f32 v234, v234, v233
    v_mul_f32 v235, v235, v233
    v_mul_f32 v236, v236, v233
    v_mul_f32 v237, v237, v233
    v_accvgpr_write_b32 a128, v234
    v_accvgpr_write_b32 a129, v235
    v_accvgpr_write_b32 a130, v236
    v_accvgpr_write_b32 a131, v237
    v_accvgpr_read_b32 v234, a132
    v_accvgpr_read_b32 v235, a133
    v_accvgpr_read_b32 v236, a134
    v_accvgpr_read_b32 v237, a135
    v_mul_f32 v234, v234, v231
    v_mul_f32 v235, v235, v231
    v_mul_f32 v236, v236, v231
    v_mul_f32 v237, v237, v231
    v_accvgpr_write_b32 a132, v234
    v_accvgpr_write_b32 a133, v235
    v_accvgpr_write_b32 a134, v236
    v_accvgpr_write_b32 a135, v237
    v_accvgpr_read_b32 v234, a136
    v_accvgpr_read_b32 v235, a137
    v_accvgpr_read_b32 v236, a138
    v_accvgpr_read_b32 v237, a139
    v_mul_f32 v234, v234, v232
    v_mul_f32 v235, v235, v232
    v_mul_f32 v236, v236, v232
    v_mul_f32 v237, v237, v232
    v_accvgpr_write_b32 a136, v234
    v_accvgpr_write_b32 a137, v235
    v_accvgpr_write_b32 a138, v236
    v_accvgpr_write_b32 a139, v237
    v_accvgpr_read_b32 v234, a140
    v_accvgpr_read_b32 v235, a141
    v_accvgpr_read_b32 v236, a142
    v_accvgpr_read_b32 v237, a143
    v_mul_f32 v234, v234, v233
    v_mul_f32 v235, v235, v233
    v_mul_f32 v236, v236, v233
    v_mul_f32 v237, v237, v233
    v_accvgpr_write_b32 a140, v234
    v_accvgpr_write_b32 a141, v235
    v_accvgpr_write_b32 a142, v236
    v_accvgpr_write_b32 a143, v237
    v_accvgpr_read_b32 v234, a144
    v_accvgpr_read_b32 v235, a145
    v_accvgpr_read_b32 v236, a146
    v_accvgpr_read_b32 v237, a147
    v_mul_f32 v234, v234, v231
    v_mul_f32 v235, v235, v231
    v_mul_f32 v236, v236, v231
    v_mul_f32 v237, v237, v231
    v_accvgpr_write_b32 a144, v234
    v_accvgpr_write_b32 a145, v235
    v_accvgpr_write_b32 a146, v236
    v_accvgpr_write_b32 a147, v237
    v_accvgpr_read_b32 v234, a148
    v_accvgpr_read_b32 v235, a149
    v_accvgpr_read_b32 v236, a150
    v_accvgpr_read_b32 v237, a151
    v_mul_f32 v234, v234, v232
    v_mul_f32 v235, v235, v232
    v_mul_f32 v236, v236, v232
    v_mul_f32 v237, v237, v232
    v_accvgpr_write_b32 a148, v234
    v_accvgpr_write_b32 a149, v235
    v_accvgpr_write_b32 a150, v236
    v_accvgpr_write_b32 a151, v237
    v_accvgpr_read_b32 v234, a152
    v_accvgpr_read_b32 v235, a153
    v_accvgpr_read_b32 v236, a154
    v_accvgpr_read_b32 v237, a155
    v_mul_f32 v234, v234, v233
    v_mul_f32 v235, v235, v233
    v_mul_f32 v236, v236, v233
    v_mul_f32 v237, v237, v233
    v_accvgpr_write_b32 a152, v234
    v_accvgpr_write_b32 a153, v235
    v_accvgpr_write_b32 a154, v236
    v_accvgpr_write_b32 a155, v237
    v_accvgpr_read_b32 v234, a156
    v_accvgpr_read_b32 v235, a157
    v_accvgpr_read_b32 v236, a158
    v_accvgpr_read_b32 v237, a159
    v_mul_f32 v234, v234, v231
    v_mul_f32 v235, v235, v231
    v_mul_f32 v236, v236, v231
    v_mul_f32 v237, v237, v231
    v_accvgpr_write_b32 a156, v234
    v_accvgpr_write_b32 a157, v235
    v_accvgpr_write_b32 a158, v236
    v_accvgpr_write_b32 a159, v237
    v_accvgpr_read_b32 v234, a160
    v_accvgpr_read_b32 v235, a161
    v_accvgpr_read_b32 v236, a162
    v_accvgpr_read_b32 v237, a163
    v_mul_f32 v234, v234, v232
    v_mul_f32 v235, v235, v232
    v_mul_f32 v236, v236, v232
    v_mul_f32 v237, v237, v232
    v_accvgpr_write_b32 a160, v234
    v_accvgpr_write_b32 a161, v235
    v_accvgpr_write_b32 a162, v236
    v_accvgpr_write_b32 a163, v237
    v_accvgpr_read_b32 v234, a164
    v_accvgpr_read_b32 v235, a165
    v_accvgpr_read_b32 v236, a166
    v_accvgpr_read_b32 v237, a167
    v_mul_f32 v234, v234, v233
    v_mul_f32 v235, v235, v233
    v_mul_f32 v236, v236, v233
    v_mul_f32 v237, v237, v233
    v_accvgpr_write_b32 a164, v234
    v_accvgpr_write_b32 a165, v235
    v_accvgpr_write_b32 a166, v236
    v_accvgpr_write_b32 a167, v237
    v_accvgpr_read_b32 v234, a168
    v_accvgpr_read_b32 v235, a169
    v_accvgpr_read_b32 v236, a170
    v_accvgpr_read_b32 v237, a171
    v_mul_f32 v234, v234, v231
    v_mul_f32 v235, v235, v231
    v_mul_f32 v236, v236, v231
    v_mul_f32 v237, v237, v231
    v_accvgpr_write_b32 a168, v234
    v_accvgpr_write_b32 a169, v235
    v_accvgpr_write_b32 a170, v236
    v_accvgpr_write_b32 a171, v237
    v_accvgpr_read_b32 v234, a172
    v_accvgpr_read_b32 v235, a173
    v_accvgpr_read_b32 v236, a174
    v_accvgpr_read_b32 v237, a175
    v_mul_f32 v234, v234, v232
    v_mul_f32 v235, v235, v232
    v_mul_f32 v236, v236, v232
    v_mul_f32 v237, v237, v232
    v_accvgpr_write_b32 a172, v234
    v_accvgpr_write_b32 a173, v235
    v_accvgpr_write_b32 a174, v236
    v_accvgpr_write_b32 a175, v237
    v_accvgpr_read_b32 v234, a176
    v_accvgpr_read_b32 v235, a177
    v_accvgpr_read_b32 v236, a178
    v_accvgpr_read_b32 v237, a179
    v_mul_f32 v234, v234, v233
    v_mul_f32 v235, v235, v233
    v_mul_f32 v236, v236, v233
    v_mul_f32 v237, v237, v233
    v_accvgpr_write_b32 a176, v234
    v_accvgpr_write_b32 a177, v235
    v_accvgpr_write_b32 a178, v236
    v_accvgpr_write_b32 a179, v237
    v_accvgpr_read_b32 v234, a180
    v_accvgpr_read_b32 v235, a181
    v_accvgpr_read_b32 v236, a182
    v_accvgpr_read_b32 v237, a183
    v_mul_f32 v234, v234, v231
    v_mul_f32 v235, v235, v231
    v_mul_f32 v236, v236, v231
    v_mul_f32 v237, v237, v231
    v_accvgpr_write_b32 a180, v234
    v_accvgpr_write_b32 a181, v235
    v_accvgpr_write_b32 a182, v236
    v_accvgpr_write_b32 a183, v237
    v_accvgpr_read_b32 v234, a184
    v_accvgpr_read_b32 v235, a185
    v_accvgpr_read_b32 v236, a186
    v_accvgpr_read_b32 v237, a187
    v_mul_f32 v234, v234, v232
    v_mul_f32 v235, v235, v232
    v_mul_f32 v236, v236, v232
    v_mul_f32 v237, v237, v232
    v_accvgpr_write_b32 a184, v234
    v_accvgpr_write_b32 a185, v235
    v_accvgpr_write_b32 a186, v236
    v_accvgpr_write_b32 a187, v237
    v_accvgpr_read_b32 v234, a188
    v_accvgpr_read_b32 v235, a189
    v_accvgpr_read_b32 v236, a190
    v_accvgpr_read_b32 v237, a191
    v_mul_f32 v234, v234, v233
    v_mul_f32 v235, v235, v233
    v_mul_f32 v236, v236, v233
    v_mul_f32 v237, v237, v233
    v_accvgpr_write_b32 a188, v234
    v_accvgpr_write_b32 a189, v235
    v_accvgpr_write_b32 a190, v236
    v_accvgpr_write_b32 a191, v237
    s_nop 1
    v_mfma_f32_16x16x32_bf16 v[128:131], a[192:195], v[96:99], v[132:135]
    v_mfma_f32_16x16x32_bf16 v[128:131], a[196:199], v[100:103], v[128:131]
    v_mfma_f32_16x16x32_bf16 v[128:131], a[200:203], v[104:107], v[128:131]
    s_nop 7
    s_setpc_b64 s[54:55]
L_rare1:
    s_nop 7
    v_max3_f32 v228, v192, v193, v194
    v_max3_f32 v228, v228, v195, v204
    v_max3_f32 v228, v228, v205, v206
    v_max_f32 v228, v228, v207
    v_max3_f32 v229, v196, v197, v198
    v_max3_f32 v229, v229, v199, v208
    v_max3_f32 v229, v229, v209, v210
    v_max_f32 v229, v229, v211
    v_max3_f32 v230, v200, v201, v202
    v_max3_f32 v230, v230, v203, v212
    v_max3_f32 v230, v230, v213, v214
    v_max_f32 v230, v230, v215
    v_mov_b32 v234, v228
    v_mov_b32 v235, v229
    v_mov_b32 v236, v230
    s_nop 1
    v_permlane32_swap_b32 v234, v228
    v_permlane32_swap_b32 v235, v229
    v_permlane32_swap_b32 v236, v230
    v_max_f32 v228, v228, v234
    v_max_f32 v229, v229, v235
    v_max_f32 v230, v230, v236
    v_mov_b32 v234, v228
    v_mov_b32 v235, v229
    v_mov_b32 v236, v230
    s_nop 1
    v_permlane16_swap_b32 v234, v228
    v_permlane16_swap_b32 v235, v229
    v_permlane16_swap_b32 v236, v230
    v_max_f32 v228, v228, v234
    v_max_f32 v229, v229, v235
    v_max_f32 v230, v230, v236
    v_max_f32 v228, 0, v228
    v_max_f32 v229, 0, v229
    v_max_f32 v230, 0, v230
    v_exp_f32 v231, -v228
    v_exp_f32 v232, -v229
    v_exp_f32 v233, -v230
    v_sub_f32 v216, v216, v228
    v_sub_f32 v217, v217, v228
    v_sub_f32 v218, v218, v228
    v_sub_f32 v219, v219, v228
    v_sub_f32 v192, v192, v228
    v_sub_f32 v193, v193, v228
    v_sub_f32 v194, v194, v228
    v_sub_f32 v195, v195, v228
    v_sub_f32 v204, v204, v228
    v_sub_f32 v205, v205, v228
    v_sub_f32 v206, v206, v228
    v_sub_f32 v207, v207, v228
    v_mul_f32 v128, v128, v231
    v_sub_f32 v220, v220, v229
    v_sub_f32 v221, v221, v229
    v_sub_f32 v222, v222, v229
    v_sub_f32 v223, v223, v229
    v_sub_f32 v196, v196, v229
    v_sub_f32 v197, v197, v229
    v_sub_f32 v198, v198, v229
    v_sub_f32 v199, v199, v229
    v_sub_f32 v208, v208, v229
    v_sub_f32 v209, v209, v229
    v_sub_f32 v210, v210, v229
    v_sub_f32 v211, v211, v229
    v_mul_f32 v129, v129, v232
    v_sub_f32 v224, v224, v230
    v_sub_f32 v225, v225, v230
    v_sub_f32 v226, v226, v230
    v_sub_f32 v227, v227, v230
    v_sub_f32 v200, v200, v230
    v_sub_f32 v201, v201, v230
    v_sub_f32 v202, v202, v230
    v_sub_f32 v203, v203, v230
    v_sub_f32 v212, v212, v230
    v_sub_f32 v213, v213, v230
    v_sub_f32 v214, v214, v230
    v_sub_f32 v215, v215, v230
    v_mul_f32 v130, v130, v233
    v_exp_f32 v120, v192
    v_exp_f32 v121, v193
    v_exp_f32 v122, v194
    v_cvt_pk_bf16_f32 v108, v120, v121
    v_exp_f32 v123, v195
    v_exp_f32 v124, v196
    v_cvt_pk_bf16_f32 v109, v122, v123
    v_exp_f32 v125, v197
    v_exp_f32 v126, v198
    v_cvt_pk_bf16_f32 v112, v124, v125
    v_exp_f32 v127, v199
    v_exp_f32 v120, v200
    v_cvt_pk_bf16_f32 v113, v126, v127
    v_exp_f32 v121, v201
    v_exp_f32 v122, v202
    v_cvt_pk_bf16_f32 v116, v120, v121
    v_exp_f32 v123, v203
    s_nop 0
    v_cvt_pk_bf16_f32 v117, v122, v123
    v_exp_f32 v124, v204
    v_exp_f32 v125, v205
    v_exp_f32 v126, v206
    v_cvt_pk_bf16_f32 v110, v124, v125
    v_exp_f32 v127, v207
    v_exp_f32 v120, v208
    v_cvt_pk_bf16_f32 v111, v126, v127
    v_exp_f32 v121, v209
    v_exp_f32 v122, v210
    v_cvt_pk_bf16_f32 v114, v120, v121
    v_exp_f32 v123, v211
    v_exp_f32 v124, v212
    v_cvt_pk_bf16_f32 v115, v122, v123
    v_exp_f32 v125, v213
    v_exp_f32 v126, v214
    v_cvt_pk_bf16_f32 v118, v124, v125
    v_exp_f32 v127, v215
    s_nop 0
    v_cvt_pk_bf16_f32 v119, v126, v127
    v_mul_f32 v144, v144, v231
    v_mul_f32 v145, v145, v231
    v_mul_f32 v146, v146, v231
    v_mul_f32 v147, v147, v231
    v_mul_f32 v148, v148, v232
    v_mul_f32 v149, v149, v232
    v_mul_f32 v150, v150, v232
    v_mul_f32 v151, v151, v232
    v_mul_f32 v152, v152, v233
    v_mul_f32 v153, v153, v233
    v_mul_f32 v154, v154, v233
    v_mul_f32 v155, v155, v233
    v_mul_f32 v156, v156, v231
    v_mul_f32 v157, v157, v231
    v_mul_f32 v158, v158, v231
    v_mul_f32 v159, v159, v231
    v_mul_f32 v160, v160, v232
    v_mul_f32 v161, v161, v232
    v_mul_f32 v162, v162, v232
    v_mul_f32 v163, v163, v232
    v_mul_f32 v164, v164, v233
    v_mul_f32 v165, v165, v233
    v_mul_f32 v166, v166, v233
    v_mul_f32 v167, v167, v233
    v_mul_f32 v168, v168, v231
    v_mul_f32 v169, v169, v231
    v_mul_f32 v170, v170, v231
    v_mul_f32 v171, v171, v231
    v_mul_f32 v172, v172, v232
    v_mul_f32 v173, v173, v232
    v_mul_f32 v174, v174, v232
    v_mul_f32 v175, v175, v232
    v_mul_f32 v176, v176, v233
    v_mul_f32 v177, v177, v233
    v_mul_f32 v178, v178, v233
    v_mul_f32 v179, v179, v233
    v_mul_f32 v180, v180, v231
    v_mul_f32 v181, v181, v231
    v_mul_f32 v182, v182, v231
    v_mul_f32 v183, v183, v231
    v_mul_f32 v184, v184, v232
    v_mul_f32 v185, v185, v232
    v_mul_f32 v186, v186, v232
    v_mul_f32 v187, v187, v232
    v_mul_f32 v188, v188, v233
    v_mul_f32 v189, v189, v233
    v_mul_f32 v190, v190, v233
    v_mul_f32 v191, v191, v233
    v_accvgpr_read_b32 v234, a48
    v_accvgpr_read_b32 v235, a49
    v_accvgpr_read_b32 v236, a50
    v_accvgpr_read_b32 v237, a51
    v_mul_f32 v234, v234, v231
    v_mul_f32 v235, v235, v231
    v_mul_f32 v236, v236, v231
    v_mul_f32 v237, v237, v231
    v_accvgpr_write_b32 a48, v234
    v_accvgpr_write_b32 a49, v235
    v_accvgpr_write_b32 a50, v236
    v_accvgpr_write_b32 a51, v237
    v_accvgpr_read_b32 v234, a52
    v_accvgpr_read_b32 v235, a53
    v_accvgpr_read_b32 v236, a54
    v_accvgpr_read_b32 v237, a55
    v_mul_f32 v234, v234, v232
    v_mul_f32 v235, v235, v232
    v_mul_f32 v236, v236, v232
    v_mul_f32 v237, v237, v232
    v_accvgpr_write_b32 a52, v234
    v_accvgpr_write_b32 a53, v235
    v_accvgpr_write_b32 a54, v236
    v_accvgpr_write_b32 a55, v237
    v_accvgpr_read_b32 v234, a56
    v_accvgpr_read_b32 v235, a57
    v_accvgpr_read_b32 v236, a58
    v_accvgpr_read_b32 v237, a59
    v_mul_f32 v234, v234, v233
    v_mul_f32 v235, v235, v233
    v_mul_f32 v236, v236, v233
    v_mul_f32 v237, v237, v233
    v_accvgpr_write_b32 a56, v234
    v_accvgpr_write_b32 a57, v235
    v_accvgpr_write_b32 a58, v236
    v_accvgpr_write_b32 a59, v237
    v_accvgpr_read_b32 v234, a60
    v_accvgpr_read_b32 v235, a61
    v_accvgpr_read_b32 v236, a62
    v_accvgpr_read_b32 v237, a63
    v_mul_f32 v234, v234, v231
    v_mul_f32 v235, v235, v231
    v_mul_f32 v236, v236, v231
    v_mul_f32 v237, v237, v231
    v_accvgpr_write_b32 a60, v234
    v_accvgpr_write_b32 a61, v235
    v_accvgpr_write_b32 a62, v236
    v_accvgpr_write_b32 a63, v237
    v_accvgpr_read_b32 v234, a64
    v_accvgpr_read_b32 v235, a65
    v_accvgpr_read_b32 v236, a66
    v_accvgpr_read_b32 v237, a67
    v_mul_f32 v234, v234, v232
    v_mul_f32 v235, v235, v232
    v_mul_f32 v236, v236, v232
    v_mul_f32 v237, v237, v232
    v_accvgpr_write_b32 a64, v234
    v_accvgpr_write_b32 a65, v235
    v_accvgpr_write_b32 a66, v236
    v_accvgpr_write_b32 a67, v237
    v_accvgpr_read_b32 v234, a68
    v_accvgpr_read_b32 v235, a69
    v_accvgpr_read_b32 v236, a70
    v_accvgpr_read_b32 v237, a71
    v_mul_f32 v234, v234, v233
    v_mul_f32 v235, v235, v233
    v_mul_f32 v236, v236, v233
    v_mul_f32 v237, v237, v233
    v_accvgpr_write_b32 a68, v234
    v_accvgpr_write_b32 a69, v235
    v_accvgpr_write_b32 a70, v236
    v_accvgpr_write_b32 a71, v237
    v_accvgpr_read_b32 v234, a72
    v_accvgpr_read_b32 v235, a73
    v_accvgpr_read_b32 v236, a74
    v_accvgpr_read_b32 v237, a75
    v_mul_f32 v234, v234, v231
    v_mul_f32 v235, v235, v231
    v_mul_f32 v236, v236, v231
    v_mul_f32 v237, v237, v231
    v_accvgpr_write_b32 a72, v234
    v_accvgpr_write_b32 a73, v235
    v_accvgpr_write_b32 a74, v236
    v_accvgpr_write_b32 a75, v237
    v_accvgpr_read_b32 v234, a76
    v_accvgpr_read_b32 v235, a77
    v_accvgpr_read_b32 v236, a78
    v_accvgpr_read_b32 v237, a79
    v_mul_f32 v234, v234, v232
    v_mul_f32 v235, v235, v232
    v_mul_f32 v236, v236, v232
    v_mul_f32 v237, v237, v232
    v_accvgpr_write_b32 a76, v234
    v_accvgpr_write_b32 a77, v235
    v_accvgpr_write_b32 a78, v236
    v_accvgpr_write_b32 a79, v237
    v_accvgpr_read_b32 v234, a80
    v_accvgpr_read_b32 v235, a81
    v_accvgpr_read_b32 v236, a82
    v_accvgpr_read_b32 v237, a83
    v_mul_f32 v234, v234, v233
    v_mul_f32 v235, v235, v233
    v_mul_f32 v236, v236, v233
    v_mul_f32 v237, v237, v233
    v_accvgpr_write_b32 a80, v234
    v_accvgpr_write_b32 a81, v235
    v_accvgpr_write_b32 a82, v236
    v_accvgpr_write_b32 a83, v237
    v_accvgpr_read_b32 v234, a84
    v_accvgpr_read_b32 v235, a85
    v_accvgpr_read_b32 v236, a86
    v_accvgpr_read_b32 v237, a87
    v_mul_f32 v234, v234, v231
    v_mul_f32 v235, v235, v231
    v_mul_f32 v236, v236, v231
    v_mul_f32 v237, v237, v231
    v_accvgpr_write_b32 a84, v234
    v_accvgpr_write_b32 a85, v235
    v_accvgpr_write_b32 a86, v236
    v_accvgpr_write_b32 a87, v237
    v_accvgpr_read_b32 v234, a88
    v_accvgpr_read_b32 v235, a89
    v_accvgpr_read_b32 v236, a90
    v_accvgpr_read_b32 v237, a91
    v_mul_f32 v234, v234, v232
    v_mul_f32 v235, v235, v232
    v_mul_f32 v236, v236, v232
    v_mul_f32 v237, v237, v232
    v_accvgpr_write_b32 a88, v234
    v_accvgpr_write_b32 a89, v235
    v_accvgpr_write_b32 a90, v236
    v_accvgpr_write_b32 a91, v237
    v_accvgpr_read_b32 v234, a92
    v_accvgpr_read_b32 v235, a93
    v_accvgpr_read_b32 v236, a94
    v_accvgpr_read_b32 v237, a95
    v_mul_f32 v234, v234, v233
    v_mul_f32 v235, v235, v233
    v_mul_f32 v236, v236, v233
    v_mul_f32 v237, v237, v233
    v_accvgpr_write_b32 a92, v234
    v_accvgpr_write_b32 a93, v235
    v_accvgpr_write_b32 a94, v236
    v_accvgpr_write_b32 a95, v237
    v_accvgpr_read_b32 v234, a96
    v_accvgpr_read_b32 v235, a97
    v_accvgpr_read_b32 v236, a98
    v_accvgpr_read_b32 v237, a99
    v_mul_f32 v234, v234, v231
    v_mul_f32 v235, v235, v231
    v_mul_f32 v236, v236, v231
    v_mul_f32 v237, v237, v231
    v_accvgpr_write_b32 a96, v234
    v_accvgpr_write_b32 a97, v235
    v_accvgpr_write_b32 a98, v236
    v_accvgpr_write_b32 a99, v237
    v_accvgpr_read_b32 v234, a100
    v_accvgpr_read_b32 v235, a101
    v_accvgpr_read_b32 v236, a102
    v_accvgpr_read_b32 v237, a103
    v_mul_f32 v234, v234, v232
    v_mul_f32 v235, v235, v232
    v_mul_f32 v236, v236, v232
    v_mul_f32 v237, v237, v232
    v_accvgpr_write_b32 a100, v234
    v_accvgpr_write_b32 a101, v235
    v_accvgpr_write_b32 a102, v236
    v_accvgpr_write_b32 a103, v237
    v_accvgpr_read_b32 v234, a104
    v_accvgpr_read_b32 v235, a105
    v_accvgpr_read_b32 v236, a106
    v_accvgpr_read_b32 v237, a107
    v_mul_f32 v234, v234, v233
    v_mul_f32 v235, v235, v233
    v_mul_f32 v236, v236, v233
    v_mul_f32 v237, v237, v233
    v_accvgpr_write_b32 a104, v234
    v_accvgpr_write_b32 a105, v235
    v_accvgpr_write_b32 a106, v236
    v_accvgpr_write_b32 a107, v237
    v_accvgpr_read_b32 v234, a108
    v_accvgpr_read_b32 v235, a109
    v_accvgpr_read_b32 v236, a110
    v_accvgpr_read_b32 v237, a111
    v_mul_f32 v234, v234, v231
    v_mul_f32 v235, v235, v231
    v_mul_f32 v236, v236, v231
    v_mul_f32 v237, v237, v231
    v_accvgpr_write_b32 a108, v234
    v_accvgpr_write_b32 a109, v235
    v_accvgpr_write_b32 a110, v236
    v_accvgpr_write_b32 a111, v237
    v_accvgpr_read_b32 v234, a112
    v_accvgpr_read_b32 v235, a113
    v_accvgpr_read_b32 v236, a114
    v_accvgpr_read_b32 v237, a115
    v_mul_f32 v234, v234, v232
    v_mul_f32 v235, v235, v232
    v_mul_f32 v236, v236, v232
    v_mul_f32 v237, v237, v232
    v_accvgpr_write_b32 a112, v234
    v_accvgpr_write_b32 a113, v235
    v_accvgpr_write_b32 a114, v236
    v_accvgpr_write_b32 a115, v237
    v_accvgpr_read_b32 v234, a116
    v_accvgpr_read_b32 v235, a117
    v_accvgpr_read_b32 v236, a118
    v_accvgpr_read_b32 v237, a119
    v_mul_f32 v234, v234, v233
    v_mul_f32 v235, v235, v233
    v_mul_f32 v236, v236, v233
    v_mul_f32 v237, v237, v233
    v_accvgpr_write_b32 a116, v234
    v_accvgpr_write_b32 a117, v235
    v_accvgpr_write_b32 a118, v236
    v_accvgpr_write_b32 a119, v237
    v_accvgpr_read_b32 v234, a120
    v_accvgpr_read_b32 v235, a121
    v_accvgpr_read_b32 v236, a122
    v_accvgpr_read_b32 v237, a123
    v_mul_f32 v234, v234, v231
    v_mul_f32 v235, v235, v231
    v_mul_f32 v236, v236, v231
    v_mul_f32 v237, v237, v231
    v_accvgpr_write_b32 a120, v234
    v_accvgpr_write_b32 a121, v235
    v_accvgpr_write_b32 a122, v236
    v_accvgpr_write_b32 a123, v237
    v_accvgpr_read_b32 v234, a124
    v_accvgpr_read_b32 v235, a125
    v_accvgpr_read_b32 v236, a126
    v_accvgpr_read_b32 v237, a127
    v_mul_f32 v234, v234, v232
    v_mul_f32 v235, v235, v232
    v_mul_f32 v236, v236, v232
    v_mul_f32 v237, v237, v232
    v_accvgpr_write_b32 a124, v234
    v_accvgpr_write_b32 a125, v235
    v_accvgpr_write_b32 a126, v236
    v_accvgpr_write_b32 a127, v237
    v_accvgpr_read_b32 v234, a128
    v_accvgpr_read_b32 v235, a129
    v_accvgpr_read_b32 v236, a130
    v_accvgpr_read_b32 v237, a131
    v_mul_f32 v234, v234, v233
    v_mul_f32 v235, v235, v233
    v_mul_f32 v236, v236, v233
    v_mul_f32 v237, v237, v233
    v_accvgpr_write_b32 a128, v234
    v_accvgpr_write_b32 a129, v235
    v_accvgpr_write_b32 a130, v236
    v_accvgpr_write_b32 a131, v237
    v_accvgpr_read_b32 v234, a132
    v_accvgpr_read_b32 v235, a133
    v_accvgpr_read_b32 v236, a134
    v_accvgpr_read_b32 v237, a135
    v_mul_f32 v234, v234, v231
    v_mul_f32 v235, v235, v231
    v_mul_f32 v236, v236, v231
    v_mul_f32 v237, v237, v231
    v_accvgpr_write_b32 a132, v234
    v_accvgpr_write_b32 a133, v235
    v_accvgpr_write_b32 a134, v236
    v_accvgpr_write_b32 a135, v237
    v_accvgpr_read_b32 v234, a136
    v_accvgpr_read_b32 v235, a137
    v_accvgpr_read_b32 v236, a138
    v_accvgpr_read_b32 v237, a139
    v_mul_f32 v234, v234, v232
    v_mul_f32 v235, v235, v232
    v_mul_f32 v236, v236, v232
    v_mul_f32 v237, v237, v232
    v_accvgpr_write_b32 a136, v234
    v_accvgpr_write_b32 a137, v235
    v_accvgpr_write_b32 a138, v236
    v_accvgpr_write_b32 a139, v237
    v_accvgpr_read_b32 v234, a140
    v_accvgpr_read_b32 v235, a141
    v_accvgpr_read_b32 v236, a142
    v_accvgpr_read_b32 v237, a143
    v_mul_f32 v234, v234, v233
    v_mul_f32 v235, v235, v233
    v_mul_f32 v236, v236, v233
    v_mul_f32 v237, v237, v233
    v_accvgpr_write_b32 a140, v234
    v_accvgpr_write_b32 a141, v235
    v_accvgpr_write_b32 a142, v236
    v_accvgpr_write_b32 a143, v237
    v_accvgpr_read_b32 v234, a144
    v_accvgpr_read_b32 v235, a145
    v_accvgpr_read_b32 v236, a146
    v_accvgpr_read_b32 v237, a147
    v_mul_f32 v234, v234, v231
    v_mul_f32 v235, v235, v231
    v_mul_f32 v236, v236, v231
    v_mul_f32 v237, v237, v231
    v_accvgpr_write_b32 a144, v234
    v_accvgpr_write_b32 a145, v235
    v_accvgpr_write_b32 a146, v236
    v_accvgpr_write_b32 a147, v237
    v_accvgpr_read_b32 v234, a148
    v_accvgpr_read_b32 v235, a149
    v_accvgpr_read_b32 v236, a150
    v_accvgpr_read_b32 v237, a151
    v_mul_f32 v234, v234, v232
    v_mul_f32 v235, v235, v232
    v_mul_f32 v236, v236, v232
    v_mul_f32 v237, v237, v232
    v_accvgpr_write_b32 a148, v234
    v_accvgpr_write_b32 a149, v235
    v_accvgpr_write_b32 a150, v236
    v_accvgpr_write_b32 a151, v237
    v_accvgpr_read_b32 v234, a152
    v_accvgpr_read_b32 v235, a153
    v_accvgpr_read_b32 v236, a154
    v_accvgpr_read_b32 v237, a155
    v_mul_f32 v234, v234, v233
    v_mul_f32 v235, v235, v233
    v_mul_f32 v236, v236, v233
    v_mul_f32 v237, v237, v233
    v_accvgpr_write_b32 a152, v234
    v_accvgpr_write_b32 a153, v235
    v_accvgpr_write_b32 a154, v236
    v_accvgpr_write_b32 a155, v237
    v_accvgpr_read_b32 v234, a156
    v_accvgpr_read_b32 v235, a157
    v_accvgpr_read_b32 v236, a158
    v_accvgpr_read_b32 v237, a159
    v_mul_f32 v234, v234, v231
    v_mul_f32 v235, v235, v231
    v_mul_f32 v236, v236, v231
    v_mul_f32 v237, v237, v231
    v_accvgpr_write_b32 a156, v234
    v_accvgpr_write_b32 a157, v235
    v_accvgpr_write_b32 a158, v236
    v_accvgpr_write_b32 a159, v237
    v_accvgpr_read_b32 v234, a160
    v_accvgpr_read_b32 v235, a161
    v_accvgpr_read_b32 v236, a162
    v_accvgpr_read_b32 v237, a163
    v_mul_f32 v234, v234, v232
    v_mul_f32 v235, v235, v232
    v_mul_f32 v236, v236, v232
    v_mul_f32 v237, v237, v232
    v_accvgpr_write_b32 a160, v234
    v_accvgpr_write_b32 a161, v235
    v_accvgpr_write_b32 a162, v236
    v_accvgpr_write_b32 a163, v237
    v_accvgpr_read_b32 v234, a164
    v_accvgpr_read_b32 v235, a165
    v_accvgpr_read_b32 v236, a166
    v_accvgpr_read_b32 v237, a167
    v_mul_f32 v234, v234, v233
    v_mul_f32 v235, v235, v233
    v_mul_f32 v236, v236, v233
    v_mul_f32 v237, v237, v233
    v_accvgpr_write_b32 a164, v234
    v_accvgpr_write_b32 a165, v235
    v_accvgpr_write_b32 a166, v236
    v_accvgpr_write_b32 a167, v237
    v_accvgpr_read_b32 v234, a168
    v_accvgpr_read_b32 v235, a169
    v_accvgpr_read_b32 v236, a170
    v_accvgpr_read_b32 v237, a171
    v_mul_f32 v234, v234, v231
    v_mul_f32 v235, v235, v231
    v_mul_f32 v236, v236, v231
    v_mul_f32 v237, v237, v231
    v_accvgpr_write_b32 a168, v234
    v_accvgpr_write_b32 a169, v235
    v_accvgpr_write_b32 a170, v236
    v_accvgpr_write_b32 a171, v237
    v_accvgpr_read_b32 v234, a172
    v_accvgpr_read_b32 v235, a173
    v_accvgpr_read_b32 v236, a174
    v_accvgpr_read_b32 v237, a175
    v_mul_f32 v234, v234, v232
    v_mul_f32 v235, v235, v232
    v_mul_f32 v236, v236, v232
    v_mul_f32 v237, v237, v232
    v_accvgpr_write_b32 a172, v234
    v_accvgpr_write_b32 a173, v235
    v_accvgpr_write_b32 a174, v236
    v_accvgpr_write_b32 a175, v237
    v_accvgpr_read_b32 v234, a176
    v_accvgpr_read_b32 v235, a177
    v_accvgpr_read_b32 v236, a178
    v_accvgpr_read_b32 v237, a179
    v_mul_f32 v234, v234, v233
    v_mul_f32 v235, v235, v233
    v_mul_f32 v236, v236, v233
    v_mul_f32 v237, v237, v233
    v_accvgpr_write_b32 a176, v234
    v_accvgpr_write_b32 a177, v235
    v_accvgpr_write_b32 a178, v236
    v_accvgpr_write_b32 a179, v237
    v_accvgpr_read_b32 v234, a180
    v_accvgpr_read_b32 v235, a181
    v_accvgpr_read_b32 v236, a182
    v_accvgpr_read_b32 v237, a183
    v_mul_f32 v234, v234, v231
    v_mul_f32 v235, v235, v231
    v_mul_f32 v236, v236, v231
    v_mul_f32 v237, v237, v231
    v_accvgpr_write_b32 a180, v234
    v_accvgpr_write_b32 a181, v235
    v_accvgpr_write_b32 a182, v236
    v_accvgpr_write_b32 a183, v237
    v_accvgpr_read_b32 v234, a184
    v_accvgpr_read_b32 v235, a185
    v_accvgpr_read_b32 v236, a186
    v_accvgpr_read_b32 v237, a187
    v_mul_f32 v234, v234, v232
    v_mul_f32 v235, v235, v232
    v_mul_f32 v236, v236, v232
    v_mul_f32 v237, v237, v232
    v_accvgpr_write_b32 a184, v234
    v_accvgpr_write_b32 a185, v235
    v_accvgpr_write_b32 a186, v236
    v_accvgpr_write_b32 a187, v237
    v_accvgpr_read_b32 v234, a188
    v_accvgpr_read_b32 v235, a189
    v_accvgpr_read_b32 v236, a190
    v_accvgpr_read_b32 v237, a191
    v_mul_f32 v234, v234, v233
    v_mul_f32 v235, v235, v233
    v_mul_f32 v236, v236, v233
    v_mul_f32 v237, v237, v233
    v_accvgpr_write_b32 a188, v234
    v_accvgpr_write_b32 a189, v235
    v_accvgpr_write_b32 a190, v236
    v_accvgpr_write_b32 a191, v237
    s_nop 1
    v_mfma_f32_16x16x32_bf16 v[132:135], a[192:195], v[108:111], v[128:131]
    v_mfma_f32_16x16x32_bf16 v[132:135], a[196:199], v[112:115], v[132:135]
    v_mfma_f32_16x16x32_bf16 v[132:135], a[200:203], v[116:119], v[132:135]
    s_nop 7
    s_setpc_b64 s[54:55]
.fill 2048, 4, 0xbf810000
.section .rodata,"a"
.p2align 6
.amdhsa_kernel concat_heads__mha_block_cached__gqa_block_cached__near_ridge_kernel
  .amdhsa_next_free_vgpr 512
  .amdhsa_next_free_sgpr 102
  .amdhsa_accum_offset 256
  .amdhsa_group_segment_fixed_size 0
  .amdhsa_kernarg_size 104
  .amdhsa_user_sgpr_count 2
  .amdhsa_user_sgpr_kernarg_segment_ptr 1
  .amdhsa_system_sgpr_workgroup_id_x 1
  .amdhsa_float_denorm_mode_32 3
.end_amdhsa_kernel
```
